```python
import torch

def _softmax(x, axis=-1):
    return torch.softmax(x, dim=axis)
def _gelu(x):
    return torch.nn.functional.gelu(x, approximate="tanh")
def _silu(x):
    return torch.nn.functional.silu(x)
def _sigmoid(x):
    return torch.sigmoid(x)
def _layernorm(x, axis=-1, eps=1e-5):
    m = x.mean(dim=axis, keepdim=True)
    v = x.var(dim=axis, keepdim=True, unbiased=False)
    return (x - m) / torch.sqrt(v + eps)
def _scatter_add(tgt, idx, src, axis=0):
    return tgt.clone().index_add_(axis, idx, src)
def _segment_sum(src, seg, n):
    out = torch.zeros((n,) + src.shape[1:], dtype=src.dtype)
    return out.index_add_(0, seg, src)
def _pad(x, pw):
    flat = tuple(v for pair in reversed(pw) for v in pair)
    return torch.nn.functional.pad(x, flat)

kernel_name = 'recurrent_scan__mha_block_cached__glu_gated_swiglu__prompt'

def setup_inputs():

    _w = (lambda a: (lambda t: t.to(torch.bfloat16) if t.is_floating_point() else t)(torch.as_tensor(a)))
    def _A_setup():
        B, Sq, D = 1, 2048, 448
        H, Sk, Dh = 16, 2048, 256
        return {
            "x": _w((lambda *s: torch.randn(*s, dtype=torch.bfloat16) * 0.05)(B, Sq, D)),
            "k_cache": _w((lambda *s: torch.randn(*s, dtype=torch.bfloat16) * 1.6)(B, H, Sk, Dh)),
            "v_cache": _w((lambda *s: torch.randn(*s, dtype=torch.bfloat16) * 1.6)(B, H, Sk, Dh)),
            "wq": _w((lambda *s: torch.randn(*s, dtype=torch.bfloat16) * 1.6)(D, H * Dh) * (D ** -0.5)),
            "wo": _w((lambda *s: torch.randn(*s, dtype=torch.bfloat16) * 1.6)(H * Dh, D) * ((H * Dh) ** -0.5)),
        }
    _A_in = _A_setup()

    def _B_setup():
        B, S, D, F = 1, 2048, 448, 1792
        return {
            "x": _w((lambda *s: torch.randn(*s, dtype=torch.bfloat16) * 0.05)(B, S, D)),
            "w1": _w((lambda *s: torch.randn(*s, dtype=torch.bfloat16) * 0.2)(D, F) * (2.0 / D) ** 0.5),
            "w3": _w((lambda *s: torch.randn(*s, dtype=torch.bfloat16) * 0.2)(D, F) * (2.0 / D) ** 0.5),
            "w2": _w((lambda *s: torch.randn(*s, dtype=torch.bfloat16) * 0.2)(F, D) * (2.0 / F) ** 0.5),
        }
    _B_in = _B_setup()

    return {
        "A_x": _A_in["x"],
        "A_k_cache": _A_in["k_cache"],
        "A_v_cache": _A_in["v_cache"],
        "A_wq": _A_in["wq"],
        "A_wo": _A_in["wo"],
        "B_x": _B_in["x"],
        "B_w1": _B_in["w1"],
        "B_w3": _B_in["w3"],
        "B_w2": _B_in["w2"],
    }

def reference(A_x, A_k_cache, A_v_cache, A_wq, A_wo, B_x, B_w1, B_w3, B_w2):
    def _A_ref(x, k_cache, v_cache, wq, wo):
        B, Sq, D = x.shape
        H, Dh = 16, 256
        q = (lambda x, *d: x.permute(*d))((x @ wq).reshape(B, Sq, H, Dh), 0, 2, 1, 3)
        scores = torch.einsum("bhqd,bhkd->bhqk", q, k_cache) * (Dh ** -0.5)
        p = _softmax(scores, axis=-1)
        o = torch.einsum("bhqk,bhkd->bhqd", p, v_cache)
        return (lambda x, *d: x.permute(*d))(o, 0, 2, 1, 3).reshape(B, Sq, H * Dh) @ wo

    def _B_ref(x, w1, w3, w2):
        gate = torch.einsum("bsd,df->bsf", x, w1)
        up = torch.einsum("bsd,df->bsf", x, w3)
        h = _silu(gate) * up
        out = torch.einsum("bsf,fd->bsd", h, w2)
        return out

    x = A_x
    xn = _layernorm(x, axis=-1)
    s = _A_ref(xn, A_k_cache, A_v_cache, A_wq, A_wo)
    g = _silu(_B_ref(xn, B_w1, B_w3, B_w2))
    return x + s * g
```

```asm
; @launch grid=(256,1,1) block=(256,1,1) lds=163840
.amdgcn_target "amdgcn-amd-amdhsa--gfx950"
.text
.globl recurrent_scan__mha_block_cached__glu_gated_swiglu__prompt_kernel
.p2align 8
.type recurrent_scan__mha_block_cached__glu_gated_swiglu__prompt_kernel,@function
recurrent_scan__mha_block_cached__glu_gated_swiglu__prompt_kernel:
    s_cmp_ge_u32 s2, 256
    s_cbranch_scc1 L_done
    s_load_dwordx16 s[64:79], s[0:1], 0
    s_load_dwordx2 s[4:5], s[0:1], 64
    s_load_dwordx2 s[6:7], s[0:1], 88
    s_getpc_b64 s[98:99]
L_pc:
    s_bfe_u32 s57, s2, 0x30003
    s_mul_i32 s57, s57, (L_end-L_pc-16384)/7
    s_and_b32 s57, s57, 0xffffffc0
    v_and_b32 v241, 0xfe, v0
    v_lshlrev_b32 v241, 6, v241
    v_add_u32 v241, s57, v241
    global_load_dword v13, v241, s[98:99]
    v_lshrrev_b32 v240, 6, v0
    v_and_b32 v0, 63, v0
    v_readfirstlane_b32 s42, v240
    s_and_b32 s43, s2, 7
    s_lshl_b32 s43, s43, 1
    s_bfe_u32 s57, s2, 0x10003
    s_add_u32 s43, s43, s57
    s_lshr_b32 s44, s2, 4
    v_lshrrev_b32 v241, 4, v0
    v_and_b32 v242, 15, v0
    s_lshr_b32 s58, s42, 1
    s_and_b32 s59, s42, 1
    s_lshl_b32 s57, s44, 7
    s_lshl_b32 s60, s42, 5
    s_add_u32 s57, s57, s60
    s_mul_i32 s63, s57, 0x380
    s_mul_i32 s62, s60, 0x3a0
    s_add_u32 s62, s62, 0xb000
    v_mul_u32_u24 v243, 0x3a0, v242
    v_lshl_add_u32 v243, v241, 4, v243
    v_add_u32 v243, s62, v243
    v_and_b32 v244, 1, v241
    v_lshrrev_b32 v245, 1, v241
    v_lshlrev_b32 v246, 2, v244
    v_lshl_add_u32 v246, v245, 4, v246
    v_mul_u32_u24 v8, 0xe00, v246
    v_lshl_add_u32 v8, v242, 4, v8
    s_mul_i32 s45, s58, 0x4200
    s_mul_i32 s57, s59, 0x2100
    s_add_u32 s45, s45, s57
    s_mul_i32 s49, s58, 0x1c000
    s_mul_i32 s57, s43, 0xe0
    s_add_u32 s49, s49, s57
    s_lshl_b32 s47, s58, 14
    s_lshl_b32 s57, s59, 12
    s_add_u32 s47, s47, s57
    s_mov_b32 s48, s47
    s_lshl_b32 s50, s58, 18
    s_lshl_b32 s57, s59, 15
    s_add_u32 s50, s50, s57
    s_lshl_b32 s57, s43, 9
    s_add_u32 s50, s50, s57
    s_mul_i32 s51, s43, 0x18800
    s_mul_i32 s57, s59, 0x1c00
    s_add_u32 s51, s51, s57
    s_lshl_b32 s60, s58, 7
    s_add_u32 s51, s51, s60
    s_mul_i32 s52, s43, 0x38000
    s_add_u32 s52, s52, s57
    s_mul_i32 s60, s58, 0x1c000
    s_add_u32 s52, s52, s60
    s_mul_i32 s80, s59, 0x4200
    s_lshl_b32 s57, s44, 4
    s_add_u32 s57, s57, s43
    s_mul_i32 s57, s57, 0x1c000
    s_lshl_b32 s60, s42, 14
    s_add_u32 s53, s57, s60
    s_mul_i32 s60, s42, 0x3000
    s_add_u32 s54, s57, s60
    s_add_u32 s54, s54, 0x10000
    s_add_u32 s55, s53, 0x1c00000
    s_add_u32 s56, s54, 0x1c00000
    v_lshrrev_b32 v246, 5, v0
    v_and_b32 v247, 31, v0
    v_lshlrev_b32 v3, 13, v246
    v_lshl_add_u32 v3, v247, 4, v3
    v_lshlrev_b32 v9, 17, v246
    v_lshl_add_u32 v9, v247, 4, v9
    v_lshrrev_b32 v248, 3, v0
    v_and_b32 v249, 7, v0
    v_mul_u32_u24 v10, 0x3800, v248
    v_lshl_add_u32 v10, v249, 4, v10
    v_lshlrev_b32 v11, 4, v0
    v_bfe_u32 v246, v0, 2, 2
    v_lshl_add_u32 v246, v244, 2, v246
    v_and_b32 v247, 3, v0
    v_mul_u32_u24 v4, 0x420, v246
    v_lshl_add_u32 v4, v245, 9, v4
    v_lshl_add_u32 v4, v247, 3, v4
    v_add_u32 v5, 0x10800, v4
    v_lshrrev_b32 v246, 2, v0
    v_mul_u32_u24 v6, 0x420, v246
    v_lshl_add_u32 v6, v247, 3, v6
    v_add_u32 v7, 0x10800, v6
    v_add_u32 v2, s80, v6
    v_mul_u32_u24 v1, 0x420, v242
    v_lshl_add_u32 v1, v241, 4, v1
    v_add_u32 v1, s80, v1
    v_add_u32 v1, 0x10800, v1
    s_waitcnt lgkmcnt(0)
    s_mov_b32 s8, s64
    s_mov_b32 s9, s65
    s_mov_b32 s10, 0x1c0000
    s_mov_b32 s11, 0x20000
    s_mov_b32 m0, s62
    s_mov_b32 exec_hi, 0x00ffffff
    buffer_load_dwordx4 v11, s[8:11], s63 offen lds
    s_add_u32 m0, m0, 32
    s_nop 0
    buffer_load_dwordx4 v11, s[8:11], s63 offen offset:896 lds
    s_add_u32 m0, m0, 32
    s_nop 0
    buffer_load_dwordx4 v11, s[8:11], s63 offen offset:1792 lds
    s_add_u32 m0, m0, 32
    s_nop 0
    buffer_load_dwordx4 v11, s[8:11], s63 offen offset:2688 lds
    s_add_u32 m0, m0, 0xe20
    s_add_u32 s63, s63, 0xe00
    buffer_load_dwordx4 v11, s[8:11], s63 offen lds
    s_add_u32 m0, m0, 32
    s_nop 0
    buffer_load_dwordx4 v11, s[8:11], s63 offen offset:896 lds
    s_add_u32 m0, m0, 32
    s_nop 0
    buffer_load_dwordx4 v11, s[8:11], s63 offen offset:1792 lds
    s_add_u32 m0, m0, 32
    s_nop 0
    buffer_load_dwordx4 v11, s[8:11], s63 offen offset:2688 lds
    s_add_u32 m0, m0, 0xe20
    s_add_u32 s63, s63, 0xe00
    buffer_load_dwordx4 v11, s[8:11], s63 offen lds
    s_add_u32 m0, m0, 32
    s_nop 0
    buffer_load_dwordx4 v11, s[8:11], s63 offen offset:896 lds
    s_add_u32 m0, m0, 32
    s_nop 0
    buffer_load_dwordx4 v11, s[8:11], s63 offen offset:1792 lds
    s_add_u32 m0, m0, 32
    s_nop 0
    buffer_load_dwordx4 v11, s[8:11], s63 offen offset:2688 lds
    s_add_u32 m0, m0, 0xe20
    s_add_u32 s63, s63, 0xe00
    buffer_load_dwordx4 v11, s[8:11], s63 offen lds
    s_add_u32 m0, m0, 32
    s_nop 0
    buffer_load_dwordx4 v11, s[8:11], s63 offen offset:896 lds
    s_add_u32 m0, m0, 32
    s_nop 0
    buffer_load_dwordx4 v11, s[8:11], s63 offen offset:1792 lds
    s_add_u32 m0, m0, 32
    s_nop 0
    buffer_load_dwordx4 v11, s[8:11], s63 offen offset:2688 lds
    s_add_u32 m0, m0, 0xe20
    s_add_u32 s63, s63, 0xe00
    s_mov_b32 exec_hi, -1
    s_cmp_eq_u32 s59, 0
    s_cselect_b32 s28, s76, s78
    s_cselect_b32 s29, s77, s79
    s_cselect_b32 s92, s66, s68
    s_cselect_b32 s93, s67, s69
    s_mov_b32 s30, 0x188000
    s_mov_b32 s31, 0x20000
    v_and_b32 v250, 3, v0
    v_min_u32 v250, 2, v250
    v_lshrrev_b32 v251, 2, v0
    v_mul_u32_u24 v251, 0xe00, v251
    v_lshl_add_u32 v250, v250, 7, v251
    s_mul_i32 s57, s44, 28
    s_mul_i32 s60, s58, 14
    s_add_u32 s57, s57, s60
    s_mul_i32 s57, s57, 0xe00
    s_mul_i32 s60, s43, 0xe0
    s_add_u32 s57, s57, s60
    s_and_b32 s57, s57, 0xffffff80
    buffer_load_dword v13, v250, s[28:31], s57 offen
    s_lshl_b32 s57, s43, 20
    s_add_u32 s12, s66, s57
    s_addc_u32 s13, s67, 0
    s_mov_b32 s14, 0x100000
    s_mov_b32 s15, 0x20000
    s_add_u32 s16, s68, s57
    s_addc_u32 s17, s69, 0
    s_mov_b32 s18, 0x100000
    s_mov_b32 s19, 0x20000
    s_add_u32 s92, s92, s57
    s_addc_u32 s93, s93, 0
    s_mov_b32 s94, 0x100000
    s_mov_b32 s95, 0x20000
    s_mov_b32 s20, s70
    s_mov_b32 s21, s71
    s_mov_b32 s22, 0x380000
    s_mov_b32 s23, 0x20000
    s_mov_b32 s24, s72
    s_mov_b32 s25, s73
    s_mov_b32 s26, 0x380000
    s_mov_b32 s27, 0x20000
    s_mov_b32 s32, s4
    s_mov_b32 s33, s5
    s_mov_b32 s34, 0x188000
    s_mov_b32 s35, 0x20000
    s_mov_b32 s36, s6
    s_mov_b32 s37, s7
    s_mov_b32 s38, 0x3a00000
    s_mov_b32 s39, 0x20000
    s_lshl_b32 s97, s44, 4
    s_add_u32 s97, s97, s43
    s_lshl_b32 s97, s97, 8
    s_add_u32 s97, s97, 0x3900000
    v_mov_b32 v16, 0
    v_mov_b32 v17, 0
    s_mov_b64 exec, 1
    buffer_store_dwordx2 v[16:17], v16, s[36:39], s97 offen sc1
    s_mov_b64 exec, -1
    v_mov_b32 v250, 0
    buffer_load_dword v13, v250, s[20:23], s50 offen
    buffer_load_dword v13, v250, s[12:15], 0 offen
    buffer_load_dword v13, v250, s[16:19], 0 offen
    buffer_load_dword v13, v250, s[32:35], s51 offen
    buffer_load_dword v13, v250, s[24:27], s52 offen
    v_mov_b32 v251, v243
    s_mov_b32 exec_hi, 0x00ffffff
    buffer_load_dwordx4 v11, s[8:11], s63 offen lds
    s_add_u32 m0, m0, 32
    s_nop 0
    buffer_load_dwordx4 v11, s[8:11], s63 offen offset:896 lds
    s_add_u32 m0, m0, 32
    s_nop 0
    buffer_load_dwordx4 v11, s[8:11], s63 offen offset:1792 lds
    s_add_u32 m0, m0, 32
    s_nop 0
    buffer_load_dwordx4 v11, s[8:11], s63 offen offset:2688 lds
    s_add_u32 m0, m0, 0xe20
    s_add_u32 s63, s63, 0xe00
    buffer_load_dwordx4 v11, s[8:11], s63 offen lds
    s_add_u32 m0, m0, 32
    s_nop 0
    buffer_load_dwordx4 v11, s[8:11], s63 offen offset:896 lds
    s_add_u32 m0, m0, 32
    s_mov_b32 exec_hi, -1
    s_load_dwordx4 s[72:75], s[0:1], 72
    s_waitcnt lgkmcnt(0)
    s_mov_b32 s68, s72
    s_mov_b32 s69, s73
    s_mov_b32 s70, 0x1c0000
    s_mov_b32 s71, 0x20000
    s_mov_b32 s64, s74
    s_mov_b32 s65, s75
    s_mov_b32 s66, 0x100
    s_mov_b32 s67, 0x20000
    buffer_load_dword v13, v250, s[64:67], 0 offen
    s_mov_b32 s61, 0x3f803f80
    v_mov_b32 v240, 0
    v_mov_b32 v241, 0
    v_mov_b32 v242, 0
    v_mov_b32 v243, 0
    v_mov_b32 v244, 0
    v_mov_b32 v245, 0
    v_mov_b32 v246, 0
    v_mov_b32 v247, 0
    s_waitcnt vmcnt(14)
    ds_read_b128 v[128:131], v251
    ds_read_b128 v[132:135], v251 offset:64
    ds_read_b128 v[136:139], v251 offset:128
    ds_read_b128 v[140:143], v251 offset:192
    ds_read_b128 v[144:147], v251 offset:256
    ds_read_b128 v[148:151], v251 offset:320
    ds_read_b128 v[152:155], v251 offset:384
    ds_read_b128 v[156:159], v251 offset:448
    ds_read_b128 v[160:163], v251 offset:512
    ds_read_b128 v[164:167], v251 offset:576
    ds_read_b128 v[168:171], v251 offset:640
    ds_read_b128 v[172:175], v251 offset:704
    ds_read_b128 v[176:179], v251 offset:768
    ds_read_b128 v[180:183], v251 offset:832
    s_mov_b32 exec_hi, 0x00ffffff
    buffer_load_dwordx4 v11, s[8:11], s63 offen offset:1792 lds
    s_add_u32 m0, m0, 32
    s_mov_b32 exec_hi, -1
    s_waitcnt lgkmcnt(13)
    v_dot2c_f32_bf16 v240, s61, v128
    v_dot2c_f32_bf16 v242, v128, v128
    v_dot2c_f32_bf16 v241, s61, v129
    v_dot2c_f32_bf16 v243, v129, v129
    v_dot2c_f32_bf16 v240, s61, v130
    v_dot2c_f32_bf16 v242, v130, v130
    v_dot2c_f32_bf16 v241, s61, v131
    v_dot2c_f32_bf16 v243, v131, v131
    s_waitcnt lgkmcnt(12)
    v_dot2c_f32_bf16 v240, s61, v132
    v_dot2c_f32_bf16 v242, v132, v132
    v_dot2c_f32_bf16 v241, s61, v133
    v_dot2c_f32_bf16 v243, v133, v133
    v_dot2c_f32_bf16 v240, s61, v134
    v_dot2c_f32_bf16 v242, v134, v134
    v_dot2c_f32_bf16 v241, s61, v135
    v_dot2c_f32_bf16 v243, v135, v135
    s_waitcnt lgkmcnt(11)
    v_dot2c_f32_bf16 v240, s61, v136
    v_dot2c_f32_bf16 v242, v136, v136
    v_dot2c_f32_bf16 v241, s61, v137
    v_dot2c_f32_bf16 v243, v137, v137
    v_dot2c_f32_bf16 v240, s61, v138
    v_dot2c_f32_bf16 v242, v138, v138
    v_dot2c_f32_bf16 v241, s61, v139
    v_dot2c_f32_bf16 v243, v139, v139
    s_waitcnt lgkmcnt(10)
    v_dot2c_f32_bf16 v240, s61, v140
    v_dot2c_f32_bf16 v242, v140, v140
    v_dot2c_f32_bf16 v241, s61, v141
    v_dot2c_f32_bf16 v243, v141, v141
    v_dot2c_f32_bf16 v240, s61, v142
    v_dot2c_f32_bf16 v242, v142, v142
    v_dot2c_f32_bf16 v241, s61, v143
    v_dot2c_f32_bf16 v243, v143, v143
    s_waitcnt lgkmcnt(9)
    v_dot2c_f32_bf16 v240, s61, v144
    s_mov_b32 exec_hi, 0x00ffffff
    buffer_load_dwordx4 v11, s[8:11], s63 offen offset:2688 lds
    s_add_u32 m0, m0, 0xe20
    s_add_u32 s63, s63, 0xe00
    s_mov_b32 exec_hi, -1
    v_dot2c_f32_bf16 v242, v144, v144
    v_dot2c_f32_bf16 v241, s61, v145
    v_dot2c_f32_bf16 v243, v145, v145
    v_dot2c_f32_bf16 v240, s61, v146
    v_dot2c_f32_bf16 v242, v146, v146
    v_dot2c_f32_bf16 v241, s61, v147
    v_dot2c_f32_bf16 v243, v147, v147
    s_waitcnt lgkmcnt(8)
    v_dot2c_f32_bf16 v240, s61, v148
    v_dot2c_f32_bf16 v242, v148, v148
    v_dot2c_f32_bf16 v241, s61, v149
    v_dot2c_f32_bf16 v243, v149, v149
    v_dot2c_f32_bf16 v240, s61, v150
    v_dot2c_f32_bf16 v242, v150, v150
    v_dot2c_f32_bf16 v241, s61, v151
    v_dot2c_f32_bf16 v243, v151, v151
    s_waitcnt lgkmcnt(7)
    v_dot2c_f32_bf16 v240, s61, v152
    v_dot2c_f32_bf16 v242, v152, v152
    v_dot2c_f32_bf16 v241, s61, v153
    v_dot2c_f32_bf16 v243, v153, v153
    v_dot2c_f32_bf16 v240, s61, v154
    v_dot2c_f32_bf16 v242, v154, v154
    v_dot2c_f32_bf16 v241, s61, v155
    v_dot2c_f32_bf16 v243, v155, v155
    s_waitcnt lgkmcnt(6)
    v_dot2c_f32_bf16 v240, s61, v156
    v_dot2c_f32_bf16 v242, v156, v156
    v_dot2c_f32_bf16 v241, s61, v157
    v_dot2c_f32_bf16 v243, v157, v157
    v_dot2c_f32_bf16 v240, s61, v158
    v_dot2c_f32_bf16 v242, v158, v158
    v_dot2c_f32_bf16 v241, s61, v159
    v_dot2c_f32_bf16 v243, v159, v159
    s_waitcnt lgkmcnt(5)
    v_dot2c_f32_bf16 v240, s61, v160
    v_dot2c_f32_bf16 v242, v160, v160
    s_mov_b32 exec_hi, 0x00ffffff
    buffer_load_dwordx4 v11, s[8:11], s63 offen lds
    s_add_u32 m0, m0, 32
    s_mov_b32 exec_hi, -1
    v_dot2c_f32_bf16 v241, s61, v161
    v_dot2c_f32_bf16 v243, v161, v161
    v_dot2c_f32_bf16 v240, s61, v162
    v_dot2c_f32_bf16 v242, v162, v162
    v_dot2c_f32_bf16 v241, s61, v163
    v_dot2c_f32_bf16 v243, v163, v163
    s_waitcnt lgkmcnt(4)
    v_dot2c_f32_bf16 v240, s61, v164
    v_dot2c_f32_bf16 v242, v164, v164
    v_dot2c_f32_bf16 v241, s61, v165
    v_dot2c_f32_bf16 v243, v165, v165
    v_dot2c_f32_bf16 v240, s61, v166
    v_dot2c_f32_bf16 v242, v166, v166
    v_dot2c_f32_bf16 v241, s61, v167
    v_dot2c_f32_bf16 v243, v167, v167
    s_waitcnt lgkmcnt(3)
    v_dot2c_f32_bf16 v240, s61, v168
    v_dot2c_f32_bf16 v242, v168, v168
    v_dot2c_f32_bf16 v241, s61, v169
    v_dot2c_f32_bf16 v243, v169, v169
    v_dot2c_f32_bf16 v240, s61, v170
    v_dot2c_f32_bf16 v242, v170, v170
    v_dot2c_f32_bf16 v241, s61, v171
    v_dot2c_f32_bf16 v243, v171, v171
    s_waitcnt lgkmcnt(2)
    v_dot2c_f32_bf16 v240, s61, v172
    v_dot2c_f32_bf16 v242, v172, v172
    v_dot2c_f32_bf16 v241, s61, v173
    v_dot2c_f32_bf16 v243, v173, v173
    v_dot2c_f32_bf16 v240, s61, v174
    v_dot2c_f32_bf16 v242, v174, v174
    v_dot2c_f32_bf16 v241, s61, v175
    v_dot2c_f32_bf16 v243, v175, v175
    s_waitcnt lgkmcnt(1)
    v_dot2c_f32_bf16 v240, s61, v176
    v_dot2c_f32_bf16 v242, v176, v176
    v_dot2c_f32_bf16 v241, s61, v177
    s_mov_b32 exec_hi, 0x00ffffff
    buffer_load_dwordx4 v11, s[8:11], s63 offen offset:896 lds
    s_add_u32 m0, m0, 32
    s_mov_b32 exec_hi, -1
    v_dot2c_f32_bf16 v243, v177, v177
    v_dot2c_f32_bf16 v240, s61, v178
    v_dot2c_f32_bf16 v242, v178, v178
    v_dot2c_f32_bf16 v241, s61, v179
    v_dot2c_f32_bf16 v243, v179, v179
    s_waitcnt lgkmcnt(0)
    v_dot2c_f32_bf16 v240, s61, v180
    v_dot2c_f32_bf16 v242, v180, v180
    v_dot2c_f32_bf16 v241, s61, v181
    v_dot2c_f32_bf16 v243, v181, v181
    v_dot2c_f32_bf16 v240, s61, v182
    v_dot2c_f32_bf16 v242, v182, v182
    v_dot2c_f32_bf16 v241, s61, v183
    v_dot2c_f32_bf16 v243, v183, v183
    s_nop 1
    v_add_f32 v240, v240, v241
    v_add_f32 v242, v242, v243
    v_mov_b32 v248, v240
    s_nop 1
    v_permlane16_swap_b32 v240, v248
    v_add_f32 v240, v240, v248
    v_mov_b32 v248, v240
    s_nop 1
    v_permlane32_swap_b32 v240, v248
    v_add_f32 v240, v240, v248
    v_mov_b32 v248, v242
    s_nop 1
    v_permlane16_swap_b32 v242, v248
    v_add_f32 v242, v242, v248
    v_mov_b32 v248, v242
    s_nop 1
    v_permlane32_swap_b32 v242, v248
    v_add_f32 v242, v242, v248
    v_mul_f32 v240, 0x3b124925, v240
    v_mul_f32 v242, 0x3b124925, v242
    v_fma_f32 v242, -v240, v240, v242
    v_max_f32 v242, 0, v242
    v_cvt_pk_bf16_f32 v242, v242, v242
    v_and_b32 v242, 0xffff0000, v242
    s_mov_b32 exec_hi, 0x00ffffff
    buffer_load_dwordx4 v11, s[8:11], s63 offen offset:1792 lds
    s_add_u32 m0, m0, 32
    s_mov_b32 exec_hi, -1
    v_add_f32 v242, 0x3727c5ac, v242
    v_cvt_pk_bf16_f32 v242, v242, v242
    v_and_b32 v242, 0xffff0000, v242
    v_sqrt_f32 v242, v242
    s_nop 0
    v_cvt_pk_bf16_f32 v242, v242, v242
    v_and_b32 v242, 0xffff0000, v242
    v_rcp_f32 v252, v242
    v_cvt_pk_bf16_f32 v240, v240, v240
    v_and_b32 v240, 0xffff0000, v240
    v_mul_f32 v254, v240, v252
    v_sub_f32 v254, 0, v254
    v_lshlrev_b32 v16, 16, v128
    v_and_b32 v17, 0xffff0000, v128
    v_lshlrev_b32 v18, 16, v129
    v_and_b32 v19, 0xffff0000, v129
    v_lshlrev_b32 v20, 16, v130
    v_and_b32 v21, 0xffff0000, v130
    v_lshlrev_b32 v22, 16, v131
    v_and_b32 v23, 0xffff0000, v131
    v_pk_fma_f32 v[16:17], v[16:17], v[252:253], v[254:255] op_sel:[0,0,0] op_sel_hi:[1,0,0]
    v_pk_fma_f32 v[18:19], v[18:19], v[252:253], v[254:255] op_sel:[0,0,0] op_sel_hi:[1,0,0]
    v_pk_fma_f32 v[20:21], v[20:21], v[252:253], v[254:255] op_sel:[0,0,0] op_sel_hi:[1,0,0]
    v_pk_fma_f32 v[22:23], v[22:23], v[252:253], v[254:255] op_sel:[0,0,0] op_sel_hi:[1,0,0]
    v_cvt_pk_bf16_f32 v128, v16, v17
    v_cvt_pk_bf16_f32 v129, v18, v19
    v_cvt_pk_bf16_f32 v130, v20, v21
    v_cvt_pk_bf16_f32 v131, v22, v23
    v_lshlrev_b32 v24, 16, v132
    v_and_b32 v25, 0xffff0000, v132
    v_lshlrev_b32 v26, 16, v133
    v_and_b32 v27, 0xffff0000, v133
    v_lshlrev_b32 v28, 16, v134
    v_and_b32 v29, 0xffff0000, v134
    s_mov_b32 exec_hi, 0x00ffffff
    buffer_load_dwordx4 v11, s[8:11], s63 offen offset:2688 lds
    s_add_u32 m0, m0, 0xe20
    s_add_u32 s63, s63, 0xe00
    s_mov_b32 exec_hi, -1
    v_lshlrev_b32 v30, 16, v135
    v_and_b32 v31, 0xffff0000, v135
    v_pk_fma_f32 v[24:25], v[24:25], v[252:253], v[254:255] op_sel:[0,0,0] op_sel_hi:[1,0,0]
    v_pk_fma_f32 v[26:27], v[26:27], v[252:253], v[254:255] op_sel:[0,0,0] op_sel_hi:[1,0,0]
    v_pk_fma_f32 v[28:29], v[28:29], v[252:253], v[254:255] op_sel:[0,0,0] op_sel_hi:[1,0,0]
    v_pk_fma_f32 v[30:31], v[30:31], v[252:253], v[254:255] op_sel:[0,0,0] op_sel_hi:[1,0,0]
    v_cvt_pk_bf16_f32 v132, v24, v25
    v_cvt_pk_bf16_f32 v133, v26, v27
    v_cvt_pk_bf16_f32 v134, v28, v29
    v_cvt_pk_bf16_f32 v135, v30, v31
    v_lshlrev_b32 v16, 16, v136
    v_and_b32 v17, 0xffff0000, v136
    v_lshlrev_b32 v18, 16, v137
    v_and_b32 v19, 0xffff0000, v137
    v_lshlrev_b32 v20, 16, v138
    v_and_b32 v21, 0xffff0000, v138
    v_lshlrev_b32 v22, 16, v139
    v_and_b32 v23, 0xffff0000, v139
    v_pk_fma_f32 v[16:17], v[16:17], v[252:253], v[254:255] op_sel:[0,0,0] op_sel_hi:[1,0,0]
    v_pk_fma_f32 v[18:19], v[18:19], v[252:253], v[254:255] op_sel:[0,0,0] op_sel_hi:[1,0,0]
    v_pk_fma_f32 v[20:21], v[20:21], v[252:253], v[254:255] op_sel:[0,0,0] op_sel_hi:[1,0,0]
    v_pk_fma_f32 v[22:23], v[22:23], v[252:253], v[254:255] op_sel:[0,0,0] op_sel_hi:[1,0,0]
    v_cvt_pk_bf16_f32 v136, v16, v17
    v_cvt_pk_bf16_f32 v137, v18, v19
    v_cvt_pk_bf16_f32 v138, v20, v21
    v_cvt_pk_bf16_f32 v139, v22, v23
    v_lshlrev_b32 v24, 16, v140
    v_and_b32 v25, 0xffff0000, v140
    v_lshlrev_b32 v26, 16, v141
    v_and_b32 v27, 0xffff0000, v141
    v_lshlrev_b32 v28, 16, v142
    v_and_b32 v29, 0xffff0000, v142
    v_lshlrev_b32 v30, 16, v143
    s_mov_b32 exec_hi, 0x00ffffff
    buffer_load_dwordx4 v11, s[8:11], s63 offen lds
    s_add_u32 m0, m0, 32
    s_mov_b32 exec_hi, -1
    v_and_b32 v31, 0xffff0000, v143
    v_pk_fma_f32 v[24:25], v[24:25], v[252:253], v[254:255] op_sel:[0,0,0] op_sel_hi:[1,0,0]
    v_pk_fma_f32 v[26:27], v[26:27], v[252:253], v[254:255] op_sel:[0,0,0] op_sel_hi:[1,0,0]
    v_pk_fma_f32 v[28:29], v[28:29], v[252:253], v[254:255] op_sel:[0,0,0] op_sel_hi:[1,0,0]
    v_pk_fma_f32 v[30:31], v[30:31], v[252:253], v[254:255] op_sel:[0,0,0] op_sel_hi:[1,0,0]
    v_cvt_pk_bf16_f32 v140, v24, v25
    v_cvt_pk_bf16_f32 v141, v26, v27
    v_cvt_pk_bf16_f32 v142, v28, v29
    v_cvt_pk_bf16_f32 v143, v30, v31
    v_lshlrev_b32 v16, 16, v144
    v_and_b32 v17, 0xffff0000, v144
    v_lshlrev_b32 v18, 16, v145
    v_and_b32 v19, 0xffff0000, v145
    v_lshlrev_b32 v20, 16, v146
    v_and_b32 v21, 0xffff0000, v146
    v_lshlrev_b32 v22, 16, v147
    v_and_b32 v23, 0xffff0000, v147
    v_pk_fma_f32 v[16:17], v[16:17], v[252:253], v[254:255] op_sel:[0,0,0] op_sel_hi:[1,0,0]
    v_pk_fma_f32 v[18:19], v[18:19], v[252:253], v[254:255] op_sel:[0,0,0] op_sel_hi:[1,0,0]
    v_pk_fma_f32 v[20:21], v[20:21], v[252:253], v[254:255] op_sel:[0,0,0] op_sel_hi:[1,0,0]
    v_pk_fma_f32 v[22:23], v[22:23], v[252:253], v[254:255] op_sel:[0,0,0] op_sel_hi:[1,0,0]
    v_cvt_pk_bf16_f32 v144, v16, v17
    v_cvt_pk_bf16_f32 v145, v18, v19
    v_cvt_pk_bf16_f32 v146, v20, v21
    v_cvt_pk_bf16_f32 v147, v22, v23
    v_lshlrev_b32 v24, 16, v148
    v_and_b32 v25, 0xffff0000, v148
    v_lshlrev_b32 v26, 16, v149
    v_and_b32 v27, 0xffff0000, v149
    v_lshlrev_b32 v28, 16, v150
    v_and_b32 v29, 0xffff0000, v150
    v_lshlrev_b32 v30, 16, v151
    v_and_b32 v31, 0xffff0000, v151
    s_mov_b32 exec_hi, 0x00ffffff
    buffer_load_dwordx4 v11, s[8:11], s63 offen offset:896 lds
    s_add_u32 m0, m0, 32
    s_mov_b32 exec_hi, -1
    v_pk_fma_f32 v[24:25], v[24:25], v[252:253], v[254:255] op_sel:[0,0,0] op_sel_hi:[1,0,0]
    v_pk_fma_f32 v[26:27], v[26:27], v[252:253], v[254:255] op_sel:[0,0,0] op_sel_hi:[1,0,0]
    v_pk_fma_f32 v[28:29], v[28:29], v[252:253], v[254:255] op_sel:[0,0,0] op_sel_hi:[1,0,0]
    v_pk_fma_f32 v[30:31], v[30:31], v[252:253], v[254:255] op_sel:[0,0,0] op_sel_hi:[1,0,0]
    v_cvt_pk_bf16_f32 v148, v24, v25
    v_cvt_pk_bf16_f32 v149, v26, v27
    v_cvt_pk_bf16_f32 v150, v28, v29
    v_cvt_pk_bf16_f32 v151, v30, v31
    v_lshlrev_b32 v16, 16, v152
    v_and_b32 v17, 0xffff0000, v152
    v_lshlrev_b32 v18, 16, v153
    v_and_b32 v19, 0xffff0000, v153
    v_lshlrev_b32 v20, 16, v154
    v_and_b32 v21, 0xffff0000, v154
    v_lshlrev_b32 v22, 16, v155
    v_and_b32 v23, 0xffff0000, v155
    v_pk_fma_f32 v[16:17], v[16:17], v[252:253], v[254:255] op_sel:[0,0,0] op_sel_hi:[1,0,0]
    v_pk_fma_f32 v[18:19], v[18:19], v[252:253], v[254:255] op_sel:[0,0,0] op_sel_hi:[1,0,0]
    v_pk_fma_f32 v[20:21], v[20:21], v[252:253], v[254:255] op_sel:[0,0,0] op_sel_hi:[1,0,0]
    v_pk_fma_f32 v[22:23], v[22:23], v[252:253], v[254:255] op_sel:[0,0,0] op_sel_hi:[1,0,0]
    v_cvt_pk_bf16_f32 v152, v16, v17
    v_cvt_pk_bf16_f32 v153, v18, v19
    v_cvt_pk_bf16_f32 v154, v20, v21
    v_cvt_pk_bf16_f32 v155, v22, v23
    v_lshlrev_b32 v24, 16, v156
    v_and_b32 v25, 0xffff0000, v156
    v_lshlrev_b32 v26, 16, v157
    v_and_b32 v27, 0xffff0000, v157
    v_lshlrev_b32 v28, 16, v158
    v_and_b32 v29, 0xffff0000, v158
    v_lshlrev_b32 v30, 16, v159
    v_and_b32 v31, 0xffff0000, v159
    v_pk_fma_f32 v[24:25], v[24:25], v[252:253], v[254:255] op_sel:[0,0,0] op_sel_hi:[1,0,0]
    s_mov_b32 exec_hi, 0x00ffffff
    buffer_load_dwordx4 v11, s[8:11], s63 offen offset:1792 lds
    s_add_u32 m0, m0, 32
    s_mov_b32 exec_hi, -1
    v_pk_fma_f32 v[26:27], v[26:27], v[252:253], v[254:255] op_sel:[0,0,0] op_sel_hi:[1,0,0]
    v_pk_fma_f32 v[28:29], v[28:29], v[252:253], v[254:255] op_sel:[0,0,0] op_sel_hi:[1,0,0]
    v_pk_fma_f32 v[30:31], v[30:31], v[252:253], v[254:255] op_sel:[0,0,0] op_sel_hi:[1,0,0]
    v_cvt_pk_bf16_f32 v156, v24, v25
    v_cvt_pk_bf16_f32 v157, v26, v27
    v_cvt_pk_bf16_f32 v158, v28, v29
    v_cvt_pk_bf16_f32 v159, v30, v31
    v_lshlrev_b32 v16, 16, v160
    v_and_b32 v17, 0xffff0000, v160
    v_lshlrev_b32 v18, 16, v161
    v_and_b32 v19, 0xffff0000, v161
    v_lshlrev_b32 v20, 16, v162
    v_and_b32 v21, 0xffff0000, v162
    v_lshlrev_b32 v22, 16, v163
    v_and_b32 v23, 0xffff0000, v163
    v_pk_fma_f32 v[16:17], v[16:17], v[252:253], v[254:255] op_sel:[0,0,0] op_sel_hi:[1,0,0]
    v_pk_fma_f32 v[18:19], v[18:19], v[252:253], v[254:255] op_sel:[0,0,0] op_sel_hi:[1,0,0]
    v_pk_fma_f32 v[20:21], v[20:21], v[252:253], v[254:255] op_sel:[0,0,0] op_sel_hi:[1,0,0]
    v_pk_fma_f32 v[22:23], v[22:23], v[252:253], v[254:255] op_sel:[0,0,0] op_sel_hi:[1,0,0]
    v_cvt_pk_bf16_f32 v160, v16, v17
    v_cvt_pk_bf16_f32 v161, v18, v19
    v_cvt_pk_bf16_f32 v162, v20, v21
    v_cvt_pk_bf16_f32 v163, v22, v23
    v_lshlrev_b32 v24, 16, v164
    v_and_b32 v25, 0xffff0000, v164
    v_lshlrev_b32 v26, 16, v165
    v_and_b32 v27, 0xffff0000, v165
    v_lshlrev_b32 v28, 16, v166
    v_and_b32 v29, 0xffff0000, v166
    v_lshlrev_b32 v30, 16, v167
    v_and_b32 v31, 0xffff0000, v167
    v_pk_fma_f32 v[24:25], v[24:25], v[252:253], v[254:255] op_sel:[0,0,0] op_sel_hi:[1,0,0]
    v_pk_fma_f32 v[26:27], v[26:27], v[252:253], v[254:255] op_sel:[0,0,0] op_sel_hi:[1,0,0]
    s_mov_b32 exec_hi, 0x00ffffff
    buffer_load_dwordx4 v11, s[8:11], s63 offen offset:2688 lds
    s_add_u32 m0, m0, 0xe20
    s_add_u32 s63, s63, 0xe00
    s_mov_b32 exec_hi, -1
    s_add_u32 m0, s45, 0
    v_pk_fma_f32 v[28:29], v[28:29], v[252:253], v[254:255] op_sel:[0,0,0] op_sel_hi:[1,0,0]
    v_pk_fma_f32 v[30:31], v[30:31], v[252:253], v[254:255] op_sel:[0,0,0] op_sel_hi:[1,0,0]
    v_cvt_pk_bf16_f32 v164, v24, v25
    v_cvt_pk_bf16_f32 v165, v26, v27
    v_cvt_pk_bf16_f32 v166, v28, v29
    v_cvt_pk_bf16_f32 v167, v30, v31
    v_lshlrev_b32 v16, 16, v168
    v_and_b32 v17, 0xffff0000, v168
    v_lshlrev_b32 v18, 16, v169
    v_and_b32 v19, 0xffff0000, v169
    v_lshlrev_b32 v20, 16, v170
    v_and_b32 v21, 0xffff0000, v170
    v_lshlrev_b32 v22, 16, v171
    v_and_b32 v23, 0xffff0000, v171
    v_pk_fma_f32 v[16:17], v[16:17], v[252:253], v[254:255] op_sel:[0,0,0] op_sel_hi:[1,0,0]
    v_pk_fma_f32 v[18:19], v[18:19], v[252:253], v[254:255] op_sel:[0,0,0] op_sel_hi:[1,0,0]
    v_pk_fma_f32 v[20:21], v[20:21], v[252:253], v[254:255] op_sel:[0,0,0] op_sel_hi:[1,0,0]
    v_pk_fma_f32 v[22:23], v[22:23], v[252:253], v[254:255] op_sel:[0,0,0] op_sel_hi:[1,0,0]
    v_cvt_pk_bf16_f32 v168, v16, v17
    v_cvt_pk_bf16_f32 v169, v18, v19
    v_cvt_pk_bf16_f32 v170, v20, v21
    v_cvt_pk_bf16_f32 v171, v22, v23
    v_lshlrev_b32 v24, 16, v172
    v_and_b32 v25, 0xffff0000, v172
    v_lshlrev_b32 v26, 16, v173
    v_and_b32 v27, 0xffff0000, v173
    v_lshlrev_b32 v28, 16, v174
    v_and_b32 v29, 0xffff0000, v174
    v_lshlrev_b32 v30, 16, v175
    v_and_b32 v31, 0xffff0000, v175
    v_pk_fma_f32 v[24:25], v[24:25], v[252:253], v[254:255] op_sel:[0,0,0] op_sel_hi:[1,0,0]
    v_pk_fma_f32 v[26:27], v[26:27], v[252:253], v[254:255] op_sel:[0,0,0] op_sel_hi:[1,0,0]
    v_pk_fma_f32 v[28:29], v[28:29], v[252:253], v[254:255] op_sel:[0,0,0] op_sel_hi:[1,0,0]
    v_pk_fma_f32 v[30:31], v[30:31], v[252:253], v[254:255] op_sel:[0,0,0] op_sel_hi:[1,0,0]
    v_cvt_pk_bf16_f32 v172, v24, v25
    v_cvt_pk_bf16_f32 v173, v26, v27
    v_cvt_pk_bf16_f32 v174, v28, v29
    v_cvt_pk_bf16_f32 v175, v30, v31
    v_lshlrev_b32 v16, 16, v176
    v_and_b32 v17, 0xffff0000, v176
    v_lshlrev_b32 v18, 16, v177
    v_and_b32 v19, 0xffff0000, v177
    v_lshlrev_b32 v20, 16, v178
    v_and_b32 v21, 0xffff0000, v178
    v_lshlrev_b32 v22, 16, v179
    v_and_b32 v23, 0xffff0000, v179
    v_pk_fma_f32 v[16:17], v[16:17], v[252:253], v[254:255] op_sel:[0,0,0] op_sel_hi:[1,0,0]
    v_pk_fma_f32 v[18:19], v[18:19], v[252:253], v[254:255] op_sel:[0,0,0] op_sel_hi:[1,0,0]
    v_pk_fma_f32 v[20:21], v[20:21], v[252:253], v[254:255] op_sel:[0,0,0] op_sel_hi:[1,0,0]
    v_pk_fma_f32 v[22:23], v[22:23], v[252:253], v[254:255] op_sel:[0,0,0] op_sel_hi:[1,0,0]
    v_cvt_pk_bf16_f32 v176, v16, v17
    v_cvt_pk_bf16_f32 v177, v18, v19
    v_cvt_pk_bf16_f32 v178, v20, v21
    v_cvt_pk_bf16_f32 v179, v22, v23
    v_lshlrev_b32 v24, 16, v180
    v_and_b32 v25, 0xffff0000, v180
    v_lshlrev_b32 v26, 16, v181
    v_and_b32 v27, 0xffff0000, v181
    v_lshlrev_b32 v28, 16, v182
    v_and_b32 v29, 0xffff0000, v182
    v_lshlrev_b32 v30, 16, v183
    v_and_b32 v31, 0xffff0000, v183
    v_pk_fma_f32 v[24:25], v[24:25], v[252:253], v[254:255] op_sel:[0,0,0] op_sel_hi:[1,0,0]
    v_pk_fma_f32 v[26:27], v[26:27], v[252:253], v[254:255] op_sel:[0,0,0] op_sel_hi:[1,0,0]
    v_pk_fma_f32 v[28:29], v[28:29], v[252:253], v[254:255] op_sel:[0,0,0] op_sel_hi:[1,0,0]
    v_pk_fma_f32 v[30:31], v[30:31], v[252:253], v[254:255] op_sel:[0,0,0] op_sel_hi:[1,0,0]
    v_cvt_pk_bf16_f32 v180, v24, v25
    v_cvt_pk_bf16_f32 v181, v26, v27
    v_cvt_pk_bf16_f32 v182, v28, v29
    v_cvt_pk_bf16_f32 v183, v30, v31
    s_waitcnt vmcnt(0)
    ds_read_b128 v[184:187], v251 offset:14848
    ds_read_b128 v[188:191], v251 offset:14912
    ds_read_b128 v[192:195], v251 offset:14976
    ds_read_b128 v[196:199], v251 offset:15040
    ds_read_b128 v[200:203], v251 offset:15104
    ds_read_b128 v[204:207], v251 offset:15168
    ds_read_b128 v[208:211], v251 offset:15232
    ds_read_b128 v[212:215], v251 offset:15296
    ds_read_b128 v[216:219], v251 offset:15360
    ds_read_b128 v[220:223], v251 offset:15424
    ds_read_b128 v[224:227], v251 offset:15488
    ds_read_b128 v[228:231], v251 offset:15552
    ds_read_b128 v[232:235], v251 offset:15616
    ds_read_b128 v[236:239], v251 offset:15680
    buffer_load_dwordx4 v8, s[28:31], s49 offen lds
    s_add_u32 m0, m0, 0x420
    s_add_u32 s49, s49, 0xe00
    s_waitcnt lgkmcnt(13)
    v_dot2c_f32_bf16 v244, s61, v184
    v_dot2c_f32_bf16 v246, v184, v184
    v_dot2c_f32_bf16 v245, s61, v185
    v_dot2c_f32_bf16 v247, v185, v185
    v_dot2c_f32_bf16 v244, s61, v186
    v_dot2c_f32_bf16 v246, v186, v186
    v_dot2c_f32_bf16 v245, s61, v187
    v_dot2c_f32_bf16 v247, v187, v187
    s_waitcnt lgkmcnt(12)
    v_dot2c_f32_bf16 v244, s61, v188
    v_dot2c_f32_bf16 v246, v188, v188
    v_dot2c_f32_bf16 v245, s61, v189
    v_dot2c_f32_bf16 v247, v189, v189
    buffer_load_dwordx4 v8, s[28:31], s49 offen lds
    s_add_u32 m0, m0, 0x420
    s_add_u32 s49, s49, 0xe00
    v_dot2c_f32_bf16 v244, s61, v190
    v_dot2c_f32_bf16 v246, v190, v190
    v_dot2c_f32_bf16 v245, s61, v191
    v_dot2c_f32_bf16 v247, v191, v191
    s_waitcnt lgkmcnt(11)
    v_dot2c_f32_bf16 v244, s61, v192
    v_dot2c_f32_bf16 v246, v192, v192
    v_dot2c_f32_bf16 v245, s61, v193
    v_dot2c_f32_bf16 v247, v193, v193
    v_dot2c_f32_bf16 v244, s61, v194
    v_dot2c_f32_bf16 v246, v194, v194
    v_dot2c_f32_bf16 v245, s61, v195
    v_dot2c_f32_bf16 v247, v195, v195
    buffer_load_dwordx4 v8, s[28:31], s49 offen lds
    s_add_u32 m0, m0, 0x420
    s_add_u32 s49, s49, 0xe00
    s_waitcnt lgkmcnt(10)
    v_dot2c_f32_bf16 v244, s61, v196
    v_dot2c_f32_bf16 v246, v196, v196
    v_dot2c_f32_bf16 v245, s61, v197
    v_dot2c_f32_bf16 v247, v197, v197
    v_dot2c_f32_bf16 v244, s61, v198
    v_dot2c_f32_bf16 v246, v198, v198
    v_dot2c_f32_bf16 v245, s61, v199
    v_dot2c_f32_bf16 v247, v199, v199
    s_waitcnt lgkmcnt(9)
    v_dot2c_f32_bf16 v244, s61, v200
    v_dot2c_f32_bf16 v246, v200, v200
    v_dot2c_f32_bf16 v245, s61, v201
    v_dot2c_f32_bf16 v247, v201, v201
    buffer_load_dwordx4 v8, s[28:31], s49 offen lds
    s_add_u32 m0, m0, 0x420
    s_add_u32 s49, s49, 0x4600
    v_dot2c_f32_bf16 v244, s61, v202
    v_dot2c_f32_bf16 v246, v202, v202
    v_dot2c_f32_bf16 v245, s61, v203
    v_dot2c_f32_bf16 v247, v203, v203
    s_waitcnt lgkmcnt(8)
    v_dot2c_f32_bf16 v244, s61, v204
    v_dot2c_f32_bf16 v246, v204, v204
    v_dot2c_f32_bf16 v245, s61, v205
    v_dot2c_f32_bf16 v247, v205, v205
    v_dot2c_f32_bf16 v244, s61, v206
    v_dot2c_f32_bf16 v246, v206, v206
    v_dot2c_f32_bf16 v245, s61, v207
    v_dot2c_f32_bf16 v247, v207, v207
    buffer_load_dwordx4 v8, s[28:31], s49 offen lds
    s_add_u32 m0, m0, 0x420
    s_add_u32 s49, s49, 0xe00
    s_waitcnt lgkmcnt(7)
    v_dot2c_f32_bf16 v244, s61, v208
    v_dot2c_f32_bf16 v246, v208, v208
    v_dot2c_f32_bf16 v245, s61, v209
    v_dot2c_f32_bf16 v247, v209, v209
    v_dot2c_f32_bf16 v244, s61, v210
    v_dot2c_f32_bf16 v246, v210, v210
    v_dot2c_f32_bf16 v245, s61, v211
    v_dot2c_f32_bf16 v247, v211, v211
    s_waitcnt lgkmcnt(6)
    v_dot2c_f32_bf16 v244, s61, v212
    v_dot2c_f32_bf16 v246, v212, v212
    v_dot2c_f32_bf16 v245, s61, v213
    v_dot2c_f32_bf16 v247, v213, v213
    buffer_load_dwordx4 v8, s[28:31], s49 offen lds
    s_add_u32 m0, m0, 0x420
    s_add_u32 s49, s49, 0xe00
    v_dot2c_f32_bf16 v244, s61, v214
    v_dot2c_f32_bf16 v246, v214, v214
    v_dot2c_f32_bf16 v245, s61, v215
    v_dot2c_f32_bf16 v247, v215, v215
    s_waitcnt lgkmcnt(5)
    v_dot2c_f32_bf16 v244, s61, v216
    v_dot2c_f32_bf16 v246, v216, v216
    v_dot2c_f32_bf16 v245, s61, v217
    v_dot2c_f32_bf16 v247, v217, v217
    v_dot2c_f32_bf16 v244, s61, v218
    v_dot2c_f32_bf16 v246, v218, v218
    v_dot2c_f32_bf16 v245, s61, v219
    v_dot2c_f32_bf16 v247, v219, v219
    buffer_load_dwordx4 v8, s[28:31], s49 offen lds
    s_add_u32 m0, m0, 0x420
    s_add_u32 s49, s49, 0xe00
    s_waitcnt lgkmcnt(4)
    v_dot2c_f32_bf16 v244, s61, v220
    v_dot2c_f32_bf16 v246, v220, v220
    v_dot2c_f32_bf16 v245, s61, v221
    v_dot2c_f32_bf16 v247, v221, v221
    v_dot2c_f32_bf16 v244, s61, v222
    v_dot2c_f32_bf16 v246, v222, v222
    v_dot2c_f32_bf16 v245, s61, v223
    v_dot2c_f32_bf16 v247, v223, v223
    s_waitcnt lgkmcnt(3)
    v_dot2c_f32_bf16 v244, s61, v224
    v_dot2c_f32_bf16 v246, v224, v224
    v_dot2c_f32_bf16 v245, s61, v225
    v_dot2c_f32_bf16 v247, v225, v225
    buffer_load_dwordx4 v8, s[28:31], s49 offen lds
    s_add_u32 m0, s45, 0x10800
    s_add_u32 s49, s49, 0x2e600
    v_dot2c_f32_bf16 v244, s61, v226
    v_dot2c_f32_bf16 v246, v226, v226
    v_dot2c_f32_bf16 v245, s61, v227
    v_dot2c_f32_bf16 v247, v227, v227
    s_waitcnt lgkmcnt(2)
    v_dot2c_f32_bf16 v244, s61, v228
    v_dot2c_f32_bf16 v246, v228, v228
    v_dot2c_f32_bf16 v245, s61, v229
    v_dot2c_f32_bf16 v247, v229, v229
    v_dot2c_f32_bf16 v244, s61, v230
    v_dot2c_f32_bf16 v246, v230, v230
    v_dot2c_f32_bf16 v245, s61, v231
    v_dot2c_f32_bf16 v247, v231, v231
    s_waitcnt lgkmcnt(1)
    v_dot2c_f32_bf16 v244, s61, v232
    v_dot2c_f32_bf16 v246, v232, v232
    v_dot2c_f32_bf16 v245, s61, v233
    v_dot2c_f32_bf16 v247, v233, v233
    v_dot2c_f32_bf16 v244, s61, v234
    v_dot2c_f32_bf16 v246, v234, v234
    v_dot2c_f32_bf16 v245, s61, v235
    v_dot2c_f32_bf16 v247, v235, v235
    s_waitcnt lgkmcnt(0)
    v_dot2c_f32_bf16 v244, s61, v236
    v_dot2c_f32_bf16 v246, v236, v236
    v_dot2c_f32_bf16 v245, s61, v237
    v_dot2c_f32_bf16 v247, v237, v237
    v_dot2c_f32_bf16 v244, s61, v238
    v_dot2c_f32_bf16 v246, v238, v238
    v_dot2c_f32_bf16 v245, s61, v239
    v_dot2c_f32_bf16 v247, v239, v239
    s_barrier
    buffer_load_dwordx4 v8, s[28:31], s49 offen lds
    s_add_u32 m0, m0, 0x420
    s_add_u32 s49, s49, 0xe00
    buffer_load_dwordx4 v8, s[28:31], s49 offen lds
    s_add_u32 m0, m0, 0x420
    s_add_u32 s49, s49, 0xe00
    buffer_load_dwordx4 v8, s[28:31], s49 offen lds
    s_add_u32 m0, m0, 0x420
    s_add_u32 s49, s49, 0xe00
    buffer_load_dwordx4 v8, s[28:31], s49 offen lds
    s_add_u32 m0, m0, 0x420
    s_add_u32 s49, s49, 0x4600
    buffer_load_dwordx4 v8, s[28:31], s49 offen lds
    s_add_u32 m0, m0, 0x420
    s_add_u32 s49, s49, 0xe00
    buffer_load_dwordx4 v8, s[28:31], s49 offen lds
    s_add_u32 m0, m0, 0x420
    s_add_u32 s49, s49, 0xe00
    buffer_load_dwordx4 v8, s[28:31], s49 offen lds
    s_add_u32 m0, m0, 0x420
    s_add_u32 s49, s49, 0xe00
    buffer_load_dwordx4 v8, s[28:31], s49 offen lds
    s_add_u32 m0, s45, 0x8400
    s_add_u32 s49, s49, 0x2e600
    v_add_f32 v244, v244, v245
    v_add_f32 v246, v246, v247
    v_mov_b32 v249, v244
    s_nop 1
    v_permlane16_swap_b32 v244, v249
    v_add_f32 v244, v244, v249
    v_mov_b32 v249, v244
    s_nop 1
    v_permlane32_swap_b32 v244, v249
    v_add_f32 v244, v244, v249
    v_mov_b32 v249, v246
    s_nop 1
    v_permlane16_swap_b32 v246, v249
    v_add_f32 v246, v246, v249
    v_mov_b32 v249, v246
    s_nop 1
    v_permlane32_swap_b32 v246, v249
    v_add_f32 v246, v246, v249
    v_mul_f32 v244, 0x3b124925, v244
    v_mul_f32 v246, 0x3b124925, v246
    v_fma_f32 v246, -v244, v244, v246
    v_max_f32 v246, 0, v246
    v_cvt_pk_bf16_f32 v246, v246, v246
    v_and_b32 v246, 0xffff0000, v246
    v_add_f32 v246, 0x3727c5ac, v246
    v_cvt_pk_bf16_f32 v246, v246, v246
    v_and_b32 v246, 0xffff0000, v246
    v_sqrt_f32 v246, v246
    s_nop 0
    v_cvt_pk_bf16_f32 v246, v246, v246
    v_and_b32 v246, 0xffff0000, v246
    v_rcp_f32 v253, v246
    v_cvt_pk_bf16_f32 v244, v244, v244
    v_and_b32 v244, 0xffff0000, v244
    v_mul_f32 v255, v244, v253
    v_sub_f32 v255, 0, v255
    v_lshlrev_b32 v16, 16, v184
    v_and_b32 v17, 0xffff0000, v184
    v_lshlrev_b32 v18, 16, v185
    v_and_b32 v19, 0xffff0000, v185
    v_lshlrev_b32 v20, 16, v186
    v_and_b32 v21, 0xffff0000, v186
    v_lshlrev_b32 v22, 16, v187
    v_and_b32 v23, 0xffff0000, v187
    v_pk_fma_f32 v[16:17], v[16:17], v[252:253], v[254:255] op_sel:[0,1,1] op_sel_hi:[1,1,1]
    v_pk_fma_f32 v[18:19], v[18:19], v[252:253], v[254:255] op_sel:[0,1,1] op_sel_hi:[1,1,1]
    v_pk_fma_f32 v[20:21], v[20:21], v[252:253], v[254:255] op_sel:[0,1,1] op_sel_hi:[1,1,1]
    v_pk_fma_f32 v[22:23], v[22:23], v[252:253], v[254:255] op_sel:[0,1,1] op_sel_hi:[1,1,1]
    v_cvt_pk_bf16_f32 v184, v16, v17
    v_cvt_pk_bf16_f32 v185, v18, v19
    v_cvt_pk_bf16_f32 v186, v20, v21
    v_cvt_pk_bf16_f32 v187, v22, v23
    v_lshlrev_b32 v24, 16, v188
    v_and_b32 v25, 0xffff0000, v188
    v_lshlrev_b32 v26, 16, v189
    v_and_b32 v27, 0xffff0000, v189
    v_lshlrev_b32 v28, 16, v190
    v_and_b32 v29, 0xffff0000, v190
    v_lshlrev_b32 v30, 16, v191
    v_and_b32 v31, 0xffff0000, v191
    v_pk_fma_f32 v[24:25], v[24:25], v[252:253], v[254:255] op_sel:[0,1,1] op_sel_hi:[1,1,1]
    v_pk_fma_f32 v[26:27], v[26:27], v[252:253], v[254:255] op_sel:[0,1,1] op_sel_hi:[1,1,1]
    v_pk_fma_f32 v[28:29], v[28:29], v[252:253], v[254:255] op_sel:[0,1,1] op_sel_hi:[1,1,1]
    v_pk_fma_f32 v[30:31], v[30:31], v[252:253], v[254:255] op_sel:[0,1,1] op_sel_hi:[1,1,1]
    v_cvt_pk_bf16_f32 v188, v24, v25
    v_cvt_pk_bf16_f32 v189, v26, v27
    v_cvt_pk_bf16_f32 v190, v28, v29
    v_cvt_pk_bf16_f32 v191, v30, v31
    s_waitcnt vmcnt(8)
    s_barrier
    ds_read_b64_tr_b16 a[128:129], v4
    ds_read_b64_tr_b16 a[130:131], v4 offset:256
    ds_read_b64_tr_b16 a[132:133], v4 offset:16896
    ds_read_b64_tr_b16 a[134:135], v4 offset:17152
    ds_read_b64_tr_b16 a[136:137], v4 offset:8448
    ds_read_b64_tr_b16 a[138:139], v4 offset:8704
    ds_read_b64_tr_b16 a[140:141], v4 offset:25344
    ds_read_b64_tr_b16 a[142:143], v4 offset:25600
    ds_read_b64_tr_b16 a[144:145], v4 offset:32
    ds_read_b64_tr_b16 a[146:147], v4 offset:288
    ds_read_b64_tr_b16 a[148:149], v4 offset:16928
    ds_read_b64_tr_b16 a[150:151], v4 offset:17184
    ds_read_b64_tr_b16 a[152:153], v4 offset:8480
    ds_read_b64_tr_b16 a[154:155], v4 offset:8736
    ds_read_b64_tr_b16 a[156:157], v4 offset:25376
    s_waitcnt lgkmcnt(12)
    ds_read_b64_tr_b16 a[158:159], v4 offset:25632
    v_mfma_f32_16x16x32_bf16 v[16:19], a[128:131], v[128:131], 0
    s_waitcnt lgkmcnt(12)
    buffer_load_dwordx4 v8, s[28:31], s49 offen lds
    v_mfma_f32_16x16x32_bf16 v[16:19], a[132:135], v[132:135], v[16:19]
    s_add_u32 m0, m0, 0x420
    s_add_u32 s49, s49, 0xe00
    v_lshlrev_b32 v240, 16, v192
    v_mfma_f32_16x16x32_bf16 v[20:23], a[128:131], v[184:187], 0
    ds_read_b64_tr_b16 a[128:129], v4 offset:64
    ds_read_b64_tr_b16 a[130:131], v4 offset:320
    v_mfma_f32_16x16x32_bf16 v[20:23], a[132:135], v[188:191], v[20:23]
    s_waitcnt lgkmcnt(12)
    ds_read_b64_tr_b16 a[132:133], v4 offset:16960
    ds_read_b64_tr_b16 a[134:135], v4 offset:17216
    v_mfma_f32_16x16x32_bf16 v[72:75], a[136:139], v[128:131], 0
    s_waitcnt lgkmcnt(12)
    buffer_load_dwordx4 v8, s[28:31], s49 offen lds
    v_mfma_f32_16x16x32_bf16 v[72:75], a[140:143], v[132:135], v[72:75]
    s_add_u32 m0, m0, 0x420
    s_add_u32 s49, s49, 0xe00
    v_and_b32 v241, 0xffff0000, v192
    v_mfma_f32_16x16x32_bf16 v[76:79], a[136:139], v[184:187], 0
    ds_read_b64_tr_b16 a[136:137], v4 offset:8512
    ds_read_b64_tr_b16 a[138:139], v4 offset:8768
    v_mfma_f32_16x16x32_bf16 v[76:79], a[140:143], v[188:191], v[76:79]
    s_waitcnt lgkmcnt(12)
    buffer_load_dwordx4 v8, s[28:31], s49 offen lds
    v_mfma_f32_16x16x32_bf16 v[24:27], a[144:147], v[128:131], 0
    s_waitcnt lgkmcnt(10)
    ds_read_b64_tr_b16 a[140:141], v4 offset:25408
    ds_read_b64_tr_b16 a[142:143], v4 offset:25664
    v_mfma_f32_16x16x32_bf16 v[24:27], a[148:151], v[132:135], v[24:27]
    s_add_u32 m0, m0, 0x420
    s_add_u32 s49, s49, 0xe00
    v_fma_f32 v240, v240, v253, v255
    v_mfma_f32_16x16x32_bf16 v[28:31], a[144:147], v[184:187], 0
    buffer_load_dwordx4 v8, s[28:31], s49 offen lds
    v_mfma_f32_16x16x32_bf16 v[28:31], a[148:151], v[188:191], v[28:31]
    s_waitcnt lgkmcnt(10)
    ds_read_b64_tr_b16 a[144:145], v4 offset:96
    ds_read_b64_tr_b16 a[146:147], v4 offset:352
    v_mfma_f32_16x16x32_bf16 v[80:83], a[152:155], v[128:131], 0
    s_waitcnt lgkmcnt(10)
    s_add_u32 m0, m0, 0x420
    s_add_u32 s49, s49, 0x4600
    v_mfma_f32_16x16x32_bf16 v[80:83], a[156:159], v[132:135], v[80:83]
    ds_read_b64_tr_b16 a[148:149], v4 offset:16992
    ds_read_b64_tr_b16 a[150:151], v4 offset:17248
    buffer_load_dwordx4 v8, s[28:31], s49 offen lds
    v_mfma_f32_16x16x32_bf16 v[84:87], a[152:155], v[184:187], 0
    s_add_u32 m0, m0, 0x420
    s_add_u32 s49, s49, 0xe00
    ds_read_b64_tr_b16 a[152:153], v4 offset:8544
    v_mfma_f32_16x16x32_bf16 v[84:87], a[156:159], v[188:191], v[84:87]
    s_waitcnt lgkmcnt(11)
    ds_read_b64_tr_b16 a[154:155], v4 offset:8800
    ds_read_b64_tr_b16 a[156:157], v4 offset:25440
    v_mfma_f32_16x16x32_bf16 v[32:35], a[128:131], v[128:131], 0
    s_waitcnt lgkmcnt(11)
    buffer_load_dwordx4 v8, s[28:31], s49 offen lds
    v_mfma_f32_16x16x32_bf16 v[32:35], a[132:135], v[132:135], v[32:35]
    s_add_u32 m0, m0, 0x420
    s_add_u32 s49, s49, 0xe00
    ds_read_b64_tr_b16 a[158:159], v4 offset:25696
    v_mfma_f32_16x16x32_bf16 v[36:39], a[128:131], v[184:187], 0
    buffer_load_dwordx4 v8, s[28:31], s49 offen lds
    v_mfma_f32_16x16x32_bf16 v[36:39], a[132:135], v[188:191], v[36:39]
    s_waitcnt lgkmcnt(10)
    ds_read_b64_tr_b16 a[128:129], v4 offset:128
    ds_read_b64_tr_b16 a[130:131], v4 offset:384
    v_mfma_f32_16x16x32_bf16 v[88:91], a[136:139], v[128:131], 0
    s_waitcnt lgkmcnt(10)
    s_add_u32 m0, m0, 0x420
    s_add_u32 s49, s49, 0xe00
    buffer_load_dwordx4 v8, s[28:31], s49 offen lds
    s_add_u32 m0, s45, 0x18c00
    s_add_u32 s49, s49, 0x2e600
    v_mfma_f32_16x16x32_bf16 v[88:91], a[140:143], v[132:135], v[88:91]
    ds_read_b64_tr_b16 a[132:133], v4 offset:17024
    ds_read_b64_tr_b16 a[134:135], v4 offset:17280
    v_mfma_f32_16x16x32_bf16 v[92:95], a[136:139], v[184:187], 0
    ds_read_b64_tr_b16 a[136:137], v4 offset:8576
    ds_read_b64_tr_b16 a[138:139], v4 offset:8832
    v_mfma_f32_16x16x32_bf16 v[92:95], a[140:143], v[188:191], v[92:95]
    s_waitcnt lgkmcnt(12)
    buffer_load_dwordx4 v8, s[28:31], s49 offen lds
    v_mfma_f32_16x16x32_bf16 v[40:43], a[144:147], v[128:131], 0
    s_waitcnt lgkmcnt(10)
    ds_read_b64_tr_b16 a[140:141], v4 offset:25472
    ds_read_b64_tr_b16 a[142:143], v4 offset:25728
    v_mfma_f32_16x16x32_bf16 v[40:43], a[148:151], v[132:135], v[40:43]
    s_add_u32 m0, m0, 0x420
    s_add_u32 s49, s49, 0xe00
    v_fma_f32 v241, v241, v253, v255
    v_mfma_f32_16x16x32_bf16 v[44:47], a[144:147], v[184:187], 0
    buffer_load_dwordx4 v8, s[28:31], s49 offen lds
    v_mfma_f32_16x16x32_bf16 v[44:47], a[148:151], v[188:191], v[44:47]
    s_waitcnt lgkmcnt(10)
    ds_read_b64_tr_b16 a[144:145], v4 offset:160
    ds_read_b64_tr_b16 a[146:147], v4 offset:416
    v_mfma_f32_16x16x32_bf16 v[96:99], a[152:155], v[128:131], 0
    s_waitcnt lgkmcnt(10)
    s_add_u32 m0, m0, 0x420
    s_add_u32 s49, s49, 0xe00
    v_mfma_f32_16x16x32_bf16 v[96:99], a[156:159], v[132:135], v[96:99]
    ds_read_b64_tr_b16 a[148:149], v4 offset:17056
    ds_read_b64_tr_b16 a[150:151], v4 offset:17312
    buffer_load_dwordx4 v8, s[28:31], s49 offen lds
    v_mfma_f32_16x16x32_bf16 v[100:103], a[152:155], v[184:187], 0
    s_add_u32 m0, m0, 0x420
    s_add_u32 s49, s49, 0xe00
    ds_read_b64_tr_b16 a[152:153], v4 offset:8608
    v_mfma_f32_16x16x32_bf16 v[100:103], a[156:159], v[188:191], v[100:103]
    s_waitcnt lgkmcnt(11)
    buffer_load_dwordx4 v8, s[28:31], s49 offen lds
    v_mfma_f32_16x16x32_bf16 v[48:51], a[128:131], v[128:131], 0
    s_waitcnt lgkmcnt(9)
    ds_read_b64_tr_b16 a[154:155], v4 offset:8864
    ds_read_b64_tr_b16 a[156:157], v4 offset:25504
    v_mfma_f32_16x16x32_bf16 v[48:51], a[132:135], v[132:135], v[48:51]
    s_add_u32 m0, m0, 0x420
    s_add_u32 s49, s49, 0x4600
    ds_read_b64_tr_b16 a[158:159], v4 offset:25760
    v_mfma_f32_16x16x32_bf16 v[52:55], a[128:131], v[184:187], 0
    s_lshl_b32 s62, s44, 2
    buffer_load_dwordx4 v8, s[28:31], s49 offen lds
    v_mfma_f32_16x16x32_bf16 v[52:55], a[132:135], v[188:191], v[52:55]
    s_waitcnt lgkmcnt(10)
    ds_read_b64_tr_b16 a[128:129], v4 offset:192
    ds_read_b64_tr_b16 a[130:131], v4 offset:448
    v_mfma_f32_16x16x32_bf16 v[104:107], a[136:139], v[128:131], 0
    s_waitcnt lgkmcnt(10)
    s_add_u32 m0, m0, 0x420
    s_add_u32 s49, s49, 0xe00
    v_mfma_f32_16x16x32_bf16 v[104:107], a[140:143], v[132:135], v[104:107]
    ds_read_b64_tr_b16 a[132:133], v4 offset:17088
    ds_read_b64_tr_b16 a[134:135], v4 offset:17344
    buffer_load_dwordx4 v8, s[28:31], s49 offen lds
    v_mfma_f32_16x16x32_bf16 v[108:111], a[136:139], v[184:187], 0
    s_add_u32 m0, m0, 0x420
    s_add_u32 s49, s49, 0xe00
    ds_read_b64_tr_b16 a[136:137], v4 offset:8640
    v_mfma_f32_16x16x32_bf16 v[108:111], a[140:143], v[188:191], v[108:111]
    s_waitcnt lgkmcnt(11)
    buffer_load_dwordx4 v8, s[28:31], s49 offen lds
    v_mfma_f32_16x16x32_bf16 v[56:59], a[144:147], v[128:131], 0
    s_waitcnt lgkmcnt(9)
    ds_read_b64_tr_b16 a[138:139], v4 offset:8896
    ds_read_b64_tr_b16 a[140:141], v4 offset:25536
    v_mfma_f32_16x16x32_bf16 v[56:59], a[148:151], v[132:135], v[56:59]
    s_add_u32 m0, m0, 0x420
    s_add_u32 s49, s49, 0xe00
    ds_read_b64_tr_b16 a[142:143], v4 offset:25792
    buffer_load_dwordx4 v8, s[28:31], s49 offen lds
    s_add_u32 m0, s45, 0
    s_add_u32 s49, s49, 0x2e600
    v_mfma_f32_16x16x32_bf16 v[60:63], a[144:147], v[184:187], 0
    s_add_u32 s62, s62, s42
    v_cvt_pk_bf16_f32 v192, v240, v241
    v_lshlrev_b32 v242, 16, v193
    v_mfma_f32_16x16x32_bf16 v[60:63], a[148:151], v[188:191], v[60:63]
    s_waitcnt lgkmcnt(10)
    s_waitcnt vmcnt(16) lgkmcnt(0)
    s_barrier
    v_mfma_f32_16x16x32_bf16 v[112:115], a[152:155], v[128:131], 0
    ds_read_b64_tr_b16 a[144:145], v5
    ds_read_b64_tr_b16 a[146:147], v5 offset:256
    v_mfma_f32_16x16x32_bf16 v[112:115], a[156:159], v[132:135], v[112:115]
    s_mul_i32 s62, s62, 7
    ds_read_b64_tr_b16 a[148:149], v5 offset:16896
    ds_read_b64_tr_b16 a[150:151], v5 offset:17152
    v_mfma_f32_16x16x32_bf16 v[116:119], a[152:155], v[184:187], 0
    buffer_load_dwordx4 v8, s[28:31], s49 offen lds
    v_mfma_f32_16x16x32_bf16 v[116:119], a[156:159], v[188:191], v[116:119]
    ds_read_b64_tr_b16 a[152:153], v5 offset:8448
    ds_read_b64_tr_b16 a[154:155], v5 offset:8704
    v_mfma_f32_16x16x32_bf16 v[64:67], a[128:131], v[128:131], 0
    ds_read_b64_tr_b16 a[156:157], v5 offset:25344
    ds_read_b64_tr_b16 a[158:159], v5 offset:25600
    v_mfma_f32_16x16x32_bf16 v[64:67], a[132:135], v[132:135], v[64:67]
    s_add_u32 m0, m0, 0x420
    s_add_u32 s49, s49, 0xe00
    v_and_b32 v243, 0xffff0000, v193
    v_mfma_f32_16x16x32_bf16 v[68:71], a[128:131], v[184:187], 0
    ds_read_b64_tr_b16 a[128:129], v5 offset:32
    ds_read_b64_tr_b16 a[130:131], v5 offset:288
    v_mfma_f32_16x16x32_bf16 v[68:71], a[132:135], v[188:191], v[68:71]
    ds_read_b64_tr_b16 a[132:133], v5 offset:16928
    ds_read_b64_tr_b16 a[134:135], v5 offset:17184
    v_mfma_f32_16x16x32_bf16 v[120:123], a[136:139], v[128:131], 0
    buffer_load_dwordx4 v8, s[28:31], s49 offen lds
    v_mfma_f32_16x16x32_bf16 v[120:123], a[140:143], v[132:135], v[120:123]
    v_fma_f32 v242, v242, v253, v255
    v_fma_f32 v243, v243, v253, v255
    v_cvt_pk_bf16_f32 v193, v242, v243
    v_lshlrev_b32 v244, 16, v194
    v_and_b32 v245, 0xffff0000, v194
    v_fma_f32 v244, v244, v253, v255
    v_fma_f32 v245, v245, v253, v255
    v_cvt_pk_bf16_f32 v194, v244, v245
    v_lshlrev_b32 v246, 16, v195
    v_and_b32 v247, 0xffff0000, v195
    v_fma_f32 v246, v246, v253, v255
    v_fma_f32 v247, v247, v253, v255
    v_cvt_pk_bf16_f32 v195, v246, v247
    v_mfma_f32_16x16x32_bf16 v[124:127], a[136:139], v[184:187], 0
    v_lshlrev_b32 v240, 16, v196
    v_and_b32 v241, 0xffff0000, v196
    v_fma_f32 v240, v240, v253, v255
    v_fma_f32 v241, v241, v253, v255
    v_cvt_pk_bf16_f32 v196, v240, v241
    v_lshlrev_b32 v242, 16, v197
    v_and_b32 v243, 0xffff0000, v197
    v_fma_f32 v242, v242, v253, v255
    v_fma_f32 v243, v243, v253, v255
    v_cvt_pk_bf16_f32 v197, v242, v243
    v_lshlrev_b32 v244, 16, v198
    v_and_b32 v245, 0xffff0000, v198
    v_fma_f32 v244, v244, v253, v255
    v_fma_f32 v245, v245, v253, v255
    v_cvt_pk_bf16_f32 v198, v244, v245
    v_lshlrev_b32 v246, 16, v199
    v_and_b32 v247, 0xffff0000, v199
    v_fma_f32 v246, v246, v253, v255
    v_fma_f32 v247, v247, v253, v255
    v_cvt_pk_bf16_f32 v199, v246, v247
    v_mfma_f32_16x16x32_bf16 v[124:127], a[140:143], v[188:191], v[124:127]
    s_waitcnt lgkmcnt(10)
    s_add_u32 m0, m0, 0x420
    s_add_u32 s49, s49, 0xe00
    v_mfma_f32_16x16x32_bf16 v[16:19], a[144:147], v[136:139], v[16:19]
    s_waitcnt lgkmcnt(8)
    ds_read_b64_tr_b16 a[136:137], v5 offset:8480
    ds_read_b64_tr_b16 a[138:139], v5 offset:8736
    v_mfma_f32_16x16x32_bf16 v[16:19], a[148:151], v[140:143], v[16:19]
    ds_read_b64_tr_b16 a[140:141], v5 offset:25376
    ds_read_b64_tr_b16 a[142:143], v5 offset:25632
    v_mfma_f32_16x16x32_bf16 v[20:23], a[144:147], v[192:195], v[20:23]
    ds_read_b64_tr_b16 a[144:145], v5 offset:64
    ds_read_b64_tr_b16 a[146:147], v5 offset:320
    v_mfma_f32_16x16x32_bf16 v[20:23], a[148:151], v[196:199], v[20:23]
    s_waitcnt lgkmcnt(12)
    buffer_load_dwordx4 v8, s[28:31], s49 offen lds
    v_mfma_f32_16x16x32_bf16 v[72:75], a[152:155], v[136:139], v[72:75]
    s_waitcnt lgkmcnt(10)
    ds_read_b64_tr_b16 a[148:149], v5 offset:16960
    ds_read_b64_tr_b16 a[150:151], v5 offset:17216
    v_mfma_f32_16x16x32_bf16 v[72:75], a[156:159], v[140:143], v[72:75]
    s_add_u32 m0, m0, 0x420
    s_add_u32 s49, s49, 0xe00
    v_lshrrev_b32 v14, 3, v0
    v_mfma_f32_16x16x32_bf16 v[76:79], a[152:155], v[192:195], v[76:79]
    ds_read_b64_tr_b16 a[152:153], v5 offset:8512
    ds_read_b64_tr_b16 a[154:155], v5 offset:8768
    v_mfma_f32_16x16x32_bf16 v[76:79], a[156:159], v[196:199], v[76:79]
    s_waitcnt lgkmcnt(12)
    ds_read_b64_tr_b16 a[156:157], v5 offset:25408
    ds_read_b64_tr_b16 a[158:159], v5 offset:25664
    v_mfma_f32_16x16x32_bf16 v[24:27], a[128:131], v[136:139], v[24:27]
    s_waitcnt lgkmcnt(12)
    buffer_load_dwordx4 v8, s[28:31], s49 offen lds
    v_mfma_f32_16x16x32_bf16 v[24:27], a[132:135], v[140:143], v[24:27]
    s_add_u32 m0, m0, 0x420
    s_add_u32 s49, s49, 0x4600
    v_min_u32 v14, 6, v14
    v_mfma_f32_16x16x32_bf16 v[28:31], a[128:131], v[192:195], v[28:31]
    ds_read_b64_tr_b16 a[128:129], v5 offset:96
    ds_read_b64_tr_b16 a[130:131], v5 offset:352
    v_mfma_f32_16x16x32_bf16 v[28:31], a[132:135], v[196:199], v[28:31]
    s_waitcnt lgkmcnt(12)
    ds_read_b64_tr_b16 a[132:133], v5 offset:16992
    ds_read_b64_tr_b16 a[134:135], v5 offset:17248
    v_mfma_f32_16x16x32_bf16 v[80:83], a[136:139], v[136:139], v[80:83]
    s_waitcnt lgkmcnt(12)
    v_add_u32 v14, s62, v14
    v_and_b32 v15, 3, v14
    v_mfma_f32_16x16x32_bf16 v[80:83], a[140:143], v[140:143], v[80:83]
    v_lshrrev_b32 v14, 2, v14
    v_lshlrev_b32 v14, 13, v14
    v_mfma_f32_16x16x32_bf16 v[84:87], a[136:139], v[192:195], v[84:87]
    v_lshl_add_u32 v14, v15, 7, v14
    s_lshl_b32 s62, s43, 9
    buffer_load_dword v13, v14, s[20:23], s62 offen
    v_mfma_f32_16x16x32_bf16 v[84:87], a[140:143], v[196:199], v[84:87]
    s_waitcnt lgkmcnt(10)
    ds_read_b64_tr_b16 a[136:137], v5 offset:8544
    ds_read_b64_tr_b16 a[138:139], v5 offset:8800
    v_mfma_f32_16x16x32_bf16 v[32:35], a[144:147], v[136:139], v[32:35]
    s_waitcnt lgkmcnt(10)
    ds_read_b64_tr_b16 a[140:141], v5 offset:25440
    ds_read_b64_tr_b16 a[142:143], v5 offset:25696
    v_mfma_f32_16x16x32_bf16 v[32:35], a[148:151], v[140:143], v[32:35]
    buffer_load_dwordx4 v8, s[28:31], s49 offen lds
    v_mfma_f32_16x16x32_bf16 v[36:39], a[144:147], v[192:195], v[36:39]
    s_add_u32 m0, m0, 0x420
    ds_read_b64_tr_b16 a[144:145], v5 offset:128
    ds_read_b64_tr_b16 a[146:147], v5 offset:384
    v_mfma_f32_16x16x32_bf16 v[36:39], a[148:151], v[196:199], v[36:39]
    s_waitcnt lgkmcnt(12)
    s_add_u32 s49, s49, 0xe00
    ds_read_b64_tr_b16 a[148:149], v5 offset:17024
    v_mfma_f32_16x16x32_bf16 v[88:91], a[152:155], v[136:139], v[88:91]
    s_waitcnt lgkmcnt(11)
    ds_read_b64_tr_b16 a[150:151], v5 offset:17280
    v_lshlrev_b32 v240, 16, v200
    v_mfma_f32_16x16x32_bf16 v[88:91], a[156:159], v[140:143], v[88:91]
    buffer_load_dwordx4 v8, s[28:31], s49 offen lds
    v_mfma_f32_16x16x32_bf16 v[92:95], a[152:155], v[192:195], v[92:95]
    s_add_u32 m0, m0, 0x420
    ds_read_b64_tr_b16 a[152:153], v5 offset:8576
    ds_read_b64_tr_b16 a[154:155], v5 offset:8832
    v_mfma_f32_16x16x32_bf16 v[92:95], a[156:159], v[196:199], v[92:95]
    s_waitcnt lgkmcnt(12)
    ds_read_b64_tr_b16 a[156:157], v5 offset:25472
    ds_read_b64_tr_b16 a[158:159], v5 offset:25728
    v_mfma_f32_16x16x32_bf16 v[40:43], a[128:131], v[136:139], v[40:43]
    s_waitcnt lgkmcnt(12)
    s_add_u32 s49, s49, 0xe00
    v_and_b32 v241, 0xffff0000, v200
    v_mfma_f32_16x16x32_bf16 v[40:43], a[132:135], v[140:143], v[40:43]
    v_fma_f32 v240, v240, v253, v255
    v_fma_f32 v241, v241, v253, v255
    v_mfma_f32_16x16x32_bf16 v[44:47], a[128:131], v[192:195], v[44:47]
    ds_read_b64_tr_b16 a[128:129], v5 offset:160
    ds_read_b64_tr_b16 a[130:131], v5 offset:416
    v_mfma_f32_16x16x32_bf16 v[44:47], a[132:135], v[196:199], v[44:47]
    s_waitcnt lgkmcnt(12)
    ds_read_b64_tr_b16 a[132:133], v5 offset:17056
    ds_read_b64_tr_b16 a[134:135], v5 offset:17312
    v_mfma_f32_16x16x32_bf16 v[96:99], a[136:139], v[136:139], v[96:99]
    s_waitcnt lgkmcnt(12)
    buffer_load_dwordx4 v8, s[28:31], s49 offen lds
    v_mfma_f32_16x16x32_bf16 v[96:99], a[140:143], v[140:143], v[96:99]
    s_add_u32 m0, m0, 0x420
    s_add_u32 s49, s49, 0xe00
    v_cvt_pk_bf16_f32 v200, v240, v241
    v_mfma_f32_16x16x32_bf16 v[100:103], a[136:139], v[192:195], v[100:103]
    ds_read_b64_tr_b16 a[136:137], v5 offset:8608
    ds_read_b64_tr_b16 a[138:139], v5 offset:8864
    v_mfma_f32_16x16x32_bf16 v[100:103], a[140:143], v[196:199], v[100:103]
    s_waitcnt lgkmcnt(12)
    ds_read_b64_tr_b16 a[140:141], v5 offset:25504
    ds_read_b64_tr_b16 a[142:143], v5 offset:25760
    v_mfma_f32_16x16x32_bf16 v[48:51], a[144:147], v[136:139], v[48:51]
    s_waitcnt lgkmcnt(12)
    v_lshlrev_b32 v242, 16, v201
    v_and_b32 v243, 0xffff0000, v201
    v_mfma_f32_16x16x32_bf16 v[48:51], a[148:151], v[140:143], v[48:51]
    v_fma_f32 v242, v242, v253, v255
    v_fma_f32 v243, v243, v253, v255
    v_mfma_f32_16x16x32_bf16 v[52:55], a[144:147], v[192:195], v[52:55]
    ds_read_b64_tr_b16 a[144:145], v5 offset:192
    ds_read_b64_tr_b16 a[146:147], v5 offset:448
    v_mfma_f32_16x16x32_bf16 v[52:55], a[148:151], v[196:199], v[52:55]
    s_waitcnt lgkmcnt(12)
    ds_read_b64_tr_b16 a[148:149], v5 offset:17088
    ds_read_b64_tr_b16 a[150:151], v5 offset:17344
    v_mfma_f32_16x16x32_bf16 v[104:107], a[152:155], v[136:139], v[104:107]
    s_waitcnt lgkmcnt(12)
    buffer_load_dwordx4 v8, s[28:31], s49 offen lds
    v_mfma_f32_16x16x32_bf16 v[104:107], a[156:159], v[140:143], v[104:107]
    s_add_u32 m0, s45, 0x10800
    s_add_u32 s49, s49, 0x2e600
    v_cvt_pk_bf16_f32 v201, v242, v243
    v_mfma_f32_16x16x32_bf16 v[108:111], a[152:155], v[192:195], v[108:111]
    ds_read_b64_tr_b16 a[152:153], v5 offset:8640
    ds_read_b64_tr_b16 a[154:155], v5 offset:8896
    v_mfma_f32_16x16x32_bf16 v[108:111], a[156:159], v[196:199], v[108:111]
    s_waitcnt lgkmcnt(12)
    ds_read_b64_tr_b16 a[156:157], v5 offset:25536
    ds_read_b64_tr_b16 a[158:159], v5 offset:25792
    v_mfma_f32_16x16x32_bf16 v[56:59], a[128:131], v[136:139], v[56:59]
    s_waitcnt lgkmcnt(12)
    v_lshlrev_b32 v244, 16, v202
    v_and_b32 v245, 0xffff0000, v202
    v_mfma_f32_16x16x32_bf16 v[56:59], a[132:135], v[140:143], v[56:59]
    v_fma_f32 v244, v244, v253, v255
    v_fma_f32 v245, v245, v253, v255
    v_mfma_f32_16x16x32_bf16 v[60:63], a[128:131], v[192:195], v[60:63]
    v_cvt_pk_bf16_f32 v202, v244, v245
    v_lshlrev_b32 v246, 16, v203
    v_mfma_f32_16x16x32_bf16 v[60:63], a[132:135], v[196:199], v[60:63]
    s_waitcnt lgkmcnt(10)
    s_waitcnt vmcnt(17) lgkmcnt(0)
    s_barrier
    v_mfma_f32_16x16x32_bf16 v[112:115], a[136:139], v[136:139], v[112:115]
    ds_read_b64_tr_b16 a[128:129], v4 offset:33792
    ds_read_b64_tr_b16 a[130:131], v4 offset:34048
    v_mfma_f32_16x16x32_bf16 v[112:115], a[140:143], v[140:143], v[112:115]
    s_add_u32 s62, s62, 0xe0000
    ds_read_b64_tr_b16 a[132:133], v4 offset:50688
    ds_read_b64_tr_b16 a[134:135], v4 offset:50944
    v_mfma_f32_16x16x32_bf16 v[116:119], a[136:139], v[192:195], v[116:119]
    buffer_load_dwordx4 v8, s[28:31], s49 offen lds
    v_mfma_f32_16x16x32_bf16 v[116:119], a[140:143], v[196:199], v[116:119]
    ds_read_b64_tr_b16 a[136:137], v4 offset:42240
    ds_read_b64_tr_b16 a[138:139], v4 offset:42496
    v_mfma_f32_16x16x32_bf16 v[64:67], a[144:147], v[136:139], v[64:67]
    ds_read_b64_tr_b16 a[140:141], v4 offset:59136
    ds_read_b64_tr_b16 a[142:143], v4 offset:59392
    v_mfma_f32_16x16x32_bf16 v[64:67], a[148:151], v[140:143], v[64:67]
    s_add_u32 m0, m0, 0x420
    s_add_u32 s49, s49, 0xe00
    v_and_b32 v247, 0xffff0000, v203
    v_mfma_f32_16x16x32_bf16 v[68:71], a[144:147], v[192:195], v[68:71]
    ds_read_b64_tr_b16 a[144:145], v4 offset:33824
    ds_read_b64_tr_b16 a[146:147], v4 offset:34080
    v_mfma_f32_16x16x32_bf16 v[68:71], a[148:151], v[196:199], v[68:71]
    ds_read_b64_tr_b16 a[148:149], v4 offset:50720
    ds_read_b64_tr_b16 a[150:151], v4 offset:50976
    v_mfma_f32_16x16x32_bf16 v[120:123], a[152:155], v[136:139], v[120:123]
    buffer_load_dwordx4 v8, s[28:31], s49 offen lds
    v_mfma_f32_16x16x32_bf16 v[120:123], a[156:159], v[140:143], v[120:123]
    v_fma_f32 v246, v246, v253, v255
    v_fma_f32 v247, v247, v253, v255
    v_cvt_pk_bf16_f32 v203, v246, v247
    v_mfma_f32_16x16x32_bf16 v[124:127], a[152:155], v[192:195], v[124:127]
    v_lshlrev_b32 v240, 16, v204
    v_and_b32 v241, 0xffff0000, v204
    v_fma_f32 v240, v240, v253, v255
    v_fma_f32 v241, v241, v253, v255
    v_cvt_pk_bf16_f32 v204, v240, v241
    v_lshlrev_b32 v242, 16, v205
    v_and_b32 v243, 0xffff0000, v205
    v_fma_f32 v242, v242, v253, v255
    v_fma_f32 v243, v243, v253, v255
    v_cvt_pk_bf16_f32 v205, v242, v243
    v_lshlrev_b32 v244, 16, v206
    v_and_b32 v245, 0xffff0000, v206
    v_fma_f32 v244, v244, v253, v255
    v_fma_f32 v245, v245, v253, v255
    v_cvt_pk_bf16_f32 v206, v244, v245
    v_lshlrev_b32 v246, 16, v207
    v_and_b32 v247, 0xffff0000, v207
    v_fma_f32 v246, v246, v253, v255
    v_fma_f32 v247, v247, v253, v255
    v_cvt_pk_bf16_f32 v207, v246, v247
    v_mfma_f32_16x16x32_bf16 v[124:127], a[156:159], v[196:199], v[124:127]
    s_waitcnt lgkmcnt(10)
    s_add_u32 m0, m0, 0x420
    s_add_u32 s49, s49, 0xe00
    v_mfma_f32_16x16x32_bf16 v[16:19], a[128:131], v[144:147], v[16:19]
    s_waitcnt lgkmcnt(8)
    ds_read_b64_tr_b16 a[152:153], v4 offset:42272
    ds_read_b64_tr_b16 a[154:155], v4 offset:42528
    v_mfma_f32_16x16x32_bf16 v[16:19], a[132:135], v[148:151], v[16:19]
    ds_read_b64_tr_b16 a[156:157], v4 offset:59168
    ds_read_b64_tr_b16 a[158:159], v4 offset:59424
    v_mfma_f32_16x16x32_bf16 v[20:23], a[128:131], v[200:203], v[20:23]
    ds_read_b64_tr_b16 a[128:129], v4 offset:33856
    ds_read_b64_tr_b16 a[130:131], v4 offset:34112
    v_mfma_f32_16x16x32_bf16 v[20:23], a[132:135], v[204:207], v[20:23]
    s_waitcnt lgkmcnt(12)
    buffer_load_dwordx4 v8, s[28:31], s49 offen lds
    v_mfma_f32_16x16x32_bf16 v[72:75], a[136:139], v[144:147], v[72:75]
    s_waitcnt lgkmcnt(10)
    ds_read_b64_tr_b16 a[132:133], v4 offset:50752
    ds_read_b64_tr_b16 a[134:135], v4 offset:51008
    v_mfma_f32_16x16x32_bf16 v[72:75], a[140:143], v[148:151], v[72:75]
    s_add_u32 m0, m0, 0x420
    s_add_u32 s49, s49, 0xe00
    v_lshlrev_b32 v240, 16, v208
    v_mfma_f32_16x16x32_bf16 v[76:79], a[136:139], v[200:203], v[76:79]
    ds_read_b64_tr_b16 a[136:137], v4 offset:42304
    ds_read_b64_tr_b16 a[138:139], v4 offset:42560
    v_mfma_f32_16x16x32_bf16 v[76:79], a[140:143], v[204:207], v[76:79]
    s_waitcnt lgkmcnt(12)
    ds_read_b64_tr_b16 a[140:141], v4 offset:59200
    ds_read_b64_tr_b16 a[142:143], v4 offset:59456
    v_mfma_f32_16x16x32_bf16 v[24:27], a[144:147], v[144:147], v[24:27]
    s_waitcnt lgkmcnt(12)
    buffer_load_dwordx4 v8, s[28:31], s49 offen lds
    v_mfma_f32_16x16x32_bf16 v[24:27], a[148:151], v[148:151], v[24:27]
    s_add_u32 m0, m0, 0x420
    s_add_u32 s49, s49, 0x4600
    v_and_b32 v241, 0xffff0000, v208
    v_mfma_f32_16x16x32_bf16 v[28:31], a[144:147], v[200:203], v[28:31]
    ds_read_b64_tr_b16 a[144:145], v4 offset:33888
    ds_read_b64_tr_b16 a[146:147], v4 offset:34144
    v_mfma_f32_16x16x32_bf16 v[28:31], a[148:151], v[204:207], v[28:31]
    s_waitcnt lgkmcnt(12)
    ds_read_b64_tr_b16 a[148:149], v4 offset:50784
    ds_read_b64_tr_b16 a[150:151], v4 offset:51040
    v_mfma_f32_16x16x32_bf16 v[80:83], a[152:155], v[144:147], v[80:83]
    s_waitcnt lgkmcnt(12)
    buffer_load_dword v13, v14, s[20:23], s62 offen
    v_mfma_f32_16x16x32_bf16 v[80:83], a[156:159], v[148:151], v[80:83]
    v_fma_f32 v240, v240, v253, v255
    v_fma_f32 v241, v241, v253, v255
    v_mfma_f32_16x16x32_bf16 v[84:87], a[152:155], v[200:203], v[84:87]
    ds_read_b64_tr_b16 a[152:153], v4 offset:42336
    ds_read_b64_tr_b16 a[154:155], v4 offset:42592
    v_mfma_f32_16x16x32_bf16 v[84:87], a[156:159], v[204:207], v[84:87]
    s_waitcnt lgkmcnt(12)
    ds_read_b64_tr_b16 a[156:157], v4 offset:59232
    ds_read_b64_tr_b16 a[158:159], v4 offset:59488
    v_mfma_f32_16x16x32_bf16 v[32:35], a[128:131], v[144:147], v[32:35]
    s_waitcnt lgkmcnt(12)
    buffer_load_dwordx4 v8, s[28:31], s49 offen lds
    v_mfma_f32_16x16x32_bf16 v[32:35], a[132:135], v[148:151], v[32:35]
    s_add_u32 m0, m0, 0x420
    s_add_u32 s49, s49, 0xe00
    v_cvt_pk_bf16_f32 v208, v240, v241
    v_mfma_f32_16x16x32_bf16 v[36:39], a[128:131], v[200:203], v[36:39]
    ds_read_b64_tr_b16 a[128:129], v4 offset:33920
    ds_read_b64_tr_b16 a[130:131], v4 offset:34176
    v_mfma_f32_16x16x32_bf16 v[36:39], a[132:135], v[204:207], v[36:39]
    s_waitcnt lgkmcnt(12)
    ds_read_b64_tr_b16 a[132:133], v4 offset:50816
    ds_read_b64_tr_b16 a[134:135], v4 offset:51072
    v_mfma_f32_16x16x32_bf16 v[88:91], a[136:139], v[144:147], v[88:91]
    s_waitcnt lgkmcnt(12)
    v_lshlrev_b32 v242, 16, v209
    v_and_b32 v243, 0xffff0000, v209
    v_mfma_f32_16x16x32_bf16 v[88:91], a[140:143], v[148:151], v[88:91]
    buffer_load_dwordx4 v8, s[28:31], s49 offen lds
    v_mfma_f32_16x16x32_bf16 v[92:95], a[136:139], v[200:203], v[92:95]
    s_add_u32 m0, m0, 0x420
    ds_read_b64_tr_b16 a[136:137], v4 offset:42368
    ds_read_b64_tr_b16 a[138:139], v4 offset:42624
    v_mfma_f32_16x16x32_bf16 v[92:95], a[140:143], v[204:207], v[92:95]
    s_waitcnt lgkmcnt(12)
    ds_read_b64_tr_b16 a[140:141], v4 offset:59264
    ds_read_b64_tr_b16 a[142:143], v4 offset:59520
    v_mfma_f32_16x16x32_bf16 v[40:43], a[144:147], v[144:147], v[40:43]
    s_waitcnt lgkmcnt(12)
    s_add_u32 s49, s49, 0xe00
    v_fma_f32 v242, v242, v253, v255
    v_mfma_f32_16x16x32_bf16 v[40:43], a[148:151], v[148:151], v[40:43]
    v_fma_f32 v243, v243, v253, v255
    v_cvt_pk_bf16_f32 v209, v242, v243
    v_mfma_f32_16x16x32_bf16 v[44:47], a[144:147], v[200:203], v[44:47]
    ds_read_b64_tr_b16 a[144:145], v4 offset:33952
    ds_read_b64_tr_b16 a[146:147], v4 offset:34208
    v_mfma_f32_16x16x32_bf16 v[44:47], a[148:151], v[204:207], v[44:47]
    s_waitcnt lgkmcnt(12)
    ds_read_b64_tr_b16 a[148:149], v4 offset:50848
    ds_read_b64_tr_b16 a[150:151], v4 offset:51104
    v_mfma_f32_16x16x32_bf16 v[96:99], a[152:155], v[144:147], v[96:99]
    s_waitcnt lgkmcnt(12)
    buffer_load_dwordx4 v8, s[28:31], s49 offen lds
    v_mfma_f32_16x16x32_bf16 v[96:99], a[156:159], v[148:151], v[96:99]
    s_add_u32 m0, m0, 0x420
    s_add_u32 s49, s49, 0xe00
    v_lshlrev_b32 v244, 16, v210
    v_mfma_f32_16x16x32_bf16 v[100:103], a[152:155], v[200:203], v[100:103]
    ds_read_b64_tr_b16 a[152:153], v4 offset:42400
    ds_read_b64_tr_b16 a[154:155], v4 offset:42656
    v_mfma_f32_16x16x32_bf16 v[100:103], a[156:159], v[204:207], v[100:103]
    s_waitcnt lgkmcnt(12)
    ds_read_b64_tr_b16 a[156:157], v4 offset:59296
    ds_read_b64_tr_b16 a[158:159], v4 offset:59552
    v_mfma_f32_16x16x32_bf16 v[48:51], a[128:131], v[144:147], v[48:51]
    s_waitcnt lgkmcnt(12)
    v_and_b32 v245, 0xffff0000, v210
    v_fma_f32 v244, v244, v253, v255
    v_mfma_f32_16x16x32_bf16 v[48:51], a[132:135], v[148:151], v[48:51]
    v_fma_f32 v245, v245, v253, v255
    v_cvt_pk_bf16_f32 v210, v244, v245
    v_mfma_f32_16x16x32_bf16 v[52:55], a[128:131], v[200:203], v[52:55]
    ds_read_b64_tr_b16 a[128:129], v4 offset:33984
    ds_read_b64_tr_b16 a[130:131], v4 offset:34240
    v_mfma_f32_16x16x32_bf16 v[52:55], a[132:135], v[204:207], v[52:55]
    s_waitcnt lgkmcnt(12)
    ds_read_b64_tr_b16 a[132:133], v4 offset:50880
    ds_read_b64_tr_b16 a[134:135], v4 offset:51136
    v_mfma_f32_16x16x32_bf16 v[104:107], a[136:139], v[144:147], v[104:107]
    s_waitcnt lgkmcnt(12)
    buffer_load_dwordx4 v8, s[28:31], s49 offen lds
    v_mfma_f32_16x16x32_bf16 v[104:107], a[140:143], v[148:151], v[104:107]
    s_add_u32 m0, s45, 0x8400
    s_add_u32 s49, s49, 0x2e600
    v_lshlrev_b32 v246, 16, v211
    v_mfma_f32_16x16x32_bf16 v[108:111], a[136:139], v[200:203], v[108:111]
    ds_read_b64_tr_b16 a[136:137], v4 offset:42432
    ds_read_b64_tr_b16 a[138:139], v4 offset:42688
    v_mfma_f32_16x16x32_bf16 v[108:111], a[140:143], v[204:207], v[108:111]
    s_waitcnt lgkmcnt(12)
    ds_read_b64_tr_b16 a[140:141], v4 offset:59328
    ds_read_b64_tr_b16 a[142:143], v4 offset:59584
    v_mfma_f32_16x16x32_bf16 v[56:59], a[144:147], v[144:147], v[56:59]
    s_waitcnt lgkmcnt(12)
    v_and_b32 v247, 0xffff0000, v211
    v_fma_f32 v246, v246, v253, v255
    v_mfma_f32_16x16x32_bf16 v[56:59], a[148:151], v[148:151], v[56:59]
    v_fma_f32 v247, v247, v253, v255
    v_cvt_pk_bf16_f32 v211, v246, v247
    v_mfma_f32_16x16x32_bf16 v[60:63], a[144:147], v[200:203], v[60:63]
    v_lshlrev_b32 v240, 16, v212
    v_and_b32 v241, 0xffff0000, v212
    v_mfma_f32_16x16x32_bf16 v[60:63], a[148:151], v[204:207], v[60:63]
    s_waitcnt lgkmcnt(10)
    s_waitcnt vmcnt(18) lgkmcnt(0)
    s_barrier
    v_mfma_f32_16x16x32_bf16 v[112:115], a[152:155], v[144:147], v[112:115]
    ds_read_b64_tr_b16 a[144:145], v5 offset:33792
    ds_read_b64_tr_b16 a[146:147], v5 offset:34048
    v_mfma_f32_16x16x32_bf16 v[112:115], a[156:159], v[148:151], v[112:115]
    ds_read_b64_tr_b16 a[148:149], v5 offset:50688
    ds_read_b64_tr_b16 a[150:151], v5 offset:50944
    v_mfma_f32_16x16x32_bf16 v[116:119], a[152:155], v[200:203], v[116:119]
    buffer_load_dwordx4 v8, s[28:31], s49 offen lds
    v_mfma_f32_16x16x32_bf16 v[116:119], a[156:159], v[204:207], v[116:119]
    ds_read_b64_tr_b16 a[152:153], v5 offset:42240
    ds_read_b64_tr_b16 a[154:155], v5 offset:42496
    v_mfma_f32_16x16x32_bf16 v[64:67], a[128:131], v[144:147], v[64:67]
    ds_read_b64_tr_b16 a[156:157], v5 offset:59136
    ds_read_b64_tr_b16 a[158:159], v5 offset:59392
    v_mfma_f32_16x16x32_bf16 v[64:67], a[132:135], v[148:151], v[64:67]
    s_add_u32 m0, m0, 0x420
    s_add_u32 s49, s49, 0xe00
    v_fma_f32 v240, v240, v253, v255
    v_mfma_f32_16x16x32_bf16 v[68:71], a[128:131], v[200:203], v[68:71]
    ds_read_b64_tr_b16 a[128:129], v5 offset:33824
    ds_read_b64_tr_b16 a[130:131], v5 offset:34080
    v_mfma_f32_16x16x32_bf16 v[68:71], a[132:135], v[204:207], v[68:71]
    ds_read_b64_tr_b16 a[132:133], v5 offset:50720
    ds_read_b64_tr_b16 a[134:135], v5 offset:50976
    v_mfma_f32_16x16x32_bf16 v[120:123], a[136:139], v[144:147], v[120:123]
    buffer_load_dwordx4 v8, s[28:31], s49 offen lds
    v_mfma_f32_16x16x32_bf16 v[120:123], a[140:143], v[148:151], v[120:123]
    s_add_u32 m0, m0, 0x420
    v_fma_f32 v241, v241, v253, v255
    v_cvt_pk_bf16_f32 v212, v240, v241
    v_mfma_f32_16x16x32_bf16 v[124:127], a[136:139], v[200:203], v[124:127]
    v_lshlrev_b32 v242, 16, v213
    v_and_b32 v243, 0xffff0000, v213
    v_fma_f32 v242, v242, v253, v255
    v_fma_f32 v243, v243, v253, v255
    v_cvt_pk_bf16_f32 v213, v242, v243
    v_lshlrev_b32 v244, 16, v214
    v_and_b32 v245, 0xffff0000, v214
    v_fma_f32 v244, v244, v253, v255
    v_fma_f32 v245, v245, v253, v255
    v_cvt_pk_bf16_f32 v214, v244, v245
    v_lshlrev_b32 v246, 16, v215
    v_and_b32 v247, 0xffff0000, v215
    v_fma_f32 v246, v246, v253, v255
    v_fma_f32 v247, v247, v253, v255
    v_cvt_pk_bf16_f32 v215, v246, v247
    v_mfma_f32_16x16x32_bf16 v[124:127], a[140:143], v[204:207], v[124:127]
    s_waitcnt lgkmcnt(10)
    s_add_u32 s49, s49, 0xe00
    ds_read_b64_tr_b16 a[136:137], v5 offset:42272
    v_mfma_f32_16x16x32_bf16 v[16:19], a[144:147], v[152:155], v[16:19]
    s_waitcnt lgkmcnt(9)
    ds_read_b64_tr_b16 a[138:139], v5 offset:42528
    ds_read_b64_tr_b16 a[140:141], v5 offset:59168
    v_mfma_f32_16x16x32_bf16 v[16:19], a[148:151], v[156:159], v[16:19]
    ds_read_b64_tr_b16 a[142:143], v5 offset:59424
    v_lshlrev_b32 v240, 16, v216
    v_mfma_f32_16x16x32_bf16 v[20:23], a[144:147], v[208:211], v[20:23]
    s_add_u32 s62, s62, 0xe0000
    ds_read_b64_tr_b16 a[144:145], v5 offset:33856
    ds_read_b64_tr_b16 a[146:147], v5 offset:34112
    v_mfma_f32_16x16x32_bf16 v[20:23], a[148:151], v[212:215], v[20:23]
    s_waitcnt lgkmcnt(12)
    buffer_load_dwordx4 v8, s[28:31], s49 offen lds
    v_mfma_f32_16x16x32_bf16 v[72:75], a[152:155], v[152:155], v[72:75]
    s_waitcnt lgkmcnt(10)
    ds_read_b64_tr_b16 a[148:149], v5 offset:50752
    ds_read_b64_tr_b16 a[150:151], v5 offset:51008
    v_mfma_f32_16x16x32_bf16 v[72:75], a[156:159], v[156:159], v[72:75]
    s_add_u32 m0, m0, 0x420
    s_add_u32 s49, s49, 0xe00
    v_and_b32 v241, 0xffff0000, v216
    v_mfma_f32_16x16x32_bf16 v[76:79], a[152:155], v[208:211], v[76:79]
    ds_read_b64_tr_b16 a[152:153], v5 offset:42304
    ds_read_b64_tr_b16 a[154:155], v5 offset:42560
    v_mfma_f32_16x16x32_bf16 v[76:79], a[156:159], v[212:215], v[76:79]
    s_waitcnt lgkmcnt(12)
    ds_read_b64_tr_b16 a[156:157], v5 offset:59200
    ds_read_b64_tr_b16 a[158:159], v5 offset:59456
    v_mfma_f32_16x16x32_bf16 v[24:27], a[128:131], v[152:155], v[24:27]
    s_waitcnt lgkmcnt(12)
    buffer_load_dwordx4 v8, s[28:31], s49 offen lds
    v_mfma_f32_16x16x32_bf16 v[24:27], a[132:135], v[156:159], v[24:27]
    s_add_u32 m0, m0, 0x420
    s_add_u32 s49, s49, 0x4600
    v_fma_f32 v240, v240, v253, v255
    v_mfma_f32_16x16x32_bf16 v[28:31], a[128:131], v[208:211], v[28:31]
    ds_read_b64_tr_b16 a[128:129], v5 offset:33888
    ds_read_b64_tr_b16 a[130:131], v5 offset:34144
    v_mfma_f32_16x16x32_bf16 v[28:31], a[132:135], v[212:215], v[28:31]
    s_waitcnt lgkmcnt(12)
    ds_read_b64_tr_b16 a[132:133], v5 offset:50784
    ds_read_b64_tr_b16 a[134:135], v5 offset:51040
    v_mfma_f32_16x16x32_bf16 v[80:83], a[136:139], v[152:155], v[80:83]
    s_waitcnt lgkmcnt(12)
    buffer_load_dword v13, v14, s[20:23], s62 offen
    v_mfma_f32_16x16x32_bf16 v[80:83], a[140:143], v[156:159], v[80:83]
    v_fma_f32 v241, v241, v253, v255
    v_cvt_pk_bf16_f32 v216, v240, v241
    v_mfma_f32_16x16x32_bf16 v[84:87], a[136:139], v[208:211], v[84:87]
    ds_read_b64_tr_b16 a[136:137], v5 offset:42336
    ds_read_b64_tr_b16 a[138:139], v5 offset:42592
    v_mfma_f32_16x16x32_bf16 v[84:87], a[140:143], v[212:215], v[84:87]
    s_waitcnt lgkmcnt(12)
    ds_read_b64_tr_b16 a[140:141], v5 offset:59232
    ds_read_b64_tr_b16 a[142:143], v5 offset:59488
    v_mfma_f32_16x16x32_bf16 v[32:35], a[144:147], v[152:155], v[32:35]
    s_waitcnt lgkmcnt(12)
    buffer_load_dwordx4 v8, s[28:31], s49 offen lds
    v_mfma_f32_16x16x32_bf16 v[32:35], a[148:151], v[156:159], v[32:35]
    s_add_u32 m0, m0, 0x420
    s_add_u32 s49, s49, 0xe00
    v_lshlrev_b32 v242, 16, v217
    v_mfma_f32_16x16x32_bf16 v[36:39], a[144:147], v[208:211], v[36:39]
    ds_read_b64_tr_b16 a[144:145], v5 offset:33920
    ds_read_b64_tr_b16 a[146:147], v5 offset:34176
    v_mfma_f32_16x16x32_bf16 v[36:39], a[148:151], v[212:215], v[36:39]
    s_waitcnt lgkmcnt(12)
    ds_read_b64_tr_b16 a[148:149], v5 offset:50816
    ds_read_b64_tr_b16 a[150:151], v5 offset:51072
    v_mfma_f32_16x16x32_bf16 v[88:91], a[152:155], v[152:155], v[88:91]
    s_waitcnt lgkmcnt(12)
    v_and_b32 v243, 0xffff0000, v217
    v_fma_f32 v242, v242, v253, v255
    v_mfma_f32_16x16x32_bf16 v[88:91], a[156:159], v[156:159], v[88:91]
    buffer_load_dwordx4 v8, s[28:31], s49 offen lds
    v_mfma_f32_16x16x32_bf16 v[92:95], a[152:155], v[208:211], v[92:95]
    s_add_u32 m0, m0, 0x420
    ds_read_b64_tr_b16 a[152:153], v5 offset:42368
    ds_read_b64_tr_b16 a[154:155], v5 offset:42624
    v_mfma_f32_16x16x32_bf16 v[92:95], a[156:159], v[212:215], v[92:95]
    s_waitcnt lgkmcnt(12)
    ds_read_b64_tr_b16 a[156:157], v5 offset:59264
    ds_read_b64_tr_b16 a[158:159], v5 offset:59520
    v_mfma_f32_16x16x32_bf16 v[40:43], a[128:131], v[152:155], v[40:43]
    s_waitcnt lgkmcnt(12)
    s_add_u32 s49, s49, 0xe00
    v_fma_f32 v243, v243, v253, v255
    v_mfma_f32_16x16x32_bf16 v[40:43], a[132:135], v[156:159], v[40:43]
    v_cvt_pk_bf16_f32 v217, v242, v243
    v_lshlrev_b32 v244, 16, v218
    v_mfma_f32_16x16x32_bf16 v[44:47], a[128:131], v[208:211], v[44:47]
    ds_read_b64_tr_b16 a[128:129], v5 offset:33952
    ds_read_b64_tr_b16 a[130:131], v5 offset:34208
    v_mfma_f32_16x16x32_bf16 v[44:47], a[132:135], v[212:215], v[44:47]
    s_waitcnt lgkmcnt(12)
    ds_read_b64_tr_b16 a[132:133], v5 offset:50848
    ds_read_b64_tr_b16 a[134:135], v5 offset:51104
    v_mfma_f32_16x16x32_bf16 v[96:99], a[136:139], v[152:155], v[96:99]
    s_waitcnt lgkmcnt(12)
    buffer_load_dwordx4 v8, s[28:31], s49 offen lds
    v_mfma_f32_16x16x32_bf16 v[96:99], a[140:143], v[156:159], v[96:99]
    s_add_u32 m0, m0, 0x420
    s_add_u32 s49, s49, 0xe00
    v_and_b32 v245, 0xffff0000, v218
    v_mfma_f32_16x16x32_bf16 v[100:103], a[136:139], v[208:211], v[100:103]
    ds_read_b64_tr_b16 a[136:137], v5 offset:42400
    ds_read_b64_tr_b16 a[138:139], v5 offset:42656
    v_mfma_f32_16x16x32_bf16 v[100:103], a[140:143], v[212:215], v[100:103]
    s_waitcnt lgkmcnt(12)
    ds_read_b64_tr_b16 a[140:141], v5 offset:59296
    ds_read_b64_tr_b16 a[142:143], v5 offset:59552
    v_mfma_f32_16x16x32_bf16 v[48:51], a[144:147], v[152:155], v[48:51]
    s_waitcnt lgkmcnt(12)
    v_fma_f32 v244, v244, v253, v255
    v_fma_f32 v245, v245, v253, v255
    v_mfma_f32_16x16x32_bf16 v[48:51], a[148:151], v[156:159], v[48:51]
    v_cvt_pk_bf16_f32 v218, v244, v245
    v_lshlrev_b32 v246, 16, v219
    v_mfma_f32_16x16x32_bf16 v[52:55], a[144:147], v[208:211], v[52:55]
    ds_read_b64_tr_b16 a[144:145], v5 offset:33984
    ds_read_b64_tr_b16 a[146:147], v5 offset:34240
    v_mfma_f32_16x16x32_bf16 v[52:55], a[148:151], v[212:215], v[52:55]
    s_waitcnt lgkmcnt(12)
    ds_read_b64_tr_b16 a[148:149], v5 offset:50880
    ds_read_b64_tr_b16 a[150:151], v5 offset:51136
    v_mfma_f32_16x16x32_bf16 v[104:107], a[152:155], v[152:155], v[104:107]
    s_waitcnt lgkmcnt(12)
    buffer_load_dwordx4 v8, s[28:31], s49 offen lds
    v_mfma_f32_16x16x32_bf16 v[104:107], a[156:159], v[156:159], v[104:107]
    s_add_u32 m0, s45, 0x18c00
    s_add_u32 s49, s49, 0x2e600
    v_and_b32 v247, 0xffff0000, v219
    v_mfma_f32_16x16x32_bf16 v[108:111], a[152:155], v[208:211], v[108:111]
    ds_read_b64_tr_b16 a[152:153], v5 offset:42432
    ds_read_b64_tr_b16 a[154:155], v5 offset:42688
    v_mfma_f32_16x16x32_bf16 v[108:111], a[156:159], v[212:215], v[108:111]
    s_waitcnt lgkmcnt(12)
    ds_read_b64_tr_b16 a[156:157], v5 offset:59328
    ds_read_b64_tr_b16 a[158:159], v5 offset:59584
    v_mfma_f32_16x16x32_bf16 v[56:59], a[128:131], v[152:155], v[56:59]
    s_waitcnt lgkmcnt(12)
    v_fma_f32 v246, v246, v253, v255
    v_fma_f32 v247, v247, v253, v255
    v_mfma_f32_16x16x32_bf16 v[56:59], a[132:135], v[156:159], v[56:59]
    v_cvt_pk_bf16_f32 v219, v246, v247
    v_lshlrev_b32 v240, 16, v220
    v_mfma_f32_16x16x32_bf16 v[60:63], a[128:131], v[208:211], v[60:63]
    v_and_b32 v241, 0xffff0000, v220
    v_fma_f32 v240, v240, v253, v255
    v_mfma_f32_16x16x32_bf16 v[60:63], a[132:135], v[212:215], v[60:63]
    s_waitcnt lgkmcnt(10)
    s_waitcnt vmcnt(18) lgkmcnt(0)
    s_barrier
    v_mfma_f32_16x16x32_bf16 v[112:115], a[136:139], v[152:155], v[112:115]
    ds_read_b64_tr_b16 a[128:129], v4
    ds_read_b64_tr_b16 a[130:131], v4 offset:256
    v_mfma_f32_16x16x32_bf16 v[112:115], a[140:143], v[156:159], v[112:115]
    ds_read_b64_tr_b16 a[132:133], v4 offset:16896
    ds_read_b64_tr_b16 a[134:135], v4 offset:17152
    v_mfma_f32_16x16x32_bf16 v[116:119], a[136:139], v[208:211], v[116:119]
    buffer_load_dwordx4 v9, s[20:23], s50 offen lds
    v_mfma_f32_16x16x32_bf16 v[116:119], a[140:143], v[212:215], v[116:119]
    ds_read_b64_tr_b16 a[136:137], v4 offset:8448
    ds_read_b64_tr_b16 a[138:139], v4 offset:8704
    v_mfma_f32_16x16x32_bf16 v[64:67], a[144:147], v[152:155], v[64:67]
    ds_read_b64_tr_b16 a[140:141], v4 offset:25344
    ds_read_b64_tr_b16 a[142:143], v4 offset:25600
    v_mfma_f32_16x16x32_bf16 v[64:67], a[148:151], v[156:159], v[64:67]
    s_add_u32 m0, m0, 0x420
    s_add_u32 s50, s50, 0x2000
    v_fma_f32 v241, v241, v253, v255
    v_mfma_f32_16x16x32_bf16 v[68:71], a[144:147], v[208:211], v[68:71]
    ds_read_b64_tr_b16 a[144:145], v4 offset:32
    ds_read_b64_tr_b16 a[146:147], v4 offset:288
    v_mfma_f32_16x16x32_bf16 v[68:71], a[148:151], v[212:215], v[68:71]
    ds_read_b64_tr_b16 a[148:149], v4 offset:16928
    ds_read_b64_tr_b16 a[150:151], v4 offset:17184
    v_mfma_f32_16x16x32_bf16 v[120:123], a[152:155], v[152:155], v[120:123]
    buffer_load_dwordx4 v9, s[20:23], s50 offen lds
    v_mfma_f32_16x16x32_bf16 v[120:123], a[156:159], v[156:159], v[120:123]
    s_add_u32 m0, m0, 0x420
    v_cvt_pk_bf16_f32 v220, v240, v241
    v_lshlrev_b32 v242, 16, v221
    v_mfma_f32_16x16x32_bf16 v[124:127], a[152:155], v[208:211], v[124:127]
    v_and_b32 v243, 0xffff0000, v221
    v_fma_f32 v242, v242, v253, v255
    v_fma_f32 v243, v243, v253, v255
    v_cvt_pk_bf16_f32 v221, v242, v243
    v_lshlrev_b32 v244, 16, v222
    v_and_b32 v245, 0xffff0000, v222
    v_fma_f32 v244, v244, v253, v255
    v_fma_f32 v245, v245, v253, v255
    v_cvt_pk_bf16_f32 v222, v244, v245
    v_lshlrev_b32 v246, 16, v223
    v_and_b32 v247, 0xffff0000, v223
    v_fma_f32 v246, v246, v253, v255
    v_fma_f32 v247, v247, v253, v255
    v_cvt_pk_bf16_f32 v223, v246, v247
    v_mfma_f32_16x16x32_bf16 v[124:127], a[156:159], v[212:215], v[124:127]
    s_waitcnt lgkmcnt(10)
    s_add_u32 s50, s50, 0x2000
    ds_read_b64_tr_b16 a[152:153], v4 offset:8480
    v_mfma_f32_16x16x32_bf16 v[16:19], a[128:131], v[160:163], v[16:19]
    s_waitcnt lgkmcnt(9)
    ds_read_b64_tr_b16 a[154:155], v4 offset:8736
    ds_read_b64_tr_b16 a[156:157], v4 offset:25376
    v_mfma_f32_16x16x32_bf16 v[16:19], a[132:135], v[164:167], v[16:19]
    ds_read_b64_tr_b16 a[158:159], v4 offset:25632
    v_lshlrev_b32 v240, 16, v224
    v_mfma_f32_16x16x32_bf16 v[20:23], a[128:131], v[216:219], v[20:23]
    ds_read_b64_tr_b16 a[128:129], v4 offset:64
    ds_read_b64_tr_b16 a[130:131], v4 offset:320
    v_mfma_f32_16x16x32_bf16 v[20:23], a[132:135], v[220:223], v[20:23]
    s_waitcnt lgkmcnt(12)
    buffer_load_dwordx4 v9, s[20:23], s50 offen lds
    v_mfma_f32_16x16x32_bf16 v[72:75], a[136:139], v[160:163], v[72:75]
    s_waitcnt lgkmcnt(10)
    ds_read_b64_tr_b16 a[132:133], v4 offset:16960
    ds_read_b64_tr_b16 a[134:135], v4 offset:17216
    v_mfma_f32_16x16x32_bf16 v[72:75], a[140:143], v[164:167], v[72:75]
    s_add_u32 m0, m0, 0x420
    s_add_u32 s50, s50, 0x2000
    v_and_b32 v241, 0xffff0000, v224
    v_mfma_f32_16x16x32_bf16 v[76:79], a[136:139], v[216:219], v[76:79]
    ds_read_b64_tr_b16 a[136:137], v4 offset:8512
    ds_read_b64_tr_b16 a[138:139], v4 offset:8768
    v_mfma_f32_16x16x32_bf16 v[76:79], a[140:143], v[220:223], v[76:79]
    s_waitcnt lgkmcnt(12)
    ds_read_b64_tr_b16 a[140:141], v4 offset:25408
    ds_read_b64_tr_b16 a[142:143], v4 offset:25664
    v_mfma_f32_16x16x32_bf16 v[24:27], a[144:147], v[160:163], v[24:27]
    s_waitcnt lgkmcnt(12)
    buffer_load_dwordx4 v9, s[20:23], s50 offen lds
    v_mfma_f32_16x16x32_bf16 v[24:27], a[148:151], v[164:167], v[24:27]
    s_add_u32 m0, m0, 0x420
    s_add_u32 s50, s50, 0xa000
    v_fma_f32 v240, v240, v253, v255
    v_mfma_f32_16x16x32_bf16 v[28:31], a[144:147], v[216:219], v[28:31]
    ds_read_b64_tr_b16 a[144:145], v4 offset:96
    ds_read_b64_tr_b16 a[146:147], v4 offset:352
    v_mfma_f32_16x16x32_bf16 v[28:31], a[148:151], v[220:223], v[28:31]
    s_waitcnt lgkmcnt(12)
    ds_read_b64_tr_b16 a[148:149], v4 offset:16992
    ds_read_b64_tr_b16 a[150:151], v4 offset:17248
    v_mfma_f32_16x16x32_bf16 v[80:83], a[152:155], v[160:163], v[80:83]
    s_waitcnt lgkmcnt(12)
    v_fma_f32 v241, v241, v253, v255
    v_cvt_pk_bf16_f32 v224, v240, v241
    v_mfma_f32_16x16x32_bf16 v[80:83], a[156:159], v[164:167], v[80:83]
    v_lshlrev_b32 v242, 16, v225
    v_and_b32 v243, 0xffff0000, v225
    v_mfma_f32_16x16x32_bf16 v[84:87], a[152:155], v[216:219], v[84:87]
    ds_read_b64_tr_b16 a[152:153], v4 offset:8544
    ds_read_b64_tr_b16 a[154:155], v4 offset:8800
    v_mfma_f32_16x16x32_bf16 v[84:87], a[156:159], v[220:223], v[84:87]
    s_waitcnt lgkmcnt(12)
    ds_read_b64_tr_b16 a[156:157], v4 offset:25440
    ds_read_b64_tr_b16 a[158:159], v4 offset:25696
    v_mfma_f32_16x16x32_bf16 v[32:35], a[128:131], v[160:163], v[32:35]
    s_waitcnt lgkmcnt(12)
    buffer_load_dwordx4 v9, s[20:23], s50 offen lds
    v_mfma_f32_16x16x32_bf16 v[32:35], a[132:135], v[164:167], v[32:35]
    s_add_u32 m0, m0, 0x420
    s_add_u32 s50, s50, 0x2000
    v_fma_f32 v242, v242, v253, v255
    v_mfma_f32_16x16x32_bf16 v[36:39], a[128:131], v[216:219], v[36:39]
    s_add_u32 s62, s62, 0xe0000
    ds_read_b64_tr_b16 a[128:129], v4 offset:128
    ds_read_b64_tr_b16 a[130:131], v4 offset:384
    v_mfma_f32_16x16x32_bf16 v[36:39], a[132:135], v[220:223], v[36:39]
    s_waitcnt lgkmcnt(12)
    ds_read_b64_tr_b16 a[132:133], v4 offset:17024
    ds_read_b64_tr_b16 a[134:135], v4 offset:17280
    v_mfma_f32_16x16x32_bf16 v[88:91], a[136:139], v[160:163], v[88:91]
    s_waitcnt lgkmcnt(12)
    v_fma_f32 v243, v243, v253, v255
    v_cvt_pk_bf16_f32 v225, v242, v243
    v_mfma_f32_16x16x32_bf16 v[88:91], a[140:143], v[164:167], v[88:91]
    buffer_load_dwordx4 v9, s[20:23], s50 offen lds
    v_mfma_f32_16x16x32_bf16 v[92:95], a[136:139], v[216:219], v[92:95]
    s_add_u32 m0, m0, 0x420
    ds_read_b64_tr_b16 a[136:137], v4 offset:8576
    ds_read_b64_tr_b16 a[138:139], v4 offset:8832
    v_mfma_f32_16x16x32_bf16 v[92:95], a[140:143], v[220:223], v[92:95]
    s_waitcnt lgkmcnt(12)
    ds_read_b64_tr_b16 a[140:141], v4 offset:25472
    ds_read_b64_tr_b16 a[142:143], v4 offset:25728
    v_mfma_f32_16x16x32_bf16 v[40:43], a[144:147], v[160:163], v[40:43]
    s_waitcnt lgkmcnt(12)
    s_add_u32 s50, s50, 0x2000
    v_lshlrev_b32 v244, 16, v226
    v_mfma_f32_16x16x32_bf16 v[40:43], a[148:151], v[164:167], v[40:43]
    v_and_b32 v245, 0xffff0000, v226
    v_fma_f32 v244, v244, v253, v255
    v_mfma_f32_16x16x32_bf16 v[44:47], a[144:147], v[216:219], v[44:47]
    ds_read_b64_tr_b16 a[144:145], v4 offset:160
    ds_read_b64_tr_b16 a[146:147], v4 offset:416
    v_mfma_f32_16x16x32_bf16 v[44:47], a[148:151], v[220:223], v[44:47]
    s_waitcnt lgkmcnt(12)
    ds_read_b64_tr_b16 a[148:149], v4 offset:17056
    ds_read_b64_tr_b16 a[150:151], v4 offset:17312
    v_mfma_f32_16x16x32_bf16 v[96:99], a[152:155], v[160:163], v[96:99]
    s_waitcnt lgkmcnt(12)
    buffer_load_dwordx4 v9, s[20:23], s50 offen lds
    v_mfma_f32_16x16x32_bf16 v[96:99], a[156:159], v[164:167], v[96:99]
    s_add_u32 m0, m0, 0x420
    s_add_u32 s50, s50, 0x2000
    v_fma_f32 v245, v245, v253, v255
    v_mfma_f32_16x16x32_bf16 v[100:103], a[152:155], v[216:219], v[100:103]
    ds_read_b64_tr_b16 a[152:153], v4 offset:8608
    ds_read_b64_tr_b16 a[154:155], v4 offset:8864
    v_mfma_f32_16x16x32_bf16 v[100:103], a[156:159], v[220:223], v[100:103]
    s_waitcnt lgkmcnt(12)
    ds_read_b64_tr_b16 a[156:157], v4 offset:25504
    ds_read_b64_tr_b16 a[158:159], v4 offset:25760
    v_mfma_f32_16x16x32_bf16 v[48:51], a[128:131], v[160:163], v[48:51]
    s_waitcnt lgkmcnt(12)
    v_cvt_pk_bf16_f32 v226, v244, v245
    v_lshlrev_b32 v246, 16, v227
    v_mfma_f32_16x16x32_bf16 v[48:51], a[132:135], v[164:167], v[48:51]
    v_and_b32 v247, 0xffff0000, v227
    v_fma_f32 v246, v246, v253, v255
    v_mfma_f32_16x16x32_bf16 v[52:55], a[128:131], v[216:219], v[52:55]
    ds_read_b64_tr_b16 a[128:129], v4 offset:192
    ds_read_b64_tr_b16 a[130:131], v4 offset:448
    v_mfma_f32_16x16x32_bf16 v[52:55], a[132:135], v[220:223], v[52:55]
    s_waitcnt lgkmcnt(12)
    ds_read_b64_tr_b16 a[132:133], v4 offset:17088
    ds_read_b64_tr_b16 a[134:135], v4 offset:17344
    v_mfma_f32_16x16x32_bf16 v[104:107], a[136:139], v[160:163], v[104:107]
    s_waitcnt lgkmcnt(12)
    buffer_load_dwordx4 v9, s[20:23], s50 offen lds
    v_mfma_f32_16x16x32_bf16 v[104:107], a[140:143], v[164:167], v[104:107]
    s_add_u32 m0, s45, 0
    s_add_u32 s50, s50, 0x6a000
    v_fma_f32 v247, v247, v253, v255
    v_mfma_f32_16x16x32_bf16 v[108:111], a[136:139], v[216:219], v[108:111]
    ds_read_b64_tr_b16 a[136:137], v4 offset:8640
    ds_read_b64_tr_b16 a[138:139], v4 offset:8896
    v_mfma_f32_16x16x32_bf16 v[108:111], a[140:143], v[220:223], v[108:111]
    s_waitcnt lgkmcnt(12)
    ds_read_b64_tr_b16 a[140:141], v4 offset:25536
    ds_read_b64_tr_b16 a[142:143], v4 offset:25792
    v_mfma_f32_16x16x32_bf16 v[56:59], a[144:147], v[160:163], v[56:59]
    s_waitcnt lgkmcnt(12)
    v_cvt_pk_bf16_f32 v227, v246, v247
    v_lshlrev_b32 v240, 16, v228
    v_mfma_f32_16x16x32_bf16 v[56:59], a[148:151], v[164:167], v[56:59]
    v_and_b32 v241, 0xffff0000, v228
    v_fma_f32 v240, v240, v253, v255
    v_mfma_f32_16x16x32_bf16 v[60:63], a[144:147], v[216:219], v[60:63]
    v_fma_f32 v241, v241, v253, v255
    v_cvt_pk_bf16_f32 v228, v240, v241
    v_mfma_f32_16x16x32_bf16 v[60:63], a[148:151], v[220:223], v[60:63]
    s_waitcnt lgkmcnt(10)
    s_waitcnt vmcnt(17) lgkmcnt(0)
    s_barrier
    v_mfma_f32_16x16x32_bf16 v[112:115], a[152:155], v[160:163], v[112:115]
    ds_read_b64_tr_b16 a[144:145], v5
    ds_read_b64_tr_b16 a[146:147], v5 offset:256
    v_mfma_f32_16x16x32_bf16 v[112:115], a[156:159], v[164:167], v[112:115]
    ds_read_b64_tr_b16 a[148:149], v5 offset:16896
    ds_read_b64_tr_b16 a[150:151], v5 offset:17152
    v_mfma_f32_16x16x32_bf16 v[116:119], a[152:155], v[216:219], v[116:119]
    buffer_load_dwordx4 v9, s[20:23], s50 offen lds
    v_mfma_f32_16x16x32_bf16 v[116:119], a[156:159], v[220:223], v[116:119]
    ds_read_b64_tr_b16 a[152:153], v5 offset:8448
    ds_read_b64_tr_b16 a[154:155], v5 offset:8704
    v_mfma_f32_16x16x32_bf16 v[64:67], a[128:131], v[160:163], v[64:67]
    ds_read_b64_tr_b16 a[156:157], v5 offset:25344
    ds_read_b64_tr_b16 a[158:159], v5 offset:25600
    v_mfma_f32_16x16x32_bf16 v[64:67], a[132:135], v[164:167], v[64:67]
    s_add_u32 m0, m0, 0x420
    s_add_u32 s50, s50, 0x2000
    v_lshlrev_b32 v242, 16, v229
    v_mfma_f32_16x16x32_bf16 v[68:71], a[128:131], v[216:219], v[68:71]
    ds_read_b64_tr_b16 a[128:129], v5 offset:32
    ds_read_b64_tr_b16 a[130:131], v5 offset:288
    v_mfma_f32_16x16x32_bf16 v[68:71], a[132:135], v[220:223], v[68:71]
    ds_read_b64_tr_b16 a[132:133], v5 offset:16928
    ds_read_b64_tr_b16 a[134:135], v5 offset:17184
    v_mfma_f32_16x16x32_bf16 v[120:123], a[136:139], v[160:163], v[120:123]
    buffer_load_dwordx4 v9, s[20:23], s50 offen lds
    v_mfma_f32_16x16x32_bf16 v[120:123], a[140:143], v[164:167], v[120:123]
    s_add_u32 m0, m0, 0x420
    v_and_b32 v243, 0xffff0000, v229
    v_fma_f32 v242, v242, v253, v255
    v_mfma_f32_16x16x32_bf16 v[124:127], a[136:139], v[216:219], v[124:127]
    v_fma_f32 v243, v243, v253, v255
    v_cvt_pk_bf16_f32 v229, v242, v243
    v_lshlrev_b32 v244, 16, v230
    v_and_b32 v245, 0xffff0000, v230
    v_fma_f32 v244, v244, v253, v255
    v_fma_f32 v245, v245, v253, v255
    v_cvt_pk_bf16_f32 v230, v244, v245
    v_lshlrev_b32 v246, 16, v231
    v_and_b32 v247, 0xffff0000, v231
    v_fma_f32 v246, v246, v253, v255
    v_fma_f32 v247, v247, v253, v255
    v_cvt_pk_bf16_f32 v231, v246, v247
    v_mfma_f32_16x16x32_bf16 v[124:127], a[140:143], v[220:223], v[124:127]
    s_waitcnt lgkmcnt(10)
    s_add_u32 s50, s50, 0x2000
    ds_read_b64_tr_b16 a[136:137], v5 offset:8480
    v_mfma_f32_16x16x32_bf16 v[16:19], a[144:147], v[168:171], v[16:19]
    s_waitcnt lgkmcnt(9)
    ds_read_b64_tr_b16 a[138:139], v5 offset:8736
    buffer_load_dword v13, v14, s[20:23], s62 offen
    v_mfma_f32_16x16x32_bf16 v[16:19], a[148:151], v[172:175], v[16:19]
    ds_read_b64_tr_b16 a[140:141], v5 offset:25376
    ds_read_b64_tr_b16 a[142:143], v5 offset:25632
    v_mfma_f32_16x16x32_bf16 v[20:23], a[144:147], v[224:227], v[20:23]
    ds_read_b64_tr_b16 a[144:145], v5 offset:64
    ds_read_b64_tr_b16 a[146:147], v5 offset:320
    v_mfma_f32_16x16x32_bf16 v[20:23], a[148:151], v[228:231], v[20:23]
    s_waitcnt lgkmcnt(12)
    buffer_load_dwordx4 v9, s[20:23], s50 offen lds
    v_mfma_f32_16x16x32_bf16 v[72:75], a[152:155], v[168:171], v[72:75]
    s_waitcnt lgkmcnt(10)
    ds_read_b64_tr_b16 a[148:149], v5 offset:16960
    ds_read_b64_tr_b16 a[150:151], v5 offset:17216
    v_mfma_f32_16x16x32_bf16 v[72:75], a[156:159], v[172:175], v[72:75]
    s_add_u32 m0, m0, 0x420
    s_add_u32 s50, s50, 0x2000
    v_lshlrev_b32 v240, 16, v232
    v_mfma_f32_16x16x32_bf16 v[76:79], a[152:155], v[224:227], v[76:79]
    ds_read_b64_tr_b16 a[152:153], v5 offset:8512
    ds_read_b64_tr_b16 a[154:155], v5 offset:8768
    v_mfma_f32_16x16x32_bf16 v[76:79], a[156:159], v[228:231], v[76:79]
    s_waitcnt lgkmcnt(12)
    ds_read_b64_tr_b16 a[156:157], v5 offset:25408
    ds_read_b64_tr_b16 a[158:159], v5 offset:25664
    v_mfma_f32_16x16x32_bf16 v[24:27], a[128:131], v[168:171], v[24:27]
    s_waitcnt lgkmcnt(12)
    buffer_load_dwordx4 v9, s[20:23], s50 offen lds
    v_mfma_f32_16x16x32_bf16 v[24:27], a[132:135], v[172:175], v[24:27]
    s_add_u32 m0, m0, 0x420
    s_add_u32 s50, s50, 0xa000
    v_and_b32 v241, 0xffff0000, v232
    v_mfma_f32_16x16x32_bf16 v[28:31], a[128:131], v[224:227], v[28:31]
    ds_read_b64_tr_b16 a[128:129], v5 offset:96
    ds_read_b64_tr_b16 a[130:131], v5 offset:352
    v_mfma_f32_16x16x32_bf16 v[28:31], a[132:135], v[228:231], v[28:31]
    s_waitcnt lgkmcnt(12)
    ds_read_b64_tr_b16 a[132:133], v5 offset:16992
    ds_read_b64_tr_b16 a[134:135], v5 offset:17248
    v_mfma_f32_16x16x32_bf16 v[80:83], a[136:139], v[168:171], v[80:83]
    s_waitcnt lgkmcnt(12)
    v_fma_f32 v240, v240, v253, v255
    v_fma_f32 v241, v241, v253, v255
    v_mfma_f32_16x16x32_bf16 v[80:83], a[140:143], v[172:175], v[80:83]
    v_cvt_pk_bf16_f32 v232, v240, v241
    v_lshlrev_b32 v242, 16, v233
    v_mfma_f32_16x16x32_bf16 v[84:87], a[136:139], v[224:227], v[84:87]
    ds_read_b64_tr_b16 a[136:137], v5 offset:8544
    ds_read_b64_tr_b16 a[138:139], v5 offset:8800
    v_mfma_f32_16x16x32_bf16 v[84:87], a[140:143], v[228:231], v[84:87]
    s_waitcnt lgkmcnt(12)
    ds_read_b64_tr_b16 a[140:141], v5 offset:25440
    ds_read_b64_tr_b16 a[142:143], v5 offset:25696
    v_mfma_f32_16x16x32_bf16 v[32:35], a[144:147], v[168:171], v[32:35]
    s_waitcnt lgkmcnt(12)
    buffer_load_dwordx4 v9, s[20:23], s50 offen lds
    v_mfma_f32_16x16x32_bf16 v[32:35], a[148:151], v[172:175], v[32:35]
    s_add_u32 m0, m0, 0x420
    s_add_u32 s50, s50, 0x2000
    v_and_b32 v243, 0xffff0000, v233
    v_mfma_f32_16x16x32_bf16 v[36:39], a[144:147], v[224:227], v[36:39]
    ds_read_b64_tr_b16 a[144:145], v5 offset:128
    ds_read_b64_tr_b16 a[146:147], v5 offset:384
    v_mfma_f32_16x16x32_bf16 v[36:39], a[148:151], v[228:231], v[36:39]
    s_waitcnt lgkmcnt(12)
    ds_read_b64_tr_b16 a[148:149], v5 offset:17024
    ds_read_b64_tr_b16 a[150:151], v5 offset:17280
    v_mfma_f32_16x16x32_bf16 v[88:91], a[152:155], v[168:171], v[88:91]
    s_waitcnt lgkmcnt(12)
    v_fma_f32 v242, v242, v253, v255
    v_fma_f32 v243, v243, v253, v255
    v_mfma_f32_16x16x32_bf16 v[88:91], a[156:159], v[172:175], v[88:91]
    buffer_load_dwordx4 v9, s[20:23], s50 offen lds
    v_mfma_f32_16x16x32_bf16 v[92:95], a[152:155], v[224:227], v[92:95]
    s_add_u32 m0, m0, 0x420
    ds_read_b64_tr_b16 a[152:153], v5 offset:8576
    ds_read_b64_tr_b16 a[154:155], v5 offset:8832
    v_mfma_f32_16x16x32_bf16 v[92:95], a[156:159], v[228:231], v[92:95]
    s_waitcnt lgkmcnt(12)
    ds_read_b64_tr_b16 a[156:157], v5 offset:25472
    ds_read_b64_tr_b16 a[158:159], v5 offset:25728
    v_mfma_f32_16x16x32_bf16 v[40:43], a[128:131], v[168:171], v[40:43]
    s_waitcnt lgkmcnt(12)
    s_add_u32 s50, s50, 0x2000
    v_cvt_pk_bf16_f32 v233, v242, v243
    v_mfma_f32_16x16x32_bf16 v[40:43], a[132:135], v[172:175], v[40:43]
    v_lshlrev_b32 v244, 16, v234
    v_and_b32 v245, 0xffff0000, v234
    v_mfma_f32_16x16x32_bf16 v[44:47], a[128:131], v[224:227], v[44:47]
    ds_read_b64_tr_b16 a[128:129], v5 offset:160
    ds_read_b64_tr_b16 a[130:131], v5 offset:416
    v_mfma_f32_16x16x32_bf16 v[44:47], a[132:135], v[228:231], v[44:47]
    s_waitcnt lgkmcnt(12)
    ds_read_b64_tr_b16 a[132:133], v5 offset:17056
    ds_read_b64_tr_b16 a[134:135], v5 offset:17312
    v_mfma_f32_16x16x32_bf16 v[96:99], a[136:139], v[168:171], v[96:99]
    s_waitcnt lgkmcnt(12)
    buffer_load_dwordx4 v9, s[20:23], s50 offen lds
    v_mfma_f32_16x16x32_bf16 v[96:99], a[140:143], v[172:175], v[96:99]
    s_add_u32 m0, m0, 0x420
    s_add_u32 s50, s50, 0x2000
    v_fma_f32 v244, v244, v253, v255
    v_mfma_f32_16x16x32_bf16 v[100:103], a[136:139], v[224:227], v[100:103]
    ds_read_b64_tr_b16 a[136:137], v5 offset:8608
    ds_read_b64_tr_b16 a[138:139], v5 offset:8864
    v_mfma_f32_16x16x32_bf16 v[100:103], a[140:143], v[228:231], v[100:103]
    s_waitcnt lgkmcnt(12)
    ds_read_b64_tr_b16 a[140:141], v5 offset:25504
    ds_read_b64_tr_b16 a[142:143], v5 offset:25760
    v_mfma_f32_16x16x32_bf16 v[48:51], a[144:147], v[168:171], v[48:51]
    s_waitcnt lgkmcnt(12)
    v_fma_f32 v245, v245, v253, v255
    v_cvt_pk_bf16_f32 v234, v244, v245
    v_mfma_f32_16x16x32_bf16 v[48:51], a[148:151], v[172:175], v[48:51]
    v_lshlrev_b32 v246, 16, v235
    v_and_b32 v247, 0xffff0000, v235
    v_mfma_f32_16x16x32_bf16 v[52:55], a[144:147], v[224:227], v[52:55]
    ds_read_b64_tr_b16 a[144:145], v5 offset:192
    ds_read_b64_tr_b16 a[146:147], v5 offset:448
    v_mfma_f32_16x16x32_bf16 v[52:55], a[148:151], v[228:231], v[52:55]
    s_waitcnt lgkmcnt(12)
    ds_read_b64_tr_b16 a[148:149], v5 offset:17088
    ds_read_b64_tr_b16 a[150:151], v5 offset:17344
    v_mfma_f32_16x16x32_bf16 v[104:107], a[152:155], v[168:171], v[104:107]
    s_waitcnt lgkmcnt(12)
    buffer_load_dwordx4 v9, s[20:23], s50 offen lds
    v_mfma_f32_16x16x32_bf16 v[104:107], a[156:159], v[172:175], v[104:107]
    s_add_u32 m0, s45, 0x10800
    s_add_u32 s50, s50, 0x6a000
    v_fma_f32 v246, v246, v253, v255
    v_mfma_f32_16x16x32_bf16 v[108:111], a[152:155], v[224:227], v[108:111]
    ds_read_b64_tr_b16 a[152:153], v5 offset:8640
    ds_read_b64_tr_b16 a[154:155], v5 offset:8896
    v_mfma_f32_16x16x32_bf16 v[108:111], a[156:159], v[228:231], v[108:111]
    s_waitcnt lgkmcnt(12)
    ds_read_b64_tr_b16 a[156:157], v5 offset:25536
    ds_read_b64_tr_b16 a[158:159], v5 offset:25792
    v_mfma_f32_16x16x32_bf16 v[56:59], a[128:131], v[168:171], v[56:59]
    s_waitcnt lgkmcnt(12)
    v_fma_f32 v247, v247, v253, v255
    v_cvt_pk_bf16_f32 v235, v246, v247
    v_mfma_f32_16x16x32_bf16 v[56:59], a[132:135], v[172:175], v[56:59]
    v_lshlrev_b32 v240, 16, v236
    v_and_b32 v241, 0xffff0000, v236
    v_mfma_f32_16x16x32_bf16 v[60:63], a[128:131], v[224:227], v[60:63]
    v_fma_f32 v240, v240, v253, v255
    v_fma_f32 v241, v241, v253, v255
    v_mfma_f32_16x16x32_bf16 v[60:63], a[132:135], v[228:231], v[60:63]
    s_waitcnt lgkmcnt(10)
    s_waitcnt vmcnt(17) lgkmcnt(0)
    s_barrier
    v_mfma_f32_16x16x32_bf16 v[112:115], a[136:139], v[168:171], v[112:115]
    ds_read_b64_tr_b16 a[128:129], v4 offset:33792
    ds_read_b64_tr_b16 a[130:131], v4 offset:34048
    v_mfma_f32_16x16x32_bf16 v[112:115], a[140:143], v[172:175], v[112:115]
    ds_read_b64_tr_b16 a[132:133], v4 offset:50688
    ds_read_b64_tr_b16 a[134:135], v4 offset:50944
    v_mfma_f32_16x16x32_bf16 v[116:119], a[136:139], v[224:227], v[116:119]
    buffer_load_dwordx4 v9, s[20:23], s50 offen lds
    v_mfma_f32_16x16x32_bf16 v[116:119], a[140:143], v[228:231], v[116:119]
    ds_read_b64_tr_b16 a[136:137], v4 offset:42240
    ds_read_b64_tr_b16 a[138:139], v4 offset:42496
    v_mfma_f32_16x16x32_bf16 v[64:67], a[144:147], v[168:171], v[64:67]
    ds_read_b64_tr_b16 a[140:141], v4 offset:59136
    ds_read_b64_tr_b16 a[142:143], v4 offset:59392
    v_mfma_f32_16x16x32_bf16 v[64:67], a[148:151], v[172:175], v[64:67]
    s_add_u32 m0, m0, 0x420
    s_add_u32 s50, s50, 0x2000
    v_cvt_pk_bf16_f32 v236, v240, v241
    v_mfma_f32_16x16x32_bf16 v[68:71], a[144:147], v[224:227], v[68:71]
    ds_read_b64_tr_b16 a[144:145], v4 offset:33824
    ds_read_b64_tr_b16 a[146:147], v4 offset:34080
    v_mfma_f32_16x16x32_bf16 v[68:71], a[148:151], v[228:231], v[68:71]
    ds_read_b64_tr_b16 a[148:149], v4 offset:50720
    ds_read_b64_tr_b16 a[150:151], v4 offset:50976
    v_mfma_f32_16x16x32_bf16 v[120:123], a[152:155], v[168:171], v[120:123]
    buffer_load_dwordx4 v9, s[20:23], s50 offen lds
    v_mfma_f32_16x16x32_bf16 v[120:123], a[156:159], v[172:175], v[120:123]
    s_add_u32 m0, m0, 0x420
    v_lshlrev_b32 v242, 16, v237
    v_and_b32 v243, 0xffff0000, v237
    v_mfma_f32_16x16x32_bf16 v[124:127], a[152:155], v[224:227], v[124:127]
    v_fma_f32 v242, v242, v253, v255
    v_fma_f32 v243, v243, v253, v255
    v_cvt_pk_bf16_f32 v237, v242, v243
    v_lshlrev_b32 v244, 16, v238
    v_and_b32 v245, 0xffff0000, v238
    v_fma_f32 v244, v244, v253, v255
    v_fma_f32 v245, v245, v253, v255
    v_cvt_pk_bf16_f32 v238, v244, v245
    v_lshlrev_b32 v246, 16, v239
    v_and_b32 v247, 0xffff0000, v239
    v_fma_f32 v246, v246, v253, v255
    v_fma_f32 v247, v247, v253, v255
    v_cvt_pk_bf16_f32 v239, v246, v247
    v_mfma_f32_16x16x32_bf16 v[124:127], a[156:159], v[228:231], v[124:127]
    s_waitcnt lgkmcnt(10)
    s_add_u32 s50, s50, 0x2000
    ds_read_b64_tr_b16 a[152:153], v4 offset:42272
    v_mfma_f32_16x16x32_bf16 v[16:19], a[128:131], v[176:179], v[16:19]
    s_waitcnt lgkmcnt(9)
    ds_read_b64_tr_b16 a[154:155], v4 offset:42528
    ds_read_b64_tr_b16 a[156:157], v4 offset:59168
    v_mfma_f32_16x16x32_bf16 v[16:19], a[132:135], v[180:183], v[16:19]
    ds_read_b64_tr_b16 a[158:159], v4 offset:59424
    v_lshrrev_b32 v14, 2, v0
    v_mfma_f32_16x16x32_bf16 v[20:23], a[128:131], v[232:235], v[20:23]
    ds_read_b64_tr_b16 a[128:129], v4 offset:33856
    ds_read_b64_tr_b16 a[130:131], v4 offset:34112
    v_mfma_f32_16x16x32_bf16 v[20:23], a[132:135], v[236:239], v[20:23]
    s_waitcnt lgkmcnt(12)
    buffer_load_dwordx4 v9, s[20:23], s50 offen lds
    v_mfma_f32_16x16x32_bf16 v[72:75], a[136:139], v[176:179], v[72:75]
    s_waitcnt lgkmcnt(10)
    ds_read_b64_tr_b16 a[132:133], v4 offset:50752
    ds_read_b64_tr_b16 a[134:135], v4 offset:51008
    v_mfma_f32_16x16x32_bf16 v[72:75], a[140:143], v[180:183], v[72:75]
    s_add_u32 m0, m0, 0x420
    s_add_u32 s50, s50, 0x2000
    v_lshlrev_b32 v14, 7, v14
    v_mfma_f32_16x16x32_bf16 v[76:79], a[136:139], v[232:235], v[76:79]
    s_lshl_b32 s62, s44, 2
    ds_read_b64_tr_b16 a[136:137], v4 offset:42304
    ds_read_b64_tr_b16 a[138:139], v4 offset:42560
    v_mfma_f32_16x16x32_bf16 v[76:79], a[140:143], v[236:239], v[76:79]
    s_waitcnt lgkmcnt(12)
    ds_read_b64_tr_b16 a[140:141], v4 offset:59200
    ds_read_b64_tr_b16 a[142:143], v4 offset:59456
    v_mfma_f32_16x16x32_bf16 v[24:27], a[144:147], v[176:179], v[24:27]
    s_waitcnt lgkmcnt(12)
    buffer_load_dwordx4 v9, s[20:23], s50 offen lds
    v_mfma_f32_16x16x32_bf16 v[24:27], a[148:151], v[180:183], v[24:27]
    s_add_u32 m0, m0, 0x420
    s_add_u32 s50, s50, 0xa000
    s_add_u32 s62, s62, s42
    v_mfma_f32_16x16x32_bf16 v[28:31], a[144:147], v[232:235], v[28:31]
    s_mul_i32 s62, s62, 0x640
    ds_read_b64_tr_b16 a[144:145], v4 offset:33888
    ds_read_b64_tr_b16 a[146:147], v4 offset:34144
    v_mfma_f32_16x16x32_bf16 v[28:31], a[148:151], v[236:239], v[28:31]
    s_waitcnt lgkmcnt(12)
    ds_read_b64_tr_b16 a[148:149], v4 offset:50784
    ds_read_b64_tr_b16 a[150:151], v4 offset:51040
    v_mfma_f32_16x16x32_bf16 v[80:83], a[152:155], v[176:179], v[80:83]
    s_waitcnt lgkmcnt(12)
    s_mul_i32 s63, s43, 0x18800
    s_add_u32 s62, s62, s63
    v_mfma_f32_16x16x32_bf16 v[80:83], a[156:159], v[180:183], v[80:83]
    buffer_load_dword v13, v14, s[32:35], s62 offen
    v_mfma_f32_16x16x32_bf16 v[84:87], a[152:155], v[232:235], v[84:87]
    ds_read_b64_tr_b16 a[152:153], v4 offset:42336
    ds_read_b64_tr_b16 a[154:155], v4 offset:42592
    v_mfma_f32_16x16x32_bf16 v[84:87], a[156:159], v[236:239], v[84:87]
    s_waitcnt lgkmcnt(12)
    ds_read_b64_tr_b16 a[156:157], v4 offset:59232
    ds_read_b64_tr_b16 a[158:159], v4 offset:59488
    v_mfma_f32_16x16x32_bf16 v[32:35], a[128:131], v[176:179], v[32:35]
    s_waitcnt lgkmcnt(12)
    buffer_load_dwordx4 v9, s[20:23], s50 offen lds
    v_mfma_f32_16x16x32_bf16 v[32:35], a[132:135], v[180:183], v[32:35]
    s_add_u32 m0, m0, 0x420
    s_add_u32 s50, s50, 0x2000
    v_mfma_f32_16x16x32_bf16 v[36:39], a[128:131], v[232:235], v[36:39]
    ds_read_b64_tr_b16 a[128:129], v4 offset:33920
    ds_read_b64_tr_b16 a[130:131], v4 offset:34176
    v_mfma_f32_16x16x32_bf16 v[36:39], a[132:135], v[236:239], v[36:39]
    s_waitcnt lgkmcnt(12)
    ds_read_b64_tr_b16 a[132:133], v4 offset:50816
    ds_read_b64_tr_b16 a[134:135], v4 offset:51072
    v_mfma_f32_16x16x32_bf16 v[88:91], a[136:139], v[176:179], v[88:91]
    s_waitcnt lgkmcnt(12)
    v_mfma_f32_16x16x32_bf16 v[88:91], a[140:143], v[180:183], v[88:91]
    buffer_load_dwordx4 v9, s[20:23], s50 offen lds
    v_mfma_f32_16x16x32_bf16 v[92:95], a[136:139], v[232:235], v[92:95]
    s_add_u32 m0, m0, 0x420
    ds_read_b64_tr_b16 a[136:137], v4 offset:42368
    ds_read_b64_tr_b16 a[138:139], v4 offset:42624
    v_mfma_f32_16x16x32_bf16 v[92:95], a[140:143], v[236:239], v[92:95]
    s_waitcnt lgkmcnt(12)
    ds_read_b64_tr_b16 a[140:141], v4 offset:59264
    ds_read_b64_tr_b16 a[142:143], v4 offset:59520
    v_mfma_f32_16x16x32_bf16 v[40:43], a[144:147], v[176:179], v[40:43]
    s_waitcnt lgkmcnt(12)
    s_add_u32 s50, s50, 0x2000
    v_mfma_f32_16x16x32_bf16 v[40:43], a[148:151], v[180:183], v[40:43]
    v_mfma_f32_16x16x32_bf16 v[44:47], a[144:147], v[232:235], v[44:47]
    ds_read_b64_tr_b16 a[144:145], v4 offset:33952
    ds_read_b64_tr_b16 a[146:147], v4 offset:34208
    v_mfma_f32_16x16x32_bf16 v[44:47], a[148:151], v[236:239], v[44:47]
    s_waitcnt lgkmcnt(12)
    ds_read_b64_tr_b16 a[148:149], v4 offset:50848
    ds_read_b64_tr_b16 a[150:151], v4 offset:51104
    v_mfma_f32_16x16x32_bf16 v[96:99], a[152:155], v[176:179], v[96:99]
    s_waitcnt lgkmcnt(12)
    buffer_load_dwordx4 v9, s[20:23], s50 offen lds
    v_mfma_f32_16x16x32_bf16 v[96:99], a[156:159], v[180:183], v[96:99]
    s_add_u32 m0, m0, 0x420
    s_add_u32 s50, s50, 0x2000
    v_mfma_f32_16x16x32_bf16 v[100:103], a[152:155], v[232:235], v[100:103]
    ds_read_b64_tr_b16 a[152:153], v4 offset:42400
    ds_read_b64_tr_b16 a[154:155], v4 offset:42656
    v_mfma_f32_16x16x32_bf16 v[100:103], a[156:159], v[236:239], v[100:103]
    s_waitcnt lgkmcnt(12)
    ds_read_b64_tr_b16 a[156:157], v4 offset:59296
    ds_read_b64_tr_b16 a[158:159], v4 offset:59552
    v_mfma_f32_16x16x32_bf16 v[48:51], a[128:131], v[176:179], v[48:51]
    s_waitcnt lgkmcnt(12)
    v_mfma_f32_16x16x32_bf16 v[48:51], a[132:135], v[180:183], v[48:51]
    v_mfma_f32_16x16x32_bf16 v[52:55], a[128:131], v[232:235], v[52:55]
    ds_read_b64_tr_b16 a[128:129], v4 offset:33984
    ds_read_b64_tr_b16 a[130:131], v4 offset:34240
    v_mfma_f32_16x16x32_bf16 v[52:55], a[132:135], v[236:239], v[52:55]
    s_waitcnt lgkmcnt(12)
    ds_read_b64_tr_b16 a[132:133], v4 offset:50880
    ds_read_b64_tr_b16 a[134:135], v4 offset:51136
    v_mfma_f32_16x16x32_bf16 v[104:107], a[136:139], v[176:179], v[104:107]
    s_waitcnt lgkmcnt(12)
    buffer_load_dwordx4 v9, s[20:23], s50 offen lds
    v_mfma_f32_16x16x32_bf16 v[104:107], a[140:143], v[180:183], v[104:107]
    s_add_u32 m0, s45, 0x8400
    s_add_u32 s50, s50, 0x6a000
    v_mfma_f32_16x16x32_bf16 v[108:111], a[136:139], v[232:235], v[108:111]
    ds_read_b64_tr_b16 a[136:137], v4 offset:42432
    ds_read_b64_tr_b16 a[138:139], v4 offset:42688
    v_mfma_f32_16x16x32_bf16 v[108:111], a[140:143], v[236:239], v[108:111]
    s_waitcnt lgkmcnt(12)
    ds_read_b64_tr_b16 a[140:141], v4 offset:59328
    ds_read_b64_tr_b16 a[142:143], v4 offset:59584
    v_mfma_f32_16x16x32_bf16 v[56:59], a[144:147], v[176:179], v[56:59]
    s_waitcnt lgkmcnt(12)
    v_mfma_f32_16x16x32_bf16 v[56:59], a[148:151], v[180:183], v[56:59]
    v_mfma_f32_16x16x32_bf16 v[60:63], a[144:147], v[232:235], v[60:63]
    v_mfma_f32_16x16x32_bf16 v[60:63], a[148:151], v[236:239], v[60:63]
    s_waitcnt lgkmcnt(10)
    s_waitcnt vmcnt(18) lgkmcnt(0)
    s_barrier
    v_mfma_f32_16x16x32_bf16 v[112:115], a[152:155], v[176:179], v[112:115]
    ds_read_b64_tr_b16 a[144:145], v5 offset:33792
    ds_read_b64_tr_b16 a[146:147], v5 offset:42240
    v_mfma_f32_16x16x32_bf16 v[112:115], a[156:159], v[180:183], v[112:115]
    ds_read_b64_tr_b16 a[148:149], v5 offset:50688
    ds_read_b64_tr_b16 a[150:151], v5 offset:59136
    v_mfma_f32_16x16x32_bf16 v[116:119], a[152:155], v[232:235], v[116:119]
    buffer_load_dwordx4 v9, s[20:23], s50 offen lds
    v_mfma_f32_16x16x32_bf16 v[116:119], a[156:159], v[236:239], v[116:119]
    ds_read_b64_tr_b16 a[152:153], v5 offset:33824
    ds_read_b64_tr_b16 a[154:155], v5 offset:42272
    v_mfma_f32_16x16x32_bf16 v[64:67], a[128:131], v[176:179], v[64:67]
    ds_read_b64_tr_b16 a[156:157], v5 offset:50720
    ds_read_b64_tr_b16 a[158:159], v5 offset:59168
    v_mfma_f32_16x16x32_bf16 v[64:67], a[132:135], v[180:183], v[64:67]
    s_add_u32 m0, m0, 0x420
    s_add_u32 s50, s50, 0x2000
    v_mfma_f32_16x16x32_bf16 v[68:71], a[128:131], v[232:235], v[68:71]
    ds_read_b64_tr_b16 a[128:129], v5 offset:33856
    ds_read_b64_tr_b16 a[130:131], v5 offset:42304
    v_mfma_f32_16x16x32_bf16 v[68:71], a[132:135], v[236:239], v[68:71]
    ds_read_b64_tr_b16 a[132:133], v5 offset:50752
    ds_read_b64_tr_b16 a[134:135], v5 offset:59200
    v_mfma_f32_16x16x32_bf16 v[120:123], a[136:139], v[176:179], v[120:123]
    buffer_load_dwordx4 v9, s[20:23], s50 offen lds
    v_mfma_f32_16x16x32_bf16 v[120:123], a[140:143], v[180:183], v[120:123]
    s_add_u32 m0, m0, 0x420
    s_add_u32 s50, s50, 0x2000
    v_mfma_f32_16x16x32_bf16 v[124:127], a[136:139], v[232:235], v[124:127]
    ds_read_b64_tr_b16 a[136:137], v5 offset:33888
    ds_read_b64_tr_b16 a[138:139], v5 offset:42336
    v_mfma_f32_16x16x32_bf16 v[124:127], a[140:143], v[236:239], v[124:127]
    s_waitcnt lgkmcnt(12)
    ds_read_b64_tr_b16 a[140:141], v5 offset:50784
    ds_read_b64_tr_b16 a[142:143], v5 offset:59232
    v_mfma_f32_16x16x32_bf16 a[0:3], a[144:147], v[128:131], 0
    s_waitcnt lgkmcnt(12)
    v_mfma_f32_16x16x32_bf16 a[0:3], a[148:151], v[132:135], a[0:3]
    v_mfma_f32_16x16x32_bf16 a[4:7], a[144:147], v[184:187], 0
    ds_read_b64_tr_b16 a[144:145], v5 offset:33920
    ds_read_b64_tr_b16 a[146:147], v5 offset:42368
    v_mfma_f32_16x16x32_bf16 a[4:7], a[148:151], v[188:191], a[4:7]
    s_waitcnt lgkmcnt(12)
    ds_read_b64_tr_b16 a[148:149], v5 offset:50816
    ds_read_b64_tr_b16 a[150:151], v5 offset:59264
    v_mfma_f32_16x16x32_bf16 a[8:11], a[152:155], v[128:131], 0
    s_waitcnt lgkmcnt(12)
    buffer_load_dwordx4 v9, s[20:23], s50 offen lds
    v_mfma_f32_16x16x32_bf16 a[8:11], a[156:159], v[132:135], a[8:11]
    s_add_u32 m0, m0, 0x420
    s_add_u32 s50, s50, 0x2000
    v_accvgpr_write_b32 a174, 0
    v_mfma_f32_16x16x32_bf16 a[12:15], a[152:155], v[184:187], 0
    ds_read_b64_tr_b16 a[152:153], v5 offset:33952
    ds_read_b64_tr_b16 a[154:155], v5 offset:42400
    v_mfma_f32_16x16x32_bf16 a[12:15], a[156:159], v[188:191], a[12:15]
    s_waitcnt lgkmcnt(12)
    ds_read_b64_tr_b16 a[156:157], v5 offset:50848
    ds_read_b64_tr_b16 a[158:159], v5 offset:59296
    v_mfma_f32_16x16x32_bf16 a[16:19], a[128:131], v[128:131], 0
    s_waitcnt lgkmcnt(12)
    v_accvgpr_write_b32 a175, 0
    v_accvgpr_write_b32 a190, 0
    v_mfma_f32_16x16x32_bf16 a[16:19], a[132:135], v[132:135], a[16:19]
    v_accvgpr_write_b32 a191, 0
    v_mul_f32 v240, 0xbfb8aa3b, v16
    v_mfma_f32_16x16x32_bf16 a[20:23], a[128:131], v[184:187], 0
    ds_read_b64_tr_b16 a[128:129], v5 offset:33984
    ds_read_b64_tr_b16 a[130:131], v5 offset:42432
    v_mfma_f32_16x16x32_bf16 a[20:23], a[132:135], v[188:191], a[20:23]
    s_waitcnt lgkmcnt(12)
    ds_read_b64_tr_b16 a[132:133], v5 offset:50880
    ds_read_b64_tr_b16 a[134:135], v5 offset:59328
    v_mfma_f32_16x16x32_bf16 a[24:27], a[136:139], v[128:131], 0
    s_waitcnt lgkmcnt(12)
    buffer_load_dwordx4 v9, s[20:23], s50 offen lds
    v_mfma_f32_16x16x32_bf16 a[24:27], a[140:143], v[132:135], a[24:27]
    s_add_u32 m0, m0, 0x420
    s_add_u32 s50, s50, 0xa000
    v_mul_f32 v241, 0xbfb8aa3b, v17
    v_mfma_f32_16x16x32_bf16 a[28:31], a[136:139], v[184:187], 0
    ds_read_b64_tr_b16 a[136:137], v5 offset:34016
    ds_read_b64_tr_b16 a[138:139], v5 offset:42464
    v_mfma_f32_16x16x32_bf16 a[28:31], a[140:143], v[188:191], a[28:31]
    s_waitcnt lgkmcnt(12)
    ds_read_b64_tr_b16 a[140:141], v5 offset:50912
    ds_read_b64_tr_b16 a[142:143], v5 offset:59360
    v_mfma_f32_16x16x32_bf16 a[32:35], a[144:147], v[128:131], 0
    s_waitcnt lgkmcnt(12)
    v_mul_f32 v242, 0xbfb8aa3b, v18
    v_mul_f32 v243, 0xbfb8aa3b, v19
    v_mfma_f32_16x16x32_bf16 a[32:35], a[148:151], v[132:135], a[32:35]
    v_exp_f32 v240, v240
    v_mfma_f32_16x16x32_bf16 a[36:39], a[144:147], v[184:187], 0
    ds_read_b64_tr_b16 a[144:145], v5 offset:34048
    ds_read_b64_tr_b16 a[146:147], v5 offset:42496
    v_mfma_f32_16x16x32_bf16 a[36:39], a[148:151], v[188:191], a[36:39]
    s_waitcnt lgkmcnt(12)
    ds_read_b64_tr_b16 a[148:149], v5 offset:50944
    ds_read_b64_tr_b16 a[150:151], v5 offset:59392
    v_mfma_f32_16x16x32_bf16 a[40:43], a[152:155], v[128:131], 0
    s_waitcnt lgkmcnt(12)
    buffer_load_dwordx4 v9, s[20:23], s50 offen lds
    v_mfma_f32_16x16x32_bf16 a[40:43], a[156:159], v[132:135], a[40:43]
    s_add_u32 m0, m0, 0x420
    s_add_u32 s50, s50, 0x2000
    v_mfma_f32_16x16x32_bf16 a[44:47], a[152:155], v[184:187], 0
    ds_read_b64_tr_b16 a[152:153], v5 offset:34080
    ds_read_b64_tr_b16 a[154:155], v5 offset:42528
    v_mfma_f32_16x16x32_bf16 a[44:47], a[156:159], v[188:191], a[44:47]
    s_waitcnt lgkmcnt(12)
    ds_read_b64_tr_b16 a[156:157], v5 offset:50976
    ds_read_b64_tr_b16 a[158:159], v5 offset:59424
    v_mfma_f32_16x16x32_bf16 a[48:51], a[128:131], v[128:131], 0
    s_waitcnt lgkmcnt(12)
    v_exp_f32 v241, v241
    v_mfma_f32_16x16x32_bf16 a[48:51], a[132:135], v[132:135], a[48:51]
    v_exp_f32 v242, v242
    v_mfma_f32_16x16x32_bf16 a[52:55], a[128:131], v[184:187], 0
    ds_read_b64_tr_b16 a[128:129], v5 offset:34112
    ds_read_b64_tr_b16 a[130:131], v5 offset:42560
    v_mfma_f32_16x16x32_bf16 a[52:55], a[132:135], v[188:191], a[52:55]
    s_waitcnt lgkmcnt(12)
    ds_read_b64_tr_b16 a[132:133], v5 offset:51008
    ds_read_b64_tr_b16 a[134:135], v5 offset:59456
    v_mfma_f32_16x16x32_bf16 a[56:59], a[136:139], v[128:131], 0
    s_waitcnt lgkmcnt(12)
    buffer_load_dwordx4 v9, s[20:23], s50 offen lds
    v_mfma_f32_16x16x32_bf16 a[56:59], a[140:143], v[132:135], a[56:59]
    s_add_u32 m0, m0, 0x420
    s_add_u32 s50, s50, 0x2000
    v_mfma_f32_16x16x32_bf16 a[60:63], a[136:139], v[184:187], 0
    ds_read_b64_tr_b16 a[136:137], v5 offset:34144
    ds_read_b64_tr_b16 a[138:139], v5 offset:42592
    v_mfma_f32_16x16x32_bf16 a[60:63], a[140:143], v[188:191], a[60:63]
    s_waitcnt lgkmcnt(12)
    ds_read_b64_tr_b16 a[140:141], v5 offset:51040
    ds_read_b64_tr_b16 a[142:143], v5 offset:59488
    v_mfma_f32_16x16x32_bf16 a[64:67], a[144:147], v[128:131], 0
    s_waitcnt lgkmcnt(12)
    v_exp_f32 v243, v243
    v_mfma_f32_16x16x32_bf16 a[64:67], a[148:151], v[132:135], a[64:67]
    v_mul_f32 v16, v16, v72
    v_mul_f32 v17, v17, v73
    v_mfma_f32_16x16x32_bf16 a[68:71], a[144:147], v[184:187], 0
    ds_read_b64_tr_b16 a[144:145], v5 offset:34176
    ds_read_b64_tr_b16 a[146:147], v5 offset:42624
    v_mfma_f32_16x16x32_bf16 a[68:71], a[148:151], v[188:191], a[68:71]
    s_waitcnt lgkmcnt(12)
    ds_read_b64_tr_b16 a[148:149], v5 offset:51072
    ds_read_b64_tr_b16 a[150:151], v5 offset:59520
    v_mfma_f32_16x16x32_bf16 a[72:75], a[152:155], v[128:131], 0
    s_waitcnt lgkmcnt(12)
    buffer_load_dwordx4 v9, s[20:23], s50 offen lds
    v_mfma_f32_16x16x32_bf16 a[72:75], a[156:159], v[132:135], a[72:75]
    s_add_u32 m0, m0, 0x420
    s_add_u32 s50, s50, 0x2000
    v_mul_f32 v18, v18, v74
    v_mfma_f32_16x16x32_bf16 a[76:79], a[152:155], v[184:187], 0
    ds_read_b64_tr_b16 a[152:153], v5 offset:34208
    ds_read_b64_tr_b16 a[154:155], v5 offset:42656
    v_mfma_f32_16x16x32_bf16 a[76:79], a[156:159], v[188:191], a[76:79]
    s_waitcnt lgkmcnt(12)
    ds_read_b64_tr_b16 a[156:157], v5 offset:51104
    ds_read_b64_tr_b16 a[158:159], v5 offset:59552
    v_mfma_f32_16x16x32_bf16 a[80:83], a[128:131], v[128:131], 0
    s_waitcnt lgkmcnt(12)
    v_mul_f32 v19, v19, v75
    v_add_f32 v240, 1.0, v240
    v_mfma_f32_16x16x32_bf16 a[80:83], a[132:135], v[132:135], a[80:83]
    v_add_f32 v241, 1.0, v241
    v_add_f32 v242, 1.0, v242
    v_mfma_f32_16x16x32_bf16 a[84:87], a[128:131], v[184:187], 0
    ds_read_b64_tr_b16 a[128:129], v5 offset:34240
    ds_read_b64_tr_b16 a[130:131], v5 offset:42688
    v_mfma_f32_16x16x32_bf16 a[84:87], a[132:135], v[188:191], a[84:87]
    s_waitcnt lgkmcnt(12)
    ds_read_b64_tr_b16 a[132:133], v5 offset:51136
    ds_read_b64_tr_b16 a[134:135], v5 offset:59584
    v_mfma_f32_16x16x32_bf16 a[88:91], a[136:139], v[128:131], 0
    s_waitcnt lgkmcnt(12)
    buffer_load_dwordx4 v9, s[20:23], s50 offen lds
    v_mfma_f32_16x16x32_bf16 a[88:91], a[140:143], v[132:135], a[88:91]
    s_add_u32 m0, s45, 0x18c00
    s_add_u32 s50, s50, 0x6a000
    v_add_f32 v243, 1.0, v243
    v_mfma_f32_16x16x32_bf16 a[92:95], a[136:139], v[184:187], 0
    ds_read_b64_tr_b16 a[136:137], v5 offset:34272
    ds_read_b64_tr_b16 a[138:139], v5 offset:42720
    v_mfma_f32_16x16x32_bf16 a[92:95], a[140:143], v[188:191], a[92:95]
    s_waitcnt lgkmcnt(12)
    ds_read_b64_tr_b16 a[140:141], v5 offset:51168
    ds_read_b64_tr_b16 a[142:143], v5 offset:59616
    v_mfma_f32_16x16x32_bf16 a[96:99], a[144:147], v[128:131], 0
    s_waitcnt lgkmcnt(12)
    v_rcp_f32 v240, v240
    v_mfma_f32_16x16x32_bf16 a[96:99], a[148:151], v[132:135], a[96:99]
    v_rcp_f32 v241, v241
    v_mfma_f32_16x16x32_bf16 a[100:103], a[144:147], v[184:187], 0
    v_rcp_f32 v242, v242
    v_mfma_f32_16x16x32_bf16 a[100:103], a[148:151], v[188:191], a[100:103]
    s_waitcnt lgkmcnt(10)
    s_waitcnt vmcnt(17) lgkmcnt(0)
    s_barrier
    v_mfma_f32_16x16x32_bf16 a[104:107], a[152:155], v[128:131], 0
    ds_read_b64_tr_b16 a[144:145], v4
    ds_read_b64_tr_b16 a[146:147], v4 offset:8448
    v_mfma_f32_16x16x32_bf16 a[104:107], a[156:159], v[132:135], a[104:107]
    ds_read_b64_tr_b16 a[148:149], v4 offset:16896
    ds_read_b64_tr_b16 a[150:151], v4 offset:25344
    v_mfma_f32_16x16x32_bf16 a[108:111], a[152:155], v[184:187], 0
    buffer_load_dwordx4 v9, s[20:23], s50 offen lds
    v_mfma_f32_16x16x32_bf16 a[108:111], a[156:159], v[188:191], a[108:111]
    ds_read_b64_tr_b16 a[152:153], v4 offset:32
    ds_read_b64_tr_b16 a[154:155], v4 offset:8480
    v_mfma_f32_16x16x32_bf16 a[112:115], a[128:131], v[128:131], 0
    ds_read_b64_tr_b16 a[156:157], v4 offset:16928
    ds_read_b64_tr_b16 a[158:159], v4 offset:25376
    v_mfma_f32_16x16x32_bf16 a[112:115], a[132:135], v[132:135], a[112:115]
    s_add_u32 m0, m0, 0x420
    s_add_u32 s50, s50, 0x2000
    v_mfma_f32_16x16x32_bf16 a[116:119], a[128:131], v[184:187], 0
    s_lshr_b32 s62, s42, 1
    ds_read_b64_tr_b16 a[128:129], v4 offset:64
    ds_read_b64_tr_b16 a[130:131], v4 offset:8512
    v_mfma_f32_16x16x32_bf16 a[116:119], a[132:135], v[188:191], a[116:119]
    ds_read_b64_tr_b16 a[132:133], v4 offset:16960
    ds_read_b64_tr_b16 a[134:135], v4 offset:25408
    v_mfma_f32_16x16x32_bf16 a[120:123], a[136:139], v[128:131], 0
    buffer_load_dwordx4 v9, s[20:23], s50 offen lds
    v_mfma_f32_16x16x32_bf16 a[120:123], a[140:143], v[132:135], a[120:123]
    s_add_u32 m0, m0, 0x420
    s_add_u32 s50, s50, 0x2000
    s_lshl_b32 s96, s44, 1
    v_mfma_f32_16x16x32_bf16 a[124:127], a[136:139], v[184:187], 0
    s_add_u32 s96, s96, s62
    ds_read_b64_tr_b16 a[136:137], v4 offset:96
    ds_read_b64_tr_b16 a[138:139], v4 offset:8544
    v_mfma_f32_16x16x32_bf16 a[124:127], a[140:143], v[188:191], a[124:127]
    s_waitcnt lgkmcnt(12)
    ds_read_b64_tr_b16 a[140:141], v4 offset:16992
    ds_read_b64_tr_b16 a[142:143], v4 offset:25440
    v_mfma_f32_16x16x32_bf16 a[0:3], a[144:147], v[136:139], a[0:3]
    s_waitcnt lgkmcnt(12)
    s_lshl_b32 s96, s96, 11
    v_mfma_f32_16x16x32_bf16 a[0:3], a[148:151], v[140:143], a[0:3]
    buffer_load_dword v13, v14, s[92:95], s96 offen
    v_mfma_f32_16x16x32_bf16 a[4:7], a[144:147], v[192:195], a[4:7]
    ds_read_b64_tr_b16 a[144:145], v4 offset:128
    ds_read_b64_tr_b16 a[146:147], v4 offset:8576
    v_mfma_f32_16x16x32_bf16 a[4:7], a[148:151], v[196:199], a[4:7]
    s_waitcnt lgkmcnt(12)
    ds_read_b64_tr_b16 a[148:149], v4 offset:17024
    ds_read_b64_tr_b16 a[150:151], v4 offset:25472
    v_mfma_f32_16x16x32_bf16 a[8:11], a[152:155], v[136:139], a[8:11]
    s_waitcnt lgkmcnt(12)
    buffer_load_dwordx4 v9, s[20:23], s50 offen lds
    v_mfma_f32_16x16x32_bf16 a[8:11], a[156:159], v[140:143], a[8:11]
    s_add_u32 m0, m0, 0x420
    s_add_u32 s50, s50, 0x2000
    v_mfma_f32_16x16x32_bf16 a[12:15], a[152:155], v[192:195], a[12:15]
    ds_read_b64_tr_b16 a[152:153], v4 offset:160
    ds_read_b64_tr_b16 a[154:155], v4 offset:8608
    v_mfma_f32_16x16x32_bf16 a[12:15], a[156:159], v[196:199], a[12:15]
    s_waitcnt lgkmcnt(12)
    ds_read_b64_tr_b16 a[156:157], v4 offset:17056
    ds_read_b64_tr_b16 a[158:159], v4 offset:25504
    v_mfma_f32_16x16x32_bf16 a[16:19], a[128:131], v[136:139], a[16:19]
    s_waitcnt lgkmcnt(12)
    v_rcp_f32 v243, v243
    v_mfma_f32_16x16x32_bf16 a[16:19], a[132:135], v[140:143], a[16:19]
    v_mul_f32 v16, v16, v240
    v_mul_f32 v17, v17, v241
    v_mfma_f32_16x16x32_bf16 a[20:23], a[128:131], v[192:195], a[20:23]
    ds_read_b64_tr_b16 a[128:129], v4 offset:192
    ds_read_b64_tr_b16 a[130:131], v4 offset:8640
    v_mfma_f32_16x16x32_bf16 a[20:23], a[132:135], v[196:199], a[20:23]
    s_waitcnt lgkmcnt(12)
    ds_read_b64_tr_b16 a[132:133], v4 offset:17088
    ds_read_b64_tr_b16 a[134:135], v4 offset:25536
    v_mfma_f32_16x16x32_bf16 a[24:27], a[136:139], v[136:139], a[24:27]
    s_waitcnt lgkmcnt(12)
    buffer_load_dwordx4 v9, s[20:23], s50 offen lds
    v_mfma_f32_16x16x32_bf16 a[24:27], a[140:143], v[140:143], a[24:27]
    s_add_u32 m0, m0, 0x420
    s_add_u32 s50, s50, 0xa000
    v_mul_f32 v18, v18, v242
    v_mfma_f32_16x16x32_bf16 a[28:31], a[136:139], v[192:195], a[28:31]
    ds_read_b64_tr_b16 a[136:137], v4 offset:224
    ds_read_b64_tr_b16 a[138:139], v4 offset:8672
    v_mfma_f32_16x16x32_bf16 a[28:31], a[140:143], v[196:199], a[28:31]
    s_waitcnt lgkmcnt(12)
    ds_read_b64_tr_b16 a[140:141], v4 offset:17120
    ds_read_b64_tr_b16 a[142:143], v4 offset:25568
    v_mfma_f32_16x16x32_bf16 a[32:35], a[144:147], v[136:139], a[32:35]
    s_waitcnt lgkmcnt(12)
    v_mul_f32 v19, v19, v243
    v_cvt_pk_bf16_f32 v72, v16, v17
    v_mfma_f32_16x16x32_bf16 a[32:35], a[148:151], v[140:143], a[32:35]
    v_cvt_pk_bf16_f32 v73, v18, v19
    v_accvgpr_write_b32 a160, v72
    v_mfma_f32_16x16x32_bf16 a[36:39], a[144:147], v[192:195], a[36:39]
    ds_read_b64_tr_b16 a[144:145], v4 offset:256
    ds_read_b64_tr_b16 a[146:147], v4 offset:8704
    v_mfma_f32_16x16x32_bf16 a[36:39], a[148:151], v[196:199], a[36:39]
    s_waitcnt lgkmcnt(12)
    ds_read_b64_tr_b16 a[148:149], v4 offset:17152
    ds_read_b64_tr_b16 a[150:151], v4 offset:25600
    v_mfma_f32_16x16x32_bf16 a[40:43], a[152:155], v[136:139], a[40:43]
    s_waitcnt lgkmcnt(12)
    buffer_load_dwordx4 v9, s[20:23], s50 offen lds
    v_mfma_f32_16x16x32_bf16 a[40:43], a[156:159], v[140:143], a[40:43]
    s_add_u32 m0, m0, 0x420
    s_add_u32 s50, s50, 0x2000
    v_accvgpr_write_b32 a161, v73
    v_mfma_f32_16x16x32_bf16 a[44:47], a[152:155], v[192:195], a[44:47]
    ds_read_b64_tr_b16 a[152:153], v4 offset:288
    ds_read_b64_tr_b16 a[154:155], v4 offset:8736
    v_mfma_f32_16x16x32_bf16 a[44:47], a[156:159], v[196:199], a[44:47]
    s_waitcnt lgkmcnt(12)
    ds_read_b64_tr_b16 a[156:157], v4 offset:17184
    ds_read_b64_tr_b16 a[158:159], v4 offset:25632
    v_mfma_f32_16x16x32_bf16 a[48:51], a[128:131], v[136:139], a[48:51]
    s_waitcnt lgkmcnt(12)
    v_mul_f32 v244, 0xbfb8aa3b, v20
    v_mul_f32 v245, 0xbfb8aa3b, v21
    v_mfma_f32_16x16x32_bf16 a[48:51], a[132:135], v[140:143], a[48:51]
    v_mul_f32 v246, 0xbfb8aa3b, v22
    v_mul_f32 v247, 0xbfb8aa3b, v23
    v_mfma_f32_16x16x32_bf16 a[52:55], a[128:131], v[192:195], a[52:55]
    ds_read_b64_tr_b16 a[128:129], v4 offset:320
    ds_read_b64_tr_b16 a[130:131], v4 offset:8768
    v_mfma_f32_16x16x32_bf16 a[52:55], a[132:135], v[196:199], a[52:55]
    s_waitcnt lgkmcnt(12)
    ds_read_b64_tr_b16 a[132:133], v4 offset:17216
    ds_read_b64_tr_b16 a[134:135], v4 offset:25664
    v_mfma_f32_16x16x32_bf16 a[56:59], a[136:139], v[136:139], a[56:59]
    s_waitcnt lgkmcnt(12)
    buffer_load_dwordx4 v9, s[20:23], s50 offen lds
    v_mfma_f32_16x16x32_bf16 a[56:59], a[140:143], v[140:143], a[56:59]
    s_add_u32 m0, m0, 0x420
    s_add_u32 s50, s50, 0x2000
    v_mfma_f32_16x16x32_bf16 a[60:63], a[136:139], v[192:195], a[60:63]
    ds_read_b64_tr_b16 a[136:137], v4 offset:352
    ds_read_b64_tr_b16 a[138:139], v4 offset:8800
    v_mfma_f32_16x16x32_bf16 a[60:63], a[140:143], v[196:199], a[60:63]
    s_waitcnt lgkmcnt(12)
    ds_read_b64_tr_b16 a[140:141], v4 offset:17248
    ds_read_b64_tr_b16 a[142:143], v4 offset:25696
    v_mfma_f32_16x16x32_bf16 a[64:67], a[144:147], v[136:139], a[64:67]
    s_waitcnt lgkmcnt(12)
    v_exp_f32 v244, v244
    v_mfma_f32_16x16x32_bf16 a[64:67], a[148:151], v[140:143], a[64:67]
    v_exp_f32 v245, v245
    v_mfma_f32_16x16x32_bf16 a[68:71], a[144:147], v[192:195], a[68:71]
    ds_read_b64_tr_b16 a[144:145], v4 offset:384
    ds_read_b64_tr_b16 a[146:147], v4 offset:8832
    v_mfma_f32_16x16x32_bf16 a[68:71], a[148:151], v[196:199], a[68:71]
    s_waitcnt lgkmcnt(12)
    ds_read_b64_tr_b16 a[148:149], v4 offset:17280
    ds_read_b64_tr_b16 a[150:151], v4 offset:25728
    v_mfma_f32_16x16x32_bf16 a[72:75], a[152:155], v[136:139], a[72:75]
    s_waitcnt lgkmcnt(12)
    buffer_load_dwordx4 v9, s[20:23], s50 offen lds
    v_mfma_f32_16x16x32_bf16 a[72:75], a[156:159], v[140:143], a[72:75]
    s_add_u32 m0, m0, 0x420
    s_add_u32 s50, s50, 0x2000
    v_mfma_f32_16x16x32_bf16 a[76:79], a[152:155], v[192:195], a[76:79]
    ds_read_b64_tr_b16 a[152:153], v4 offset:416
    ds_read_b64_tr_b16 a[154:155], v4 offset:8864
    v_mfma_f32_16x16x32_bf16 a[76:79], a[156:159], v[196:199], a[76:79]
    s_waitcnt lgkmcnt(12)
    ds_read_b64_tr_b16 a[156:157], v4 offset:17312
    ds_read_b64_tr_b16 a[158:159], v4 offset:25760
    v_mfma_f32_16x16x32_bf16 a[80:83], a[128:131], v[136:139], a[80:83]
    s_waitcnt lgkmcnt(12)
    v_exp_f32 v246, v246
    v_mfma_f32_16x16x32_bf16 a[80:83], a[132:135], v[140:143], a[80:83]
    v_exp_f32 v247, v247
    v_mfma_f32_16x16x32_bf16 a[84:87], a[128:131], v[192:195], a[84:87]
    ds_read_b64_tr_b16 a[128:129], v4 offset:448
    ds_read_b64_tr_b16 a[130:131], v4 offset:8896
    v_mfma_f32_16x16x32_bf16 a[84:87], a[132:135], v[196:199], a[84:87]
    s_waitcnt lgkmcnt(12)
    ds_read_b64_tr_b16 a[132:133], v4 offset:17344
    ds_read_b64_tr_b16 a[134:135], v4 offset:25792
    v_mfma_f32_16x16x32_bf16 a[88:91], a[136:139], v[136:139], a[88:91]
    s_waitcnt lgkmcnt(12)
    buffer_load_dwordx4 v9, s[20:23], s50 offen lds
    v_mfma_f32_16x16x32_bf16 a[88:91], a[140:143], v[140:143], a[88:91]
    s_add_u32 m0, s45, 0
    s_add_u32 s50, s50, 0x6a000
    v_mul_f32 v20, v20, v76
    v_mfma_f32_16x16x32_bf16 a[92:95], a[136:139], v[192:195], a[92:95]
    ds_read_b64_tr_b16 a[136:137], v4 offset:480
    ds_read_b64_tr_b16 a[138:139], v4 offset:8928
    v_mfma_f32_16x16x32_bf16 a[92:95], a[140:143], v[196:199], a[92:95]
    s_waitcnt lgkmcnt(12)
    ds_read_b64_tr_b16 a[140:141], v4 offset:17376
    ds_read_b64_tr_b16 a[142:143], v4 offset:25824
    v_mfma_f32_16x16x32_bf16 a[96:99], a[144:147], v[136:139], a[96:99]
    s_waitcnt lgkmcnt(12)
    v_mul_f32 v21, v21, v77
    v_mul_f32 v22, v22, v78
    v_mfma_f32_16x16x32_bf16 a[96:99], a[148:151], v[140:143], a[96:99]
    v_mul_f32 v23, v23, v79
    v_add_f32 v244, 1.0, v244
    v_mfma_f32_16x16x32_bf16 a[100:103], a[144:147], v[192:195], a[100:103]
    v_add_f32 v245, 1.0, v245
    v_add_f32 v246, 1.0, v246
    v_mfma_f32_16x16x32_bf16 a[100:103], a[148:151], v[196:199], a[100:103]
    s_waitcnt lgkmcnt(10)
    s_waitcnt vmcnt(17) lgkmcnt(0)
    s_barrier
    v_mfma_f32_16x16x32_bf16 a[104:107], a[152:155], v[136:139], a[104:107]
    ds_read_b64_tr_b16 a[144:145], v5
    ds_read_b64_tr_b16 a[146:147], v5 offset:8448
    v_mfma_f32_16x16x32_bf16 a[104:107], a[156:159], v[140:143], a[104:107]
    ds_read_b64_tr_b16 a[148:149], v5 offset:16896
    ds_read_b64_tr_b16 a[150:151], v5 offset:25344
    v_mfma_f32_16x16x32_bf16 a[108:111], a[152:155], v[192:195], a[108:111]
    buffer_load_dwordx4 v9, s[20:23], s50 offen lds
    v_mfma_f32_16x16x32_bf16 a[108:111], a[156:159], v[196:199], a[108:111]
    ds_read_b64_tr_b16 a[152:153], v5 offset:32
    ds_read_b64_tr_b16 a[154:155], v5 offset:8480
    v_mfma_f32_16x16x32_bf16 a[112:115], a[128:131], v[136:139], a[112:115]
    ds_read_b64_tr_b16 a[156:157], v5 offset:16928
    ds_read_b64_tr_b16 a[158:159], v5 offset:25376
    v_mfma_f32_16x16x32_bf16 a[112:115], a[132:135], v[140:143], a[112:115]
    s_add_u32 m0, m0, 0x420
    s_add_u32 s50, s50, 0x2000
    v_add_f32 v247, 1.0, v247
    v_mfma_f32_16x16x32_bf16 a[116:119], a[128:131], v[192:195], a[116:119]
    ds_read_b64_tr_b16 a[128:129], v5 offset:64
    ds_read_b64_tr_b16 a[130:131], v5 offset:8512
    v_mfma_f32_16x16x32_bf16 a[116:119], a[132:135], v[196:199], a[116:119]
    ds_read_b64_tr_b16 a[132:133], v5 offset:16960
    ds_read_b64_tr_b16 a[134:135], v5 offset:25408
    v_mfma_f32_16x16x32_bf16 a[120:123], a[136:139], v[136:139], a[120:123]
    buffer_load_dwordx4 v9, s[20:23], s50 offen lds
    v_mfma_f32_16x16x32_bf16 a[120:123], a[140:143], v[140:143], a[120:123]
    s_add_u32 m0, m0, 0x420
    s_add_u32 s50, s50, 0x2000
    v_mfma_f32_16x16x32_bf16 a[124:127], a[136:139], v[192:195], a[124:127]
    ds_read_b64_tr_b16 a[136:137], v5 offset:96
    ds_read_b64_tr_b16 a[138:139], v5 offset:8544
    v_mfma_f32_16x16x32_bf16 a[124:127], a[140:143], v[196:199], a[124:127]
    s_waitcnt lgkmcnt(12)
    ds_read_b64_tr_b16 a[140:141], v5 offset:16992
    ds_read_b64_tr_b16 a[142:143], v5 offset:25440
    v_mfma_f32_16x16x32_bf16 a[0:3], a[144:147], v[144:147], a[0:3]
    s_waitcnt lgkmcnt(12)
    v_rcp_f32 v244, v244
    v_mfma_f32_16x16x32_bf16 a[0:3], a[148:151], v[148:151], a[0:3]
    v_rcp_f32 v245, v245
    v_mfma_f32_16x16x32_bf16 a[4:7], a[144:147], v[200:203], a[4:7]
    ds_read_b64_tr_b16 a[144:145], v5 offset:128
    ds_read_b64_tr_b16 a[146:147], v5 offset:8576
    v_mfma_f32_16x16x32_bf16 a[4:7], a[148:151], v[204:207], a[4:7]
    s_waitcnt lgkmcnt(12)
    ds_read_b64_tr_b16 a[148:149], v5 offset:17024
    ds_read_b64_tr_b16 a[150:151], v5 offset:25472
    v_mfma_f32_16x16x32_bf16 a[8:11], a[152:155], v[144:147], a[8:11]
    s_waitcnt lgkmcnt(12)
    buffer_load_dwordx4 v9, s[20:23], s50 offen lds
    v_mfma_f32_16x16x32_bf16 a[8:11], a[156:159], v[148:151], a[8:11]
    s_add_u32 m0, m0, 0x420
    s_add_u32 s50, s50, 0x2000
    v_mfma_f32_16x16x32_bf16 a[12:15], a[152:155], v[200:203], a[12:15]
    ds_read_b64_tr_b16 a[152:153], v5 offset:160
    ds_read_b64_tr_b16 a[154:155], v5 offset:8608
    v_mfma_f32_16x16x32_bf16 a[12:15], a[156:159], v[204:207], a[12:15]
    s_waitcnt lgkmcnt(12)
    ds_read_b64_tr_b16 a[156:157], v5 offset:17056
    ds_read_b64_tr_b16 a[158:159], v5 offset:25504
    v_mfma_f32_16x16x32_bf16 a[16:19], a[128:131], v[144:147], a[16:19]
    s_waitcnt lgkmcnt(12)
    v_rcp_f32 v246, v246
    v_mfma_f32_16x16x32_bf16 a[16:19], a[132:135], v[148:151], a[16:19]
    v_rcp_f32 v247, v247
    v_mfma_f32_16x16x32_bf16 a[20:23], a[128:131], v[200:203], a[20:23]
    ds_read_b64_tr_b16 a[128:129], v5 offset:192
    ds_read_b64_tr_b16 a[130:131], v5 offset:8640
    v_mfma_f32_16x16x32_bf16 a[20:23], a[132:135], v[204:207], a[20:23]
    s_waitcnt lgkmcnt(12)
    ds_read_b64_tr_b16 a[132:133], v5 offset:17088
    ds_read_b64_tr_b16 a[134:135], v5 offset:25536
    v_mfma_f32_16x16x32_bf16 a[24:27], a[136:139], v[144:147], a[24:27]
    s_waitcnt lgkmcnt(12)
    buffer_load_dwordx4 v9, s[20:23], s50 offen lds
    v_mfma_f32_16x16x32_bf16 a[24:27], a[140:143], v[148:151], a[24:27]
    s_add_u32 m0, m0, 0x420
    s_add_u32 s50, s50, 0xa000
    v_mul_f32 v20, v20, v244
    v_mfma_f32_16x16x32_bf16 a[28:31], a[136:139], v[200:203], a[28:31]
    ds_read_b64_tr_b16 a[136:137], v5 offset:224
    ds_read_b64_tr_b16 a[138:139], v5 offset:8672
    v_mfma_f32_16x16x32_bf16 a[28:31], a[140:143], v[204:207], a[28:31]
    s_waitcnt lgkmcnt(12)
    ds_read_b64_tr_b16 a[140:141], v5 offset:17120
    ds_read_b64_tr_b16 a[142:143], v5 offset:25568
    v_mfma_f32_16x16x32_bf16 a[32:35], a[144:147], v[144:147], a[32:35]
    s_waitcnt lgkmcnt(12)
    v_mul_f32 v21, v21, v245
    v_mul_f32 v22, v22, v246
    v_mfma_f32_16x16x32_bf16 a[32:35], a[148:151], v[148:151], a[32:35]
    v_mul_f32 v23, v23, v247
    v_cvt_pk_bf16_f32 v76, v20, v21
    v_mfma_f32_16x16x32_bf16 a[36:39], a[144:147], v[200:203], a[36:39]
    ds_read_b64_tr_b16 a[144:145], v5 offset:256
    ds_read_b64_tr_b16 a[146:147], v5 offset:8704
    v_mfma_f32_16x16x32_bf16 a[36:39], a[148:151], v[204:207], a[36:39]
    s_waitcnt lgkmcnt(12)
    ds_read_b64_tr_b16 a[148:149], v5 offset:17152
    ds_read_b64_tr_b16 a[150:151], v5 offset:25600
    v_mfma_f32_16x16x32_bf16 a[40:43], a[152:155], v[144:147], a[40:43]
    s_waitcnt lgkmcnt(12)
    buffer_load_dwordx4 v9, s[20:23], s50 offen lds
    v_mfma_f32_16x16x32_bf16 a[40:43], a[156:159], v[148:151], a[40:43]
    s_add_u32 m0, m0, 0x420
    s_add_u32 s50, s50, 0x2000
    v_cvt_pk_bf16_f32 v77, v22, v23
    v_mfma_f32_16x16x32_bf16 a[44:47], a[152:155], v[200:203], a[44:47]
    ds_read_b64_tr_b16 a[152:153], v5 offset:288
    ds_read_b64_tr_b16 a[154:155], v5 offset:8736
    v_mfma_f32_16x16x32_bf16 a[44:47], a[156:159], v[204:207], a[44:47]
    s_waitcnt lgkmcnt(12)
    ds_read_b64_tr_b16 a[156:157], v5 offset:17184
    ds_read_b64_tr_b16 a[158:159], v5 offset:25632
    v_mfma_f32_16x16x32_bf16 a[48:51], a[128:131], v[144:147], a[48:51]
    s_waitcnt lgkmcnt(12)
    v_accvgpr_write_b32 a176, v76
    v_accvgpr_write_b32 a177, v77
    v_mfma_f32_16x16x32_bf16 a[48:51], a[132:135], v[148:151], a[48:51]
    v_mul_f32 v240, 0xbfb8aa3b, v24
    v_mul_f32 v241, 0xbfb8aa3b, v25
    v_mfma_f32_16x16x32_bf16 a[52:55], a[128:131], v[200:203], a[52:55]
    ds_read_b64_tr_b16 a[128:129], v5 offset:320
    ds_read_b64_tr_b16 a[130:131], v5 offset:8768
    v_mfma_f32_16x16x32_bf16 a[52:55], a[132:135], v[204:207], a[52:55]
    s_waitcnt lgkmcnt(12)
    ds_read_b64_tr_b16 a[132:133], v5 offset:17216
    ds_read_b64_tr_b16 a[134:135], v5 offset:25664
    v_mfma_f32_16x16x32_bf16 a[56:59], a[136:139], v[144:147], a[56:59]
    s_waitcnt lgkmcnt(12)
    buffer_load_dwordx4 v9, s[20:23], s50 offen lds
    v_mfma_f32_16x16x32_bf16 a[56:59], a[140:143], v[148:151], a[56:59]
    s_add_u32 m0, m0, 0x420
    s_add_u32 s50, s50, 0x2000
    v_mul_f32 v242, 0xbfb8aa3b, v26
    v_mfma_f32_16x16x32_bf16 a[60:63], a[136:139], v[200:203], a[60:63]
    s_add_u32 s96, s96, 0x10000
    ds_read_b64_tr_b16 a[136:137], v5 offset:352
    ds_read_b64_tr_b16 a[138:139], v5 offset:8800
    v_mfma_f32_16x16x32_bf16 a[60:63], a[140:143], v[204:207], a[60:63]
    s_waitcnt lgkmcnt(12)
    ds_read_b64_tr_b16 a[140:141], v5 offset:17248
    ds_read_b64_tr_b16 a[142:143], v5 offset:25696
    v_mfma_f32_16x16x32_bf16 a[64:67], a[144:147], v[144:147], a[64:67]
    s_waitcnt lgkmcnt(12)
    buffer_load_dword v13, v14, s[92:95], s96 offen
    v_mfma_f32_16x16x32_bf16 a[64:67], a[148:151], v[148:151], a[64:67]
    v_mul_f32 v243, 0xbfb8aa3b, v27
    v_mfma_f32_16x16x32_bf16 a[68:71], a[144:147], v[200:203], a[68:71]
    ds_read_b64_tr_b16 a[144:145], v5 offset:384
    ds_read_b64_tr_b16 a[146:147], v5 offset:8832
    v_mfma_f32_16x16x32_bf16 a[68:71], a[148:151], v[204:207], a[68:71]
    s_waitcnt lgkmcnt(12)
    ds_read_b64_tr_b16 a[148:149], v5 offset:17280
    ds_read_b64_tr_b16 a[150:151], v5 offset:25728
    v_mfma_f32_16x16x32_bf16 a[72:75], a[152:155], v[144:147], a[72:75]
    s_waitcnt lgkmcnt(12)
    buffer_load_dwordx4 v9, s[20:23], s50 offen lds
    v_mfma_f32_16x16x32_bf16 a[72:75], a[156:159], v[148:151], a[72:75]
    s_add_u32 m0, m0, 0x420
    s_add_u32 s50, s50, 0x2000
    v_mfma_f32_16x16x32_bf16 a[76:79], a[152:155], v[200:203], a[76:79]
    ds_read_b64_tr_b16 a[152:153], v5 offset:416
    ds_read_b64_tr_b16 a[154:155], v5 offset:8864
    v_mfma_f32_16x16x32_bf16 a[76:79], a[156:159], v[204:207], a[76:79]
    s_waitcnt lgkmcnt(12)
    ds_read_b64_tr_b16 a[156:157], v5 offset:17312
    ds_read_b64_tr_b16 a[158:159], v5 offset:25760
    v_mfma_f32_16x16x32_bf16 a[80:83], a[128:131], v[144:147], a[80:83]
    s_waitcnt lgkmcnt(12)
    v_exp_f32 v240, v240
    v_mfma_f32_16x16x32_bf16 a[80:83], a[132:135], v[148:151], a[80:83]
    v_exp_f32 v241, v241
    v_mfma_f32_16x16x32_bf16 a[84:87], a[128:131], v[200:203], a[84:87]
    ds_read_b64_tr_b16 a[128:129], v5 offset:448
    ds_read_b64_tr_b16 a[130:131], v5 offset:8896
    v_mfma_f32_16x16x32_bf16 a[84:87], a[132:135], v[204:207], a[84:87]
    s_waitcnt lgkmcnt(12)
    ds_read_b64_tr_b16 a[132:133], v5 offset:17344
    ds_read_b64_tr_b16 a[134:135], v5 offset:25792
    v_mfma_f32_16x16x32_bf16 a[88:91], a[136:139], v[144:147], a[88:91]
    s_waitcnt lgkmcnt(12)
    buffer_load_dwordx4 v9, s[20:23], s50 offen lds
    v_mfma_f32_16x16x32_bf16 a[88:91], a[140:143], v[148:151], a[88:91]
    s_add_u32 m0, s45, 0x10800
    s_add_u32 s50, s50, 0x6a000
    v_mfma_f32_16x16x32_bf16 a[92:95], a[136:139], v[200:203], a[92:95]
    ds_read_b64_tr_b16 a[136:137], v5 offset:480
    ds_read_b64_tr_b16 a[138:139], v5 offset:8928
    v_mfma_f32_16x16x32_bf16 a[92:95], a[140:143], v[204:207], a[92:95]
    s_waitcnt lgkmcnt(12)
    ds_read_b64_tr_b16 a[140:141], v5 offset:17376
    ds_read_b64_tr_b16 a[142:143], v5 offset:25824
    v_mfma_f32_16x16x32_bf16 a[96:99], a[144:147], v[144:147], a[96:99]
    s_waitcnt lgkmcnt(12)
    v_exp_f32 v242, v242
    v_mfma_f32_16x16x32_bf16 a[96:99], a[148:151], v[148:151], a[96:99]
    v_exp_f32 v243, v243
    v_mfma_f32_16x16x32_bf16 a[100:103], a[144:147], v[200:203], a[100:103]
    v_mul_f32 v24, v24, v80
    v_mul_f32 v25, v25, v81
    v_mfma_f32_16x16x32_bf16 a[100:103], a[148:151], v[204:207], a[100:103]
    s_waitcnt lgkmcnt(10)
    s_waitcnt vmcnt(18) lgkmcnt(0)
    s_barrier
    v_mfma_f32_16x16x32_bf16 a[104:107], a[152:155], v[144:147], a[104:107]
    ds_read_b64_tr_b16 a[144:145], v4 offset:33792
    ds_read_b64_tr_b16 a[146:147], v4 offset:42240
    v_mfma_f32_16x16x32_bf16 a[104:107], a[156:159], v[148:151], a[104:107]
    ds_read_b64_tr_b16 a[148:149], v4 offset:50688
    ds_read_b64_tr_b16 a[150:151], v4 offset:59136
    v_mfma_f32_16x16x32_bf16 a[108:111], a[152:155], v[200:203], a[108:111]
    buffer_load_dwordx4 v9, s[20:23], s50 offen lds
    v_mfma_f32_16x16x32_bf16 a[108:111], a[156:159], v[204:207], a[108:111]
    ds_read_b64_tr_b16 a[152:153], v4 offset:33824
    ds_read_b64_tr_b16 a[154:155], v4 offset:42272
    v_mfma_f32_16x16x32_bf16 a[112:115], a[128:131], v[144:147], a[112:115]
    ds_read_b64_tr_b16 a[156:157], v4 offset:50720
    ds_read_b64_tr_b16 a[158:159], v4 offset:59168
    v_mfma_f32_16x16x32_bf16 a[112:115], a[132:135], v[148:151], a[112:115]
    s_add_u32 m0, m0, 0x420
    s_add_u32 s50, s50, 0x2000
    v_mul_f32 v26, v26, v82
    v_mfma_f32_16x16x32_bf16 a[116:119], a[128:131], v[200:203], a[116:119]
    ds_read_b64_tr_b16 a[128:129], v4 offset:33856
    ds_read_b64_tr_b16 a[130:131], v4 offset:42304
    v_mfma_f32_16x16x32_bf16 a[116:119], a[132:135], v[204:207], a[116:119]
    ds_read_b64_tr_b16 a[132:133], v4 offset:50752
    ds_read_b64_tr_b16 a[134:135], v4 offset:59200
    v_mfma_f32_16x16x32_bf16 a[120:123], a[136:139], v[144:147], a[120:123]
    buffer_load_dwordx4 v9, s[20:23], s50 offen lds
    v_mfma_f32_16x16x32_bf16 a[120:123], a[140:143], v[148:151], a[120:123]
    s_add_u32 m0, m0, 0x420
    s_add_u32 s50, s50, 0x2000
    v_mul_f32 v27, v27, v83
    v_mfma_f32_16x16x32_bf16 a[124:127], a[136:139], v[200:203], a[124:127]
    ds_read_b64_tr_b16 a[136:137], v4 offset:33888
    ds_read_b64_tr_b16 a[138:139], v4 offset:42336
    v_mfma_f32_16x16x32_bf16 a[124:127], a[140:143], v[204:207], a[124:127]
    s_waitcnt lgkmcnt(12)
    ds_read_b64_tr_b16 a[140:141], v4 offset:50784
    ds_read_b64_tr_b16 a[142:143], v4 offset:59232
    v_mfma_f32_16x16x32_bf16 a[0:3], a[144:147], v[152:155], a[0:3]
    s_waitcnt lgkmcnt(12)
    v_add_f32 v240, 1.0, v240
    v_add_f32 v241, 1.0, v241
    v_mfma_f32_16x16x32_bf16 a[0:3], a[148:151], v[156:159], a[0:3]
    v_add_f32 v242, 1.0, v242
    v_add_f32 v243, 1.0, v243
    v_mfma_f32_16x16x32_bf16 a[4:7], a[144:147], v[208:211], a[4:7]
    ds_read_b64_tr_b16 a[144:145], v4 offset:33920
    ds_read_b64_tr_b16 a[146:147], v4 offset:42368
    v_mfma_f32_16x16x32_bf16 a[4:7], a[148:151], v[212:215], a[4:7]
    s_waitcnt lgkmcnt(12)
    ds_read_b64_tr_b16 a[148:149], v4 offset:50816
    ds_read_b64_tr_b16 a[150:151], v4 offset:59264
    v_mfma_f32_16x16x32_bf16 a[8:11], a[152:155], v[152:155], a[8:11]
    s_waitcnt lgkmcnt(12)
    buffer_load_dwordx4 v9, s[20:23], s50 offen lds
    v_mfma_f32_16x16x32_bf16 a[8:11], a[156:159], v[156:159], a[8:11]
    s_add_u32 m0, m0, 0x420
    s_add_u32 s50, s50, 0x2000
    v_mfma_f32_16x16x32_bf16 a[12:15], a[152:155], v[208:211], a[12:15]
    ds_read_b64_tr_b16 a[152:153], v4 offset:33952
    ds_read_b64_tr_b16 a[154:155], v4 offset:42400
    v_mfma_f32_16x16x32_bf16 a[12:15], a[156:159], v[212:215], a[12:15]
    s_waitcnt lgkmcnt(12)
    ds_read_b64_tr_b16 a[156:157], v4 offset:50848
    ds_read_b64_tr_b16 a[158:159], v4 offset:59296
    v_mfma_f32_16x16x32_bf16 a[16:19], a[128:131], v[152:155], a[16:19]
    s_waitcnt lgkmcnt(12)
    v_rcp_f32 v240, v240
    v_mfma_f32_16x16x32_bf16 a[16:19], a[132:135], v[156:159], a[16:19]
    v_rcp_f32 v241, v241
    v_mfma_f32_16x16x32_bf16 a[20:23], a[128:131], v[208:211], a[20:23]
    ds_read_b64_tr_b16 a[128:129], v4 offset:33984
    ds_read_b64_tr_b16 a[130:131], v4 offset:42432
    v_mfma_f32_16x16x32_bf16 a[20:23], a[132:135], v[212:215], a[20:23]
    s_waitcnt lgkmcnt(12)
    ds_read_b64_tr_b16 a[132:133], v4 offset:50880
    ds_read_b64_tr_b16 a[134:135], v4 offset:59328
    v_mfma_f32_16x16x32_bf16 a[24:27], a[136:139], v[152:155], a[24:27]
    s_waitcnt lgkmcnt(12)
    buffer_load_dwordx4 v9, s[20:23], s50 offen lds
    v_mfma_f32_16x16x32_bf16 a[24:27], a[140:143], v[156:159], a[24:27]
    s_add_u32 m0, m0, 0x420
    s_add_u32 s50, s50, 0xa000
    v_mfma_f32_16x16x32_bf16 a[28:31], a[136:139], v[208:211], a[28:31]
    ds_read_b64_tr_b16 a[136:137], v4 offset:34016
    ds_read_b64_tr_b16 a[138:139], v4 offset:42464
    v_mfma_f32_16x16x32_bf16 a[28:31], a[140:143], v[212:215], a[28:31]
    s_waitcnt lgkmcnt(12)
    ds_read_b64_tr_b16 a[140:141], v4 offset:50912
    ds_read_b64_tr_b16 a[142:143], v4 offset:59360
    v_mfma_f32_16x16x32_bf16 a[32:35], a[144:147], v[152:155], a[32:35]
    s_waitcnt lgkmcnt(12)
    v_rcp_f32 v242, v242
    v_mfma_f32_16x16x32_bf16 a[32:35], a[148:151], v[156:159], a[32:35]
    v_rcp_f32 v243, v243
    v_mfma_f32_16x16x32_bf16 a[36:39], a[144:147], v[208:211], a[36:39]
    ds_read_b64_tr_b16 a[144:145], v4 offset:34048
    ds_read_b64_tr_b16 a[146:147], v4 offset:42496
    v_mfma_f32_16x16x32_bf16 a[36:39], a[148:151], v[212:215], a[36:39]
    s_waitcnt lgkmcnt(12)
    ds_read_b64_tr_b16 a[148:149], v4 offset:50944
    ds_read_b64_tr_b16 a[150:151], v4 offset:59392
    v_mfma_f32_16x16x32_bf16 a[40:43], a[152:155], v[152:155], a[40:43]
    s_waitcnt lgkmcnt(12)
    buffer_load_dwordx4 v9, s[20:23], s50 offen lds
    v_mfma_f32_16x16x32_bf16 a[40:43], a[156:159], v[156:159], a[40:43]
    s_add_u32 m0, m0, 0x420
    s_add_u32 s50, s50, 0x2000
    v_mul_f32 v24, v24, v240
    v_mfma_f32_16x16x32_bf16 a[44:47], a[152:155], v[208:211], a[44:47]
    ds_read_b64_tr_b16 a[152:153], v4 offset:34080
    ds_read_b64_tr_b16 a[154:155], v4 offset:42528
    v_mfma_f32_16x16x32_bf16 a[44:47], a[156:159], v[212:215], a[44:47]
    s_waitcnt lgkmcnt(12)
    ds_read_b64_tr_b16 a[156:157], v4 offset:50976
    ds_read_b64_tr_b16 a[158:159], v4 offset:59424
    v_mfma_f32_16x16x32_bf16 a[48:51], a[128:131], v[152:155], a[48:51]
    s_waitcnt lgkmcnt(12)
    v_mul_f32 v25, v25, v241
    v_mul_f32 v26, v26, v242
    v_mfma_f32_16x16x32_bf16 a[48:51], a[132:135], v[156:159], a[48:51]
    v_mul_f32 v27, v27, v243
    v_cvt_pk_bf16_f32 v80, v24, v25
    v_mfma_f32_16x16x32_bf16 a[52:55], a[128:131], v[208:211], a[52:55]
    ds_read_b64_tr_b16 a[128:129], v4 offset:34112
    ds_read_b64_tr_b16 a[130:131], v4 offset:42560
    v_mfma_f32_16x16x32_bf16 a[52:55], a[132:135], v[212:215], a[52:55]
    s_waitcnt lgkmcnt(12)
    ds_read_b64_tr_b16 a[132:133], v4 offset:51008
    ds_read_b64_tr_b16 a[134:135], v4 offset:59456
    v_mfma_f32_16x16x32_bf16 a[56:59], a[136:139], v[152:155], a[56:59]
    s_waitcnt lgkmcnt(12)
    buffer_load_dwordx4 v9, s[20:23], s50 offen lds
    v_mfma_f32_16x16x32_bf16 a[56:59], a[140:143], v[156:159], a[56:59]
    s_add_u32 m0, m0, 0x420
    s_add_u32 s50, s50, 0x2000
    v_cvt_pk_bf16_f32 v81, v26, v27
    v_mfma_f32_16x16x32_bf16 a[60:63], a[136:139], v[208:211], a[60:63]
    ds_read_b64_tr_b16 a[136:137], v4 offset:34144
    ds_read_b64_tr_b16 a[138:139], v4 offset:42592
    v_mfma_f32_16x16x32_bf16 a[60:63], a[140:143], v[212:215], a[60:63]
    s_waitcnt lgkmcnt(12)
    ds_read_b64_tr_b16 a[140:141], v4 offset:51040
    ds_read_b64_tr_b16 a[142:143], v4 offset:59488
    v_mfma_f32_16x16x32_bf16 a[64:67], a[144:147], v[152:155], a[64:67]
    s_waitcnt lgkmcnt(12)
    v_accvgpr_write_b32 a162, v80
    v_accvgpr_write_b32 a163, v81
    v_mfma_f32_16x16x32_bf16 a[64:67], a[148:151], v[156:159], a[64:67]
    v_mul_f32 v244, 0xbfb8aa3b, v28
    v_mul_f32 v245, 0xbfb8aa3b, v29
    v_mfma_f32_16x16x32_bf16 a[68:71], a[144:147], v[208:211], a[68:71]
    ds_read_b64_tr_b16 a[144:145], v4 offset:34176
    ds_read_b64_tr_b16 a[146:147], v4 offset:42624
    v_mfma_f32_16x16x32_bf16 a[68:71], a[148:151], v[212:215], a[68:71]
    s_waitcnt lgkmcnt(12)
    ds_read_b64_tr_b16 a[148:149], v4 offset:51072
    ds_read_b64_tr_b16 a[150:151], v4 offset:59520
    v_mfma_f32_16x16x32_bf16 a[72:75], a[152:155], v[152:155], a[72:75]
    s_waitcnt lgkmcnt(12)
    buffer_load_dwordx4 v9, s[20:23], s50 offen lds
    v_mfma_f32_16x16x32_bf16 a[72:75], a[156:159], v[156:159], a[72:75]
    s_add_u32 m0, m0, 0x420
    s_add_u32 s50, s50, 0x2000
    v_mul_f32 v246, 0xbfb8aa3b, v30
    v_mfma_f32_16x16x32_bf16 a[76:79], a[152:155], v[208:211], a[76:79]
    ds_read_b64_tr_b16 a[152:153], v4 offset:34208
    ds_read_b64_tr_b16 a[154:155], v4 offset:42656
    v_mfma_f32_16x16x32_bf16 a[76:79], a[156:159], v[212:215], a[76:79]
    s_waitcnt lgkmcnt(12)
    ds_read_b64_tr_b16 a[156:157], v4 offset:51104
    ds_read_b64_tr_b16 a[158:159], v4 offset:59552
    v_mfma_f32_16x16x32_bf16 a[80:83], a[128:131], v[152:155], a[80:83]
    s_waitcnt lgkmcnt(12)
    v_mul_f32 v247, 0xbfb8aa3b, v31
    v_mfma_f32_16x16x32_bf16 a[80:83], a[132:135], v[156:159], a[80:83]
    v_exp_f32 v244, v244
    v_mfma_f32_16x16x32_bf16 a[84:87], a[128:131], v[208:211], a[84:87]
    ds_read_b64_tr_b16 a[128:129], v4 offset:34240
    ds_read_b64_tr_b16 a[130:131], v4 offset:42688
    v_mfma_f32_16x16x32_bf16 a[84:87], a[132:135], v[212:215], a[84:87]
    s_waitcnt lgkmcnt(12)
    ds_read_b64_tr_b16 a[132:133], v4 offset:51136
    ds_read_b64_tr_b16 a[134:135], v4 offset:59584
    v_mfma_f32_16x16x32_bf16 a[88:91], a[136:139], v[152:155], a[88:91]
    s_waitcnt lgkmcnt(12)
    buffer_load_dwordx4 v9, s[20:23], s50 offen lds
    v_mfma_f32_16x16x32_bf16 a[88:91], a[140:143], v[156:159], a[88:91]
    s_add_u32 m0, s45, 0x8400
    s_add_u32 s50, s50, 0x6a000
    v_mfma_f32_16x16x32_bf16 a[92:95], a[136:139], v[208:211], a[92:95]
    ds_read_b64_tr_b16 a[136:137], v4 offset:34272
    ds_read_b64_tr_b16 a[138:139], v4 offset:42720
    v_mfma_f32_16x16x32_bf16 a[92:95], a[140:143], v[212:215], a[92:95]
    s_waitcnt lgkmcnt(12)
    ds_read_b64_tr_b16 a[140:141], v4 offset:51168
    ds_read_b64_tr_b16 a[142:143], v4 offset:59616
    v_mfma_f32_16x16x32_bf16 a[96:99], a[144:147], v[152:155], a[96:99]
    s_waitcnt lgkmcnt(12)
    v_exp_f32 v245, v245
    v_mfma_f32_16x16x32_bf16 a[96:99], a[148:151], v[156:159], a[96:99]
    v_exp_f32 v246, v246
    v_mfma_f32_16x16x32_bf16 a[100:103], a[144:147], v[208:211], a[100:103]
    v_exp_f32 v247, v247
    v_mfma_f32_16x16x32_bf16 a[100:103], a[148:151], v[212:215], a[100:103]
    s_waitcnt lgkmcnt(10)
    s_waitcnt vmcnt(17) lgkmcnt(0)
    s_barrier
    v_mfma_f32_16x16x32_bf16 a[104:107], a[152:155], v[152:155], a[104:107]
    ds_read_b64_tr_b16 a[144:145], v5 offset:33792
    ds_read_b64_tr_b16 a[146:147], v5 offset:42240
    v_mfma_f32_16x16x32_bf16 a[104:107], a[156:159], v[156:159], a[104:107]
    ds_read_b64_tr_b16 a[148:149], v5 offset:50688
    ds_read_b64_tr_b16 a[150:151], v5 offset:59136
    v_mfma_f32_16x16x32_bf16 a[108:111], a[152:155], v[208:211], a[108:111]
    buffer_load_dwordx4 v10, s[32:35], s51 offen lds
    v_mfma_f32_16x16x32_bf16 a[108:111], a[156:159], v[212:215], a[108:111]
    ds_read_b64_tr_b16 a[152:153], v5 offset:33824
    ds_read_b64_tr_b16 a[154:155], v5 offset:42272
    v_mfma_f32_16x16x32_bf16 a[112:115], a[128:131], v[152:155], a[112:115]
    ds_read_b64_tr_b16 a[156:157], v5 offset:50720
    ds_read_b64_tr_b16 a[158:159], v5 offset:59168
    v_mfma_f32_16x16x32_bf16 a[112:115], a[132:135], v[156:159], a[112:115]
    s_add_u32 m0, m0, 0x420
    s_add_u32 s51, s51, 0x380
    v_mul_f32 v28, v28, v84
    v_mfma_f32_16x16x32_bf16 a[116:119], a[128:131], v[208:211], a[116:119]
    ds_read_b64_tr_b16 a[128:129], v5 offset:33856
    ds_read_b64_tr_b16 a[130:131], v5 offset:42304
    v_mfma_f32_16x16x32_bf16 a[116:119], a[132:135], v[212:215], a[116:119]
    ds_read_b64_tr_b16 a[132:133], v5 offset:50752
    ds_read_b64_tr_b16 a[134:135], v5 offset:59200
    v_mfma_f32_16x16x32_bf16 a[120:123], a[136:139], v[152:155], a[120:123]
    buffer_load_dwordx4 v10, s[32:35], s51 offen lds
    v_mfma_f32_16x16x32_bf16 a[120:123], a[140:143], v[156:159], a[120:123]
    s_add_u32 m0, m0, 0x420
    s_add_u32 s51, s51, 0x380
    v_mul_f32 v29, v29, v85
    v_mfma_f32_16x16x32_bf16 a[124:127], a[136:139], v[208:211], a[124:127]
    ds_read_b64_tr_b16 a[136:137], v5 offset:33888
    ds_read_b64_tr_b16 a[138:139], v5 offset:42336
    v_mfma_f32_16x16x32_bf16 a[124:127], a[140:143], v[212:215], a[124:127]
    s_waitcnt lgkmcnt(12)
    ds_read_b64_tr_b16 a[140:141], v5 offset:50784
    ds_read_b64_tr_b16 a[142:143], v5 offset:59232
    v_mfma_f32_16x16x32_bf16 a[0:3], a[144:147], v[160:163], a[0:3]
    s_waitcnt lgkmcnt(12)
    v_mul_f32 v30, v30, v86
    v_mul_f32 v31, v31, v87
    v_mfma_f32_16x16x32_bf16 a[0:3], a[148:151], v[164:167], a[0:3]
    v_add_f32 v244, 1.0, v244
    v_add_f32 v245, 1.0, v245
    v_mfma_f32_16x16x32_bf16 a[4:7], a[144:147], v[216:219], a[4:7]
    s_add_u32 s96, s96, 0x10000
    ds_read_b64_tr_b16 a[144:145], v5 offset:33920
    ds_read_b64_tr_b16 a[146:147], v5 offset:42368
    v_mfma_f32_16x16x32_bf16 a[4:7], a[148:151], v[220:223], a[4:7]
    s_waitcnt lgkmcnt(12)
    ds_read_b64_tr_b16 a[148:149], v5 offset:50816
    ds_read_b64_tr_b16 a[150:151], v5 offset:59264
    v_mfma_f32_16x16x32_bf16 a[8:11], a[152:155], v[160:163], a[8:11]
    s_waitcnt lgkmcnt(12)
    buffer_load_dwordx4 v10, s[32:35], s51 offen lds
    v_mfma_f32_16x16x32_bf16 a[8:11], a[156:159], v[164:167], a[8:11]
    s_add_u32 m0, m0, 0x420
    s_add_u32 s51, s51, 0x380
    v_add_f32 v246, 1.0, v246
    v_mfma_f32_16x16x32_bf16 a[12:15], a[152:155], v[216:219], a[12:15]
    ds_read_b64_tr_b16 a[152:153], v5 offset:33952
    ds_read_b64_tr_b16 a[154:155], v5 offset:42400
    v_mfma_f32_16x16x32_bf16 a[12:15], a[156:159], v[220:223], a[12:15]
    s_waitcnt lgkmcnt(12)
    ds_read_b64_tr_b16 a[156:157], v5 offset:50848
    ds_read_b64_tr_b16 a[158:159], v5 offset:59296
    v_mfma_f32_16x16x32_bf16 a[16:19], a[128:131], v[160:163], a[16:19]
    s_waitcnt lgkmcnt(12)
    buffer_load_dword v13, v14, s[92:95], s96 offen
    v_mfma_f32_16x16x32_bf16 a[16:19], a[132:135], v[164:167], a[16:19]
    v_add_f32 v247, 1.0, v247
    v_mfma_f32_16x16x32_bf16 a[20:23], a[128:131], v[216:219], a[20:23]
    ds_read_b64_tr_b16 a[128:129], v5 offset:33984
    ds_read_b64_tr_b16 a[130:131], v5 offset:42432
    v_mfma_f32_16x16x32_bf16 a[20:23], a[132:135], v[220:223], a[20:23]
    s_waitcnt lgkmcnt(12)
    ds_read_b64_tr_b16 a[132:133], v5 offset:50880
    ds_read_b64_tr_b16 a[134:135], v5 offset:59328
    v_mfma_f32_16x16x32_bf16 a[24:27], a[136:139], v[160:163], a[24:27]
    s_waitcnt lgkmcnt(12)
    buffer_load_dwordx4 v10, s[32:35], s51 offen lds
    v_mfma_f32_16x16x32_bf16 a[24:27], a[140:143], v[164:167], a[24:27]
    s_add_u32 m0, m0, 0x420
    s_add_u32 s51, s51, 0x380
    v_mfma_f32_16x16x32_bf16 a[28:31], a[136:139], v[216:219], a[28:31]
    ds_read_b64_tr_b16 a[136:137], v5 offset:34016
    ds_read_b64_tr_b16 a[138:139], v5 offset:42464
    v_mfma_f32_16x16x32_bf16 a[28:31], a[140:143], v[220:223], a[28:31]
    s_waitcnt lgkmcnt(12)
    ds_read_b64_tr_b16 a[140:141], v5 offset:50912
    ds_read_b64_tr_b16 a[142:143], v5 offset:59360
    v_mfma_f32_16x16x32_bf16 a[32:35], a[144:147], v[160:163], a[32:35]
    s_waitcnt lgkmcnt(12)
    v_rcp_f32 v244, v244
    v_mfma_f32_16x16x32_bf16 a[32:35], a[148:151], v[164:167], a[32:35]
    v_rcp_f32 v245, v245
    v_mfma_f32_16x16x32_bf16 a[36:39], a[144:147], v[216:219], a[36:39]
    ds_read_b64_tr_b16 a[144:145], v5 offset:34048
    ds_read_b64_tr_b16 a[146:147], v5 offset:42496
    v_mfma_f32_16x16x32_bf16 a[36:39], a[148:151], v[220:223], a[36:39]
    s_waitcnt lgkmcnt(12)
    ds_read_b64_tr_b16 a[148:149], v5 offset:50944
    ds_read_b64_tr_b16 a[150:151], v5 offset:59392
    v_mfma_f32_16x16x32_bf16 a[40:43], a[152:155], v[160:163], a[40:43]
    s_waitcnt lgkmcnt(12)
    buffer_load_dwordx4 v10, s[32:35], s51 offen lds
    v_mfma_f32_16x16x32_bf16 a[40:43], a[156:159], v[164:167], a[40:43]
    s_add_u32 m0, m0, 0x420
    s_add_u32 s51, s51, 0x380
    v_mfma_f32_16x16x32_bf16 a[44:47], a[152:155], v[216:219], a[44:47]
    ds_read_b64_tr_b16 a[152:153], v5 offset:34080
    ds_read_b64_tr_b16 a[154:155], v5 offset:42528
    v_mfma_f32_16x16x32_bf16 a[44:47], a[156:159], v[220:223], a[44:47]
    s_waitcnt lgkmcnt(12)
    ds_read_b64_tr_b16 a[156:157], v5 offset:50976
    ds_read_b64_tr_b16 a[158:159], v5 offset:59424
    v_mfma_f32_16x16x32_bf16 a[48:51], a[128:131], v[160:163], a[48:51]
    s_waitcnt lgkmcnt(12)
    v_rcp_f32 v246, v246
    v_mfma_f32_16x16x32_bf16 a[48:51], a[132:135], v[164:167], a[48:51]
    v_rcp_f32 v247, v247
    v_mfma_f32_16x16x32_bf16 a[52:55], a[128:131], v[216:219], a[52:55]
    ds_read_b64_tr_b16 a[128:129], v5 offset:34112
    ds_read_b64_tr_b16 a[130:131], v5 offset:42560
    v_mfma_f32_16x16x32_bf16 a[52:55], a[132:135], v[220:223], a[52:55]
    s_waitcnt lgkmcnt(12)
    ds_read_b64_tr_b16 a[132:133], v5 offset:51008
    ds_read_b64_tr_b16 a[134:135], v5 offset:59456
    v_mfma_f32_16x16x32_bf16 a[56:59], a[136:139], v[160:163], a[56:59]
    s_waitcnt lgkmcnt(12)
    buffer_load_dwordx4 v10, s[32:35], s51 offen lds
    v_mfma_f32_16x16x32_bf16 a[56:59], a[140:143], v[164:167], a[56:59]
    s_add_u32 m0, m0, 0x420
    s_add_u32 s51, s51, 0x380
    v_mul_f32 v28, v28, v244
    v_mfma_f32_16x16x32_bf16 a[60:63], a[136:139], v[216:219], a[60:63]
    ds_read_b64_tr_b16 a[136:137], v5 offset:34144
    ds_read_b64_tr_b16 a[138:139], v5 offset:42592
    v_mfma_f32_16x16x32_bf16 a[60:63], a[140:143], v[220:223], a[60:63]
    s_waitcnt lgkmcnt(12)
    ds_read_b64_tr_b16 a[140:141], v5 offset:51040
    ds_read_b64_tr_b16 a[142:143], v5 offset:59488
    v_mfma_f32_16x16x32_bf16 a[64:67], a[144:147], v[160:163], a[64:67]
    s_waitcnt lgkmcnt(12)
    v_mul_f32 v29, v29, v245
    v_mul_f32 v30, v30, v246
    v_mfma_f32_16x16x32_bf16 a[64:67], a[148:151], v[164:167], a[64:67]
    v_mul_f32 v31, v31, v247
    v_cvt_pk_bf16_f32 v84, v28, v29
    v_mfma_f32_16x16x32_bf16 a[68:71], a[144:147], v[216:219], a[68:71]
    ds_read_b64_tr_b16 a[144:145], v5 offset:34176
    ds_read_b64_tr_b16 a[146:147], v5 offset:42624
    v_mfma_f32_16x16x32_bf16 a[68:71], a[148:151], v[220:223], a[68:71]
    s_waitcnt lgkmcnt(12)
    ds_read_b64_tr_b16 a[148:149], v5 offset:51072
    ds_read_b64_tr_b16 a[150:151], v5 offset:59520
    v_mfma_f32_16x16x32_bf16 a[72:75], a[152:155], v[160:163], a[72:75]
    s_waitcnt lgkmcnt(12)
    buffer_load_dwordx4 v10, s[32:35], s51 offen lds
    v_mfma_f32_16x16x32_bf16 a[72:75], a[156:159], v[164:167], a[72:75]
    s_add_u32 m0, m0, 0x420
    s_add_u32 s51, s51, 0x380
    v_cvt_pk_bf16_f32 v85, v30, v31
    v_mfma_f32_16x16x32_bf16 a[76:79], a[152:155], v[216:219], a[76:79]
    ds_read_b64_tr_b16 a[152:153], v5 offset:34208
    ds_read_b64_tr_b16 a[154:155], v5 offset:42656
    v_mfma_f32_16x16x32_bf16 a[76:79], a[156:159], v[220:223], a[76:79]
    s_waitcnt lgkmcnt(12)
    ds_read_b64_tr_b16 a[156:157], v5 offset:51104
    ds_read_b64_tr_b16 a[158:159], v5 offset:59552
    v_mfma_f32_16x16x32_bf16 a[80:83], a[128:131], v[160:163], a[80:83]
    s_waitcnt lgkmcnt(12)
    v_accvgpr_write_b32 a178, v84
    v_accvgpr_write_b32 a179, v85
    v_mfma_f32_16x16x32_bf16 a[80:83], a[132:135], v[164:167], a[80:83]
    v_mul_f32 v240, 0xbfb8aa3b, v32
    v_mul_f32 v241, 0xbfb8aa3b, v33
    v_mfma_f32_16x16x32_bf16 a[84:87], a[128:131], v[216:219], a[84:87]
    ds_read_b64_tr_b16 a[128:129], v5 offset:34240
    ds_read_b64_tr_b16 a[130:131], v5 offset:42688
    v_mfma_f32_16x16x32_bf16 a[84:87], a[132:135], v[220:223], a[84:87]
    s_waitcnt lgkmcnt(12)
    ds_read_b64_tr_b16 a[132:133], v5 offset:51136
    ds_read_b64_tr_b16 a[134:135], v5 offset:59584
    v_mfma_f32_16x16x32_bf16 a[88:91], a[136:139], v[160:163], a[88:91]
    s_waitcnt lgkmcnt(12)
    buffer_load_dwordx4 v10, s[32:35], s51 offen lds
    v_mfma_f32_16x16x32_bf16 a[88:91], a[140:143], v[164:167], a[88:91]
    s_add_u32 m0, s45, 0x18c00
    s_add_u32 s51, s51, 0xffffe880
    v_mul_f32 v242, 0xbfb8aa3b, v34
    v_mfma_f32_16x16x32_bf16 a[92:95], a[136:139], v[216:219], a[92:95]
    ds_read_b64_tr_b16 a[136:137], v5 offset:34272
    ds_read_b64_tr_b16 a[138:139], v5 offset:42720
    v_mfma_f32_16x16x32_bf16 a[92:95], a[140:143], v[220:223], a[92:95]
    s_waitcnt lgkmcnt(12)
    ds_read_b64_tr_b16 a[140:141], v5 offset:51168
    ds_read_b64_tr_b16 a[142:143], v5 offset:59616
    v_mfma_f32_16x16x32_bf16 a[96:99], a[144:147], v[160:163], a[96:99]
    s_waitcnt lgkmcnt(12)
    v_mul_f32 v243, 0xbfb8aa3b, v35
    v_mfma_f32_16x16x32_bf16 a[96:99], a[148:151], v[164:167], a[96:99]
    v_exp_f32 v240, v240
    v_mfma_f32_16x16x32_bf16 a[100:103], a[144:147], v[216:219], a[100:103]
    v_exp_f32 v241, v241
    v_mfma_f32_16x16x32_bf16 a[100:103], a[148:151], v[220:223], a[100:103]
    s_waitcnt lgkmcnt(10)
    s_waitcnt vmcnt(17) lgkmcnt(0)
    s_barrier
    v_mfma_f32_16x16x32_bf16 a[104:107], a[152:155], v[160:163], a[104:107]
    ds_read_b64_tr_b16 a[144:145], v4
    ds_read_b64_tr_b16 a[146:147], v4 offset:8448
    v_mfma_f32_16x16x32_bf16 a[104:107], a[156:159], v[164:167], a[104:107]
    ds_read_b64_tr_b16 a[148:149], v4 offset:16896
    ds_read_b64_tr_b16 a[150:151], v4 offset:25344
    v_mfma_f32_16x16x32_bf16 a[108:111], a[152:155], v[216:219], a[108:111]
    buffer_load_dwordx4 v10, s[32:35], s51 offen lds
    v_mfma_f32_16x16x32_bf16 a[108:111], a[156:159], v[220:223], a[108:111]
    ds_read_b64_tr_b16 a[152:153], v4 offset:32
    ds_read_b64_tr_b16 a[154:155], v4 offset:8480
    v_mfma_f32_16x16x32_bf16 a[112:115], a[128:131], v[160:163], a[112:115]
    ds_read_b64_tr_b16 a[156:157], v4 offset:16928
    ds_read_b64_tr_b16 a[158:159], v4 offset:25376
    v_mfma_f32_16x16x32_bf16 a[112:115], a[132:135], v[164:167], a[112:115]
    s_add_u32 m0, m0, 0x420
    s_add_u32 s51, s51, 0x380
    v_mfma_f32_16x16x32_bf16 a[116:119], a[128:131], v[216:219], a[116:119]
    ds_read_b64_tr_b16 a[128:129], v4 offset:64
    ds_read_b64_tr_b16 a[130:131], v4 offset:8512
    v_mfma_f32_16x16x32_bf16 a[116:119], a[132:135], v[220:223], a[116:119]
    ds_read_b64_tr_b16 a[132:133], v4 offset:16960
    ds_read_b64_tr_b16 a[134:135], v4 offset:25408
    v_mfma_f32_16x16x32_bf16 a[120:123], a[136:139], v[160:163], a[120:123]
    buffer_load_dwordx4 v10, s[32:35], s51 offen lds
    v_mfma_f32_16x16x32_bf16 a[120:123], a[140:143], v[164:167], a[120:123]
    s_add_u32 m0, m0, 0x420
    s_add_u32 s51, s51, 0x380
    v_mfma_f32_16x16x32_bf16 a[124:127], a[136:139], v[216:219], a[124:127]
    ds_read_b64_tr_b16 a[136:137], v4 offset:96
    ds_read_b64_tr_b16 a[138:139], v4 offset:8544
    v_mfma_f32_16x16x32_bf16 a[124:127], a[140:143], v[220:223], a[124:127]
    s_waitcnt lgkmcnt(12)
    ds_read_b64_tr_b16 a[140:141], v4 offset:16992
    ds_read_b64_tr_b16 a[142:143], v4 offset:25440
    v_mfma_f32_16x16x32_bf16 a[0:3], a[144:147], v[168:171], a[0:3]
    s_waitcnt lgkmcnt(12)
    v_exp_f32 v242, v242
    v_mfma_f32_16x16x32_bf16 a[0:3], a[148:151], v[172:175], a[0:3]
    v_exp_f32 v243, v243
    v_mfma_f32_16x16x32_bf16 a[4:7], a[144:147], v[224:227], a[4:7]
    ds_read_b64_tr_b16 a[144:145], v4 offset:128
    ds_read_b64_tr_b16 a[146:147], v4 offset:8576
    v_mfma_f32_16x16x32_bf16 a[4:7], a[148:151], v[228:231], a[4:7]
    s_waitcnt lgkmcnt(12)
    ds_read_b64_tr_b16 a[148:149], v4 offset:17024
    ds_read_b64_tr_b16 a[150:151], v4 offset:25472
    v_mfma_f32_16x16x32_bf16 a[8:11], a[152:155], v[168:171], a[8:11]
    s_waitcnt lgkmcnt(12)
    buffer_load_dwordx4 v10, s[32:35], s51 offen lds
    v_mfma_f32_16x16x32_bf16 a[8:11], a[156:159], v[172:175], a[8:11]
    s_add_u32 m0, m0, 0x420
    s_add_u32 s51, s51, 0x380
    v_mul_f32 v32, v32, v88
    v_mfma_f32_16x16x32_bf16 a[12:15], a[152:155], v[224:227], a[12:15]
    ds_read_b64_tr_b16 a[152:153], v4 offset:160
    ds_read_b64_tr_b16 a[154:155], v4 offset:8608
    v_mfma_f32_16x16x32_bf16 a[12:15], a[156:159], v[228:231], a[12:15]
    s_waitcnt lgkmcnt(12)
    ds_read_b64_tr_b16 a[156:157], v4 offset:17056
    ds_read_b64_tr_b16 a[158:159], v4 offset:25504
    v_mfma_f32_16x16x32_bf16 a[16:19], a[128:131], v[168:171], a[16:19]
    s_waitcnt lgkmcnt(12)
    v_mul_f32 v33, v33, v89
    v_mul_f32 v34, v34, v90
    v_mfma_f32_16x16x32_bf16 a[16:19], a[132:135], v[172:175], a[16:19]
    v_mul_f32 v35, v35, v91
    v_add_f32 v240, 1.0, v240
    v_mfma_f32_16x16x32_bf16 a[20:23], a[128:131], v[224:227], a[20:23]
    ds_read_b64_tr_b16 a[128:129], v4 offset:192
    ds_read_b64_tr_b16 a[130:131], v4 offset:8640
    v_mfma_f32_16x16x32_bf16 a[20:23], a[132:135], v[228:231], a[20:23]
    s_waitcnt lgkmcnt(12)
    ds_read_b64_tr_b16 a[132:133], v4 offset:17088
    ds_read_b64_tr_b16 a[134:135], v4 offset:25536
    v_mfma_f32_16x16x32_bf16 a[24:27], a[136:139], v[168:171], a[24:27]
    s_waitcnt lgkmcnt(12)
    buffer_load_dwordx4 v10, s[32:35], s51 offen lds
    v_mfma_f32_16x16x32_bf16 a[24:27], a[140:143], v[172:175], a[24:27]
    s_add_u32 m0, m0, 0x420
    s_add_u32 s51, s51, 0x380
    v_add_f32 v241, 1.0, v241
    v_mfma_f32_16x16x32_bf16 a[28:31], a[136:139], v[224:227], a[28:31]
    ds_read_b64_tr_b16 a[136:137], v4 offset:224
    ds_read_b64_tr_b16 a[138:139], v4 offset:8672
    v_mfma_f32_16x16x32_bf16 a[28:31], a[140:143], v[228:231], a[28:31]
    s_waitcnt lgkmcnt(12)
    ds_read_b64_tr_b16 a[140:141], v4 offset:17120
    ds_read_b64_tr_b16 a[142:143], v4 offset:25568
    v_mfma_f32_16x16x32_bf16 a[32:35], a[144:147], v[168:171], a[32:35]
    s_waitcnt lgkmcnt(12)
    v_add_f32 v242, 1.0, v242
    v_add_f32 v243, 1.0, v243
    v_mfma_f32_16x16x32_bf16 a[32:35], a[148:151], v[172:175], a[32:35]
    v_rcp_f32 v240, v240
    v_mfma_f32_16x16x32_bf16 a[36:39], a[144:147], v[224:227], a[36:39]
    ds_read_b64_tr_b16 a[144:145], v4 offset:256
    ds_read_b64_tr_b16 a[146:147], v4 offset:8704
    v_mfma_f32_16x16x32_bf16 a[36:39], a[148:151], v[228:231], a[36:39]
    s_waitcnt lgkmcnt(12)
    ds_read_b64_tr_b16 a[148:149], v4 offset:17152
    ds_read_b64_tr_b16 a[150:151], v4 offset:25600
    v_mfma_f32_16x16x32_bf16 a[40:43], a[152:155], v[168:171], a[40:43]
    s_waitcnt lgkmcnt(12)
    buffer_load_dwordx4 v10, s[32:35], s51 offen lds
    v_mfma_f32_16x16x32_bf16 a[40:43], a[156:159], v[172:175], a[40:43]
    s_add_u32 m0, m0, 0x420
    s_add_u32 s51, s51, 0x380
    v_mfma_f32_16x16x32_bf16 a[44:47], a[152:155], v[224:227], a[44:47]
    ds_read_b64_tr_b16 a[152:153], v4 offset:288
    ds_read_b64_tr_b16 a[154:155], v4 offset:8736
    v_mfma_f32_16x16x32_bf16 a[44:47], a[156:159], v[228:231], a[44:47]
    s_waitcnt lgkmcnt(12)
    ds_read_b64_tr_b16 a[156:157], v4 offset:17184
    ds_read_b64_tr_b16 a[158:159], v4 offset:25632
    v_mfma_f32_16x16x32_bf16 a[48:51], a[128:131], v[168:171], a[48:51]
    s_waitcnt lgkmcnt(12)
    v_rcp_f32 v241, v241
    v_mfma_f32_16x16x32_bf16 a[48:51], a[132:135], v[172:175], a[48:51]
    v_rcp_f32 v242, v242
    v_mfma_f32_16x16x32_bf16 a[52:55], a[128:131], v[224:227], a[52:55]
    ds_read_b64_tr_b16 a[128:129], v4 offset:320
    ds_read_b64_tr_b16 a[130:131], v4 offset:8768
    v_mfma_f32_16x16x32_bf16 a[52:55], a[132:135], v[228:231], a[52:55]
    s_waitcnt lgkmcnt(12)
    ds_read_b64_tr_b16 a[132:133], v4 offset:17216
    ds_read_b64_tr_b16 a[134:135], v4 offset:25664
    v_mfma_f32_16x16x32_bf16 a[56:59], a[136:139], v[168:171], a[56:59]
    s_waitcnt lgkmcnt(12)
    buffer_load_dwordx4 v10, s[32:35], s51 offen lds
    v_mfma_f32_16x16x32_bf16 a[56:59], a[140:143], v[172:175], a[56:59]
    s_add_u32 m0, m0, 0x420
    s_add_u32 s51, s51, 0x380
    v_mfma_f32_16x16x32_bf16 a[60:63], a[136:139], v[224:227], a[60:63]
    ds_read_b64_tr_b16 a[136:137], v4 offset:352
    ds_read_b64_tr_b16 a[138:139], v4 offset:8800
    v_mfma_f32_16x16x32_bf16 a[60:63], a[140:143], v[228:231], a[60:63]
    s_waitcnt lgkmcnt(12)
    ds_read_b64_tr_b16 a[140:141], v4 offset:17248
    ds_read_b64_tr_b16 a[142:143], v4 offset:25696
    v_mfma_f32_16x16x32_bf16 a[64:67], a[144:147], v[168:171], a[64:67]
    s_waitcnt lgkmcnt(12)
    v_rcp_f32 v243, v243
    v_mfma_f32_16x16x32_bf16 a[64:67], a[148:151], v[172:175], a[64:67]
    v_mul_f32 v32, v32, v240
    v_mul_f32 v33, v33, v241
    v_mfma_f32_16x16x32_bf16 a[68:71], a[144:147], v[224:227], a[68:71]
    ds_read_b64_tr_b16 a[144:145], v4 offset:384
    ds_read_b64_tr_b16 a[146:147], v4 offset:8832
    v_mfma_f32_16x16x32_bf16 a[68:71], a[148:151], v[228:231], a[68:71]
    s_waitcnt lgkmcnt(12)
    ds_read_b64_tr_b16 a[148:149], v4 offset:17280
    ds_read_b64_tr_b16 a[150:151], v4 offset:25728
    v_mfma_f32_16x16x32_bf16 a[72:75], a[152:155], v[168:171], a[72:75]
    s_waitcnt lgkmcnt(12)
    buffer_load_dwordx4 v10, s[32:35], s51 offen lds
    v_mfma_f32_16x16x32_bf16 a[72:75], a[156:159], v[172:175], a[72:75]
    s_add_u32 m0, m0, 0x420
    s_add_u32 s51, s51, 0x380
    v_mul_f32 v34, v34, v242
    v_mfma_f32_16x16x32_bf16 a[76:79], a[152:155], v[224:227], a[76:79]
    s_add_u32 s96, s96, 0x10000
    ds_read_b64_tr_b16 a[152:153], v4 offset:416
    ds_read_b64_tr_b16 a[154:155], v4 offset:8864
    v_mfma_f32_16x16x32_bf16 a[76:79], a[156:159], v[228:231], a[76:79]
    s_waitcnt lgkmcnt(12)
    ds_read_b64_tr_b16 a[156:157], v4 offset:17312
    ds_read_b64_tr_b16 a[158:159], v4 offset:25760
    v_mfma_f32_16x16x32_bf16 a[80:83], a[128:131], v[168:171], a[80:83]
    s_waitcnt lgkmcnt(12)
    buffer_load_dword v13, v14, s[92:95], s96 offen
    v_mfma_f32_16x16x32_bf16 a[80:83], a[132:135], v[172:175], a[80:83]
    v_mul_f32 v35, v35, v243
    v_cvt_pk_bf16_f32 v88, v32, v33
    v_mfma_f32_16x16x32_bf16 a[84:87], a[128:131], v[224:227], a[84:87]
    ds_read_b64_tr_b16 a[128:129], v4 offset:448
    ds_read_b64_tr_b16 a[130:131], v4 offset:8896
    v_mfma_f32_16x16x32_bf16 a[84:87], a[132:135], v[228:231], a[84:87]
    s_waitcnt lgkmcnt(12)
    ds_read_b64_tr_b16 a[132:133], v4 offset:17344
    ds_read_b64_tr_b16 a[134:135], v4 offset:25792
    v_mfma_f32_16x16x32_bf16 a[88:91], a[136:139], v[168:171], a[88:91]
    s_waitcnt lgkmcnt(12)
    buffer_load_dwordx4 v10, s[32:35], s51 offen lds
    v_mfma_f32_16x16x32_bf16 a[88:91], a[140:143], v[172:175], a[88:91]
    s_add_u32 m0, s45, 0
    s_add_u32 s51, s51, 0xffffe880
    v_cvt_pk_bf16_f32 v89, v34, v35
    v_mfma_f32_16x16x32_bf16 a[92:95], a[136:139], v[224:227], a[92:95]
    ds_read_b64_tr_b16 a[136:137], v4 offset:480
    ds_read_b64_tr_b16 a[138:139], v4 offset:8928
    v_mfma_f32_16x16x32_bf16 a[92:95], a[140:143], v[228:231], a[92:95]
    s_waitcnt lgkmcnt(12)
    ds_read_b64_tr_b16 a[140:141], v4 offset:17376
    ds_read_b64_tr_b16 a[142:143], v4 offset:25824
    v_mfma_f32_16x16x32_bf16 a[96:99], a[144:147], v[168:171], a[96:99]
    s_waitcnt lgkmcnt(12)
    v_accvgpr_write_b32 a164, v88
    v_accvgpr_write_b32 a165, v89
    v_mfma_f32_16x16x32_bf16 a[96:99], a[148:151], v[172:175], a[96:99]
    v_mul_f32 v244, 0xbfb8aa3b, v36
    v_mul_f32 v245, 0xbfb8aa3b, v37
    v_mfma_f32_16x16x32_bf16 a[100:103], a[144:147], v[224:227], a[100:103]
    v_mul_f32 v246, 0xbfb8aa3b, v38
    v_mul_f32 v247, 0xbfb8aa3b, v39
    v_mfma_f32_16x16x32_bf16 a[100:103], a[148:151], v[228:231], a[100:103]
    s_waitcnt lgkmcnt(10)
    s_waitcnt vmcnt(18) lgkmcnt(0)
    s_barrier
    v_mfma_f32_16x16x32_bf16 a[104:107], a[152:155], v[168:171], a[104:107]
    ds_read_b64_tr_b16 a[144:145], v5
    ds_read_b64_tr_b16 a[146:147], v5 offset:8448
    v_mfma_f32_16x16x32_bf16 a[104:107], a[156:159], v[172:175], a[104:107]
    ds_read_b64_tr_b16 a[148:149], v5 offset:16896
    ds_read_b64_tr_b16 a[150:151], v5 offset:25344
    v_mfma_f32_16x16x32_bf16 a[108:111], a[152:155], v[224:227], a[108:111]
    buffer_load_dwordx4 v10, s[32:35], s51 offen lds
    v_mfma_f32_16x16x32_bf16 a[108:111], a[156:159], v[228:231], a[108:111]
    ds_read_b64_tr_b16 a[152:153], v5 offset:32
    ds_read_b64_tr_b16 a[154:155], v5 offset:8480
    v_mfma_f32_16x16x32_bf16 a[112:115], a[128:131], v[168:171], a[112:115]
    ds_read_b64_tr_b16 a[156:157], v5 offset:16928
    ds_read_b64_tr_b16 a[158:159], v5 offset:25376
    v_mfma_f32_16x16x32_bf16 a[112:115], a[132:135], v[172:175], a[112:115]
    s_add_u32 m0, m0, 0x420
    s_add_u32 s51, s51, 0x380
    v_mfma_f32_16x16x32_bf16 a[116:119], a[128:131], v[224:227], a[116:119]
    ds_read_b64_tr_b16 a[128:129], v5 offset:64
    ds_read_b64_tr_b16 a[130:131], v5 offset:8512
    v_mfma_f32_16x16x32_bf16 a[116:119], a[132:135], v[228:231], a[116:119]
    ds_read_b64_tr_b16 a[132:133], v5 offset:16960
    ds_read_b64_tr_b16 a[134:135], v5 offset:25408
    v_mfma_f32_16x16x32_bf16 a[120:123], a[136:139], v[168:171], a[120:123]
    buffer_load_dwordx4 v10, s[32:35], s51 offen lds
    v_mfma_f32_16x16x32_bf16 a[120:123], a[140:143], v[172:175], a[120:123]
    s_add_u32 m0, m0, 0x420
    s_add_u32 s51, s51, 0x380
    v_mfma_f32_16x16x32_bf16 a[124:127], a[136:139], v[224:227], a[124:127]
    ds_read_b64_tr_b16 a[136:137], v5 offset:96
    ds_read_b64_tr_b16 a[138:139], v5 offset:8544
    v_mfma_f32_16x16x32_bf16 a[124:127], a[140:143], v[228:231], a[124:127]
    s_waitcnt lgkmcnt(12)
    ds_read_b64_tr_b16 a[140:141], v5 offset:16992
    ds_read_b64_tr_b16 a[142:143], v5 offset:25440
    v_mfma_f32_16x16x32_bf16 a[0:3], a[144:147], v[176:179], a[0:3]
    s_waitcnt lgkmcnt(12)
    v_exp_f32 v244, v244
    v_mfma_f32_16x16x32_bf16 a[0:3], a[148:151], v[180:183], a[0:3]
    v_exp_f32 v245, v245
    v_mfma_f32_16x16x32_bf16 a[4:7], a[144:147], v[232:235], a[4:7]
    ds_read_b64_tr_b16 a[144:145], v5 offset:128
    ds_read_b64_tr_b16 a[146:147], v5 offset:8576
    v_mfma_f32_16x16x32_bf16 a[4:7], a[148:151], v[236:239], a[4:7]
    s_waitcnt lgkmcnt(12)
    ds_read_b64_tr_b16 a[148:149], v5 offset:17024
    ds_read_b64_tr_b16 a[150:151], v5 offset:25472
    v_mfma_f32_16x16x32_bf16 a[8:11], a[152:155], v[176:179], a[8:11]
    s_waitcnt lgkmcnt(12)
    buffer_load_dwordx4 v10, s[32:35], s51 offen lds
    v_mfma_f32_16x16x32_bf16 a[8:11], a[156:159], v[180:183], a[8:11]
    s_add_u32 m0, m0, 0x420
    s_add_u32 s51, s51, 0x380
    v_mfma_f32_16x16x32_bf16 a[12:15], a[152:155], v[232:235], a[12:15]
    ds_read_b64_tr_b16 a[152:153], v5 offset:160
    ds_read_b64_tr_b16 a[154:155], v5 offset:8608
    v_mfma_f32_16x16x32_bf16 a[12:15], a[156:159], v[236:239], a[12:15]
    s_waitcnt lgkmcnt(12)
    ds_read_b64_tr_b16 a[156:157], v5 offset:17056
    ds_read_b64_tr_b16 a[158:159], v5 offset:25504
    v_mfma_f32_16x16x32_bf16 a[16:19], a[128:131], v[176:179], a[16:19]
    s_waitcnt lgkmcnt(12)
    v_exp_f32 v246, v246
    v_mfma_f32_16x16x32_bf16 a[16:19], a[132:135], v[180:183], a[16:19]
    v_exp_f32 v247, v247
    v_mfma_f32_16x16x32_bf16 a[20:23], a[128:131], v[232:235], a[20:23]
    ds_read_b64_tr_b16 a[128:129], v5 offset:192
    ds_read_b64_tr_b16 a[130:131], v5 offset:8640
    v_mfma_f32_16x16x32_bf16 a[20:23], a[132:135], v[236:239], a[20:23]
    s_waitcnt lgkmcnt(12)
    ds_read_b64_tr_b16 a[132:133], v5 offset:17088
    ds_read_b64_tr_b16 a[134:135], v5 offset:25536
    v_mfma_f32_16x16x32_bf16 a[24:27], a[136:139], v[176:179], a[24:27]
    s_waitcnt lgkmcnt(12)
    buffer_load_dwordx4 v10, s[32:35], s51 offen lds
    v_mfma_f32_16x16x32_bf16 a[24:27], a[140:143], v[180:183], a[24:27]
    s_add_u32 m0, m0, 0x420
    s_add_u32 s51, s51, 0x380
    v_mul_f32 v36, v36, v92
    v_mfma_f32_16x16x32_bf16 a[28:31], a[136:139], v[232:235], a[28:31]
    ds_read_b64_tr_b16 a[136:137], v5 offset:224
    ds_read_b64_tr_b16 a[138:139], v5 offset:8672
    v_mfma_f32_16x16x32_bf16 a[28:31], a[140:143], v[236:239], a[28:31]
    s_waitcnt lgkmcnt(12)
    ds_read_b64_tr_b16 a[140:141], v5 offset:17120
    ds_read_b64_tr_b16 a[142:143], v5 offset:25568
    v_mfma_f32_16x16x32_bf16 a[32:35], a[144:147], v[176:179], a[32:35]
    s_waitcnt lgkmcnt(12)
    v_mul_f32 v37, v37, v93
    v_mul_f32 v38, v38, v94
    v_mfma_f32_16x16x32_bf16 a[32:35], a[148:151], v[180:183], a[32:35]
    v_mul_f32 v39, v39, v95
    v_add_f32 v244, 1.0, v244
    v_mfma_f32_16x16x32_bf16 a[36:39], a[144:147], v[232:235], a[36:39]
    ds_read_b64_tr_b16 a[144:145], v5 offset:256
    ds_read_b64_tr_b16 a[146:147], v5 offset:8704
    v_mfma_f32_16x16x32_bf16 a[36:39], a[148:151], v[236:239], a[36:39]
    s_waitcnt lgkmcnt(12)
    ds_read_b64_tr_b16 a[148:149], v5 offset:17152
    ds_read_b64_tr_b16 a[150:151], v5 offset:25600
    v_mfma_f32_16x16x32_bf16 a[40:43], a[152:155], v[176:179], a[40:43]
    s_waitcnt lgkmcnt(12)
    buffer_load_dwordx4 v10, s[32:35], s51 offen lds
    v_mfma_f32_16x16x32_bf16 a[40:43], a[156:159], v[180:183], a[40:43]
    s_add_u32 m0, m0, 0x420
    s_add_u32 s51, s51, 0x380
    v_add_f32 v245, 1.0, v245
    v_mfma_f32_16x16x32_bf16 a[44:47], a[152:155], v[232:235], a[44:47]
    ds_read_b64_tr_b16 a[152:153], v5 offset:288
    ds_read_b64_tr_b16 a[154:155], v5 offset:8736
    v_mfma_f32_16x16x32_bf16 a[44:47], a[156:159], v[236:239], a[44:47]
    s_waitcnt lgkmcnt(12)
    ds_read_b64_tr_b16 a[156:157], v5 offset:17184
    ds_read_b64_tr_b16 a[158:159], v5 offset:25632
    v_mfma_f32_16x16x32_bf16 a[48:51], a[128:131], v[176:179], a[48:51]
    s_waitcnt lgkmcnt(12)
    v_add_f32 v246, 1.0, v246
    v_add_f32 v247, 1.0, v247
    v_mfma_f32_16x16x32_bf16 a[48:51], a[132:135], v[180:183], a[48:51]
    v_rcp_f32 v244, v244
    v_mfma_f32_16x16x32_bf16 a[52:55], a[128:131], v[232:235], a[52:55]
    ds_read_b64_tr_b16 a[128:129], v5 offset:320
    ds_read_b64_tr_b16 a[130:131], v5 offset:8768
    v_mfma_f32_16x16x32_bf16 a[52:55], a[132:135], v[236:239], a[52:55]
    s_waitcnt lgkmcnt(12)
    ds_read_b64_tr_b16 a[132:133], v5 offset:17216
    ds_read_b64_tr_b16 a[134:135], v5 offset:25664
    v_mfma_f32_16x16x32_bf16 a[56:59], a[136:139], v[176:179], a[56:59]
    s_waitcnt lgkmcnt(12)
    buffer_load_dwordx4 v10, s[32:35], s51 offen lds
    v_mfma_f32_16x16x32_bf16 a[56:59], a[140:143], v[180:183], a[56:59]
    s_add_u32 m0, m0, 0x420
    s_add_u32 s51, s51, 0x380
    v_mfma_f32_16x16x32_bf16 a[60:63], a[136:139], v[232:235], a[60:63]
    ds_read_b64_tr_b16 a[136:137], v5 offset:352
    ds_read_b64_tr_b16 a[138:139], v5 offset:8800
    v_mfma_f32_16x16x32_bf16 a[60:63], a[140:143], v[236:239], a[60:63]
    s_waitcnt lgkmcnt(12)
    ds_read_b64_tr_b16 a[140:141], v5 offset:17248
    ds_read_b64_tr_b16 a[142:143], v5 offset:25696
    v_mfma_f32_16x16x32_bf16 a[64:67], a[144:147], v[176:179], a[64:67]
    s_waitcnt lgkmcnt(12)
    v_rcp_f32 v245, v245
    v_mfma_f32_16x16x32_bf16 a[64:67], a[148:151], v[180:183], a[64:67]
    v_rcp_f32 v246, v246
    v_mfma_f32_16x16x32_bf16 a[68:71], a[144:147], v[232:235], a[68:71]
    ds_read_b64_tr_b16 a[144:145], v5 offset:384
    ds_read_b64_tr_b16 a[146:147], v5 offset:8832
    v_mfma_f32_16x16x32_bf16 a[68:71], a[148:151], v[236:239], a[68:71]
    s_waitcnt lgkmcnt(12)
    ds_read_b64_tr_b16 a[148:149], v5 offset:17280
    ds_read_b64_tr_b16 a[150:151], v5 offset:25728
    v_mfma_f32_16x16x32_bf16 a[72:75], a[152:155], v[176:179], a[72:75]
    s_waitcnt lgkmcnt(12)
    buffer_load_dwordx4 v10, s[32:35], s51 offen lds
    v_mfma_f32_16x16x32_bf16 a[72:75], a[156:159], v[180:183], a[72:75]
    s_add_u32 m0, m0, 0x420
    s_add_u32 s51, s51, 0x380
    v_mfma_f32_16x16x32_bf16 a[76:79], a[152:155], v[232:235], a[76:79]
    ds_read_b64_tr_b16 a[152:153], v5 offset:416
    ds_read_b64_tr_b16 a[154:155], v5 offset:8864
    v_mfma_f32_16x16x32_bf16 a[76:79], a[156:159], v[236:239], a[76:79]
    s_waitcnt lgkmcnt(12)
    ds_read_b64_tr_b16 a[156:157], v5 offset:17312
    ds_read_b64_tr_b16 a[158:159], v5 offset:25760
    v_mfma_f32_16x16x32_bf16 a[80:83], a[128:131], v[176:179], a[80:83]
    s_waitcnt lgkmcnt(12)
    v_rcp_f32 v247, v247
    v_mfma_f32_16x16x32_bf16 a[80:83], a[132:135], v[180:183], a[80:83]
    v_mul_f32 v36, v36, v244
    v_mul_f32 v37, v37, v245
    v_mfma_f32_16x16x32_bf16 a[84:87], a[128:131], v[232:235], a[84:87]
    ds_read_b64_tr_b16 a[128:129], v5 offset:448
    ds_read_b64_tr_b16 a[130:131], v5 offset:8896
    v_mfma_f32_16x16x32_bf16 a[84:87], a[132:135], v[236:239], a[84:87]
    s_waitcnt lgkmcnt(12)
    ds_read_b64_tr_b16 a[132:133], v5 offset:17344
    ds_read_b64_tr_b16 a[134:135], v5 offset:25792
    v_mfma_f32_16x16x32_bf16 a[88:91], a[136:139], v[176:179], a[88:91]
    s_waitcnt lgkmcnt(12)
    buffer_load_dwordx4 v10, s[32:35], s51 offen lds
    v_mfma_f32_16x16x32_bf16 a[88:91], a[140:143], v[180:183], a[88:91]
    s_add_u32 m0, s45, 0x10800
    s_add_u32 s51, s51, 0xffffe880
    v_mul_f32 v38, v38, v246
    v_mfma_f32_16x16x32_bf16 a[92:95], a[136:139], v[232:235], a[92:95]
    ds_read_b64_tr_b16 a[136:137], v5 offset:480
    ds_read_b64_tr_b16 a[138:139], v5 offset:8928
    v_mfma_f32_16x16x32_bf16 a[92:95], a[140:143], v[236:239], a[92:95]
    s_waitcnt lgkmcnt(12)
    ds_read_b64_tr_b16 a[140:141], v5 offset:17376
    ds_read_b64_tr_b16 a[142:143], v5 offset:25824
    v_mfma_f32_16x16x32_bf16 a[96:99], a[144:147], v[176:179], a[96:99]
    s_waitcnt lgkmcnt(12)
    v_mul_f32 v39, v39, v247
    v_cvt_pk_bf16_f32 v92, v36, v37
    v_mfma_f32_16x16x32_bf16 a[96:99], a[148:151], v[180:183], a[96:99]
    v_cvt_pk_bf16_f32 v93, v38, v39
    v_accvgpr_write_b32 a180, v92
    v_mfma_f32_16x16x32_bf16 a[100:103], a[144:147], v[232:235], a[100:103]
    v_accvgpr_write_b32 a181, v93
    v_mul_f32 v240, 0xbfb8aa3b, v40
    v_mfma_f32_16x16x32_bf16 a[100:103], a[148:151], v[236:239], a[100:103]
    s_waitcnt lgkmcnt(10)
    s_waitcnt vmcnt(17) lgkmcnt(0)
    s_barrier
    v_mfma_f32_16x16x32_bf16 a[104:107], a[152:155], v[176:179], a[104:107]
    ds_read_b64_tr_b16 a[144:145], v6 offset:33792
    ds_read_b64_tr_b16 a[146:147], v6 offset:33920
    v_mfma_f32_16x16x32_bf16 a[104:107], a[156:159], v[180:183], a[104:107]
    ds_read_b64_tr_b16 a[148:149], v6 offset:34048
    ds_read_b64_tr_b16 a[150:151], v6 offset:34176
    v_mfma_f32_16x16x32_bf16 a[108:111], a[152:155], v[232:235], a[108:111]
    buffer_load_dwordx4 v10, s[32:35], s51 offen lds
    v_mfma_f32_16x16x32_bf16 a[108:111], a[156:159], v[236:239], a[108:111]
    ds_read_b64_tr_b16 a[152:153], v6 offset:33824
    ds_read_b64_tr_b16 a[154:155], v6 offset:33952
    v_mfma_f32_16x16x32_bf16 a[112:115], a[128:131], v[176:179], a[112:115]
    ds_read_b64_tr_b16 a[156:157], v6 offset:34080
    ds_read_b64_tr_b16 a[158:159], v6 offset:34208
    v_mfma_f32_16x16x32_bf16 a[112:115], a[132:135], v[180:183], a[112:115]
    s_add_u32 m0, m0, 0x420
    s_add_u32 s51, s51, 0x380
    v_mul_f32 v241, 0xbfb8aa3b, v41
    v_mfma_f32_16x16x32_bf16 a[116:119], a[128:131], v[232:235], a[116:119]
    ds_read_b64_tr_b16 a[128:129], v6 offset:33856
    ds_read_b64_tr_b16 a[130:131], v6 offset:33984
    v_mfma_f32_16x16x32_bf16 a[116:119], a[132:135], v[236:239], a[116:119]
    ds_read_b64_tr_b16 a[132:133], v6 offset:34112
    ds_read_b64_tr_b16 a[134:135], v6 offset:34240
    v_mfma_f32_16x16x32_bf16 a[120:123], a[136:139], v[176:179], a[120:123]
    v_mul_f32 v242, 0xbfb8aa3b, v42
    v_mul_f32 v243, 0xbfb8aa3b, v43
    v_mfma_f32_16x16x32_bf16 a[120:123], a[140:143], v[180:183], a[120:123]
    v_exp_f32 v240, v240
    v_exp_f32 v241, v241
    v_exp_f32 v242, v242
    v_exp_f32 v243, v243
    v_mul_f32 v40, v40, v96
    v_mul_f32 v41, v41, v97
    v_mul_f32 v42, v42, v98
    v_mul_f32 v43, v43, v99
    v_add_f32 v240, 1.0, v240
    v_add_f32 v241, 1.0, v241
    v_add_f32 v242, 1.0, v242
    v_add_f32 v243, 1.0, v243
    v_rcp_f32 v240, v240
    v_rcp_f32 v241, v241
    v_rcp_f32 v242, v242
    v_rcp_f32 v243, v243
    v_mul_f32 v40, v40, v240
    v_mul_f32 v41, v41, v241
    v_mul_f32 v42, v42, v242
    v_mul_f32 v43, v43, v243
    v_cvt_pk_bf16_f32 v96, v40, v41
    v_cvt_pk_bf16_f32 v97, v42, v43
    v_accvgpr_write_b32 a166, v96
    v_accvgpr_write_b32 a167, v97
    v_mov_b32 v248, 0xbfb8aa3b
    v_mov_b32 v249, 1.0
    v_pk_mul_f32 v[244:245], v[44:45], v[248:249] op_sel:[0,0] op_sel_hi:[1,0]
    v_pk_mul_f32 v[246:247], v[46:47], v[248:249] op_sel:[0,0] op_sel_hi:[1,0]
    v_exp_f32 v244, v244
    v_exp_f32 v245, v245
    v_exp_f32 v246, v246
    v_exp_f32 v247, v247
    v_pk_mul_f32 v[44:45], v[44:45], v[100:101]
    v_pk_mul_f32 v[46:47], v[46:47], v[102:103]
    v_pk_add_f32 v[244:245], v[244:245], v[248:249] op_sel:[0,1] op_sel_hi:[1,1]
    v_pk_add_f32 v[246:247], v[246:247], v[248:249] op_sel:[0,1] op_sel_hi:[1,1]
    v_rcp_f32 v244, v244
    v_rcp_f32 v245, v245
    v_rcp_f32 v246, v246
    v_rcp_f32 v247, v247
    v_pk_mul_f32 v[44:45], v[44:45], v[244:245]
    v_pk_mul_f32 v[46:47], v[46:47], v[246:247]
    v_cvt_pk_bf16_f32 v100, v44, v45
    v_cvt_pk_bf16_f32 v101, v46, v47
    v_accvgpr_write_b32 a182, v100
    v_accvgpr_write_b32 a183, v101
    v_pk_mul_f32 v[240:241], v[48:49], v[248:249] op_sel:[0,0] op_sel_hi:[1,0]
    v_pk_mul_f32 v[242:243], v[50:51], v[248:249] op_sel:[0,0] op_sel_hi:[1,0]
    v_exp_f32 v240, v240
    v_exp_f32 v241, v241
    v_exp_f32 v242, v242
    v_exp_f32 v243, v243
    v_pk_mul_f32 v[48:49], v[48:49], v[104:105]
    v_pk_mul_f32 v[50:51], v[50:51], v[106:107]
    v_pk_add_f32 v[240:241], v[240:241], v[248:249] op_sel:[0,1] op_sel_hi:[1,1]
    v_pk_add_f32 v[242:243], v[242:243], v[248:249] op_sel:[0,1] op_sel_hi:[1,1]
    v_rcp_f32 v240, v240
    v_rcp_f32 v241, v241
    v_rcp_f32 v242, v242
    v_rcp_f32 v243, v243
    v_pk_mul_f32 v[48:49], v[48:49], v[240:241]
    v_pk_mul_f32 v[50:51], v[50:51], v[242:243]
    v_cvt_pk_bf16_f32 v104, v48, v49
    v_cvt_pk_bf16_f32 v105, v50, v51
    v_accvgpr_write_b32 a168, v104
    v_accvgpr_write_b32 a169, v105
    v_pk_mul_f32 v[244:245], v[52:53], v[248:249] op_sel:[0,0] op_sel_hi:[1,0]
    v_pk_mul_f32 v[246:247], v[54:55], v[248:249] op_sel:[0,0] op_sel_hi:[1,0]
    v_exp_f32 v244, v244
    v_exp_f32 v245, v245
    v_exp_f32 v246, v246
    v_exp_f32 v247, v247
    v_pk_mul_f32 v[52:53], v[52:53], v[108:109]
    v_pk_mul_f32 v[54:55], v[54:55], v[110:111]
    v_pk_add_f32 v[244:245], v[244:245], v[248:249] op_sel:[0,1] op_sel_hi:[1,1]
    v_pk_add_f32 v[246:247], v[246:247], v[248:249] op_sel:[0,1] op_sel_hi:[1,1]
    v_rcp_f32 v244, v244
    v_rcp_f32 v245, v245
    v_rcp_f32 v246, v246
    v_rcp_f32 v247, v247
    v_pk_mul_f32 v[52:53], v[52:53], v[244:245]
    v_pk_mul_f32 v[54:55], v[54:55], v[246:247]
    v_cvt_pk_bf16_f32 v108, v52, v53
    v_cvt_pk_bf16_f32 v109, v54, v55
    v_accvgpr_write_b32 a184, v108
    v_accvgpr_write_b32 a185, v109
    v_pk_mul_f32 v[240:241], v[56:57], v[248:249] op_sel:[0,0] op_sel_hi:[1,0]
    v_pk_mul_f32 v[242:243], v[58:59], v[248:249] op_sel:[0,0] op_sel_hi:[1,0]
    v_exp_f32 v240, v240
    v_exp_f32 v241, v241
    v_exp_f32 v242, v242
    v_exp_f32 v243, v243
    v_pk_mul_f32 v[56:57], v[56:57], v[112:113]
    v_pk_mul_f32 v[58:59], v[58:59], v[114:115]
    v_pk_add_f32 v[240:241], v[240:241], v[248:249] op_sel:[0,1] op_sel_hi:[1,1]
    v_pk_add_f32 v[242:243], v[242:243], v[248:249] op_sel:[0,1] op_sel_hi:[1,1]
    v_rcp_f32 v240, v240
    v_rcp_f32 v241, v241
    v_rcp_f32 v242, v242
    v_rcp_f32 v243, v243
    v_pk_mul_f32 v[56:57], v[56:57], v[240:241]
    v_pk_mul_f32 v[58:59], v[58:59], v[242:243]
    v_cvt_pk_bf16_f32 v112, v56, v57
    v_cvt_pk_bf16_f32 v113, v58, v59
    v_accvgpr_write_b32 a170, v112
    v_accvgpr_write_b32 a171, v113
    v_pk_mul_f32 v[244:245], v[60:61], v[248:249] op_sel:[0,0] op_sel_hi:[1,0]
    v_pk_mul_f32 v[246:247], v[62:63], v[248:249] op_sel:[0,0] op_sel_hi:[1,0]
    v_exp_f32 v244, v244
    v_exp_f32 v245, v245
    v_exp_f32 v246, v246
    v_exp_f32 v247, v247
    v_pk_mul_f32 v[60:61], v[60:61], v[116:117]
    v_pk_mul_f32 v[62:63], v[62:63], v[118:119]
    v_pk_add_f32 v[244:245], v[244:245], v[248:249] op_sel:[0,1] op_sel_hi:[1,1]
    v_pk_add_f32 v[246:247], v[246:247], v[248:249] op_sel:[0,1] op_sel_hi:[1,1]
    v_rcp_f32 v244, v244
    v_rcp_f32 v245, v245
    v_rcp_f32 v246, v246
    v_rcp_f32 v247, v247
    v_pk_mul_f32 v[60:61], v[60:61], v[244:245]
    v_pk_mul_f32 v[62:63], v[62:63], v[246:247]
    v_cvt_pk_bf16_f32 v116, v60, v61
    v_cvt_pk_bf16_f32 v117, v62, v63
    v_accvgpr_write_b32 a186, v116
    v_accvgpr_write_b32 a187, v117
    v_pk_mul_f32 v[240:241], v[64:65], v[248:249] op_sel:[0,0] op_sel_hi:[1,0]
    v_pk_mul_f32 v[242:243], v[66:67], v[248:249] op_sel:[0,0] op_sel_hi:[1,0]
    v_exp_f32 v240, v240
    v_exp_f32 v241, v241
    v_exp_f32 v242, v242
    v_exp_f32 v243, v243
    v_pk_mul_f32 v[64:65], v[64:65], v[120:121]
    v_pk_mul_f32 v[66:67], v[66:67], v[122:123]
    v_pk_add_f32 v[240:241], v[240:241], v[248:249] op_sel:[0,1] op_sel_hi:[1,1]
    v_pk_add_f32 v[242:243], v[242:243], v[248:249] op_sel:[0,1] op_sel_hi:[1,1]
    v_rcp_f32 v240, v240
    v_rcp_f32 v241, v241
    v_rcp_f32 v242, v242
    v_rcp_f32 v243, v243
    v_pk_mul_f32 v[64:65], v[64:65], v[240:241]
    v_pk_mul_f32 v[66:67], v[66:67], v[242:243]
    v_cvt_pk_bf16_f32 v120, v64, v65
    v_cvt_pk_bf16_f32 v121, v66, v67
    v_accvgpr_write_b32 a172, v120
    v_accvgpr_write_b32 a173, v121
    v_pk_mul_f32 v[244:245], v[68:69], v[248:249] op_sel:[0,0] op_sel_hi:[1,0]
    v_pk_mul_f32 v[246:247], v[70:71], v[248:249] op_sel:[0,0] op_sel_hi:[1,0]
    v_exp_f32 v244, v244
    v_exp_f32 v245, v245
    v_exp_f32 v246, v246
    v_exp_f32 v247, v247
    v_pk_mul_f32 v[68:69], v[68:69], v[124:125]
    v_pk_mul_f32 v[70:71], v[70:71], v[126:127]
    v_pk_add_f32 v[244:245], v[244:245], v[248:249] op_sel:[0,1] op_sel_hi:[1,1]
    v_pk_add_f32 v[246:247], v[246:247], v[248:249] op_sel:[0,1] op_sel_hi:[1,1]
    v_rcp_f32 v244, v244
    v_rcp_f32 v245, v245
    v_rcp_f32 v246, v246
    v_rcp_f32 v247, v247
    v_pk_mul_f32 v[68:69], v[68:69], v[244:245]
    v_pk_mul_f32 v[70:71], v[70:71], v[246:247]
    v_cvt_pk_bf16_f32 v124, v68, v69
    v_cvt_pk_bf16_f32 v125, v70, v71
    v_accvgpr_write_b32 a188, v124
    v_accvgpr_write_b32 a189, v125
    v_mfma_f32_16x16x32_bf16 a[124:127], a[136:139], v[232:235], a[124:127]
    buffer_load_dwordx4 v10, s[32:35], s51 offen lds
    v_mfma_f32_16x16x32_bf16 a[124:127], a[140:143], v[236:239], a[124:127]
    s_waitcnt lgkmcnt(10)
    ds_read_b64_tr_b16 a[136:137], v6 offset:33888
    ds_read_b64_tr_b16 a[138:139], v6 offset:34016
    v_mfma_f32_16x16x32_bf16 v[16:19], a[144:147], a[160:163], 0
    s_waitcnt lgkmcnt(10)
    s_add_u32 m0, m0, 0x420
    s_add_u32 s51, s51, 0x380
    v_mfma_f32_16x16x32_bf16 v[16:19], a[148:151], a[164:167], v[16:19]
    ds_read_b64_tr_b16 a[140:141], v6 offset:34144
    ds_read_b64_tr_b16 a[142:143], v6 offset:34272
    v_mfma_f32_16x16x32_bf16 v[20:23], a[144:147], a[176:179], 0
    ds_read_b64_tr_b16 a[144:145], v6 offset:34304
    ds_read_b64_tr_b16 a[146:147], v6 offset:34432
    v_mfma_f32_16x16x32_bf16 v[20:23], a[148:151], a[180:183], v[20:23]
    s_waitcnt lgkmcnt(12)
    ds_read_b64_tr_b16 a[148:149], v6 offset:34560
    ds_read_b64_tr_b16 a[150:151], v6 offset:34688
    v_mfma_f32_16x16x32_bf16 v[24:27], a[152:155], a[160:163], 0
    s_waitcnt lgkmcnt(12)
    s_lshr_b32 s62, s42, 1
    s_mul_i32 s62, s62, 0xfffe7400
    s_add_u32 s62, s62, s80
    s_add_u32 s62, s62, 0x18c00
    v_add_u32 v12, s62, v11
    v_accvgpr_read_b32 v240, a0
    v_accvgpr_read_b32 v241, a1
    v_mfma_f32_16x16x32_bf16 v[24:27], a[156:159], a[164:167], v[24:27]
    v_accvgpr_read_b32 v242, a2
    v_accvgpr_read_b32 v243, a3
    v_mfma_f32_16x16x32_bf16 v[28:31], a[152:155], a[176:179], 0
    buffer_load_dwordx4 v10, s[32:35], s51 offen lds
    v_accvgpr_read_b32 v244, a8
    v_accvgpr_read_b32 v245, a9
    v_mfma_f32_16x16x32_bf16 v[28:31], a[156:159], a[180:183], v[28:31]
    s_waitcnt lgkmcnt(10)
    v_accvgpr_read_b32 v246, a10
    v_accvgpr_read_b32 v247, a11
    v_mfma_f32_16x16x32_bf16 v[32:35], a[128:131], a[160:163], 0
    s_waitcnt lgkmcnt(8)
    s_add_u32 m0, m0, 0x420
    s_add_u32 s51, s51, 0x380
    ds_read_b64_tr_b16 a[152:153], v6 offset:34336
    ds_read_b64_tr_b16 a[154:155], v6 offset:34464
    v_mul_f32 v240, 0x3db8aa3b, v240
    v_mul_f32 v241, 0x3db8aa3b, v241
    v_mfma_f32_16x16x32_bf16 v[32:35], a[132:135], a[164:167], v[32:35]
    ds_read_b64_tr_b16 a[156:157], v6 offset:34592
    ds_read_b64_tr_b16 a[158:159], v6 offset:34720
    v_mul_f32 v242, 0x3db8aa3b, v242
    v_mul_f32 v243, 0x3db8aa3b, v243
    v_mfma_f32_16x16x32_bf16 v[36:39], a[128:131], a[176:179], 0
    v_mul_f32 v244, 0x3db8aa3b, v244
    v_mul_f32 v245, 0x3db8aa3b, v245
    v_mul_f32 v246, 0x3db8aa3b, v246
    v_mfma_f32_16x16x32_bf16 v[36:39], a[132:135], a[180:183], v[36:39]
    s_waitcnt lgkmcnt(10)
    v_mul_f32 v247, 0x3db8aa3b, v247
    v_cvt_pk_bf16_f32 v128, v240, v241
    v_mfma_f32_16x16x32_bf16 v[40:43], a[136:139], a[160:163], 0
    s_waitcnt lgkmcnt(8)
    ds_read_b64_tr_b16 a[128:129], v6 offset:34368
    ds_read_b64_tr_b16 a[130:131], v6 offset:34496
    v_cvt_pk_bf16_f32 v129, v242, v243
    v_cvt_pk_bf16_f32 v130, v244, v245
    v_mfma_f32_16x16x32_bf16 v[40:43], a[140:143], a[164:167], v[40:43]
    ds_read_b64_tr_b16 a[132:133], v6 offset:34624
    ds_read_b64_tr_b16 a[134:135], v6 offset:34752
    v_cvt_pk_bf16_f32 v131, v246, v247
    v_permlane32_swap_b32 v128, v130
    v_mfma_f32_16x16x32_bf16 v[44:47], a[136:139], a[176:179], 0
    buffer_load_dwordx4 v10, s[32:35], s51 offen lds
    v_permlane32_swap_b32 v129, v131
    v_permlane16_swap_b32 v128, v130
    v_mfma_f32_16x16x32_bf16 v[44:47], a[140:143], a[180:183], v[44:47]
    s_waitcnt lgkmcnt(10)
    v_permlane16_swap_b32 v129, v131
    v_accvgpr_read_b32 v248, a16
    v_mfma_f32_16x16x32_bf16 v[16:19], a[144:147], a[168:171], v[16:19]
    s_waitcnt lgkmcnt(8)
    s_add_u32 m0, m0, 0x420
    s_add_u32 s51, s51, 0x380
    ds_read_b64_tr_b16 a[136:137], v6 offset:34400
    ds_read_b64_tr_b16 a[138:139], v6 offset:34528
    v_accvgpr_read_b32 v249, a17
    v_accvgpr_read_b32 v250, a18
    v_mfma_f32_16x16x32_bf16 v[16:19], a[148:151], a[172:175], v[16:19]
    ds_read_b64_tr_b16 a[140:141], v6 offset:34656
    ds_read_b64_tr_b16 a[142:143], v6 offset:34784
    v_accvgpr_read_b32 v251, a19
    v_accvgpr_read_b32 v252, a24
    v_accvgpr_read_b32 v253, a25
    v_mfma_f32_16x16x32_bf16 v[20:23], a[144:147], a[184:187], v[20:23]
    s_add_u32 s96, s96, 0x10000
    v_accvgpr_read_b32 v254, a26
    v_accvgpr_read_b32 v255, a27
    v_mfma_f32_16x16x32_bf16 v[20:23], a[148:151], a[188:191], v[20:23]
    s_waitcnt lgkmcnt(10)
    v_mul_f32 v248, 0x3db8aa3b, v248
    v_mul_f32 v249, 0x3db8aa3b, v249
    v_mfma_f32_16x16x32_bf16 v[24:27], a[152:155], a[168:171], v[24:27]
    s_waitcnt lgkmcnt(8)
    ds_read_b64_tr_b16 a[144:145], v6 offset:50688
    ds_read_b64_tr_b16 a[146:147], v6 offset:50816
    v_mul_f32 v250, 0x3db8aa3b, v250
    v_mul_f32 v251, 0x3db8aa3b, v251
    v_mfma_f32_16x16x32_bf16 v[24:27], a[156:159], a[172:175], v[24:27]
    ds_read_b64_tr_b16 a[148:149], v6 offset:50944
    ds_read_b64_tr_b16 a[150:151], v6 offset:51072
    v_mul_f32 v252, 0x3db8aa3b, v252
    v_mul_f32 v253, 0x3db8aa3b, v253
    v_mfma_f32_16x16x32_bf16 v[28:31], a[152:155], a[184:187], v[28:31]
    buffer_load_dwordx4 v10, s[32:35], s51 offen lds
    v_mul_f32 v254, 0x3db8aa3b, v254
    v_mul_f32 v255, 0x3db8aa3b, v255
    v_mfma_f32_16x16x32_bf16 v[28:31], a[156:159], a[188:191], v[28:31]
    s_waitcnt lgkmcnt(10)
    v_cvt_pk_bf16_f32 v132, v248, v249
    v_cvt_pk_bf16_f32 v133, v250, v251
    v_mfma_f32_16x16x32_bf16 v[32:35], a[128:131], a[168:171], v[32:35]
    s_waitcnt lgkmcnt(8)
    s_add_u32 m0, m0, 0x420
    s_add_u32 s51, s51, 0x380
    ds_read_b64_tr_b16 a[152:153], v6 offset:50720
    ds_read_b64_tr_b16 a[154:155], v6 offset:50848
    v_cvt_pk_bf16_f32 v134, v252, v253
    v_cvt_pk_bf16_f32 v135, v254, v255
    s_nop 0
    v_permlane32_swap_b32 v132, v134
    v_mfma_f32_16x16x32_bf16 v[32:35], a[132:135], a[172:175], v[32:35]
    ds_read_b64_tr_b16 a[156:157], v6 offset:50976
    ds_read_b64_tr_b16 a[158:159], v6 offset:51104
    v_permlane32_swap_b32 v133, v135
    v_permlane16_swap_b32 v132, v134
    v_mfma_f32_16x16x32_bf16 v[36:39], a[128:131], a[184:187], v[36:39]
    v_permlane16_swap_b32 v133, v135
    v_accvgpr_read_b32 v240, a32
    v_mfma_f32_16x16x32_bf16 v[36:39], a[132:135], a[188:191], v[36:39]
    s_waitcnt lgkmcnt(10)
    v_accvgpr_read_b32 v241, a33
    v_accvgpr_read_b32 v242, a34
    v_mfma_f32_16x16x32_bf16 v[40:43], a[136:139], a[168:171], v[40:43]
    s_waitcnt lgkmcnt(8)
    ds_read_b64_tr_b16 a[128:129], v6 offset:50752
    ds_read_b64_tr_b16 a[130:131], v6 offset:50880
    v_accvgpr_read_b32 v243, a35
    v_accvgpr_read_b32 v244, a40
    v_mfma_f32_16x16x32_bf16 v[40:43], a[140:143], a[172:175], v[40:43]
    ds_read_b64_tr_b16 a[132:133], v6 offset:51008
    ds_read_b64_tr_b16 a[134:135], v6 offset:51136
    buffer_load_dwordx4 v10, s[32:35], s51 offen lds
    v_accvgpr_read_b32 v245, a41
    v_accvgpr_read_b32 v246, a42
    v_mfma_f32_16x16x32_bf16 v[44:47], a[136:139], a[184:187], v[44:47]
    s_add_u32 m0, m0, 0x420
    v_accvgpr_read_b32 v247, a43
    v_mul_f32 v240, 0x3db8aa3b, v240
    v_mfma_f32_16x16x32_bf16 v[44:47], a[140:143], a[188:191], v[44:47]
    s_waitcnt lgkmcnt(10)
    s_add_u32 s51, s51, 0x380
    v_mul_f32 v241, 0x3db8aa3b, v241
    v_mul_f32 v242, 0x3db8aa3b, v242
    v_mul_f32 v243, 0x3db8aa3b, v243
    v_mfma_f32_16x16x32_bf16 v[48:51], a[144:147], a[160:163], 0
    s_waitcnt lgkmcnt(8)
    ds_read_b64_tr_b16 a[136:137], v6 offset:50784
    ds_read_b64_tr_b16 a[138:139], v6 offset:50912
    v_mul_f32 v244, 0x3db8aa3b, v244
    v_mul_f32 v245, 0x3db8aa3b, v245
    v_mfma_f32_16x16x32_bf16 v[48:51], a[148:151], a[164:167], v[48:51]
    ds_read_b64_tr_b16 a[140:141], v6 offset:51040
    ds_read_b64_tr_b16 a[142:143], v6 offset:51168
    v_mul_f32 v246, 0x3db8aa3b, v246
    v_mul_f32 v247, 0x3db8aa3b, v247
    v_mfma_f32_16x16x32_bf16 v[52:55], a[144:147], a[176:179], 0
    v_cvt_pk_bf16_f32 v136, v240, v241
    v_cvt_pk_bf16_f32 v137, v242, v243
    v_mfma_f32_16x16x32_bf16 v[52:55], a[148:151], a[180:183], v[52:55]
    s_waitcnt lgkmcnt(10)
    v_cvt_pk_bf16_f32 v138, v244, v245
    v_cvt_pk_bf16_f32 v139, v246, v247
    v_mfma_f32_16x16x32_bf16 v[56:59], a[152:155], a[160:163], 0
    s_waitcnt lgkmcnt(8)
    ds_read_b64_tr_b16 a[144:145], v6 offset:51200
    ds_read_b64_tr_b16 a[146:147], v6 offset:51328
    v_permlane32_swap_b32 v136, v138
    v_permlane32_swap_b32 v137, v139
    v_mfma_f32_16x16x32_bf16 v[56:59], a[156:159], a[164:167], v[56:59]
    ds_read_b64_tr_b16 a[148:149], v6 offset:51456
    ds_read_b64_tr_b16 a[150:151], v6 offset:51584
    buffer_load_dwordx4 v10, s[32:35], s51 offen lds
    v_permlane16_swap_b32 v136, v138
    v_permlane16_swap_b32 v137, v139
    v_mfma_f32_16x16x32_bf16 v[60:63], a[152:155], a[176:179], 0
    v_accvgpr_read_b32 v248, a48
    v_accvgpr_read_b32 v249, a49
    v_accvgpr_read_b32 v250, a50
    v_mfma_f32_16x16x32_bf16 v[60:63], a[156:159], a[180:183], v[60:63]
    s_waitcnt lgkmcnt(10)
    s_add_u32 m0, m0, 0x420
    s_add_u32 s51, s51, 0x380
    v_accvgpr_read_b32 v251, a51
    v_accvgpr_read_b32 v252, a56
    v_mfma_f32_16x16x32_bf16 v[64:67], a[128:131], a[160:163], 0
    s_waitcnt lgkmcnt(8)
    ds_read_b64_tr_b16 a[152:153], v6 offset:51232
    ds_read_b64_tr_b16 a[154:155], v6 offset:51360
    v_accvgpr_read_b32 v253, a57
    v_accvgpr_read_b32 v254, a58
    v_mfma_f32_16x16x32_bf16 v[64:67], a[132:135], a[164:167], v[64:67]
    ds_read_b64_tr_b16 a[156:157], v6 offset:51488
    ds_read_b64_tr_b16 a[158:159], v6 offset:51616
    v_accvgpr_read_b32 v255, a59
    v_mul_f32 v248, 0x3db8aa3b, v248
    v_mfma_f32_16x16x32_bf16 v[68:71], a[128:131], a[176:179], 0
    v_mul_f32 v249, 0x3db8aa3b, v249
    v_mul_f32 v250, 0x3db8aa3b, v250
    v_mfma_f32_16x16x32_bf16 v[68:71], a[132:135], a[180:183], v[68:71]
    s_waitcnt lgkmcnt(10)
    v_mul_f32 v251, 0x3db8aa3b, v251
    v_mul_f32 v252, 0x3db8aa3b, v252
    v_mfma_f32_16x16x32_bf16 v[72:75], a[136:139], a[160:163], 0
    s_waitcnt lgkmcnt(8)
    ds_read_b64_tr_b16 a[128:129], v6 offset:51264
    ds_read_b64_tr_b16 a[130:131], v6 offset:51392
    v_mul_f32 v253, 0x3db8aa3b, v253
    v_mul_f32 v254, 0x3db8aa3b, v254
    v_mfma_f32_16x16x32_bf16 v[72:75], a[140:143], a[164:167], v[72:75]
    ds_read_b64_tr_b16 a[132:133], v6 offset:51520
    ds_read_b64_tr_b16 a[134:135], v6 offset:51648
    buffer_load_dwordx4 v10, s[32:35], s51 offen lds
    v_mul_f32 v255, 0x3db8aa3b, v255
    v_cvt_pk_bf16_f32 v140, v248, v249
    v_cvt_pk_bf16_f32 v141, v250, v251
    v_mfma_f32_16x16x32_bf16 v[76:79], a[136:139], a[176:179], 0
    s_add_u32 m0, s45, 0x8400
    v_cvt_pk_bf16_f32 v142, v252, v253
    v_cvt_pk_bf16_f32 v143, v254, v255
    v_mfma_f32_16x16x32_bf16 v[76:79], a[140:143], a[180:183], v[76:79]
    s_waitcnt lgkmcnt(10)
    s_add_u32 s51, s51, 0xffffe880
    v_permlane32_swap_b32 v140, v142
    v_permlane32_swap_b32 v141, v143
    v_mfma_f32_16x16x32_bf16 v[48:51], a[144:147], a[168:171], v[48:51]
    s_waitcnt lgkmcnt(8)
    ds_read_b64_tr_b16 a[136:137], v6 offset:51296
    ds_read_b64_tr_b16 a[138:139], v6 offset:51424
    v_permlane16_swap_b32 v140, v142
    v_permlane16_swap_b32 v141, v143
    v_cvt_pk_bf16_f32 v96, v16, v17
    v_cvt_pk_bf16_f32 v97, v18, v19
    v_cvt_pk_bf16_f32 v98, v24, v25
    v_cvt_pk_bf16_f32 v99, v26, v27
    v_cvt_pk_bf16_f32 v100, v32, v33
    v_cvt_pk_bf16_f32 v101, v34, v35
    v_cvt_pk_bf16_f32 v102, v40, v41
    v_cvt_pk_bf16_f32 v103, v42, v43
    v_cvt_pk_bf16_f32 v104, v20, v21
    v_cvt_pk_bf16_f32 v105, v22, v23
    v_cvt_pk_bf16_f32 v106, v28, v29
    v_cvt_pk_bf16_f32 v107, v30, v31
    v_cvt_pk_bf16_f32 v108, v36, v37
    v_cvt_pk_bf16_f32 v109, v38, v39
    v_cvt_pk_bf16_f32 v110, v44, v45
    v_cvt_pk_bf16_f32 v111, v46, v47
    v_mfma_f32_16x16x32_bf16 v[48:51], a[148:151], a[172:175], v[48:51]
    ds_read_b64_tr_b16 a[140:141], v6 offset:51552
    ds_read_b64_tr_b16 a[142:143], v6 offset:51680
    v_accvgpr_read_b32 v240, a64
    v_accvgpr_read_b32 v241, a65
    v_mfma_f32_16x16x32_bf16 v[52:55], a[144:147], a[184:187], v[52:55]
    s_add_u32 s57, s53, 0
    v_accvgpr_read_b32 v242, a66
    v_accvgpr_read_b32 v243, a67
    v_mfma_f32_16x16x32_bf16 v[52:55], a[148:151], a[188:191], v[52:55]
    s_waitcnt lgkmcnt(10)
    s_waitcnt vmcnt(16) lgkmcnt(0)
    s_barrier
    buffer_store_dwordx4 v[96:99], v11, s[36:39], s57 offen sc1
    v_accvgpr_read_b32 v244, a72
    v_accvgpr_read_b32 v245, a73
    v_mfma_f32_16x16x32_bf16 v[56:59], a[152:155], a[168:171], v[56:59]
    v_accvgpr_read_b32 v246, a74
    v_accvgpr_read_b32 v247, a75
    v_mul_f32 v240, 0x3db8aa3b, v240
    v_mfma_f32_16x16x32_bf16 v[56:59], a[156:159], a[172:175], v[56:59]
    ds_read_b64_tr_b16 a[144:145], v7 offset:33792
    ds_read_b64_tr_b16 a[146:147], v7 offset:33920
    ds_read_b64_tr_b16 a[148:149], v7 offset:34048
    ds_read_b64_tr_b16 a[150:151], v7 offset:34176
    v_mul_f32 v241, 0x3db8aa3b, v241
    v_mul_f32 v242, 0x3db8aa3b, v242
    v_mfma_f32_16x16x32_bf16 v[60:63], a[152:155], a[184:187], v[60:63]
    v_mul_f32 v243, 0x3db8aa3b, v243
    v_mul_f32 v244, 0x3db8aa3b, v244
    v_mfma_f32_16x16x32_bf16 v[60:63], a[156:159], a[188:191], v[60:63]
    buffer_load_dwordx4 v3, s[12:15], s47 offen lds
    v_mul_f32 v245, 0x3db8aa3b, v245
    v_mul_f32 v246, 0x3db8aa3b, v246
    v_mfma_f32_16x16x32_bf16 v[64:67], a[128:131], a[168:171], v[64:67]
    ds_read_b64_tr_b16 a[152:153], v7 offset:33824
    ds_read_b64_tr_b16 a[154:155], v7 offset:33952
    v_mul_f32 v247, 0x3db8aa3b, v247
    v_cvt_pk_bf16_f32 v144, v240, v241
    v_mfma_f32_16x16x32_bf16 v[64:67], a[132:135], a[172:175], v[64:67]
    s_add_u32 m0, m0, 0x220
    ds_read_b64_tr_b16 a[156:157], v7 offset:34080
    ds_read_b64_tr_b16 a[158:159], v7 offset:34208
    v_cvt_pk_bf16_f32 v145, v242, v243
    v_cvt_pk_bf16_f32 v146, v244, v245
    v_mfma_f32_16x16x32_bf16 v[68:71], a[128:131], a[184:187], v[68:71]
    v_cvt_pk_bf16_f32 v147, v246, v247
    v_permlane32_swap_b32 v144, v146
    v_mfma_f32_16x16x32_bf16 v[68:71], a[132:135], a[188:191], v[68:71]
    v_permlane32_swap_b32 v145, v147
    v_permlane16_swap_b32 v144, v146
    s_nop 0
    v_permlane16_swap_b32 v145, v147
    v_mfma_f32_16x16x32_bf16 v[72:75], a[136:139], a[168:171], v[72:75]
    ds_read_b64_tr_b16 a[128:129], v7 offset:33856
    ds_read_b64_tr_b16 a[130:131], v7 offset:33984
    v_accvgpr_read_b32 v248, a80
    v_accvgpr_read_b32 v249, a81
    v_mfma_f32_16x16x32_bf16 v[72:75], a[140:143], a[172:175], v[72:75]
    s_add_u32 s58, s53, 0x400
    ds_read_b64_tr_b16 a[132:133], v7 offset:34112
    ds_read_b64_tr_b16 a[134:135], v7 offset:34240
    v_accvgpr_read_b32 v250, a82
    v_accvgpr_read_b32 v251, a83
    v_mfma_f32_16x16x32_bf16 v[76:79], a[136:139], a[184:187], v[76:79]
    buffer_load_dwordx4 v3, s[12:15], s47 offen offset:512 lds
    buffer_store_dwordx4 v[100:103], v11, s[36:39], s58 offen sc1
    v_accvgpr_read_b32 v252, a88
    v_accvgpr_read_b32 v253, a89
    v_mfma_f32_16x16x32_bf16 v[76:79], a[140:143], a[188:191], v[76:79]
    s_waitcnt lgkmcnt(10)
    v_accvgpr_read_b32 v254, a90
    v_accvgpr_read_b32 v255, a91
    v_mfma_f32_16x16x32_bf16 v[16:19], a[144:147], a[160:163], 0
    s_waitcnt lgkmcnt(8)
    s_add_u32 m0, m0, 0x220
    ds_read_b64_tr_b16 a[136:137], v7 offset:33888
    ds_read_b64_tr_b16 a[138:139], v7 offset:34016
    v_mul_f32 v248, 0x3db8aa3b, v248
    v_mul_f32 v249, 0x3db8aa3b, v249
    v_mfma_f32_16x16x32_bf16 v[16:19], a[148:151], a[164:167], v[16:19]
    ds_read_b64_tr_b16 a[140:141], v7 offset:34144
    ds_read_b64_tr_b16 a[142:143], v7 offset:34272
    v_mul_f32 v250, 0x3db8aa3b, v250
    v_mul_f32 v251, 0x3db8aa3b, v251
    v_mul_f32 v252, 0x3db8aa3b, v252
    v_mfma_f32_16x16x32_bf16 v[20:23], a[144:147], a[176:179], 0
    v_mul_f32 v253, 0x3db8aa3b, v253
    v_mul_f32 v254, 0x3db8aa3b, v254
    v_mfma_f32_16x16x32_bf16 v[20:23], a[148:151], a[180:183], v[20:23]
    s_waitcnt lgkmcnt(10)
    v_mul_f32 v255, 0x3db8aa3b, v255
    v_cvt_pk_bf16_f32 v148, v248, v249
    v_mfma_f32_16x16x32_bf16 v[24:27], a[152:155], a[160:163], 0
    s_waitcnt lgkmcnt(8)
    ds_read_b64_tr_b16 a[144:145], v7 offset:34304
    ds_read_b64_tr_b16 a[146:147], v7 offset:34432
    v_cvt_pk_bf16_f32 v149, v250, v251
    v_cvt_pk_bf16_f32 v150, v252, v253
    v_mfma_f32_16x16x32_bf16 v[24:27], a[156:159], a[164:167], v[24:27]
    ds_read_b64_tr_b16 a[148:149], v7 offset:34560
    ds_read_b64_tr_b16 a[150:151], v7 offset:34688
    v_cvt_pk_bf16_f32 v151, v254, v255
    v_permlane32_swap_b32 v148, v150
    v_mfma_f32_16x16x32_bf16 v[28:31], a[152:155], a[176:179], 0
    buffer_load_dwordx4 v3, s[12:15], s47 offen offset:1024 lds
    v_permlane32_swap_b32 v149, v151
    v_permlane16_swap_b32 v148, v150
    v_mfma_f32_16x16x32_bf16 v[28:31], a[156:159], a[180:183], v[28:31]
    s_waitcnt lgkmcnt(10)
    v_permlane16_swap_b32 v149, v151
    v_accvgpr_read_b32 v240, a96
    v_mfma_f32_16x16x32_bf16 v[32:35], a[128:131], a[160:163], 0
    s_waitcnt lgkmcnt(8)
    s_add_u32 m0, m0, 0x220
    s_add_u32 s59, s53, 0x2000
    ds_read_b64_tr_b16 a[152:153], v7 offset:34336
    ds_read_b64_tr_b16 a[154:155], v7 offset:34464
    v_accvgpr_read_b32 v241, a97
    v_accvgpr_read_b32 v242, a98
    v_accvgpr_read_b32 v243, a99
    v_mfma_f32_16x16x32_bf16 v[32:35], a[132:135], a[164:167], v[32:35]
    ds_read_b64_tr_b16 a[156:157], v7 offset:34592
    ds_read_b64_tr_b16 a[158:159], v7 offset:34720
    buffer_store_dwordx4 v[104:107], v11, s[36:39], s59 offen sc1
    v_accvgpr_read_b32 v244, a104
    v_accvgpr_read_b32 v245, a105
    v_mfma_f32_16x16x32_bf16 v[36:39], a[128:131], a[176:179], 0
    v_accvgpr_read_b32 v246, a106
    v_accvgpr_read_b32 v247, a107
    v_mfma_f32_16x16x32_bf16 v[36:39], a[132:135], a[180:183], v[36:39]
    s_waitcnt lgkmcnt(10)
    v_mul_f32 v240, 0x3db8aa3b, v240
    v_mul_f32 v241, 0x3db8aa3b, v241
    v_mfma_f32_16x16x32_bf16 v[40:43], a[136:139], a[160:163], 0
    s_waitcnt lgkmcnt(8)
    ds_read_b64_tr_b16 a[128:129], v7 offset:34368
    ds_read_b64_tr_b16 a[130:131], v7 offset:34496
    v_mul_f32 v242, 0x3db8aa3b, v242
    v_mul_f32 v243, 0x3db8aa3b, v243
    v_mfma_f32_16x16x32_bf16 v[40:43], a[140:143], a[164:167], v[40:43]
    ds_read_b64_tr_b16 a[132:133], v7 offset:34624
    ds_read_b64_tr_b16 a[134:135], v7 offset:34752
    v_mul_f32 v244, 0x3db8aa3b, v244
    v_mul_f32 v245, 0x3db8aa3b, v245
    v_mfma_f32_16x16x32_bf16 v[44:47], a[136:139], a[176:179], 0
    buffer_load_dwordx4 v3, s[12:15], s47 offen offset:1536 lds
    v_mul_f32 v246, 0x3db8aa3b, v246
    v_mul_f32 v247, 0x3db8aa3b, v247
    v_mfma_f32_16x16x32_bf16 v[44:47], a[140:143], a[180:183], v[44:47]
    s_waitcnt lgkmcnt(10)
    v_cvt_pk_bf16_f32 v152, v240, v241
    v_cvt_pk_bf16_f32 v153, v242, v243
    v_cvt_pk_bf16_f32 v154, v244, v245
    v_mfma_f32_16x16x32_bf16 v[16:19], a[144:147], a[168:171], v[16:19]
    s_waitcnt lgkmcnt(8)
    s_add_u32 m0, m0, 0x220
    ds_read_b64_tr_b16 a[136:137], v7 offset:34400
    ds_read_b64_tr_b16 a[138:139], v7 offset:34528
    v_cvt_pk_bf16_f32 v155, v246, v247
    v_permlane32_swap_b32 v152, v154
    v_cvt_pk_bf16_f32 v80, v48, v49
    v_cvt_pk_bf16_f32 v81, v50, v51
    v_cvt_pk_bf16_f32 v82, v56, v57
    v_cvt_pk_bf16_f32 v83, v58, v59
    v_cvt_pk_bf16_f32 v84, v64, v65
    v_cvt_pk_bf16_f32 v85, v66, v67
    v_cvt_pk_bf16_f32 v86, v72, v73
    v_cvt_pk_bf16_f32 v87, v74, v75
    v_cvt_pk_bf16_f32 v88, v52, v53
    v_cvt_pk_bf16_f32 v89, v54, v55
    v_cvt_pk_bf16_f32 v90, v60, v61
    v_cvt_pk_bf16_f32 v91, v62, v63
    v_cvt_pk_bf16_f32 v92, v68, v69
    v_cvt_pk_bf16_f32 v93, v70, v71
    v_cvt_pk_bf16_f32 v94, v76, v77
    v_cvt_pk_bf16_f32 v95, v78, v79
    v_mfma_f32_16x16x32_bf16 v[16:19], a[148:151], a[172:175], v[16:19]
    ds_read_b64_tr_b16 a[140:141], v7 offset:34656
    ds_read_b64_tr_b16 a[142:143], v7 offset:34784
    v_permlane32_swap_b32 v153, v155
    v_permlane16_swap_b32 v152, v154
    v_mfma_f32_16x16x32_bf16 v[20:23], a[144:147], a[184:187], v[20:23]
    v_permlane16_swap_b32 v153, v155
    v_accvgpr_read_b32 v248, a112
    v_mfma_f32_16x16x32_bf16 v[20:23], a[148:151], a[188:191], v[20:23]
    s_waitcnt lgkmcnt(10)
    s_add_u32 s60, s53, 0x2400
    v_accvgpr_read_b32 v249, a113
    v_accvgpr_read_b32 v250, a114
    v_mfma_f32_16x16x32_bf16 v[24:27], a[152:155], a[168:171], v[24:27]
    s_waitcnt lgkmcnt(8)
    ds_read_b64_tr_b16 a[144:145], v7 offset:50688
    ds_read_b64_tr_b16 a[146:147], v7 offset:50816
    buffer_store_dwordx4 v[108:111], v11, s[36:39], s60 offen sc1
    v_accvgpr_read_b32 v251, a115
    v_accvgpr_read_b32 v252, a120
    v_mfma_f32_16x16x32_bf16 v[24:27], a[156:159], a[172:175], v[24:27]
    ds_read_b64_tr_b16 a[148:149], v7 offset:50944
    ds_read_b64_tr_b16 a[150:151], v7 offset:51072
    v_accvgpr_read_b32 v253, a121
    v_accvgpr_read_b32 v254, a122
    v_mfma_f32_16x16x32_bf16 v[28:31], a[152:155], a[184:187], v[28:31]
    buffer_load_dwordx4 v3, s[12:15], s47 offen offset:2048 lds
    v_accvgpr_read_b32 v255, a123
    v_mul_f32 v248, 0x3db8aa3b, v248
    v_mul_f32 v249, 0x3db8aa3b, v249
    v_mfma_f32_16x16x32_bf16 v[28:31], a[156:159], a[188:191], v[28:31]
    s_waitcnt lgkmcnt(10)
    v_mul_f32 v250, 0x3db8aa3b, v250
    v_mul_f32 v251, 0x3db8aa3b, v251
    v_mfma_f32_16x16x32_bf16 v[32:35], a[128:131], a[168:171], v[32:35]
    s_waitcnt lgkmcnt(8)
    s_add_u32 m0, m0, 0x220
    ds_read_b64_tr_b16 a[152:153], v7 offset:50720
    ds_read_b64_tr_b16 a[154:155], v7 offset:50848
    v_mul_f32 v252, 0x3db8aa3b, v252
    v_mul_f32 v253, 0x3db8aa3b, v253
    v_mfma_f32_16x16x32_bf16 v[32:35], a[132:135], a[172:175], v[32:35]
    ds_read_b64_tr_b16 a[156:157], v7 offset:50976
    ds_read_b64_tr_b16 a[158:159], v7 offset:51104
    v_mul_f32 v254, 0x3db8aa3b, v254
    v_mul_f32 v255, 0x3db8aa3b, v255
    v_mfma_f32_16x16x32_bf16 v[36:39], a[128:131], a[184:187], v[36:39]
    v_cvt_pk_bf16_f32 v156, v248, v249
    v_cvt_pk_bf16_f32 v157, v250, v251
    v_mfma_f32_16x16x32_bf16 v[36:39], a[132:135], a[188:191], v[36:39]
    s_waitcnt lgkmcnt(10)
    v_cvt_pk_bf16_f32 v158, v252, v253
    v_cvt_pk_bf16_f32 v159, v254, v255
    v_mfma_f32_16x16x32_bf16 v[40:43], a[136:139], a[168:171], v[40:43]
    s_waitcnt lgkmcnt(8)
    ds_read_b64_tr_b16 a[128:129], v7 offset:50752
    ds_read_b64_tr_b16 a[130:131], v7 offset:50880
    v_permlane32_swap_b32 v156, v158
    v_permlane32_swap_b32 v157, v159
    v_mfma_f32_16x16x32_bf16 v[40:43], a[140:143], a[172:175], v[40:43]
    ds_read_b64_tr_b16 a[132:133], v7 offset:51008
    ds_read_b64_tr_b16 a[134:135], v7 offset:51136
    buffer_load_dwordx4 v3, s[12:15], s47 offen offset:2560 lds
    v_permlane16_swap_b32 v156, v158
    v_permlane16_swap_b32 v157, v159
    v_accvgpr_read_b32 v240, a4
    v_mfma_f32_16x16x32_bf16 v[44:47], a[136:139], a[184:187], v[44:47]
    s_add_u32 s57, s53, 0x800
    v_accvgpr_read_b32 v241, a5
    v_accvgpr_read_b32 v242, a6
    v_mfma_f32_16x16x32_bf16 v[44:47], a[140:143], a[188:191], v[44:47]
    s_waitcnt lgkmcnt(10)
    s_add_u32 m0, m0, 0x220
    buffer_store_dwordx4 v[80:83], v11, s[36:39], s57 offen sc1
    v_accvgpr_read_b32 v243, a7
    v_accvgpr_read_b32 v244, a12
    v_mfma_f32_16x16x32_bf16 v[48:51], a[144:147], a[160:163], 0
    s_waitcnt lgkmcnt(8)
    ds_read_b64_tr_b16 a[136:137], v7 offset:50784
    ds_read_b64_tr_b16 a[138:139], v7 offset:50912
    v_accvgpr_read_b32 v245, a13
    v_accvgpr_read_b32 v246, a14
    v_mfma_f32_16x16x32_bf16 v[48:51], a[148:151], a[164:167], v[48:51]
    ds_read_b64_tr_b16 a[140:141], v7 offset:51040
    ds_read_b64_tr_b16 a[142:143], v7 offset:51168
    v_accvgpr_read_b32 v247, a15
    v_mul_f32 v240, 0x3db8aa3b, v240
    v_mfma_f32_16x16x32_bf16 v[52:55], a[144:147], a[176:179], 0
    v_mul_f32 v241, 0x3db8aa3b, v241
    v_mul_f32 v242, 0x3db8aa3b, v242
    v_mfma_f32_16x16x32_bf16 v[52:55], a[148:151], a[180:183], v[52:55]
    s_waitcnt lgkmcnt(10)
    v_mul_f32 v243, 0x3db8aa3b, v243
    v_mul_f32 v244, 0x3db8aa3b, v244
    v_mfma_f32_16x16x32_bf16 v[56:59], a[152:155], a[160:163], 0
    s_waitcnt lgkmcnt(8)
    ds_read_b64_tr_b16 a[144:145], v7 offset:51200
    ds_read_b64_tr_b16 a[146:147], v7 offset:51328
    v_mul_f32 v245, 0x3db8aa3b, v245
    v_mul_f32 v246, 0x3db8aa3b, v246
    v_mul_f32 v247, 0x3db8aa3b, v247
    v_mfma_f32_16x16x32_bf16 v[56:59], a[156:159], a[164:167], v[56:59]
    ds_read_b64_tr_b16 a[148:149], v7 offset:51456
    ds_read_b64_tr_b16 a[150:151], v7 offset:51584
    buffer_load_dwordx4 v3, s[12:15], s47 offen offset:3072 lds
    v_cvt_pk_bf16_f32 v160, v240, v241
    v_cvt_pk_bf16_f32 v161, v242, v243
    v_mfma_f32_16x16x32_bf16 v[60:63], a[152:155], a[176:179], 0
    s_add_u32 m0, m0, 0x220
    v_cvt_pk_bf16_f32 v162, v244, v245
    v_cvt_pk_bf16_f32 v163, v246, v247
    v_mfma_f32_16x16x32_bf16 v[60:63], a[156:159], a[180:183], v[60:63]
    s_waitcnt lgkmcnt(10)
    v_permlane32_swap_b32 v160, v162
    v_permlane32_swap_b32 v161, v163
    v_mfma_f32_16x16x32_bf16 v[64:67], a[128:131], a[160:163], 0
    s_waitcnt lgkmcnt(8)
    ds_read_b64_tr_b16 a[152:153], v7 offset:51232
    ds_read_b64_tr_b16 a[154:155], v7 offset:51360
    v_permlane16_swap_b32 v160, v162
    v_permlane16_swap_b32 v161, v163
    v_mfma_f32_16x16x32_bf16 v[64:67], a[132:135], a[164:167], v[64:67]
    s_add_u32 s58, s53, 0xc00
    ds_read_b64_tr_b16 a[156:157], v7 offset:51488
    ds_read_b64_tr_b16 a[158:159], v7 offset:51616
    v_accvgpr_read_b32 v248, a20
    v_accvgpr_read_b32 v249, a21
    v_mfma_f32_16x16x32_bf16 v[68:71], a[128:131], a[176:179], 0
    buffer_store_dwordx4 v[84:87], v11, s[36:39], s58 offen sc1
    v_accvgpr_read_b32 v250, a22
    v_accvgpr_read_b32 v251, a23
    v_mfma_f32_16x16x32_bf16 v[68:71], a[132:135], a[180:183], v[68:71]
    s_waitcnt lgkmcnt(10)
    v_accvgpr_read_b32 v252, a28
    v_accvgpr_read_b32 v253, a29
    v_accvgpr_read_b32 v254, a30
    v_mfma_f32_16x16x32_bf16 v[72:75], a[136:139], a[160:163], 0
    s_waitcnt lgkmcnt(8)
    ds_read_b64_tr_b16 a[128:129], v7 offset:51264
    ds_read_b64_tr_b16 a[130:131], v7 offset:51392
    v_accvgpr_read_b32 v255, a31
    v_mul_f32 v248, 0x3db8aa3b, v248
    v_mfma_f32_16x16x32_bf16 v[72:75], a[140:143], a[164:167], v[72:75]
    ds_read_b64_tr_b16 a[132:133], v7 offset:51520
    ds_read_b64_tr_b16 a[134:135], v7 offset:51648
    buffer_load_dwordx4 v3, s[12:15], s47 offen offset:3584 lds
    v_mul_f32 v249, 0x3db8aa3b, v249
    v_mul_f32 v250, 0x3db8aa3b, v250
    v_mfma_f32_16x16x32_bf16 v[76:79], a[136:139], a[176:179], 0
    s_add_u32 m0, s45, 0x10800
    v_mul_f32 v251, 0x3db8aa3b, v251
    v_mul_f32 v252, 0x3db8aa3b, v252
    v_mfma_f32_16x16x32_bf16 v[76:79], a[140:143], a[180:183], v[76:79]
    s_waitcnt lgkmcnt(10)
    s_add_u32 s47, s47, 0x8000
    v_mul_f32 v253, 0x3db8aa3b, v253
    v_mul_f32 v254, 0x3db8aa3b, v254
    v_mfma_f32_16x16x32_bf16 v[48:51], a[144:147], a[168:171], v[48:51]
    s_waitcnt lgkmcnt(8)
    ds_read_b64_tr_b16 a[136:137], v7 offset:51296
    ds_read_b64_tr_b16 a[138:139], v7 offset:51424
    v_mul_f32 v255, 0x3db8aa3b, v255
    v_cvt_pk_bf16_f32 v164, v248, v249
    v_cvt_pk_bf16_f32 v112, v16, v17
    v_cvt_pk_bf16_f32 v113, v18, v19
    v_cvt_pk_bf16_f32 v114, v24, v25
    v_cvt_pk_bf16_f32 v115, v26, v27
    v_cvt_pk_bf16_f32 v116, v32, v33
    v_cvt_pk_bf16_f32 v117, v34, v35
    v_cvt_pk_bf16_f32 v118, v40, v41
    v_cvt_pk_bf16_f32 v119, v42, v43
    v_cvt_pk_bf16_f32 v120, v20, v21
    v_cvt_pk_bf16_f32 v121, v22, v23
    v_cvt_pk_bf16_f32 v122, v28, v29
    v_cvt_pk_bf16_f32 v123, v30, v31
    v_cvt_pk_bf16_f32 v124, v36, v37
    v_cvt_pk_bf16_f32 v125, v38, v39
    v_cvt_pk_bf16_f32 v126, v44, v45
    v_cvt_pk_bf16_f32 v127, v46, v47
    v_mfma_f32_16x16x32_bf16 v[48:51], a[148:151], a[172:175], v[48:51]
    ds_read_b64_tr_b16 a[140:141], v7 offset:51552
    ds_read_b64_tr_b16 a[142:143], v7 offset:51680
    v_cvt_pk_bf16_f32 v165, v250, v251
    v_cvt_pk_bf16_f32 v166, v252, v253
    v_mfma_f32_16x16x32_bf16 v[52:55], a[144:147], a[184:187], v[52:55]
    v_cvt_pk_bf16_f32 v167, v254, v255
    v_permlane32_swap_b32 v164, v166
    s_nop 0
    v_permlane32_swap_b32 v165, v167
    v_mfma_f32_16x16x32_bf16 v[52:55], a[148:151], a[188:191], v[52:55]
    s_waitcnt lgkmcnt(10)
    s_waitcnt vmcnt(22) lgkmcnt(0)
    s_barrier
    v_permlane16_swap_b32 v164, v166
    v_permlane16_swap_b32 v165, v167
    v_mfma_f32_16x16x32_bf16 v[56:59], a[152:155], a[168:171], v[56:59]
    s_add_u32 s59, s53, 0x2800
    v_accvgpr_read_b32 v240, a36
    v_accvgpr_read_b32 v241, a37
    v_mfma_f32_16x16x32_bf16 v[56:59], a[156:159], a[172:175], v[56:59]
    ds_read_b64_tr_b16 a[144:145], v6
    ds_read_b64_tr_b16 a[146:147], v6 offset:128
    ds_read_b64_tr_b16 a[148:149], v6 offset:256
    ds_read_b64_tr_b16 a[150:151], v6 offset:384
    buffer_store_dwordx4 v[88:91], v11, s[36:39], s59 offen sc1
    v_accvgpr_read_b32 v242, a38
    v_accvgpr_read_b32 v243, a39
    v_mfma_f32_16x16x32_bf16 v[60:63], a[152:155], a[184:187], v[60:63]
    v_accvgpr_read_b32 v244, a44
    v_accvgpr_read_b32 v245, a45
    v_mfma_f32_16x16x32_bf16 v[60:63], a[156:159], a[188:191], v[60:63]
    v_accvgpr_read_b32 v246, a46
    v_accvgpr_read_b32 v247, a47
    v_mfma_f32_16x16x32_bf16 v[64:67], a[128:131], a[168:171], v[64:67]
    ds_read_b64_tr_b16 a[152:153], v6 offset:32
    ds_read_b64_tr_b16 a[154:155], v6 offset:160
    v_mul_f32 v240, 0x3db8aa3b, v240
    v_mul_f32 v241, 0x3db8aa3b, v241
    v_mfma_f32_16x16x32_bf16 v[64:67], a[132:135], a[172:175], v[64:67]
    ds_read_b64_tr_b16 a[156:157], v6 offset:288
    ds_read_b64_tr_b16 a[158:159], v6 offset:416
    v_mul_f32 v242, 0x3db8aa3b, v242
    v_mul_f32 v243, 0x3db8aa3b, v243
    v_mul_f32 v244, 0x3db8aa3b, v244
    v_mfma_f32_16x16x32_bf16 v[68:71], a[128:131], a[184:187], v[68:71]
    v_mul_f32 v245, 0x3db8aa3b, v245
    v_mul_f32 v246, 0x3db8aa3b, v246
    v_mfma_f32_16x16x32_bf16 v[68:71], a[132:135], a[188:191], v[68:71]
    v_mul_f32 v247, 0x3db8aa3b, v247
    v_cvt_pk_bf16_f32 v168, v240, v241
    v_mfma_f32_16x16x32_bf16 v[72:75], a[136:139], a[168:171], v[72:75]
    ds_read_b64_tr_b16 a[128:129], v6 offset:64
    ds_read_b64_tr_b16 a[130:131], v6 offset:192
    v_cvt_pk_bf16_f32 v169, v242, v243
    v_cvt_pk_bf16_f32 v170, v244, v245
    v_mfma_f32_16x16x32_bf16 v[72:75], a[140:143], a[172:175], v[72:75]
    ds_read_b64_tr_b16 a[132:133], v6 offset:320
    ds_read_b64_tr_b16 a[134:135], v6 offset:448
    v_cvt_pk_bf16_f32 v171, v246, v247
    v_permlane32_swap_b32 v168, v170
    v_mfma_f32_16x16x32_bf16 v[76:79], a[136:139], a[184:187], v[76:79]
    v_permlane32_swap_b32 v169, v171
    v_permlane16_swap_b32 v168, v170
    v_mfma_f32_16x16x32_bf16 v[76:79], a[140:143], a[188:191], v[76:79]
    s_waitcnt lgkmcnt(10)
    s_add_u32 s60, s53, 0x2c00
    v_permlane16_swap_b32 v169, v171
    v_accvgpr_read_b32 v248, a52
    v_accvgpr_read_b32 v249, a53
    v_mfma_f32_16x16x32_bf16 v[16:19], a[144:147], a[160:163], 0
    s_waitcnt lgkmcnt(8)
    ds_read_b64_tr_b16 a[136:137], v6 offset:96
    ds_read_b64_tr_b16 a[138:139], v6 offset:224
    buffer_store_dwordx4 v[92:95], v11, s[36:39], s60 offen sc1
    v_accvgpr_read_b32 v250, a54
    v_accvgpr_read_b32 v251, a55
    v_mfma_f32_16x16x32_bf16 v[16:19], a[148:151], a[164:167], v[16:19]
    ds_read_b64_tr_b16 a[140:141], v6 offset:352
    ds_read_b64_tr_b16 a[142:143], v6 offset:480
    v_accvgpr_read_b32 v252, a60
    v_accvgpr_read_b32 v253, a61
    v_mfma_f32_16x16x32_bf16 v[20:23], a[144:147], a[176:179], 0
    v_accvgpr_read_b32 v254, a62
    v_accvgpr_read_b32 v255, a63
    v_mfma_f32_16x16x32_bf16 v[20:23], a[148:151], a[180:183], v[20:23]
    s_waitcnt lgkmcnt(10)
    v_mul_f32 v248, 0x3db8aa3b, v248
    v_mul_f32 v249, 0x3db8aa3b, v249
    v_mfma_f32_16x16x32_bf16 v[24:27], a[152:155], a[160:163], 0
    s_waitcnt lgkmcnt(8)
    ds_read_b64_tr_b16 a[144:145], v6 offset:512
    ds_read_b64_tr_b16 a[146:147], v6 offset:640
    v_mul_f32 v250, 0x3db8aa3b, v250
    v_mul_f32 v251, 0x3db8aa3b, v251
    v_mfma_f32_16x16x32_bf16 v[24:27], a[156:159], a[164:167], v[24:27]
    ds_read_b64_tr_b16 a[148:149], v6 offset:768
    ds_read_b64_tr_b16 a[150:151], v6 offset:896
    v_mul_f32 v252, 0x3db8aa3b, v252
    v_mul_f32 v253, 0x3db8aa3b, v253
    v_mfma_f32_16x16x32_bf16 v[28:31], a[152:155], a[176:179], 0
    v_mul_f32 v254, 0x3db8aa3b, v254
    v_mul_f32 v255, 0x3db8aa3b, v255
    v_cvt_pk_bf16_f32 v172, v248, v249
    v_mfma_f32_16x16x32_bf16 v[28:31], a[156:159], a[180:183], v[28:31]
    s_waitcnt lgkmcnt(10)
    v_cvt_pk_bf16_f32 v173, v250, v251
    v_cvt_pk_bf16_f32 v174, v252, v253
    v_mfma_f32_16x16x32_bf16 v[32:35], a[128:131], a[160:163], 0
    s_waitcnt lgkmcnt(8)
    ds_read_b64_tr_b16 a[152:153], v6 offset:544
    ds_read_b64_tr_b16 a[154:155], v6 offset:672
    v_cvt_pk_bf16_f32 v175, v254, v255
    v_permlane32_swap_b32 v172, v174
    v_mfma_f32_16x16x32_bf16 v[32:35], a[132:135], a[164:167], v[32:35]
    ds_read_b64_tr_b16 a[156:157], v6 offset:800
    ds_read_b64_tr_b16 a[158:159], v6 offset:928
    v_permlane32_swap_b32 v173, v175
    v_permlane16_swap_b32 v172, v174
    v_mfma_f32_16x16x32_bf16 v[36:39], a[128:131], a[176:179], 0
    s_add_u32 s57, s53, 0x1000
    v_permlane16_swap_b32 v173, v175
    v_accvgpr_read_b32 v240, a68
    v_mfma_f32_16x16x32_bf16 v[36:39], a[132:135], a[180:183], v[36:39]
    s_waitcnt lgkmcnt(10)
    buffer_store_dwordx4 v[112:115], v11, s[36:39], s57 offen sc1
    v_accvgpr_read_b32 v241, a69
    v_accvgpr_read_b32 v242, a70
    v_mfma_f32_16x16x32_bf16 v[40:43], a[136:139], a[160:163], 0
    s_waitcnt lgkmcnt(8)
    ds_read_b64_tr_b16 a[128:129], v6 offset:576
    ds_read_b64_tr_b16 a[130:131], v6 offset:704
    v_accvgpr_read_b32 v243, a71
    v_accvgpr_read_b32 v244, a76
    v_mfma_f32_16x16x32_bf16 v[40:43], a[140:143], a[164:167], v[40:43]
    ds_read_b64_tr_b16 a[132:133], v6 offset:832
    ds_read_b64_tr_b16 a[134:135], v6 offset:960
    v_accvgpr_read_b32 v245, a77
    v_accvgpr_read_b32 v246, a78
    v_accvgpr_read_b32 v247, a79
    v_mfma_f32_16x16x32_bf16 v[44:47], a[136:139], a[176:179], 0
    v_mul_f32 v240, 0x3db8aa3b, v240
    v_mul_f32 v241, 0x3db8aa3b, v241
    v_mfma_f32_16x16x32_bf16 v[44:47], a[140:143], a[180:183], v[44:47]
    s_waitcnt lgkmcnt(10)
    v_mul_f32 v242, 0x3db8aa3b, v242
    v_mul_f32 v243, 0x3db8aa3b, v243
    v_mfma_f32_16x16x32_bf16 v[16:19], a[144:147], a[168:171], v[16:19]
    s_waitcnt lgkmcnt(8)
    ds_read_b64_tr_b16 a[136:137], v6 offset:608
    ds_read_b64_tr_b16 a[138:139], v6 offset:736
    v_mul_f32 v244, 0x3db8aa3b, v244
    v_mul_f32 v245, 0x3db8aa3b, v245
    v_cvt_pk_bf16_f32 v96, v48, v49
    v_cvt_pk_bf16_f32 v97, v50, v51
    v_cvt_pk_bf16_f32 v98, v56, v57
    v_cvt_pk_bf16_f32 v99, v58, v59
    v_cvt_pk_bf16_f32 v100, v64, v65
    v_cvt_pk_bf16_f32 v101, v66, v67
    v_cvt_pk_bf16_f32 v102, v72, v73
    v_cvt_pk_bf16_f32 v103, v74, v75
    v_cvt_pk_bf16_f32 v104, v52, v53
    v_cvt_pk_bf16_f32 v105, v54, v55
    v_cvt_pk_bf16_f32 v106, v60, v61
    v_cvt_pk_bf16_f32 v107, v62, v63
    v_cvt_pk_bf16_f32 v108, v68, v69
    v_cvt_pk_bf16_f32 v109, v70, v71
    v_cvt_pk_bf16_f32 v110, v76, v77
    v_cvt_pk_bf16_f32 v111, v78, v79
    v_mfma_f32_16x16x32_bf16 v[16:19], a[148:151], a[172:175], v[16:19]
    ds_read_b64_tr_b16 a[140:141], v6 offset:864
    ds_read_b64_tr_b16 a[142:143], v6 offset:992
    v_mul_f32 v246, 0x3db8aa3b, v246
    v_mul_f32 v247, 0x3db8aa3b, v247
    v_mfma_f32_16x16x32_bf16 v[20:23], a[144:147], a[184:187], v[20:23]
    v_cvt_pk_bf16_f32 v176, v240, v241
    v_cvt_pk_bf16_f32 v177, v242, v243
    v_mfma_f32_16x16x32_bf16 v[20:23], a[148:151], a[188:191], v[20:23]
    s_waitcnt lgkmcnt(10)
    v_cvt_pk_bf16_f32 v178, v244, v245
    v_cvt_pk_bf16_f32 v179, v246, v247
    v_mfma_f32_16x16x32_bf16 v[24:27], a[152:155], a[168:171], v[24:27]
    s_waitcnt lgkmcnt(8)
    ds_read_b64_tr_b16 a[144:145], v6 offset:16896
    ds_read_b64_tr_b16 a[146:147], v6 offset:17024
    v_permlane32_swap_b32 v176, v178
    v_permlane32_swap_b32 v177, v179
    s_nop 0
    v_permlane16_swap_b32 v176, v178
    v_mfma_f32_16x16x32_bf16 v[24:27], a[156:159], a[172:175], v[24:27]
    s_add_u32 s58, s53, 0x1400
    ds_read_b64_tr_b16 a[148:149], v6 offset:17152
    ds_read_b64_tr_b16 a[150:151], v6 offset:17280
    v_permlane16_swap_b32 v177, v179
    v_accvgpr_read_b32 v248, a84
    v_mfma_f32_16x16x32_bf16 v[28:31], a[152:155], a[184:187], v[28:31]
    buffer_store_dwordx4 v[116:119], v11, s[36:39], s58 offen sc1
    v_accvgpr_read_b32 v249, a85
    v_accvgpr_read_b32 v250, a86
    v_mfma_f32_16x16x32_bf16 v[28:31], a[156:159], a[188:191], v[28:31]
    s_waitcnt lgkmcnt(10)
    v_accvgpr_read_b32 v251, a87
    v_accvgpr_read_b32 v252, a92
    v_mfma_f32_16x16x32_bf16 v[32:35], a[128:131], a[168:171], v[32:35]
    s_waitcnt lgkmcnt(8)
    ds_read_b64_tr_b16 a[152:153], v6 offset:16928
    ds_read_b64_tr_b16 a[154:155], v6 offset:17056
    v_accvgpr_read_b32 v253, a93
    v_accvgpr_read_b32 v254, a94
    v_mfma_f32_16x16x32_bf16 v[32:35], a[132:135], a[172:175], v[32:35]
    ds_read_b64_tr_b16 a[156:157], v6 offset:17184
    ds_read_b64_tr_b16 a[158:159], v6 offset:17312
    v_accvgpr_read_b32 v255, a95
    v_mul_f32 v248, 0x3db8aa3b, v248
    v_mfma_f32_16x16x32_bf16 v[36:39], a[128:131], a[184:187], v[36:39]
    v_mul_f32 v249, 0x3db8aa3b, v249
    v_mul_f32 v250, 0x3db8aa3b, v250
    v_mfma_f32_16x16x32_bf16 v[36:39], a[132:135], a[188:191], v[36:39]
    s_waitcnt lgkmcnt(10)
    v_mul_f32 v251, 0x3db8aa3b, v251
    v_mul_f32 v252, 0x3db8aa3b, v252
    v_mul_f32 v253, 0x3db8aa3b, v253
    v_mfma_f32_16x16x32_bf16 v[40:43], a[136:139], a[168:171], v[40:43]
    s_waitcnt lgkmcnt(8)
    ds_read_b64_tr_b16 a[128:129], v6 offset:16960
    ds_read_b64_tr_b16 a[130:131], v6 offset:17088
    v_mul_f32 v254, 0x3db8aa3b, v254
    v_mul_f32 v255, 0x3db8aa3b, v255
    v_mfma_f32_16x16x32_bf16 v[40:43], a[140:143], a[172:175], v[40:43]
    ds_read_b64_tr_b16 a[132:133], v6 offset:17216
    ds_read_b64_tr_b16 a[134:135], v6 offset:17344
    v_cvt_pk_bf16_f32 v180, v248, v249
    v_cvt_pk_bf16_f32 v181, v250, v251
    v_mfma_f32_16x16x32_bf16 v[44:47], a[136:139], a[184:187], v[44:47]
    s_add_u32 s59, s53, 0x3000
    v_cvt_pk_bf16_f32 v182, v252, v253
    v_cvt_pk_bf16_f32 v183, v254, v255
    v_mfma_f32_16x16x32_bf16 v[44:47], a[140:143], a[188:191], v[44:47]
    s_waitcnt lgkmcnt(10)
    v_permlane32_swap_b32 v180, v182
    v_permlane32_swap_b32 v181, v183
    v_mfma_f32_16x16x32_bf16 v[48:51], a[144:147], a[160:163], 0
    s_waitcnt lgkmcnt(8)
    ds_read_b64_tr_b16 a[136:137], v6 offset:16992
    ds_read_b64_tr_b16 a[138:139], v6 offset:17120
    v_permlane16_swap_b32 v180, v182
    v_permlane16_swap_b32 v181, v183
    v_mfma_f32_16x16x32_bf16 v[48:51], a[148:151], a[164:167], v[48:51]
    ds_read_b64_tr_b16 a[140:141], v6 offset:17248
    ds_read_b64_tr_b16 a[142:143], v6 offset:17376
    buffer_store_dwordx4 v[120:123], v11, s[36:39], s59 offen sc1
    v_accvgpr_read_b32 v240, a100
    v_accvgpr_read_b32 v241, a101
    v_mfma_f32_16x16x32_bf16 v[52:55], a[144:147], a[176:179], 0
    v_accvgpr_read_b32 v242, a102
    v_accvgpr_read_b32 v243, a103
    v_accvgpr_read_b32 v244, a108
    v_mfma_f32_16x16x32_bf16 v[52:55], a[148:151], a[180:183], v[52:55]
    s_waitcnt lgkmcnt(10)
    v_accvgpr_read_b32 v245, a109
    v_accvgpr_read_b32 v246, a110
    v_mfma_f32_16x16x32_bf16 v[56:59], a[152:155], a[160:163], 0
    s_waitcnt lgkmcnt(8)
    ds_read_b64_tr_b16 a[144:145], v6 offset:17408
    ds_read_b64_tr_b16 a[146:147], v6 offset:17536
    v_accvgpr_read_b32 v247, a111
    v_mul_f32 v240, 0x3db8aa3b, v240
    v_mfma_f32_16x16x32_bf16 v[56:59], a[156:159], a[164:167], v[56:59]
    ds_read_b64_tr_b16 a[148:149], v6 offset:17664
    ds_read_b64_tr_b16 a[150:151], v6 offset:17792
    v_mul_f32 v241, 0x3db8aa3b, v241
    v_mul_f32 v242, 0x3db8aa3b, v242
    v_mfma_f32_16x16x32_bf16 v[60:63], a[152:155], a[176:179], 0
    v_mul_f32 v243, 0x3db8aa3b, v243
    v_mul_f32 v244, 0x3db8aa3b, v244
    v_mfma_f32_16x16x32_bf16 v[60:63], a[156:159], a[180:183], v[60:63]
    s_waitcnt lgkmcnt(10)
    v_mul_f32 v245, 0x3db8aa3b, v245
    v_mul_f32 v246, 0x3db8aa3b, v246
    v_mfma_f32_16x16x32_bf16 v[64:67], a[128:131], a[160:163], 0
    s_waitcnt lgkmcnt(8)
    ds_read_b64_tr_b16 a[152:153], v6 offset:17440
    ds_read_b64_tr_b16 a[154:155], v6 offset:17568
    v_mul_f32 v247, 0x3db8aa3b, v247
    v_cvt_pk_bf16_f32 v184, v240, v241
    v_mfma_f32_16x16x32_bf16 v[64:67], a[132:135], a[164:167], v[64:67]
    ds_read_b64_tr_b16 a[156:157], v6 offset:17696
    ds_read_b64_tr_b16 a[158:159], v6 offset:17824
    v_cvt_pk_bf16_f32 v185, v242, v243
    v_cvt_pk_bf16_f32 v186, v244, v245
    v_cvt_pk_bf16_f32 v187, v246, v247
    v_mfma_f32_16x16x32_bf16 v[68:71], a[128:131], a[176:179], 0
    v_permlane32_swap_b32 v184, v186
    v_permlane32_swap_b32 v185, v187
    v_mfma_f32_16x16x32_bf16 v[68:71], a[132:135], a[180:183], v[68:71]
    s_waitcnt lgkmcnt(10)
    s_add_u32 s60, s53, 0x3400
    v_permlane16_swap_b32 v184, v186
    v_permlane16_swap_b32 v185, v187
    v_mfma_f32_16x16x32_bf16 v[72:75], a[136:139], a[160:163], 0
    s_waitcnt lgkmcnt(8)
    ds_read_b64_tr_b16 a[128:129], v6 offset:17472
    ds_read_b64_tr_b16 a[130:131], v6 offset:17600
    buffer_store_dwordx4 v[124:127], v11, s[36:39], s60 offen sc1
    v_accvgpr_read_b32 v248, a116
    v_accvgpr_read_b32 v249, a117
    v_mfma_f32_16x16x32_bf16 v[72:75], a[140:143], a[164:167], v[72:75]
    ds_read_b64_tr_b16 a[132:133], v6 offset:17728
    ds_read_b64_tr_b16 a[134:135], v6 offset:17856
    v_accvgpr_read_b32 v250, a118
    v_accvgpr_read_b32 v251, a119
    v_mfma_f32_16x16x32_bf16 v[76:79], a[136:139], a[176:179], 0
    v_accvgpr_read_b32 v252, a124
    v_accvgpr_read_b32 v253, a125
    v_mfma_f32_16x16x32_bf16 v[76:79], a[140:143], a[180:183], v[76:79]
    s_waitcnt lgkmcnt(10)
    v_accvgpr_read_b32 v254, a126
    v_accvgpr_read_b32 v255, a127
    v_mfma_f32_16x16x32_bf16 v[48:51], a[144:147], a[168:171], v[48:51]
    s_waitcnt lgkmcnt(8)
    ds_read_b64_tr_b16 a[136:137], v6 offset:17504
    ds_read_b64_tr_b16 a[138:139], v6 offset:17632
    v_mul_f32 v248, 0x3db8aa3b, v248
    v_mul_f32 v249, 0x3db8aa3b, v249
    v_mul_f32 v250, 0x3db8aa3b, v250
    v_cvt_pk_bf16_f32 v80, v16, v17
    v_cvt_pk_bf16_f32 v81, v18, v19
    v_cvt_pk_bf16_f32 v82, v24, v25
    v_cvt_pk_bf16_f32 v83, v26, v27
    v_cvt_pk_bf16_f32 v84, v32, v33
    v_cvt_pk_bf16_f32 v85, v34, v35
    v_cvt_pk_bf16_f32 v86, v40, v41
    v_cvt_pk_bf16_f32 v87, v42, v43
    v_cvt_pk_bf16_f32 v88, v20, v21
    v_cvt_pk_bf16_f32 v89, v22, v23
    v_cvt_pk_bf16_f32 v90, v28, v29
    v_cvt_pk_bf16_f32 v91, v30, v31
    v_cvt_pk_bf16_f32 v92, v36, v37
    v_cvt_pk_bf16_f32 v93, v38, v39
    v_cvt_pk_bf16_f32 v94, v44, v45
    v_cvt_pk_bf16_f32 v95, v46, v47
    v_mfma_f32_16x16x32_bf16 v[48:51], a[148:151], a[172:175], v[48:51]
    ds_read_b64_tr_b16 a[140:141], v6 offset:17760
    ds_read_b64_tr_b16 a[142:143], v6 offset:17888
    v_mul_f32 v251, 0x3db8aa3b, v251
    v_mul_f32 v252, 0x3db8aa3b, v252
    v_mfma_f32_16x16x32_bf16 v[52:55], a[144:147], a[184:187], v[52:55]
    v_mul_f32 v253, 0x3db8aa3b, v253
    v_mul_f32 v254, 0x3db8aa3b, v254
    v_mfma_f32_16x16x32_bf16 v[52:55], a[148:151], a[188:191], v[52:55]
    s_waitcnt lgkmcnt(10)
    s_waitcnt vmcnt(20) lgkmcnt(0)
    s_barrier
    v_mul_f32 v255, 0x3db8aa3b, v255
    v_cvt_pk_bf16_f32 v188, v248, v249
    v_mfma_f32_16x16x32_bf16 v[56:59], a[152:155], a[168:171], v[56:59]
    v_cvt_pk_bf16_f32 v189, v250, v251
    v_cvt_pk_bf16_f32 v190, v252, v253
    v_mfma_f32_16x16x32_bf16 v[56:59], a[156:159], a[172:175], v[56:59]
    ds_read_b64_tr_b16 a[144:145], v7
    ds_read_b64_tr_b16 a[146:147], v7 offset:128
    ds_read_b64_tr_b16 a[148:149], v7 offset:256
    ds_read_b64_tr_b16 a[150:151], v7 offset:384
    v_cvt_pk_bf16_f32 v191, v254, v255
    v_permlane32_swap_b32 v188, v190
    v_mfma_f32_16x16x32_bf16 v[60:63], a[152:155], a[184:187], v[60:63]
    s_add_u32 s57, s53, 0x1800
    v_permlane32_swap_b32 v189, v191
    v_permlane16_swap_b32 v188, v190
    v_mfma_f32_16x16x32_bf16 v[60:63], a[156:159], a[188:191], v[60:63]
    buffer_store_dwordx4 v[96:99], v11, s[36:39], s57 offen sc1
    v_permlane16_swap_b32 v189, v191
    v_mfma_f32_16x16x32_bf16 v[64:67], a[128:131], a[168:171], v[64:67]
    ds_read_b64_tr_b16 a[152:153], v7 offset:32
    ds_read_b64_tr_b16 a[154:155], v7 offset:160
    v_mfma_f32_16x16x32_bf16 v[64:67], a[132:135], a[172:175], v[64:67]
    ds_read_b64_tr_b16 a[156:157], v7 offset:288
    ds_read_b64_tr_b16 a[158:159], v7 offset:416
    v_mfma_f32_16x16x32_bf16 v[68:71], a[128:131], a[184:187], v[68:71]
    ds_read_b64_tr_b16 a[128:129], v7 offset:64
    ds_read_b64_tr_b16 a[130:131], v7 offset:192
    v_mfma_f32_16x16x32_bf16 v[68:71], a[132:135], a[188:191], v[68:71]
    ds_read_b64_tr_b16 a[132:133], v7 offset:320
    ds_read_b64_tr_b16 a[134:135], v7 offset:448
    v_mfma_f32_16x16x32_bf16 v[72:75], a[136:139], a[168:171], v[72:75]
    ds_write_b128 v12, v[128:131]
    v_mfma_f32_16x16x32_bf16 v[72:75], a[140:143], a[172:175], v[72:75]
    ds_write_b128 v12, v[132:135] offset:1024
    v_mfma_f32_16x16x32_bf16 v[76:79], a[136:139], a[184:187], v[76:79]
    ds_read_b64_tr_b16 a[136:137], v7 offset:96
    s_waitcnt lgkmcnt(12)
    ds_read_b64_tr_b16 a[138:139], v7 offset:224
    v_mfma_f32_16x16x32_bf16 v[76:79], a[140:143], a[188:191], v[76:79]
    ds_read_b64_tr_b16 a[140:141], v7 offset:352
    ds_read_b64_tr_b16 a[142:143], v7 offset:480
    v_mfma_f32_16x16x32_bf16 v[16:19], a[144:147], a[160:163], 0
    s_waitcnt lgkmcnt(14)
    s_add_u32 s58, s53, 0x1c00
    v_mfma_f32_16x16x32_bf16 v[16:19], a[148:151], a[164:167], v[16:19]
    buffer_store_dwordx4 v[100:103], v11, s[36:39], s58 offen sc1
    v_mfma_f32_16x16x32_bf16 v[20:23], a[144:147], a[176:179], 0
    ds_read_b64_tr_b16 a[144:145], v7 offset:512
    s_waitcnt lgkmcnt(12)
    ds_read_b64_tr_b16 a[146:147], v7 offset:640
    v_mfma_f32_16x16x32_bf16 v[20:23], a[148:151], a[180:183], v[20:23]
    ds_read_b64_tr_b16 a[148:149], v7 offset:768
    ds_read_b64_tr_b16 a[150:151], v7 offset:896
    v_mfma_f32_16x16x32_bf16 v[24:27], a[152:155], a[160:163], 0
    s_waitcnt lgkmcnt(14)
    v_cvt_pk_bf16_f32 v112, v48, v49
    v_cvt_pk_bf16_f32 v113, v50, v51
    v_mfma_f32_16x16x32_bf16 v[24:27], a[156:159], a[164:167], v[24:27]
    v_cvt_pk_bf16_f32 v114, v56, v57
    v_cvt_pk_bf16_f32 v115, v58, v59
    v_mfma_f32_16x16x32_bf16 v[28:31], a[152:155], a[176:179], 0
    ds_read_b64_tr_b16 a[152:153], v7 offset:544
    s_waitcnt lgkmcnt(12)
    ds_read_b64_tr_b16 a[154:155], v7 offset:672
    v_mfma_f32_16x16x32_bf16 v[28:31], a[156:159], a[180:183], v[28:31]
    ds_read_b64_tr_b16 a[156:157], v7 offset:800
    ds_read_b64_tr_b16 a[158:159], v7 offset:928
    v_mfma_f32_16x16x32_bf16 v[32:35], a[128:131], a[160:163], 0
    s_waitcnt lgkmcnt(14)
    v_cvt_pk_bf16_f32 v116, v64, v65
    v_cvt_pk_bf16_f32 v117, v66, v67
    v_mfma_f32_16x16x32_bf16 v[32:35], a[132:135], a[164:167], v[32:35]
    v_cvt_pk_bf16_f32 v118, v72, v73
    v_cvt_pk_bf16_f32 v119, v74, v75
    v_mfma_f32_16x16x32_bf16 v[36:39], a[128:131], a[176:179], 0
    s_add_u32 s59, s53, 0x3800
    ds_read_b64_tr_b16 a[128:129], v7 offset:576
    s_waitcnt lgkmcnt(12)
    ds_read_b64_tr_b16 a[130:131], v7 offset:704
    v_mfma_f32_16x16x32_bf16 v[36:39], a[132:135], a[180:183], v[36:39]
    s_waitcnt lgkmcnt(12)
    ds_read_b64_tr_b16 a[132:133], v7 offset:832
    ds_read_b64_tr_b16 a[134:135], v7 offset:960
    v_mfma_f32_16x16x32_bf16 v[40:43], a[136:139], a[160:163], 0
    s_waitcnt lgkmcnt(12)
    buffer_store_dwordx4 v[104:107], v11, s[36:39], s59 offen sc1
    v_mfma_f32_16x16x32_bf16 v[40:43], a[140:143], a[164:167], v[40:43]
    v_cvt_pk_bf16_f32 v120, v52, v53
    v_cvt_pk_bf16_f32 v121, v54, v55
    v_mfma_f32_16x16x32_bf16 v[44:47], a[136:139], a[176:179], 0
    ds_read_b64_tr_b16 a[136:137], v7 offset:608
    ds_read_b64_tr_b16 a[138:139], v7 offset:736
    v_mfma_f32_16x16x32_bf16 v[44:47], a[140:143], a[180:183], v[44:47]
    s_waitcnt lgkmcnt(12)
    v_cvt_pk_bf16_f32 v122, v60, v61
    v_cvt_pk_bf16_f32 v123, v62, v63
    v_mfma_f32_16x16x32_bf16 v[16:19], a[144:147], a[168:171], v[16:19]
    s_waitcnt lgkmcnt(10)
    v_cvt_pk_bf16_f32 v124, v68, v69
    v_cvt_pk_bf16_f32 v125, v70, v71
    v_cvt_pk_bf16_f32 v126, v76, v77
    v_cvt_pk_bf16_f32 v127, v78, v79
    v_mfma_f32_16x16x32_bf16 v[16:19], a[148:151], a[172:175], v[16:19]
    ds_read_b64_tr_b16 a[140:141], v7 offset:864
    ds_read_b64_tr_b16 a[142:143], v7 offset:992
    v_mfma_f32_16x16x32_bf16 v[20:23], a[144:147], a[184:187], v[20:23]
    ds_write_b128 v12, v[136:139] offset:2048
    v_mfma_f32_16x16x32_bf16 v[20:23], a[148:151], a[188:191], v[20:23]
    s_waitcnt lgkmcnt(11)
    ds_write_b128 v12, v[140:143] offset:3072
    v_mfma_f32_16x16x32_bf16 v[24:27], a[152:155], a[168:171], v[24:27]
    s_waitcnt lgkmcnt(10)
    ds_write_b128 v12, v[144:147] offset:4096
    v_mfma_f32_16x16x32_bf16 v[24:27], a[156:159], a[172:175], v[24:27]
    s_add_u32 s60, s53, 0x3c00
    ds_write_b128 v12, v[148:151] offset:5120
    v_mfma_f32_16x16x32_bf16 v[28:31], a[152:155], a[184:187], v[28:31]
    buffer_store_dwordx4 v[108:111], v11, s[36:39], s60 offen sc1
    v_mfma_f32_16x16x32_bf16 v[28:31], a[156:159], a[188:191], v[28:31]
    s_waitcnt lgkmcnt(10)
    ds_write_b128 v12, v[152:155] offset:6144
    v_mfma_f32_16x16x32_bf16 v[32:35], a[128:131], a[168:171], v[32:35]
    s_waitcnt lgkmcnt(9)
    ds_write_b128 v12, v[156:159] offset:7168
    v_mfma_f32_16x16x32_bf16 v[32:35], a[132:135], a[172:175], v[32:35]
    ds_write_b128 v12, v[160:163] offset:8192
    v_mfma_f32_16x16x32_bf16 v[36:39], a[128:131], a[184:187], v[36:39]
    ds_write_b128 v12, v[164:167] offset:9216
    v_mfma_f32_16x16x32_bf16 v[36:39], a[132:135], a[188:191], v[36:39]
    s_waitcnt lgkmcnt(10)
    ds_write_b128 v12, v[168:171] offset:10240
    v_mfma_f32_16x16x32_bf16 v[40:43], a[136:139], a[168:171], v[40:43]
    s_waitcnt lgkmcnt(9)
    ds_write_b128 v12, v[172:175] offset:11264
    v_mfma_f32_16x16x32_bf16 v[40:43], a[140:143], a[172:175], v[40:43]
    ds_write_b128 v12, v[176:179] offset:12288
    v_mfma_f32_16x16x32_bf16 v[44:47], a[136:139], a[184:187], v[44:47]
    ds_write_b128 v12, v[180:183] offset:13312
    v_mfma_f32_16x16x32_bf16 v[44:47], a[140:143], a[188:191], v[44:47]
    ds_write_b128 v12, v[184:187] offset:14336
    ds_write_b128 v12, v[188:191] offset:15360
    v_cvt_pk_bf16_f32 v96, v16, v17
    v_cvt_pk_bf16_f32 v97, v18, v19
    v_cvt_pk_bf16_f32 v98, v24, v25
    v_cvt_pk_bf16_f32 v99, v26, v27
    v_cvt_pk_bf16_f32 v100, v32, v33
    v_cvt_pk_bf16_f32 v101, v34, v35
    v_cvt_pk_bf16_f32 v102, v40, v41
    v_cvt_pk_bf16_f32 v103, v42, v43
    v_cvt_pk_bf16_f32 v104, v20, v21
    v_cvt_pk_bf16_f32 v105, v22, v23
    v_cvt_pk_bf16_f32 v106, v28, v29
    v_cvt_pk_bf16_f32 v107, v30, v31
    v_cvt_pk_bf16_f32 v108, v36, v37
    v_cvt_pk_bf16_f32 v109, v38, v39
    v_cvt_pk_bf16_f32 v110, v44, v45
    v_cvt_pk_bf16_f32 v111, v46, v47
    s_add_u32 s57, s54, 0
    buffer_store_dwordx4 v[80:83], v11, s[36:39], s57 offen sc1
    s_add_u32 s58, s54, 0x400
    buffer_store_dwordx4 v[84:87], v11, s[36:39], s58 offen sc1
    s_waitcnt lgkmcnt(0)
    s_barrier
    s_sub_u32 s57, 0x4200, s80
    s_sub_u32 s57, s57, s80
    v_add_u32 v12, s57, v12
    ds_read_b128 v[192:195], v12
    ds_read_b128 v[196:199], v12 offset:1024
    ds_read_b128 v[200:203], v12 offset:2048
    ds_read_b128 v[204:207], v12 offset:3072
    ds_read_b128 v[208:211], v12 offset:4096
    ds_read_b128 v[212:215], v12 offset:5120
    ds_read_b128 v[216:219], v12 offset:6144
    ds_read_b128 v[220:223], v12 offset:7168
    ds_read_b128 v[224:227], v12 offset:8192
    ds_read_b128 v[228:231], v12 offset:9216
    ds_read_b128 v[232:235], v12 offset:10240
    ds_read_b128 v[236:239], v12 offset:11264
    ds_read_b128 v[240:243], v12 offset:12288
    ds_read_b128 v[244:247], v12 offset:13312
    ds_read_b128 v[248:251], v12 offset:14336
    s_waitcnt lgkmcnt(12)
    ds_read_b128 v[252:255], v12 offset:15360
    buffer_load_dwordx4 v3, s[12:15], s47 offen lds
    s_add_u32 m0, m0, 0x220
    s_nop 0
    buffer_load_dwordx4 v3, s[12:15], s47 offen offset:512 lds
    s_add_u32 m0, m0, 0x220
    s_nop 0
    buffer_load_dwordx4 v3, s[12:15], s47 offen offset:1024 lds
    s_add_u32 m0, m0, 0x220
    s_nop 0
    buffer_load_dwordx4 v3, s[12:15], s47 offen offset:1536 lds
    s_add_u32 m0, m0, 0x220
    s_nop 0
    buffer_load_dwordx4 v3, s[12:15], s47 offen offset:2048 lds
    s_add_u32 m0, m0, 0x220
    s_nop 0
    buffer_load_dwordx4 v3, s[12:15], s47 offen offset:2560 lds
    s_add_u32 m0, m0, 0x220
    s_nop 0
    buffer_load_dwordx4 v3, s[12:15], s47 offen offset:3072 lds
    s_add_u32 m0, m0, 0x220
    s_nop 0
    buffer_load_dwordx4 v3, s[12:15], s47 offen offset:3584 lds
    s_add_u32 m0, s45, 0x18c00
    s_add_u32 s47, s47, 0x8000
    v_subrev_u32 v14, 0x10800, v1
    v_add_u32 v15, 0x10800, v2
    v_lshrrev_b32 v9, 2, v0
    v_lshlrev_b32 v9, 7, v9
    v_and_b32 v10, 3, v0
    v_lshl_add_u32 v9, v10, 2, v9
    v_mov_b32 v4, 0
    v_mov_b32 v5, 0
    v_mov_b32 v6, 0
    v_mov_b32 v7, 0
    s_mov_b32 s46, 13
    s_add_u32 s59, s54, 0x1800
    buffer_store_dwordx4 v[88:91], v11, s[36:39], s59 offen sc1
    s_add_u32 s60, s54, 0x1c00
    buffer_store_dwordx4 v[92:95], v11, s[36:39], s60 offen sc1
    s_waitcnt vmcnt(22) lgkmcnt(0)
    s_barrier
    ds_read_b128 v[16:19], v14 offset:33792
    ds_read_b128 v[20:23], v14 offset:33856
    ds_read_b128 v[24:27], v14 offset:33920
    ds_read_b128 v[28:31], v14 offset:33984
    ds_read_b128 v[32:35], v14 offset:34048
    s_waitcnt lgkmcnt(4)
    v_mfma_f32_16x16x32_bf16 v[64:67], v[16:19], v[128:131], 0
    s_waitcnt lgkmcnt(3)
    ds_read_b128 v[36:39], v14 offset:34112
    v_mfma_f32_16x16x32_bf16 v[64:67], v[20:23], v[132:135], v[64:67]
    buffer_load_dwordx4 v3, s[12:15], s47 offen lds
    v_mfma_f32_16x16x32_bf16 v[72:75], v[16:19], v[160:163], 0
    s_add_u32 m0, m0, 0x220
    v_mfma_f32_16x16x32_bf16 v[72:75], v[20:23], v[164:167], v[72:75]
    s_add_u32 s57, s54, 0x800
    v_mfma_f32_16x16x32_bf16 v[80:83], v[16:19], v[192:195], 0
    buffer_store_dwordx4 v[112:115], v11, s[36:39], s57 offen sc1
    v_mfma_f32_16x16x32_bf16 v[80:83], v[20:23], v[196:199], v[80:83]
    v_mfma_f32_16x16x32_bf16 v[88:91], v[16:19], v[224:227], 0
    ds_read_b128 v[16:19], v14 offset:34176
    v_mfma_f32_16x16x32_bf16 v[88:91], v[20:23], v[228:231], v[88:91]
    s_waitcnt lgkmcnt(4)
    ds_read_b128 v[20:23], v14 offset:34240
    v_mfma_f32_16x16x32_bf16 v[88:91], v[24:27], v[232:235], v[88:91]
    s_waitcnt lgkmcnt(4)
    buffer_load_dwordx4 v3, s[12:15], s47 offen offset:512 lds
    v_mfma_f32_16x16x32_bf16 v[88:91], v[28:31], v[236:239], v[88:91]
    s_add_u32 m0, m0, 0x220
    v_mfma_f32_16x16x32_bf16 v[80:83], v[24:27], v[200:203], v[80:83]
    v_mfma_f32_16x16x32_bf16 v[80:83], v[28:31], v[204:207], v[80:83]
    v_mfma_f32_16x16x32_bf16 v[72:75], v[24:27], v[168:171], v[72:75]
    buffer_load_dwordx4 v3, s[12:15], s47 offen offset:1024 lds
    v_mfma_f32_16x16x32_bf16 v[72:75], v[28:31], v[172:175], v[72:75]
    s_add_u32 m0, m0, 0x220
    v_mfma_f32_16x16x32_bf16 v[64:67], v[24:27], v[136:139], v[64:67]
    ds_read_b128 v[24:27], v14 offset:34304
    v_mfma_f32_16x16x32_bf16 v[64:67], v[28:31], v[140:143], v[64:67]
    s_waitcnt lgkmcnt(4)
    ds_read_b128 v[28:31], v14 offset:34368
    v_mfma_f32_16x16x32_bf16 v[64:67], v[32:35], v[144:147], v[64:67]
    s_waitcnt lgkmcnt(4)
    v_mfma_f32_16x16x32_bf16 v[64:67], v[36:39], v[148:151], v[64:67]
    v_mfma_f32_16x16x32_bf16 v[72:75], v[32:35], v[176:179], v[72:75]
    buffer_load_dwordx4 v3, s[12:15], s47 offen offset:1536 lds
    v_mfma_f32_16x16x32_bf16 v[72:75], v[36:39], v[180:183], v[72:75]
    s_add_u32 s58, s54, 0xc00
    s_add_u32 m0, m0, 0x220
    v_mfma_f32_16x16x32_bf16 v[80:83], v[32:35], v[208:211], v[80:83]
    buffer_store_dwordx4 v[116:119], v11, s[36:39], s58 offen sc1
    v_mfma_f32_16x16x32_bf16 v[80:83], v[36:39], v[212:215], v[80:83]
    v_mfma_f32_16x16x32_bf16 v[88:91], v[32:35], v[240:243], v[88:91]
    ds_read_b128 v[32:35], v14 offset:34432
    v_mfma_f32_16x16x32_bf16 v[88:91], v[36:39], v[244:247], v[88:91]
    s_waitcnt lgkmcnt(4)
    v_mfma_f32_16x16x32_bf16 v[88:91], v[16:19], v[248:251], v[88:91]
    s_waitcnt lgkmcnt(3)
    buffer_load_dwordx4 v3, s[12:15], s47 offen offset:2048 lds
    v_mfma_f32_16x16x32_bf16 v[88:91], v[20:23], v[252:255], v[88:91]
    s_add_u32 m0, m0, 0x220
    v_mfma_f32_16x16x32_bf16 v[80:83], v[16:19], v[216:219], v[80:83]
    v_mfma_f32_16x16x32_bf16 v[80:83], v[20:23], v[220:223], v[80:83]
    v_mfma_f32_16x16x32_bf16 v[72:75], v[16:19], v[184:187], v[72:75]
    v_mfma_f32_16x16x32_bf16 v[72:75], v[20:23], v[188:191], v[72:75]
    v_mfma_f32_16x16x32_bf16 v[64:67], v[16:19], v[152:155], v[64:67]
    ds_read_b128 v[16:19], v14 offset:34496
    v_mfma_f32_16x16x32_bf16 v[64:67], v[20:23], v[156:159], v[64:67]
    s_waitcnt lgkmcnt(3)
    ds_read_b128 v[20:23], v14 offset:34560
    v_mfma_f32_16x16x32_bf16 v[68:71], v[24:27], v[128:131], 0
    s_waitcnt lgkmcnt(3)
    buffer_load_dwordx4 v3, s[12:15], s47 offen offset:2560 lds
    v_mfma_f32_16x16x32_bf16 v[68:71], v[28:31], v[132:135], v[68:71]
    s_add_u32 m0, m0, 0x220
    v_mfma_f32_16x16x32_bf16 v[76:79], v[24:27], v[160:163], 0
    v_mfma_f32_16x16x32_bf16 v[76:79], v[28:31], v[164:167], v[76:79]
    s_add_u32 s59, s54, 0x2000
    v_mfma_f32_16x16x32_bf16 v[84:87], v[24:27], v[192:195], 0
    buffer_load_dwordx4 v3, s[12:15], s47 offen offset:3072 lds
    v_mfma_f32_16x16x32_bf16 v[84:87], v[28:31], v[196:199], v[84:87]
    s_add_u32 m0, m0, 0x220
    buffer_store_dwordx4 v[120:123], v11, s[36:39], s59 offen sc1
    v_mfma_f32_16x16x32_bf16 v[92:95], v[24:27], v[224:227], 0
    ds_read_b128 v[24:27], v14 offset:34624
    v_mfma_f32_16x16x32_bf16 v[92:95], v[28:31], v[228:231], v[92:95]
    s_waitcnt lgkmcnt(3)
    ds_read_b128 v[28:31], v14 offset:34688
    v_mfma_f32_16x16x32_bf16 v[92:95], v[32:35], v[232:235], v[92:95]
    s_waitcnt lgkmcnt(3)
    v_mfma_f32_16x16x32_bf16 v[92:95], v[16:19], v[236:239], v[92:95]
    v_mfma_f32_16x16x32_bf16 v[84:87], v[32:35], v[200:203], v[84:87]
    buffer_load_dwordx4 v3, s[12:15], s47 offen offset:3584 lds
    v_mfma_f32_16x16x32_bf16 v[84:87], v[16:19], v[204:207], v[84:87]
    s_add_u32 m0, s45, 0x8400
    s_add_u32 s47, s47, 0x8000
    v_mfma_f32_16x16x32_bf16 v[76:79], v[32:35], v[168:171], v[76:79]
    v_mfma_f32_16x16x32_bf16 v[76:79], v[16:19], v[172:175], v[76:79]
    v_mfma_f32_16x16x32_bf16 v[68:71], v[32:35], v[136:139], v[68:71]
    ds_read_b128 v[32:35], v14 offset:34752
    v_mfma_f32_16x16x32_bf16 v[68:71], v[16:19], v[140:143], v[68:71]
    s_waitcnt lgkmcnt(3)
    v_mfma_f32_16x16x32_bf16 v[68:71], v[20:23], v[144:147], v[68:71]
    s_waitcnt lgkmcnt(2)
    v_mfma_f32_16x16x32_bf16 v[68:71], v[24:27], v[148:151], v[68:71]
    v_mfma_f32_16x16x32_bf16 v[76:79], v[20:23], v[176:179], v[76:79]
    s_waitcnt vmcnt(13) lgkmcnt(0)
    s_barrier
    ds_read_b128 v[16:19], v1
    v_mfma_f32_16x16x32_bf16 v[76:79], v[24:27], v[180:183], v[76:79]
    s_add_u32 s60, s54, 0x2400
    v_mfma_f32_16x16x32_bf16 v[84:87], v[20:23], v[208:211], v[84:87]
    buffer_store_dwordx4 v[124:127], v11, s[36:39], s60 offen sc1
    v_mfma_f32_16x16x32_bf16 v[84:87], v[24:27], v[212:215], v[84:87]
    v_mfma_f32_16x16x32_bf16 v[92:95], v[20:23], v[240:243], v[92:95]
    ds_read_b128 v[20:23], v1 offset:64
    v_mfma_f32_16x16x32_bf16 v[92:95], v[24:27], v[244:247], v[92:95]
    ds_read_b128 v[24:27], v1 offset:128
    v_mfma_f32_16x16x32_bf16 v[92:95], v[28:31], v[248:251], v[92:95]
    v_mfma_f32_16x16x32_bf16 v[92:95], v[32:35], v[252:255], v[92:95]
    v_mfma_f32_16x16x32_bf16 v[84:87], v[28:31], v[216:219], v[84:87]
    v_mfma_f32_16x16x32_bf16 v[84:87], v[32:35], v[220:223], v[84:87]
    v_mfma_f32_16x16x32_bf16 v[76:79], v[28:31], v[184:187], v[76:79]
    v_mfma_f32_16x16x32_bf16 v[76:79], v[32:35], v[188:191], v[76:79]
    v_mfma_f32_16x16x32_bf16 v[68:71], v[28:31], v[152:155], v[68:71]
    ds_read_b128 v[28:31], v1 offset:192
    v_mfma_f32_16x16x32_bf16 v[68:71], v[32:35], v[156:159], v[68:71]
    s_waitcnt lgkmcnt(3)
    ds_read_b128 v[32:35], v1 offset:256
    buffer_load_dwordx4 v3, s[16:19], s48 offen lds
    s_add_u32 m0, m0, 0x220
    s_nop 0
    buffer_load_dwordx4 v3, s[16:19], s48 offen offset:512 lds
    s_add_u32 m0, m0, 0x220
    s_nop 0
    buffer_load_dwordx4 v3, s[16:19], s48 offen offset:1024 lds
    s_add_u32 m0, m0, 0x220
    s_nop 0
    buffer_load_dwordx4 v3, s[16:19], s48 offen offset:1536 lds
    s_add_u32 m0, m0, 0x220
    s_nop 0
    buffer_load_dwordx4 v3, s[16:19], s48 offen offset:2048 lds
    s_add_u32 m0, m0, 0x220
    s_nop 0
    buffer_load_dwordx4 v3, s[16:19], s48 offen offset:2560 lds
    s_add_u32 m0, m0, 0x220
    s_nop 0
    buffer_load_dwordx4 v3, s[16:19], s48 offen offset:3072 lds
    s_add_u32 m0, m0, 0x220
    s_nop 0
    buffer_load_dwordx4 v3, s[16:19], s48 offen offset:3584 lds
    s_add_u32 m0, s45, 0
    s_add_u32 s48, s48, 0x8000
    v_max3_f32 v44, v64, v65, v66
    v_max3_f32 v44, v44, v67, v68
    v_max3_f32 v44, v44, v69, v70
    v_max_f32 v44, v44, v71
    v_mov_b32 v45, v44
    s_nop 1
    v_permlane16_swap_b32 v44, v45
    v_max_f32 v44, v44, v45
    v_mov_b32 v45, v44
    s_nop 1
    v_permlane32_swap_b32 v44, v45
    v_max_f32 v44, v44, v45
    v_sub_f32 v64, v64, v44
    v_sub_f32 v65, v65, v44
    v_sub_f32 v66, v66, v44
    v_sub_f32 v67, v67, v44
    v_sub_f32 v68, v68, v44
    v_sub_f32 v69, v69, v44
    v_sub_f32 v70, v70, v44
    v_sub_f32 v71, v71, v44
    v_sub_f32 v48, 0, v44
    v_sub_f32 v49, 0, v44
    v_sub_f32 v50, 0, v44
    v_sub_f32 v51, 0, v44
    v_max3_f32 v44, v72, v73, v74
    v_max3_f32 v44, v44, v75, v76
    v_max3_f32 v44, v44, v77, v78
    v_max_f32 v44, v44, v79
    v_mov_b32 v45, v44
    s_nop 1
    v_permlane16_swap_b32 v44, v45
    v_max_f32 v44, v44, v45
    v_mov_b32 v45, v44
    s_nop 1
    v_permlane32_swap_b32 v44, v45
    v_max_f32 v44, v44, v45
    v_sub_f32 v72, v72, v44
    v_sub_f32 v73, v73, v44
    v_sub_f32 v74, v74, v44
    v_sub_f32 v75, v75, v44
    v_sub_f32 v76, v76, v44
    v_sub_f32 v77, v77, v44
    v_sub_f32 v78, v78, v44
    v_sub_f32 v79, v79, v44
    v_sub_f32 v52, 0, v44
    v_sub_f32 v53, 0, v44
    v_sub_f32 v54, 0, v44
    v_sub_f32 v55, 0, v44
    s_add_u32 s57, s54, 0x1000
    buffer_store_dwordx4 v[96:99], v11, s[36:39], s57 offen sc1
    v_max3_f32 v44, v80, v81, v82
    v_max3_f32 v44, v44, v83, v84
    v_max3_f32 v44, v44, v85, v86
    v_max_f32 v44, v44, v87
    v_mov_b32 v45, v44
    s_nop 1
    v_permlane16_swap_b32 v44, v45
    v_max_f32 v44, v44, v45
    v_mov_b32 v45, v44
    s_nop 1
    v_permlane32_swap_b32 v44, v45
    v_max_f32 v44, v44, v45
    v_sub_f32 v80, v80, v44
    v_sub_f32 v81, v81, v44
    v_sub_f32 v82, v82, v44
    v_sub_f32 v83, v83, v44
    v_sub_f32 v84, v84, v44
    v_sub_f32 v85, v85, v44
    v_sub_f32 v86, v86, v44
    v_sub_f32 v87, v87, v44
    v_sub_f32 v56, 0, v44
    v_sub_f32 v57, 0, v44
    v_sub_f32 v58, 0, v44
    v_sub_f32 v59, 0, v44
    v_max3_f32 v44, v88, v89, v90
    v_max3_f32 v44, v44, v91, v92
    v_max3_f32 v44, v44, v93, v94
    v_max_f32 v44, v44, v95
    v_mov_b32 v45, v44
    s_nop 1
    v_permlane16_swap_b32 v44, v45
    v_max_f32 v44, v44, v45
    v_mov_b32 v45, v44
    s_nop 1
    v_permlane32_swap_b32 v44, v45
    v_max_f32 v44, v44, v45
    v_sub_f32 v88, v88, v44
    v_sub_f32 v89, v89, v44
    v_sub_f32 v90, v90, v44
    v_sub_f32 v91, v91, v44
    v_sub_f32 v92, v92, v44
    v_sub_f32 v93, v93, v44
    v_sub_f32 v94, v94, v44
    v_sub_f32 v95, v95, v44
    v_sub_f32 v60, 0, v44
    v_sub_f32 v61, 0, v44
    v_sub_f32 v62, 0, v44
    v_sub_f32 v63, 0, v44
    s_add_u32 s58, s54, 0x1400
    buffer_store_dwordx4 v[100:103], v11, s[36:39], s58 offen sc1
    s_add_u32 s59, s54, 0x2800
    buffer_store_dwordx4 v[104:107], v11, s[36:39], s59 offen sc1
    v_exp_f32 v64, v64
    v_exp_f32 v65, v65
    v_exp_f32 v66, v66
    v_add_f32 v4, v4, v64
    v_add_f32 v4, v4, v65
    v_exp_f32 v67, v67
    v_cvt_pk_bf16_f32 v64, v64, v65
    v_add_f32 v4, v4, v66
    v_add_f32 v4, v4, v67
    v_cvt_pk_bf16_f32 v65, v66, v67
    v_exp_f32 v68, v68
    v_exp_f32 v69, v69
    v_exp_f32 v70, v70
    s_add_u32 s60, s54, 0x2c00
    buffer_store_dwordx4 v[108:111], v11, s[36:39], s60 offen sc1
    v_add_f32 v4, v4, v68
    v_add_f32 v4, v4, v69
    v_exp_f32 v71, v71
    v_cvt_pk_bf16_f32 v66, v68, v69
    v_add_f32 v4, v4, v70
    v_add_f32 v4, v4, v71
    v_cvt_pk_bf16_f32 v67, v70, v71
    v_exp_f32 v72, v72
    v_exp_f32 v73, v73
    v_exp_f32 v74, v74
    v_add_f32 v5, v5, v72
    v_add_f32 v5, v5, v73
    v_exp_f32 v75, v75
    v_cvt_pk_bf16_f32 v72, v72, v73
    v_add_f32 v5, v5, v74
    v_add_f32 v5, v5, v75
    v_cvt_pk_bf16_f32 v73, v74, v75
    v_exp_f32 v76, v76
    v_exp_f32 v77, v77
    v_exp_f32 v78, v78
    v_add_f32 v5, v5, v76
    v_add_f32 v5, v5, v77
    v_exp_f32 v79, v79
    v_cvt_pk_bf16_f32 v74, v76, v77
    v_add_f32 v5, v5, v78
    v_add_f32 v5, v5, v79
    v_cvt_pk_bf16_f32 v75, v78, v79
    v_mfma_f32_16x16x32_bf16 v[96:99], v[16:19], v[128:131], v[48:51]
    s_waitcnt lgkmcnt(3)
    ds_read_b128 v[36:39], v1 offset:320
    v_mfma_f32_16x16x32_bf16 v[96:99], v[20:23], v[132:135], v[96:99]
    buffer_load_dwordx4 v3, s[16:19], s48 offen lds
    v_mfma_f32_16x16x32_bf16 v[104:107], v[16:19], v[160:163], v[52:55]
    s_add_u32 m0, m0, 0x220
    v_exp_f32 v80, v80
    v_mfma_f32_16x16x32_bf16 v[104:107], v[20:23], v[164:167], v[104:107]
    v_exp_f32 v81, v81
    v_mfma_f32_16x16x32_bf16 v[112:115], v[16:19], v[192:195], v[56:59]
    v_exp_f32 v82, v82
    v_mfma_f32_16x16x32_bf16 v[112:115], v[20:23], v[196:199], v[112:115]
    v_add_f32 v6, v6, v80
    v_add_f32 v6, v6, v81
    v_mfma_f32_16x16x32_bf16 v[120:123], v[16:19], v[224:227], v[60:63]
    ds_read_b128 v[16:19], v1 offset:384
    v_mfma_f32_16x16x32_bf16 v[120:123], v[20:23], v[228:231], v[120:123]
    s_waitcnt lgkmcnt(4)
    ds_read_b128 v[20:23], v1 offset:448
    v_mfma_f32_16x16x32_bf16 v[120:123], v[24:27], v[232:235], v[120:123]
    s_waitcnt lgkmcnt(4)
    buffer_load_dwordx4 v3, s[16:19], s48 offen offset:512 lds
    v_mfma_f32_16x16x32_bf16 v[120:123], v[28:31], v[236:239], v[120:123]
    s_add_u32 m0, m0, 0x220
    v_exp_f32 v83, v83
    v_mfma_f32_16x16x32_bf16 v[112:115], v[24:27], v[200:203], v[112:115]
    v_cvt_pk_bf16_f32 v80, v80, v81
    v_add_f32 v6, v6, v82
    v_mfma_f32_16x16x32_bf16 v[112:115], v[28:31], v[204:207], v[112:115]
    v_add_f32 v6, v6, v83
    v_cvt_pk_bf16_f32 v81, v82, v83
    v_mfma_f32_16x16x32_bf16 v[104:107], v[24:27], v[168:171], v[104:107]
    buffer_load_dwordx4 v3, s[16:19], s48 offen offset:1024 lds
    v_mfma_f32_16x16x32_bf16 v[104:107], v[28:31], v[172:175], v[104:107]
    s_add_u32 m0, m0, 0x220
    v_exp_f32 v84, v84
    v_mfma_f32_16x16x32_bf16 v[96:99], v[24:27], v[136:139], v[96:99]
    ds_read_b128 v[24:27], v1 offset:512
    v_mfma_f32_16x16x32_bf16 v[96:99], v[28:31], v[140:143], v[96:99]
    s_waitcnt lgkmcnt(4)
    ds_read_b128 v[28:31], v1 offset:576
    v_mfma_f32_16x16x32_bf16 v[96:99], v[32:35], v[144:147], v[96:99]
    s_waitcnt lgkmcnt(4)
    v_exp_f32 v85, v85
    v_mfma_f32_16x16x32_bf16 v[96:99], v[36:39], v[148:151], v[96:99]
    v_exp_f32 v86, v86
    v_mfma_f32_16x16x32_bf16 v[104:107], v[32:35], v[176:179], v[104:107]
    buffer_load_dwordx4 v3, s[16:19], s48 offen offset:1536 lds
    v_mfma_f32_16x16x32_bf16 v[104:107], v[36:39], v[180:183], v[104:107]
    s_add_u32 m0, m0, 0x220
    v_add_f32 v6, v6, v84
    v_add_f32 v6, v6, v85
    v_mfma_f32_16x16x32_bf16 v[112:115], v[32:35], v[208:211], v[112:115]
    v_exp_f32 v87, v87
    v_mfma_f32_16x16x32_bf16 v[112:115], v[36:39], v[212:215], v[112:115]
    v_cvt_pk_bf16_f32 v82, v84, v85
    v_add_f32 v6, v6, v86
    v_mfma_f32_16x16x32_bf16 v[120:123], v[32:35], v[240:243], v[120:123]
    ds_read_b128 v[32:35], v1 offset:640
    v_add_f32 v6, v6, v87
    v_mfma_f32_16x16x32_bf16 v[120:123], v[36:39], v[244:247], v[120:123]
    s_waitcnt lgkmcnt(4)
    v_cvt_pk_bf16_f32 v83, v86, v87
    v_mfma_f32_16x16x32_bf16 v[120:123], v[16:19], v[248:251], v[120:123]
    s_waitcnt lgkmcnt(3)
    buffer_load_dwordx4 v3, s[16:19], s48 offen offset:2048 lds
    v_mfma_f32_16x16x32_bf16 v[120:123], v[20:23], v[252:255], v[120:123]
    s_add_u32 m0, m0, 0x220
    v_exp_f32 v88, v88
    v_mfma_f32_16x16x32_bf16 v[112:115], v[16:19], v[216:219], v[112:115]
    v_exp_f32 v89, v89
    v_mfma_f32_16x16x32_bf16 v[112:115], v[20:23], v[220:223], v[112:115]
    v_exp_f32 v90, v90
    v_mfma_f32_16x16x32_bf16 v[104:107], v[16:19], v[184:187], v[104:107]
    v_add_f32 v7, v7, v88
    v_add_f32 v7, v7, v89
    v_mfma_f32_16x16x32_bf16 v[104:107], v[20:23], v[188:191], v[104:107]
    v_exp_f32 v91, v91
    v_mfma_f32_16x16x32_bf16 v[96:99], v[16:19], v[152:155], v[96:99]
    ds_read_b128 v[16:19], v1 offset:704
    v_cvt_pk_bf16_f32 v88, v88, v89
    v_mfma_f32_16x16x32_bf16 v[96:99], v[20:23], v[156:159], v[96:99]
    s_waitcnt lgkmcnt(3)
    ds_read_b128 v[20:23], v1 offset:768
    v_add_f32 v7, v7, v90
    v_mfma_f32_16x16x32_bf16 v[100:103], v[24:27], v[128:131], v[48:51]
    s_waitcnt lgkmcnt(3)
    buffer_load_dwordx4 v3, s[16:19], s48 offen offset:2560 lds
    v_mfma_f32_16x16x32_bf16 v[100:103], v[28:31], v[132:135], v[100:103]
    s_add_u32 m0, m0, 0x220
    v_add_f32 v7, v7, v91
    v_cvt_pk_bf16_f32 v89, v90, v91
    v_mfma_f32_16x16x32_bf16 v[108:111], v[24:27], v[160:163], v[52:55]
    v_exp_f32 v92, v92
    v_mfma_f32_16x16x32_bf16 v[108:111], v[28:31], v[164:167], v[108:111]
    v_exp_f32 v93, v93
    v_mfma_f32_16x16x32_bf16 v[116:119], v[24:27], v[192:195], v[56:59]
    buffer_load_dwordx4 v3, s[16:19], s48 offen offset:3072 lds
    v_mfma_f32_16x16x32_bf16 v[116:119], v[28:31], v[196:199], v[116:119]
    s_add_u32 m0, m0, 0x220
    v_exp_f32 v94, v94
    v_mfma_f32_16x16x32_bf16 v[124:127], v[24:27], v[224:227], v[60:63]
    ds_read_b128 v[24:27], v1 offset:832
    v_add_f32 v7, v7, v92
    v_mfma_f32_16x16x32_bf16 v[124:127], v[28:31], v[228:231], v[124:127]
    s_waitcnt lgkmcnt(3)
    ds_read_b128 v[28:31], v1 offset:896
    v_add_f32 v7, v7, v93
    v_mfma_f32_16x16x32_bf16 v[124:127], v[32:35], v[232:235], v[124:127]
    s_waitcnt lgkmcnt(3)
    v_exp_f32 v95, v95
    v_mfma_f32_16x16x32_bf16 v[124:127], v[16:19], v[236:239], v[124:127]
    v_cvt_pk_bf16_f32 v90, v92, v93
    v_add_f32 v7, v7, v94
    v_mfma_f32_16x16x32_bf16 v[116:119], v[32:35], v[200:203], v[116:119]
    buffer_load_dwordx4 v3, s[16:19], s48 offen offset:3584 lds
    v_mfma_f32_16x16x32_bf16 v[116:119], v[16:19], v[204:207], v[116:119]
    s_add_u32 m0, s45, 0x10800
    s_add_u32 s48, s48, 0x8000
    v_add_f32 v7, v7, v95
    v_mfma_f32_16x16x32_bf16 v[108:111], v[32:35], v[168:171], v[108:111]
    v_cvt_pk_bf16_f32 v91, v94, v95
    v_max3_f32 v8, v96, v97, v98
    v_mfma_f32_16x16x32_bf16 v[108:111], v[16:19], v[172:175], v[108:111]
    v_max3_f32 v8, v8, v99, v104
    v_max3_f32 v8, v8, v105, v106
    v_mfma_f32_16x16x32_bf16 v[100:103], v[32:35], v[136:139], v[100:103]
    ds_read_b128 v[32:35], v1 offset:960
    v_max3_f32 v8, v8, v107, v112
    v_mfma_f32_16x16x32_bf16 v[100:103], v[16:19], v[140:143], v[100:103]
    s_waitcnt lgkmcnt(3)
    v_max3_f32 v8, v8, v113, v114
    v_max3_f32 v8, v8, v115, v120
    v_mfma_f32_16x16x32_bf16 v[100:103], v[20:23], v[144:147], v[100:103]
    s_waitcnt lgkmcnt(2)
    v_max3_f32 v8, v8, v121, v122
    v_mfma_f32_16x16x32_bf16 v[100:103], v[24:27], v[148:151], v[100:103]
    v_mfma_f32_16x16x32_bf16 v[108:111], v[20:23], v[176:179], v[108:111]
    s_waitcnt vmcnt(12) lgkmcnt(0)
    s_barrier
    ds_read_b64_tr_b16 v[16:17], v2 offset:33792
    v_mfma_f32_16x16x32_bf16 v[108:111], v[24:27], v[180:183], v[108:111]
    ds_read_b64_tr_b16 v[18:19], v2 offset:34304
    v_mfma_f32_16x16x32_bf16 v[116:119], v[20:23], v[208:211], v[116:119]
    buffer_load_dwordx4 v3, s[12:15], s47 offen lds
    v_mfma_f32_16x16x32_bf16 v[116:119], v[24:27], v[212:215], v[116:119]
    s_add_u32 m0, m0, 0x220
    v_mfma_f32_16x16x32_bf16 v[124:127], v[20:23], v[240:243], v[124:127]
    ds_read_b64_tr_b16 v[20:21], v2 offset:33824
    ds_read_b64_tr_b16 v[22:23], v2 offset:34336
    v_mfma_f32_16x16x32_bf16 v[124:127], v[24:27], v[244:247], v[124:127]
    ds_read_b64_tr_b16 v[24:25], v2 offset:33856
    ds_read_b64_tr_b16 v[26:27], v2 offset:34368
    v_mfma_f32_16x16x32_bf16 v[124:127], v[28:31], v[248:251], v[124:127]
    buffer_load_dword v13, v9, s[92:95], s96 offen
    v_mfma_f32_16x16x32_bf16 v[124:127], v[32:35], v[252:255], v[124:127]
    s_add_u32 s96, s96, 0x10000
    v_mfma_f32_16x16x32_bf16 v[116:119], v[28:31], v[216:219], v[116:119]
    buffer_load_dwordx4 v3, s[12:15], s47 offen offset:512 lds
    v_mfma_f32_16x16x32_bf16 v[116:119], v[32:35], v[220:223], v[116:119]
    s_add_u32 m0, m0, 0x220
    v_mfma_f32_16x16x32_bf16 v[108:111], v[28:31], v[184:187], v[108:111]
    v_mfma_f32_16x16x32_bf16 v[108:111], v[32:35], v[188:191], v[108:111]
    v_mfma_f32_16x16x32_bf16 v[100:103], v[28:31], v[152:155], v[100:103]
    ds_read_b64_tr_b16 v[28:29], v2 offset:33888
    ds_read_b64_tr_b16 v[30:31], v2 offset:34400
    v_mfma_f32_16x16x32_bf16 v[100:103], v[32:35], v[156:159], v[100:103]
    s_waitcnt lgkmcnt(6)
    ds_read_b64_tr_b16 v[32:33], v2 offset:33920
    ds_read_b64_tr_b16 v[34:35], v2 offset:34432
    v_mfma_f32_16x16x32_bf16 a[0:3], v[16:19], v[64:67], 0
    ds_read_b64_tr_b16 v[36:37], v2 offset:33952
    ds_read_b64_tr_b16 v[38:39], v2 offset:34464
    v_mfma_f32_16x16x32_bf16 a[4:7], v[16:19], v[72:75], 0
    buffer_load_dwordx4 v3, s[12:15], s47 offen offset:1024 lds
    v_mfma_f32_16x16x32_bf16 a[8:11], v[16:19], v[80:83], 0
    s_add_u32 m0, m0, 0x220
    v_mfma_f32_16x16x32_bf16 a[12:15], v[16:19], v[88:91], 0
    s_waitcnt lgkmcnt(8)
    ds_read_b64_tr_b16 v[16:17], v2 offset:33984
    ds_read_b64_tr_b16 v[18:19], v2 offset:34496
    v_mfma_f32_16x16x32_bf16 a[16:19], v[20:23], v[64:67], 0
    v_max3_f32 v8, v8, v123, v100
    v_max3_f32 v8, v8, v101, v102
    v_mfma_f32_16x16x32_bf16 a[20:23], v[20:23], v[72:75], 0
    v_max3_f32 v8, v8, v103, v108
    v_max3_f32 v8, v8, v109, v110
    v_mfma_f32_16x16x32_bf16 a[24:27], v[20:23], v[80:83], 0
    v_max3_f32 v8, v8, v111, v116
    v_max3_f32 v8, v8, v117, v118
    v_mfma_f32_16x16x32_bf16 a[28:31], v[20:23], v[88:91], 0
    s_waitcnt lgkmcnt(8)
    ds_read_b64_tr_b16 v[20:21], v2 offset:34016
    ds_read_b64_tr_b16 v[22:23], v2 offset:34528
    v_mfma_f32_16x16x32_bf16 a[32:35], v[24:27], v[64:67], 0
    v_max3_f32 v8, v8, v119, v124
    v_max3_f32 v8, v8, v125, v126
    v_mfma_f32_16x16x32_bf16 a[36:39], v[24:27], v[72:75], 0
    buffer_load_dwordx4 v3, s[12:15], s47 offen offset:1536 lds
    v_mfma_f32_16x16x32_bf16 a[40:43], v[24:27], v[80:83], 0
    s_add_u32 m0, m0, 0x220
    v_max_f32 v8, v8, v127
    v_cmp_lt_f32 vcc, 0x41800000, v8
    v_mfma_f32_16x16x32_bf16 a[44:47], v[24:27], v[88:91], 0
    s_waitcnt lgkmcnt(8)
    ds_read_b64_tr_b16 v[24:25], v2 offset:34048
    ds_read_b64_tr_b16 v[26:27], v2 offset:34560
    v_mfma_f32_16x16x32_bf16 a[48:51], v[28:31], v[64:67], 0
    v_mfma_f32_16x16x32_bf16 a[52:55], v[28:31], v[72:75], 0
    v_mfma_f32_16x16x32_bf16 a[56:59], v[28:31], v[80:83], 0
    s_cbranch_vccnz L_stub_r1_p0
L_ret_r1_p0:
    v_exp_f32 v96, v96
    v_mfma_f32_16x16x32_bf16 a[60:63], v[28:31], v[88:91], 0
    s_waitcnt lgkmcnt(8)
    ds_read_b64_tr_b16 v[28:29], v2 offset:34080
    ds_read_b64_tr_b16 v[30:31], v2 offset:34592
    v_mfma_f32_16x16x32_bf16 a[64:67], v[32:35], v[64:67], 0
    buffer_load_dwordx4 v3, s[12:15], s47 offen offset:2048 lds
    v_mfma_f32_16x16x32_bf16 a[68:71], v[32:35], v[72:75], 0
    s_add_u32 m0, m0, 0x220
    v_exp_f32 v97, v97
    v_mfma_f32_16x16x32_bf16 a[72:75], v[32:35], v[80:83], 0
    v_exp_f32 v98, v98
    v_mfma_f32_16x16x32_bf16 a[76:79], v[32:35], v[88:91], 0
    s_waitcnt lgkmcnt(8)
    ds_read_b64_tr_b16 v[32:33], v2 offset:34112
    ds_read_b64_tr_b16 v[34:35], v2 offset:34624
    v_mfma_f32_16x16x32_bf16 a[80:83], v[36:39], v[64:67], 0
    v_add_f32 v4, v4, v96
    v_add_f32 v4, v4, v97
    v_mfma_f32_16x16x32_bf16 a[84:87], v[36:39], v[72:75], 0
    v_exp_f32 v99, v99
    v_mfma_f32_16x16x32_bf16 a[88:91], v[36:39], v[80:83], 0
    v_cvt_pk_bf16_f32 v96, v96, v97
    v_add_f32 v4, v4, v98
    v_mfma_f32_16x16x32_bf16 a[92:95], v[36:39], v[88:91], 0
    s_waitcnt lgkmcnt(8)
    buffer_load_dwordx4 v3, s[12:15], s47 offen offset:2560 lds
    v_mfma_f32_16x16x32_bf16 a[96:99], v[16:19], v[64:67], 0
    s_add_u32 m0, m0, 0x220
    v_add_f32 v4, v4, v99
    v_cvt_pk_bf16_f32 v97, v98, v99
    v_mfma_f32_16x16x32_bf16 a[100:103], v[16:19], v[72:75], 0
    v_exp_f32 v100, v100
    v_mfma_f32_16x16x32_bf16 a[104:107], v[16:19], v[80:83], 0
    v_exp_f32 v101, v101
    v_mfma_f32_16x16x32_bf16 a[108:111], v[16:19], v[88:91], 0
    s_waitcnt lgkmcnt(6)
    ds_read_b64_tr_b16 v[16:17], v2 offset:34144
    ds_read_b64_tr_b16 v[18:19], v2 offset:34656
    v_mfma_f32_16x16x32_bf16 a[112:115], v[20:23], v[64:67], 0
    v_exp_f32 v102, v102
    v_mfma_f32_16x16x32_bf16 a[116:119], v[20:23], v[72:75], 0
    v_add_f32 v4, v4, v100
    v_add_f32 v4, v4, v101
    v_mfma_f32_16x16x32_bf16 a[120:123], v[20:23], v[80:83], 0
    v_exp_f32 v103, v103
    v_mfma_f32_16x16x32_bf16 a[124:127], v[20:23], v[88:91], 0
    s_waitcnt lgkmcnt(6)
    ds_read_b64_tr_b16 v[20:21], v2 offset:34176
    ds_read_b64_tr_b16 v[22:23], v2 offset:34688
    v_mfma_f32_16x16x32_bf16 a[128:131], v[24:27], v[64:67], 0
    buffer_load_dwordx4 v3, s[12:15], s47 offen offset:3072 lds
    v_mfma_f32_16x16x32_bf16 a[132:135], v[24:27], v[72:75], 0
    s_add_u32 m0, m0, 0x220
    v_cvt_pk_bf16_f32 v98, v100, v101
    v_add_f32 v4, v4, v102
    v_mfma_f32_16x16x32_bf16 a[136:139], v[24:27], v[80:83], 0
    v_add_f32 v4, v4, v103
    v_cvt_pk_bf16_f32 v99, v102, v103
    v_mfma_f32_16x16x32_bf16 a[140:143], v[24:27], v[88:91], 0
    s_waitcnt lgkmcnt(6)
    ds_read_b64_tr_b16 v[24:25], v2 offset:34208
    ds_read_b64_tr_b16 v[26:27], v2 offset:34720
    v_mfma_f32_16x16x32_bf16 a[144:147], v[28:31], v[64:67], 0
    v_exp_f32 v104, v104
    v_mfma_f32_16x16x32_bf16 a[148:151], v[28:31], v[72:75], 0
    v_exp_f32 v105, v105
    v_mfma_f32_16x16x32_bf16 a[152:155], v[28:31], v[80:83], 0
    buffer_load_dwordx4 v3, s[12:15], s47 offen offset:3584 lds
    v_mfma_f32_16x16x32_bf16 a[156:159], v[28:31], v[88:91], 0
    s_waitcnt lgkmcnt(6)
    ds_read_b64_tr_b16 v[28:29], v2 offset:34240
    ds_read_b64_tr_b16 v[30:31], v2 offset:34752
    v_mfma_f32_16x16x32_bf16 a[160:163], v[32:35], v[64:67], 0
    s_add_u32 m0, s45, 0x8400
    s_add_u32 s47, s47, 0x8000
    v_mfma_f32_16x16x32_bf16 a[164:167], v[32:35], v[72:75], 0
    v_exp_f32 v106, v106
    v_mfma_f32_16x16x32_bf16 a[168:171], v[32:35], v[80:83], 0
    v_add_f32 v5, v5, v104
    v_add_f32 v5, v5, v105
    v_mfma_f32_16x16x32_bf16 a[172:175], v[32:35], v[88:91], 0
    s_waitcnt lgkmcnt(6)
    ds_read_b64_tr_b16 v[32:33], v2 offset:34272
    ds_read_b64_tr_b16 v[34:35], v2 offset:34784
    v_mfma_f32_16x16x32_bf16 a[176:179], v[16:19], v[64:67], 0
    v_exp_f32 v107, v107
    v_mfma_f32_16x16x32_bf16 a[180:183], v[16:19], v[72:75], 0
    v_cvt_pk_bf16_f32 v104, v104, v105
    v_add_f32 v5, v5, v106
    v_mfma_f32_16x16x32_bf16 a[184:187], v[16:19], v[80:83], 0
    v_add_f32 v5, v5, v107
    v_cvt_pk_bf16_f32 v105, v106, v107
    v_mfma_f32_16x16x32_bf16 a[188:191], v[16:19], v[88:91], 0
    s_waitcnt lgkmcnt(6)
    s_waitcnt vmcnt(17) lgkmcnt(0)
    s_barrier
    v_mfma_f32_16x16x32_bf16 a[192:195], v[20:23], v[64:67], 0
    ds_read_b128 v[16:19], v1 offset:33792
    v_mfma_f32_16x16x32_bf16 a[196:199], v[20:23], v[72:75], 0
    v_exp_f32 v108, v108
    v_mfma_f32_16x16x32_bf16 a[200:203], v[20:23], v[80:83], 0
    v_exp_f32 v109, v109
    v_mfma_f32_16x16x32_bf16 a[204:207], v[20:23], v[88:91], 0
    ds_read_b128 v[20:23], v1 offset:33856
    v_mfma_f32_16x16x32_bf16 a[208:211], v[24:27], v[64:67], 0
    v_exp_f32 v110, v110
    v_mfma_f32_16x16x32_bf16 a[212:215], v[24:27], v[72:75], 0
    v_add_f32 v5, v5, v108
    v_add_f32 v5, v5, v109
    v_mfma_f32_16x16x32_bf16 a[216:219], v[24:27], v[80:83], 0
    v_exp_f32 v111, v111
    v_mfma_f32_16x16x32_bf16 a[220:223], v[24:27], v[88:91], 0
    ds_read_b128 v[24:27], v1 offset:33920
    v_cvt_pk_bf16_f32 v106, v108, v109
    v_mfma_f32_16x16x32_bf16 a[224:227], v[28:31], v[64:67], 0
    v_add_f32 v5, v5, v110
    v_add_f32 v5, v5, v111
    v_mfma_f32_16x16x32_bf16 a[228:231], v[28:31], v[72:75], 0
    v_cvt_pk_bf16_f32 v107, v110, v111
    v_mfma_f32_16x16x32_bf16 a[232:235], v[28:31], v[80:83], 0
    v_mfma_f32_16x16x32_bf16 a[236:239], v[28:31], v[88:91], 0
    ds_read_b128 v[28:31], v1 offset:33984
    v_mfma_f32_16x16x32_bf16 a[240:243], v[32:35], v[64:67], 0
    v_mfma_f32_16x16x32_bf16 a[244:247], v[32:35], v[72:75], 0
    v_mfma_f32_16x16x32_bf16 a[248:251], v[32:35], v[80:83], 0
    v_mfma_f32_16x16x32_bf16 a[252:255], v[32:35], v[88:91], 0
    s_waitcnt lgkmcnt(3)
    ds_read_b128 v[32:35], v1 offset:34048
    s_cbranch_vccnz L_stub_r2_p1
L_ret_r2_p1:
    v_mfma_f32_16x16x32_bf16 v[64:67], v[16:19], v[128:131], v[48:51]
    s_waitcnt lgkmcnt(3)
    ds_read_b128 v[36:39], v1 offset:34112
    v_mfma_f32_16x16x32_bf16 v[64:67], v[20:23], v[132:135], v[64:67]
    buffer_load_dwordx4 v3, s[16:19], s48 offen lds
    v_mfma_f32_16x16x32_bf16 v[72:75], v[16:19], v[160:163], v[52:55]
    s_lshl_b32 s57, s44, 4
    s_cmp_eq_u32 s42, 0
    s_cselect_b32 s57, s57, 0x10000
    v_mov_b32 v10, s57
    v_mov_b32 v11, 1
    s_mov_b64 exec, 1
    buffer_atomic_add v11, v10, s[64:67], 0 offen
    s_mov_b64 exec, -1
    v_mfma_f32_16x16x32_bf16 v[72:75], v[20:23], v[164:167], v[72:75]
    s_add_u32 m0, m0, 0x220
    v_exp_f32 v112, v112
    v_mfma_f32_16x16x32_bf16 v[80:83], v[16:19], v[192:195], v[56:59]
    v_exp_f32 v113, v113
    v_mfma_f32_16x16x32_bf16 v[80:83], v[20:23], v[196:199], v[80:83]
    v_exp_f32 v114, v114
    v_mfma_f32_16x16x32_bf16 v[88:91], v[16:19], v[224:227], v[60:63]
    ds_read_b128 v[16:19], v1 offset:34176
    v_add_f32 v6, v6, v112
    v_mfma_f32_16x16x32_bf16 v[88:91], v[20:23], v[228:231], v[88:91]
    s_waitcnt lgkmcnt(4)
    ds_read_b128 v[20:23], v1 offset:34240
    v_add_f32 v6, v6, v113
    v_mfma_f32_16x16x32_bf16 v[88:91], v[24:27], v[232:235], v[88:91]
    s_waitcnt lgkmcnt(4)
    buffer_load_dwordx4 v3, s[16:19], s48 offen offset:512 lds
    v_mfma_f32_16x16x32_bf16 v[88:91], v[28:31], v[236:239], v[88:91]
    s_add_u32 m0, m0, 0x220
    v_exp_f32 v115, v115
    v_mfma_f32_16x16x32_bf16 v[80:83], v[24:27], v[200:203], v[80:83]
    v_cvt_pk_bf16_f32 v112, v112, v113
    v_add_f32 v6, v6, v114
    v_mfma_f32_16x16x32_bf16 v[80:83], v[28:31], v[204:207], v[80:83]
    v_add_f32 v6, v6, v115
    v_cvt_pk_bf16_f32 v113, v114, v115
    v_mfma_f32_16x16x32_bf16 v[72:75], v[24:27], v[168:171], v[72:75]
    buffer_load_dwordx4 v3, s[16:19], s48 offen offset:1024 lds
    v_mfma_f32_16x16x32_bf16 v[72:75], v[28:31], v[172:175], v[72:75]
    s_add_u32 m0, m0, 0x220
    v_exp_f32 v116, v116
    v_mfma_f32_16x16x32_bf16 v[64:67], v[24:27], v[136:139], v[64:67]
    ds_read_b128 v[24:27], v1 offset:34304
    v_mfma_f32_16x16x32_bf16 v[64:67], v[28:31], v[140:143], v[64:67]
    s_waitcnt lgkmcnt(4)
    ds_read_b128 v[28:31], v1 offset:34368
    v_mfma_f32_16x16x32_bf16 v[64:67], v[32:35], v[144:147], v[64:67]
    s_waitcnt lgkmcnt(4)
    v_exp_f32 v117, v117
    v_mfma_f32_16x16x32_bf16 v[64:67], v[36:39], v[148:151], v[64:67]
    v_exp_f32 v118, v118
    v_mfma_f32_16x16x32_bf16 v[72:75], v[32:35], v[176:179], v[72:75]
    buffer_load_dwordx4 v3, s[16:19], s48 offen offset:1536 lds
    v_mfma_f32_16x16x32_bf16 v[72:75], v[36:39], v[180:183], v[72:75]
    s_add_u32 m0, m0, 0x220
    v_add_f32 v6, v6, v116
    v_add_f32 v6, v6, v117
    v_mfma_f32_16x16x32_bf16 v[80:83], v[32:35], v[208:211], v[80:83]
    v_exp_f32 v119, v119
    v_mfma_f32_16x16x32_bf16 v[80:83], v[36:39], v[212:215], v[80:83]
    v_cvt_pk_bf16_f32 v114, v116, v117
    v_add_f32 v6, v6, v118
    v_mfma_f32_16x16x32_bf16 v[88:91], v[32:35], v[240:243], v[88:91]
    ds_read_b128 v[32:35], v1 offset:34432
    v_add_f32 v6, v6, v119
    v_mfma_f32_16x16x32_bf16 v[88:91], v[36:39], v[244:247], v[88:91]
    s_waitcnt lgkmcnt(4)
    v_cvt_pk_bf16_f32 v115, v118, v119
    v_mfma_f32_16x16x32_bf16 v[88:91], v[16:19], v[248:251], v[88:91]
    s_waitcnt lgkmcnt(3)
    buffer_load_dwordx4 v3, s[16:19], s48 offen offset:2048 lds
    v_mfma_f32_16x16x32_bf16 v[88:91], v[20:23], v[252:255], v[88:91]
    s_add_u32 m0, m0, 0x220
    v_exp_f32 v120, v120
    v_mfma_f32_16x16x32_bf16 v[80:83], v[16:19], v[216:219], v[80:83]
    v_exp_f32 v121, v121
    v_mfma_f32_16x16x32_bf16 v[80:83], v[20:23], v[220:223], v[80:83]
    v_exp_f32 v122, v122
    v_mfma_f32_16x16x32_bf16 v[72:75], v[16:19], v[184:187], v[72:75]
    v_add_f32 v7, v7, v120
    v_add_f32 v7, v7, v121
    v_mfma_f32_16x16x32_bf16 v[72:75], v[20:23], v[188:191], v[72:75]
    v_exp_f32 v123, v123
    v_mfma_f32_16x16x32_bf16 v[64:67], v[16:19], v[152:155], v[64:67]
    ds_read_b128 v[16:19], v1 offset:34496
    v_cvt_pk_bf16_f32 v120, v120, v121
    v_mfma_f32_16x16x32_bf16 v[64:67], v[20:23], v[156:159], v[64:67]
    s_waitcnt lgkmcnt(3)
    ds_read_b128 v[20:23], v1 offset:34560
    v_add_f32 v7, v7, v122
    v_mfma_f32_16x16x32_bf16 v[68:71], v[24:27], v[128:131], v[48:51]
    s_waitcnt lgkmcnt(3)
    buffer_load_dwordx4 v3, s[16:19], s48 offen offset:2560 lds
    v_mfma_f32_16x16x32_bf16 v[68:71], v[28:31], v[132:135], v[68:71]
    s_add_u32 m0, m0, 0x220
    v_add_f32 v7, v7, v123
    v_cvt_pk_bf16_f32 v121, v122, v123
    v_mfma_f32_16x16x32_bf16 v[76:79], v[24:27], v[160:163], v[52:55]
    v_exp_f32 v124, v124
    v_mfma_f32_16x16x32_bf16 v[76:79], v[28:31], v[164:167], v[76:79]
    v_exp_f32 v125, v125
    v_mfma_f32_16x16x32_bf16 v[84:87], v[24:27], v[192:195], v[56:59]
    buffer_load_dwordx4 v3, s[16:19], s48 offen offset:3072 lds
    v_mfma_f32_16x16x32_bf16 v[84:87], v[28:31], v[196:199], v[84:87]
    s_add_u32 m0, m0, 0x220
    v_exp_f32 v126, v126
    v_mfma_f32_16x16x32_bf16 v[92:95], v[24:27], v[224:227], v[60:63]
    ds_read_b128 v[24:27], v1 offset:34624
    v_add_f32 v7, v7, v124
    v_mfma_f32_16x16x32_bf16 v[92:95], v[28:31], v[228:231], v[92:95]
    s_waitcnt lgkmcnt(3)
    ds_read_b128 v[28:31], v1 offset:34688
    v_add_f32 v7, v7, v125
    v_mfma_f32_16x16x32_bf16 v[92:95], v[32:35], v[232:235], v[92:95]
    s_waitcnt lgkmcnt(3)
    v_exp_f32 v127, v127
    v_mfma_f32_16x16x32_bf16 v[92:95], v[16:19], v[236:239], v[92:95]
    v_cvt_pk_bf16_f32 v122, v124, v125
    v_add_f32 v7, v7, v126
    v_mfma_f32_16x16x32_bf16 v[84:87], v[32:35], v[200:203], v[84:87]
    buffer_load_dwordx4 v3, s[16:19], s48 offen offset:3584 lds
    v_mfma_f32_16x16x32_bf16 v[84:87], v[16:19], v[204:207], v[84:87]
    s_add_u32 m0, s45, 0x18c00
    s_add_u32 s48, s48, 0x8000
    v_add_f32 v7, v7, v127
    v_mfma_f32_16x16x32_bf16 v[76:79], v[32:35], v[168:171], v[76:79]
    v_cvt_pk_bf16_f32 v123, v126, v127
    v_max3_f32 v8, v64, v65, v66
    v_mfma_f32_16x16x32_bf16 v[76:79], v[16:19], v[172:175], v[76:79]
    v_max3_f32 v8, v8, v67, v72
    v_max3_f32 v8, v8, v73, v74
    v_mfma_f32_16x16x32_bf16 v[68:71], v[32:35], v[136:139], v[68:71]
    ds_read_b128 v[32:35], v1 offset:34752
    v_max3_f32 v8, v8, v75, v80
    v_mfma_f32_16x16x32_bf16 v[68:71], v[16:19], v[140:143], v[68:71]
    s_waitcnt lgkmcnt(3)
    v_max3_f32 v8, v8, v81, v82
    v_max3_f32 v8, v8, v83, v88
    v_mfma_f32_16x16x32_bf16 v[68:71], v[20:23], v[144:147], v[68:71]
    s_waitcnt lgkmcnt(2)
    v_max3_f32 v8, v8, v89, v90
    v_mfma_f32_16x16x32_bf16 v[68:71], v[24:27], v[148:151], v[68:71]
    v_mfma_f32_16x16x32_bf16 v[76:79], v[20:23], v[176:179], v[76:79]
    s_waitcnt vmcnt(18) lgkmcnt(0)
    s_barrier
    ds_read_b64_tr_b16 v[16:17], v2
    v_mfma_f32_16x16x32_bf16 v[76:79], v[24:27], v[180:183], v[76:79]
    ds_read_b64_tr_b16 v[18:19], v2 offset:512
    v_mfma_f32_16x16x32_bf16 v[84:87], v[20:23], v[208:211], v[84:87]
    buffer_load_dwordx4 v3, s[12:15], s47 offen lds
    v_mfma_f32_16x16x32_bf16 v[84:87], v[24:27], v[212:215], v[84:87]
    s_add_u32 m0, m0, 0x220
    v_mfma_f32_16x16x32_bf16 v[92:95], v[20:23], v[240:243], v[92:95]
    ds_read_b64_tr_b16 v[20:21], v2 offset:32
    ds_read_b64_tr_b16 v[22:23], v2 offset:544
    v_mfma_f32_16x16x32_bf16 v[92:95], v[24:27], v[244:247], v[92:95]
    ds_read_b64_tr_b16 v[24:25], v2 offset:64
    ds_read_b64_tr_b16 v[26:27], v2 offset:576
    v_mfma_f32_16x16x32_bf16 v[92:95], v[28:31], v[248:251], v[92:95]
    v_mfma_f32_16x16x32_bf16 v[92:95], v[32:35], v[252:255], v[92:95]
    v_mfma_f32_16x16x32_bf16 v[84:87], v[28:31], v[216:219], v[84:87]
    buffer_load_dwordx4 v3, s[12:15], s47 offen offset:512 lds
    v_mfma_f32_16x16x32_bf16 v[84:87], v[32:35], v[220:223], v[84:87]
    s_add_u32 m0, m0, 0x220
    v_mfma_f32_16x16x32_bf16 v[76:79], v[28:31], v[184:187], v[76:79]
    v_mfma_f32_16x16x32_bf16 v[76:79], v[32:35], v[188:191], v[76:79]
    v_mfma_f32_16x16x32_bf16 v[68:71], v[28:31], v[152:155], v[68:71]
    ds_read_b64_tr_b16 v[28:29], v2 offset:96
    ds_read_b64_tr_b16 v[30:31], v2 offset:608
    v_mfma_f32_16x16x32_bf16 v[68:71], v[32:35], v[156:159], v[68:71]
    s_waitcnt lgkmcnt(6)
    ds_read_b64_tr_b16 v[32:33], v2 offset:128
    ds_read_b64_tr_b16 v[34:35], v2 offset:640
    v_mfma_f32_16x16x32_bf16 a[0:3], v[16:19], v[96:99], a[0:3]
    ds_read_b64_tr_b16 v[36:37], v2 offset:160
    ds_read_b64_tr_b16 v[38:39], v2 offset:672
    v_mfma_f32_16x16x32_bf16 a[4:7], v[16:19], v[104:107], a[4:7]
    buffer_load_dwordx4 v3, s[12:15], s47 offen offset:1024 lds
    v_mfma_f32_16x16x32_bf16 a[8:11], v[16:19], v[112:115], a[8:11]
    s_add_u32 m0, m0, 0x220
    v_mfma_f32_16x16x32_bf16 a[12:15], v[16:19], v[120:123], a[12:15]
    s_waitcnt lgkmcnt(8)
    ds_read_b64_tr_b16 v[16:17], v2 offset:192
    ds_read_b64_tr_b16 v[18:19], v2 offset:704
    v_mfma_f32_16x16x32_bf16 a[16:19], v[20:23], v[96:99], a[16:19]
    v_max3_f32 v8, v8, v91, v68
    v_max3_f32 v8, v8, v69, v70
    v_mfma_f32_16x16x32_bf16 a[20:23], v[20:23], v[104:107], a[20:23]
    v_max3_f32 v8, v8, v71, v76
    v_max3_f32 v8, v8, v77, v78
    v_mfma_f32_16x16x32_bf16 a[24:27], v[20:23], v[112:115], a[24:27]
    v_max3_f32 v8, v8, v79, v84
    v_max3_f32 v8, v8, v85, v86
    v_mfma_f32_16x16x32_bf16 a[28:31], v[20:23], v[120:123], a[28:31]
    s_waitcnt lgkmcnt(8)
    ds_read_b64_tr_b16 v[20:21], v2 offset:224
    ds_read_b64_tr_b16 v[22:23], v2 offset:736
    v_mfma_f32_16x16x32_bf16 a[32:35], v[24:27], v[96:99], a[32:35]
    v_max3_f32 v8, v8, v87, v92
    v_max3_f32 v8, v8, v93, v94
    v_mfma_f32_16x16x32_bf16 a[36:39], v[24:27], v[104:107], a[36:39]
    buffer_load_dwordx4 v3, s[12:15], s47 offen offset:1536 lds
    v_mfma_f32_16x16x32_bf16 a[40:43], v[24:27], v[112:115], a[40:43]
    s_add_u32 m0, m0, 0x220
    v_max_f32 v8, v8, v95
    v_cmp_lt_f32 vcc, 0x41800000, v8
    v_mfma_f32_16x16x32_bf16 a[44:47], v[24:27], v[120:123], a[44:47]
    s_waitcnt lgkmcnt(8)
    ds_read_b64_tr_b16 v[24:25], v2 offset:256
    ds_read_b64_tr_b16 v[26:27], v2 offset:768
    v_mfma_f32_16x16x32_bf16 a[48:51], v[28:31], v[96:99], a[48:51]
    v_mfma_f32_16x16x32_bf16 a[52:55], v[28:31], v[104:107], a[52:55]
    v_mfma_f32_16x16x32_bf16 a[56:59], v[28:31], v[112:115], a[56:59]
    s_cbranch_vccnz L_stub_r1_p1
L_ret_r1_p1:
    v_exp_f32 v64, v64
    v_mfma_f32_16x16x32_bf16 a[60:63], v[28:31], v[120:123], a[60:63]
    s_waitcnt lgkmcnt(8)
    ds_read_b64_tr_b16 v[28:29], v2 offset:288
    ds_read_b64_tr_b16 v[30:31], v2 offset:800
    v_mfma_f32_16x16x32_bf16 a[64:67], v[32:35], v[96:99], a[64:67]
    buffer_load_dwordx4 v3, s[12:15], s47 offen offset:2048 lds
    v_mfma_f32_16x16x32_bf16 a[68:71], v[32:35], v[104:107], a[68:71]
    s_add_u32 m0, m0, 0x220
    v_exp_f32 v65, v65
    v_mfma_f32_16x16x32_bf16 a[72:75], v[32:35], v[112:115], a[72:75]
    v_exp_f32 v66, v66
    v_mfma_f32_16x16x32_bf16 a[76:79], v[32:35], v[120:123], a[76:79]
    s_waitcnt lgkmcnt(8)
    ds_read_b64_tr_b16 v[32:33], v2 offset:320
    ds_read_b64_tr_b16 v[34:35], v2 offset:832
    v_mfma_f32_16x16x32_bf16 a[80:83], v[36:39], v[96:99], a[80:83]
    v_add_f32 v4, v4, v64
    v_add_f32 v4, v4, v65
    v_mfma_f32_16x16x32_bf16 a[84:87], v[36:39], v[104:107], a[84:87]
    v_exp_f32 v67, v67
    v_mfma_f32_16x16x32_bf16 a[88:91], v[36:39], v[112:115], a[88:91]
    v_cvt_pk_bf16_f32 v64, v64, v65
    v_add_f32 v4, v4, v66
    v_mfma_f32_16x16x32_bf16 a[92:95], v[36:39], v[120:123], a[92:95]
    s_waitcnt lgkmcnt(8)
    buffer_load_dwordx4 v3, s[12:15], s47 offen offset:2560 lds
    v_mfma_f32_16x16x32_bf16 a[96:99], v[16:19], v[96:99], a[96:99]
    s_add_u32 m0, m0, 0x220
    v_add_f32 v4, v4, v67
    v_cvt_pk_bf16_f32 v65, v66, v67
    v_mfma_f32_16x16x32_bf16 a[100:103], v[16:19], v[104:107], a[100:103]
    v_exp_f32 v68, v68
    v_mfma_f32_16x16x32_bf16 a[104:107], v[16:19], v[112:115], a[104:107]
    v_exp_f32 v69, v69
    v_mfma_f32_16x16x32_bf16 a[108:111], v[16:19], v[120:123], a[108:111]
    s_waitcnt lgkmcnt(6)
    ds_read_b64_tr_b16 v[16:17], v2 offset:352
    ds_read_b64_tr_b16 v[18:19], v2 offset:864
    v_mfma_f32_16x16x32_bf16 a[112:115], v[20:23], v[96:99], a[112:115]
    v_exp_f32 v70, v70
    v_mfma_f32_16x16x32_bf16 a[116:119], v[20:23], v[104:107], a[116:119]
    v_add_f32 v4, v4, v68
    v_add_f32 v4, v4, v69
    v_mfma_f32_16x16x32_bf16 a[120:123], v[20:23], v[112:115], a[120:123]
    v_exp_f32 v71, v71
    v_mfma_f32_16x16x32_bf16 a[124:127], v[20:23], v[120:123], a[124:127]
    s_waitcnt lgkmcnt(6)
    ds_read_b64_tr_b16 v[20:21], v2 offset:384
    ds_read_b64_tr_b16 v[22:23], v2 offset:896
    v_mfma_f32_16x16x32_bf16 a[128:131], v[24:27], v[96:99], a[128:131]
    buffer_load_dwordx4 v3, s[12:15], s47 offen offset:3072 lds
    v_mfma_f32_16x16x32_bf16 a[132:135], v[24:27], v[104:107], a[132:135]
    s_add_u32 m0, m0, 0x220
    v_cvt_pk_bf16_f32 v66, v68, v69
    v_add_f32 v4, v4, v70
    v_mfma_f32_16x16x32_bf16 a[136:139], v[24:27], v[112:115], a[136:139]
    v_add_f32 v4, v4, v71
    v_cvt_pk_bf16_f32 v67, v70, v71
    v_mfma_f32_16x16x32_bf16 a[140:143], v[24:27], v[120:123], a[140:143]
    s_waitcnt lgkmcnt(6)
    ds_read_b64_tr_b16 v[24:25], v2 offset:416
    ds_read_b64_tr_b16 v[26:27], v2 offset:928
    v_mfma_f32_16x16x32_bf16 a[144:147], v[28:31], v[96:99], a[144:147]
    v_exp_f32 v72, v72
    v_mfma_f32_16x16x32_bf16 a[148:151], v[28:31], v[104:107], a[148:151]
    v_exp_f32 v73, v73
    v_mfma_f32_16x16x32_bf16 a[152:155], v[28:31], v[112:115], a[152:155]
    buffer_load_dwordx4 v3, s[12:15], s47 offen offset:3584 lds
    v_mfma_f32_16x16x32_bf16 a[156:159], v[28:31], v[120:123], a[156:159]
    s_waitcnt lgkmcnt(6)
    ds_read_b64_tr_b16 v[28:29], v2 offset:448
    ds_read_b64_tr_b16 v[30:31], v2 offset:960
    v_mfma_f32_16x16x32_bf16 a[160:163], v[32:35], v[96:99], a[160:163]
    s_add_u32 m0, s45, 0
    s_add_u32 s47, s47, 0x8000
    v_mfma_f32_16x16x32_bf16 a[164:167], v[32:35], v[104:107], a[164:167]
    v_exp_f32 v74, v74
    v_mfma_f32_16x16x32_bf16 a[168:171], v[32:35], v[112:115], a[168:171]
    v_add_f32 v5, v5, v72
    v_add_f32 v5, v5, v73
    v_mfma_f32_16x16x32_bf16 a[172:175], v[32:35], v[120:123], a[172:175]
    s_waitcnt lgkmcnt(6)
    ds_read_b64_tr_b16 v[32:33], v2 offset:480
    ds_read_b64_tr_b16 v[34:35], v2 offset:992
    v_mfma_f32_16x16x32_bf16 a[176:179], v[16:19], v[96:99], a[176:179]
    v_exp_f32 v75, v75
    v_mfma_f32_16x16x32_bf16 a[180:183], v[16:19], v[104:107], a[180:183]
    v_cvt_pk_bf16_f32 v72, v72, v73
    v_add_f32 v5, v5, v74
    v_mfma_f32_16x16x32_bf16 a[184:187], v[16:19], v[112:115], a[184:187]
    v_add_f32 v5, v5, v75
    v_cvt_pk_bf16_f32 v73, v74, v75
    v_mfma_f32_16x16x32_bf16 a[188:191], v[16:19], v[120:123], a[188:191]
    s_waitcnt lgkmcnt(6)
    s_waitcnt vmcnt(17) lgkmcnt(0)
    s_barrier
    v_mfma_f32_16x16x32_bf16 a[192:195], v[20:23], v[96:99], a[192:195]
    ds_read_b128 v[16:19], v1
    v_mfma_f32_16x16x32_bf16 a[196:199], v[20:23], v[104:107], a[196:199]
    v_exp_f32 v76, v76
    v_mfma_f32_16x16x32_bf16 a[200:203], v[20:23], v[112:115], a[200:203]
    v_exp_f32 v77, v77
    v_mfma_f32_16x16x32_bf16 a[204:207], v[20:23], v[120:123], a[204:207]
    ds_read_b128 v[20:23], v1 offset:64
    v_mfma_f32_16x16x32_bf16 a[208:211], v[24:27], v[96:99], a[208:211]
    v_exp_f32 v78, v78
    v_mfma_f32_16x16x32_bf16 a[212:215], v[24:27], v[104:107], a[212:215]
    v_add_f32 v5, v5, v76
    v_add_f32 v5, v5, v77
    v_mfma_f32_16x16x32_bf16 a[216:219], v[24:27], v[112:115], a[216:219]
    v_exp_f32 v79, v79
    v_mfma_f32_16x16x32_bf16 a[220:223], v[24:27], v[120:123], a[220:223]
    ds_read_b128 v[24:27], v1 offset:128
    v_cvt_pk_bf16_f32 v74, v76, v77
    v_mfma_f32_16x16x32_bf16 a[224:227], v[28:31], v[96:99], a[224:227]
    v_add_f32 v5, v5, v78
    v_add_f32 v5, v5, v79
    v_mfma_f32_16x16x32_bf16 a[228:231], v[28:31], v[104:107], a[228:231]
    v_cvt_pk_bf16_f32 v75, v78, v79
    v_mfma_f32_16x16x32_bf16 a[232:235], v[28:31], v[112:115], a[232:235]
    v_mfma_f32_16x16x32_bf16 a[236:239], v[28:31], v[120:123], a[236:239]
    ds_read_b128 v[28:31], v1 offset:192
    v_mfma_f32_16x16x32_bf16 a[240:243], v[32:35], v[96:99], a[240:243]
    v_mfma_f32_16x16x32_bf16 a[244:247], v[32:35], v[104:107], a[244:247]
    v_mfma_f32_16x16x32_bf16 a[248:251], v[32:35], v[112:115], a[248:251]
    v_mfma_f32_16x16x32_bf16 a[252:255], v[32:35], v[120:123], a[252:255]
    s_waitcnt lgkmcnt(3)
    ds_read_b128 v[32:35], v1 offset:256
.p2align 6
L_loop:
    s_cbranch_vccnz L_stub_r2_0
L_ret_r2_0:
    v_mfma_f32_16x16x32_bf16 v[96:99], v[16:19], v[128:131], v[48:51]
    s_waitcnt lgkmcnt(3)
    ds_read_b128 v[36:39], v1 offset:320
    v_mfma_f32_16x16x32_bf16 v[96:99], v[20:23], v[132:135], v[96:99]
    buffer_load_dwordx4 v3, s[16:19], s48 offen lds
    v_mfma_f32_16x16x32_bf16 v[104:107], v[16:19], v[160:163], v[52:55]
    s_add_u32 m0, m0, 0x220
    v_exp_f32 v80, v80
    v_mfma_f32_16x16x32_bf16 v[104:107], v[20:23], v[164:167], v[104:107]
    v_exp_f32 v81, v81
    v_mfma_f32_16x16x32_bf16 v[112:115], v[16:19], v[192:195], v[56:59]
    v_exp_f32 v82, v82
    v_mfma_f32_16x16x32_bf16 v[112:115], v[20:23], v[196:199], v[112:115]
    v_add_f32 v6, v6, v80
    v_add_f32 v6, v6, v81
    v_mfma_f32_16x16x32_bf16 v[120:123], v[16:19], v[224:227], v[60:63]
    ds_read_b128 v[16:19], v1 offset:384
    v_mfma_f32_16x16x32_bf16 v[120:123], v[20:23], v[228:231], v[120:123]
    s_waitcnt lgkmcnt(4)
    ds_read_b128 v[20:23], v1 offset:448
    v_mfma_f32_16x16x32_bf16 v[120:123], v[24:27], v[232:235], v[120:123]
    s_waitcnt lgkmcnt(4)
    buffer_load_dwordx4 v3, s[16:19], s48 offen offset:512 lds
    v_mfma_f32_16x16x32_bf16 v[120:123], v[28:31], v[236:239], v[120:123]
    s_add_u32 m0, m0, 0x220
    v_exp_f32 v83, v83
    v_mfma_f32_16x16x32_bf16 v[112:115], v[24:27], v[200:203], v[112:115]
    v_cvt_pk_bf16_f32 v80, v80, v81
    v_add_f32 v6, v6, v82
    v_mfma_f32_16x16x32_bf16 v[112:115], v[28:31], v[204:207], v[112:115]
    v_add_f32 v6, v6, v83
    v_cvt_pk_bf16_f32 v81, v82, v83
    v_mfma_f32_16x16x32_bf16 v[104:107], v[24:27], v[168:171], v[104:107]
    buffer_load_dwordx4 v3, s[16:19], s48 offen offset:1024 lds
    v_mfma_f32_16x16x32_bf16 v[104:107], v[28:31], v[172:175], v[104:107]
    s_add_u32 m0, m0, 0x220
    v_exp_f32 v84, v84
    v_mfma_f32_16x16x32_bf16 v[96:99], v[24:27], v[136:139], v[96:99]
    ds_read_b128 v[24:27], v1 offset:512
    v_mfma_f32_16x16x32_bf16 v[96:99], v[28:31], v[140:143], v[96:99]
    s_waitcnt lgkmcnt(4)
    ds_read_b128 v[28:31], v1 offset:576
    v_mfma_f32_16x16x32_bf16 v[96:99], v[32:35], v[144:147], v[96:99]
    s_waitcnt lgkmcnt(4)
    v_exp_f32 v85, v85
    v_mfma_f32_16x16x32_bf16 v[96:99], v[36:39], v[148:151], v[96:99]
    v_exp_f32 v86, v86
    v_mfma_f32_16x16x32_bf16 v[104:107], v[32:35], v[176:179], v[104:107]
    buffer_load_dwordx4 v3, s[16:19], s48 offen offset:1536 lds
    v_mfma_f32_16x16x32_bf16 v[104:107], v[36:39], v[180:183], v[104:107]
    s_add_u32 m0, m0, 0x220
    v_add_f32 v6, v6, v84
    v_add_f32 v6, v6, v85
    v_mfma_f32_16x16x32_bf16 v[112:115], v[32:35], v[208:211], v[112:115]
    v_exp_f32 v87, v87
    v_mfma_f32_16x16x32_bf16 v[112:115], v[36:39], v[212:215], v[112:115]
    v_cvt_pk_bf16_f32 v82, v84, v85
    v_add_f32 v6, v6, v86
    v_mfma_f32_16x16x32_bf16 v[120:123], v[32:35], v[240:243], v[120:123]
    ds_read_b128 v[32:35], v1 offset:640
    v_add_f32 v6, v6, v87
    v_mfma_f32_16x16x32_bf16 v[120:123], v[36:39], v[244:247], v[120:123]
    s_waitcnt lgkmcnt(4)
    v_cvt_pk_bf16_f32 v83, v86, v87
    v_mfma_f32_16x16x32_bf16 v[120:123], v[16:19], v[248:251], v[120:123]
    s_waitcnt lgkmcnt(3)
    buffer_load_dwordx4 v3, s[16:19], s48 offen offset:2048 lds
    v_mfma_f32_16x16x32_bf16 v[120:123], v[20:23], v[252:255], v[120:123]
    s_add_u32 m0, m0, 0x220
    v_exp_f32 v88, v88
    v_mfma_f32_16x16x32_bf16 v[112:115], v[16:19], v[216:219], v[112:115]
    v_exp_f32 v89, v89
    v_mfma_f32_16x16x32_bf16 v[112:115], v[20:23], v[220:223], v[112:115]
    v_exp_f32 v90, v90
    v_mfma_f32_16x16x32_bf16 v[104:107], v[16:19], v[184:187], v[104:107]
    v_add_f32 v7, v7, v88
    v_add_f32 v7, v7, v89
    v_mfma_f32_16x16x32_bf16 v[104:107], v[20:23], v[188:191], v[104:107]
    v_exp_f32 v91, v91
    v_mfma_f32_16x16x32_bf16 v[96:99], v[16:19], v[152:155], v[96:99]
    ds_read_b128 v[16:19], v1 offset:704
    v_cvt_pk_bf16_f32 v88, v88, v89
    v_mfma_f32_16x16x32_bf16 v[96:99], v[20:23], v[156:159], v[96:99]
    s_waitcnt lgkmcnt(3)
    ds_read_b128 v[20:23], v1 offset:768
    v_add_f32 v7, v7, v90
    v_mfma_f32_16x16x32_bf16 v[100:103], v[24:27], v[128:131], v[48:51]
    s_waitcnt lgkmcnt(3)
    buffer_load_dwordx4 v3, s[16:19], s48 offen offset:2560 lds
    v_mfma_f32_16x16x32_bf16 v[100:103], v[28:31], v[132:135], v[100:103]
    s_add_u32 m0, m0, 0x220
    v_add_f32 v7, v7, v91
    v_cvt_pk_bf16_f32 v89, v90, v91
    v_mfma_f32_16x16x32_bf16 v[108:111], v[24:27], v[160:163], v[52:55]
    v_exp_f32 v92, v92
    v_mfma_f32_16x16x32_bf16 v[108:111], v[28:31], v[164:167], v[108:111]
    v_exp_f32 v93, v93
    v_mfma_f32_16x16x32_bf16 v[116:119], v[24:27], v[192:195], v[56:59]
    buffer_load_dwordx4 v3, s[16:19], s48 offen offset:3072 lds
    v_mfma_f32_16x16x32_bf16 v[116:119], v[28:31], v[196:199], v[116:119]
    s_add_u32 m0, m0, 0x220
    v_exp_f32 v94, v94
    v_mfma_f32_16x16x32_bf16 v[124:127], v[24:27], v[224:227], v[60:63]
    ds_read_b128 v[24:27], v1 offset:832
    v_add_f32 v7, v7, v92
    v_mfma_f32_16x16x32_bf16 v[124:127], v[28:31], v[228:231], v[124:127]
    s_waitcnt lgkmcnt(3)
    ds_read_b128 v[28:31], v1 offset:896
    v_add_f32 v7, v7, v93
    v_mfma_f32_16x16x32_bf16 v[124:127], v[32:35], v[232:235], v[124:127]
    s_waitcnt lgkmcnt(3)
    v_exp_f32 v95, v95
    v_mfma_f32_16x16x32_bf16 v[124:127], v[16:19], v[236:239], v[124:127]
    v_cvt_pk_bf16_f32 v90, v92, v93
    v_add_f32 v7, v7, v94
    v_mfma_f32_16x16x32_bf16 v[116:119], v[32:35], v[200:203], v[116:119]
    buffer_load_dwordx4 v3, s[16:19], s48 offen offset:3584 lds
    v_mfma_f32_16x16x32_bf16 v[116:119], v[16:19], v[204:207], v[116:119]
    s_add_u32 m0, s45, 0x10800
    s_add_u32 s48, s48, 0x8000
    v_add_f32 v7, v7, v95
    v_mfma_f32_16x16x32_bf16 v[108:111], v[32:35], v[168:171], v[108:111]
    v_cvt_pk_bf16_f32 v91, v94, v95
    v_max3_f32 v8, v96, v97, v98
    v_mfma_f32_16x16x32_bf16 v[108:111], v[16:19], v[172:175], v[108:111]
    v_max3_f32 v8, v8, v99, v104
    v_max3_f32 v8, v8, v105, v106
    v_mfma_f32_16x16x32_bf16 v[100:103], v[32:35], v[136:139], v[100:103]
    ds_read_b128 v[32:35], v1 offset:960
    v_max3_f32 v8, v8, v107, v112
    v_mfma_f32_16x16x32_bf16 v[100:103], v[16:19], v[140:143], v[100:103]
    s_waitcnt lgkmcnt(3)
    v_max3_f32 v8, v8, v113, v114
    v_max3_f32 v8, v8, v115, v120
    v_mfma_f32_16x16x32_bf16 v[100:103], v[20:23], v[144:147], v[100:103]
    s_waitcnt lgkmcnt(2)
    v_max3_f32 v8, v8, v121, v122
    v_mfma_f32_16x16x32_bf16 v[100:103], v[24:27], v[148:151], v[100:103]
    v_mfma_f32_16x16x32_bf16 v[108:111], v[20:23], v[176:179], v[108:111]
    s_waitcnt vmcnt(16) lgkmcnt(0)
    s_barrier
    ds_read_b64_tr_b16 v[16:17], v2 offset:33792
    v_mfma_f32_16x16x32_bf16 v[108:111], v[24:27], v[180:183], v[108:111]
    ds_read_b64_tr_b16 v[18:19], v2 offset:34304
    v_mfma_f32_16x16x32_bf16 v[116:119], v[20:23], v[208:211], v[116:119]
    buffer_load_dwordx4 v3, s[12:15], s47 offen lds
    v_mfma_f32_16x16x32_bf16 v[116:119], v[24:27], v[212:215], v[116:119]
    s_add_u32 m0, m0, 0x220
    v_mfma_f32_16x16x32_bf16 v[124:127], v[20:23], v[240:243], v[124:127]
    ds_read_b64_tr_b16 v[20:21], v2 offset:33824
    ds_read_b64_tr_b16 v[22:23], v2 offset:34336
    v_mfma_f32_16x16x32_bf16 v[124:127], v[24:27], v[244:247], v[124:127]
    ds_read_b64_tr_b16 v[24:25], v2 offset:33856
    ds_read_b64_tr_b16 v[26:27], v2 offset:34368
    v_mfma_f32_16x16x32_bf16 v[124:127], v[28:31], v[248:251], v[124:127]
    buffer_load_dword v13, v9, s[92:95], s96 offen
    v_mfma_f32_16x16x32_bf16 v[124:127], v[32:35], v[252:255], v[124:127]
    s_add_u32 s96, s96, 0x10000
    v_mfma_f32_16x16x32_bf16 v[116:119], v[28:31], v[216:219], v[116:119]
    buffer_load_dwordx4 v3, s[12:15], s47 offen offset:512 lds
    v_mfma_f32_16x16x32_bf16 v[116:119], v[32:35], v[220:223], v[116:119]
    s_add_u32 m0, m0, 0x220
    v_mfma_f32_16x16x32_bf16 v[108:111], v[28:31], v[184:187], v[108:111]
    v_mfma_f32_16x16x32_bf16 v[108:111], v[32:35], v[188:191], v[108:111]
    v_mfma_f32_16x16x32_bf16 v[100:103], v[28:31], v[152:155], v[100:103]
    ds_read_b64_tr_b16 v[28:29], v2 offset:33888
    ds_read_b64_tr_b16 v[30:31], v2 offset:34400
    v_mfma_f32_16x16x32_bf16 v[100:103], v[32:35], v[156:159], v[100:103]
    s_waitcnt lgkmcnt(6)
    ds_read_b64_tr_b16 v[32:33], v2 offset:33920
    ds_read_b64_tr_b16 v[34:35], v2 offset:34432
    v_mfma_f32_16x16x32_bf16 a[0:3], v[16:19], v[64:67], a[0:3]
    ds_read_b64_tr_b16 v[36:37], v2 offset:33952
    ds_read_b64_tr_b16 v[38:39], v2 offset:34464
    v_mfma_f32_16x16x32_bf16 a[4:7], v[16:19], v[72:75], a[4:7]
    buffer_load_dwordx4 v3, s[12:15], s47 offen offset:1024 lds
    v_mfma_f32_16x16x32_bf16 a[8:11], v[16:19], v[80:83], a[8:11]
    s_add_u32 m0, m0, 0x220
    v_mfma_f32_16x16x32_bf16 a[12:15], v[16:19], v[88:91], a[12:15]
    s_waitcnt lgkmcnt(8)
    ds_read_b64_tr_b16 v[16:17], v2 offset:33984
    ds_read_b64_tr_b16 v[18:19], v2 offset:34496
    v_mfma_f32_16x16x32_bf16 a[16:19], v[20:23], v[64:67], a[16:19]
    v_max3_f32 v8, v8, v123, v100
    v_max3_f32 v8, v8, v101, v102
    v_mfma_f32_16x16x32_bf16 a[20:23], v[20:23], v[72:75], a[20:23]
    v_max3_f32 v8, v8, v103, v108
    v_max3_f32 v8, v8, v109, v110
    v_mfma_f32_16x16x32_bf16 a[24:27], v[20:23], v[80:83], a[24:27]
    v_max3_f32 v8, v8, v111, v116
    v_max3_f32 v8, v8, v117, v118
    v_mfma_f32_16x16x32_bf16 a[28:31], v[20:23], v[88:91], a[28:31]
    s_waitcnt lgkmcnt(8)
    ds_read_b64_tr_b16 v[20:21], v2 offset:34016
    ds_read_b64_tr_b16 v[22:23], v2 offset:34528
    v_mfma_f32_16x16x32_bf16 a[32:35], v[24:27], v[64:67], a[32:35]
    v_max3_f32 v8, v8, v119, v124
    v_max3_f32 v8, v8, v125, v126
    v_mfma_f32_16x16x32_bf16 a[36:39], v[24:27], v[72:75], a[36:39]
    buffer_load_dwordx4 v3, s[12:15], s47 offen offset:1536 lds
    v_mfma_f32_16x16x32_bf16 a[40:43], v[24:27], v[80:83], a[40:43]
    s_add_u32 m0, m0, 0x220
    v_max_f32 v8, v8, v127
    v_cmp_lt_f32 vcc, 0x41800000, v8
    v_mfma_f32_16x16x32_bf16 a[44:47], v[24:27], v[88:91], a[44:47]
    s_waitcnt lgkmcnt(8)
    ds_read_b64_tr_b16 v[24:25], v2 offset:34048
    ds_read_b64_tr_b16 v[26:27], v2 offset:34560
    v_mfma_f32_16x16x32_bf16 a[48:51], v[28:31], v[64:67], a[48:51]
    v_mfma_f32_16x16x32_bf16 a[52:55], v[28:31], v[72:75], a[52:55]
    v_mfma_f32_16x16x32_bf16 a[56:59], v[28:31], v[80:83], a[56:59]
    s_cbranch_vccnz L_stub_r1_0
L_ret_r1_0:
    v_exp_f32 v96, v96
    v_mfma_f32_16x16x32_bf16 a[60:63], v[28:31], v[88:91], a[60:63]
    s_waitcnt lgkmcnt(8)
    ds_read_b64_tr_b16 v[28:29], v2 offset:34080
    ds_read_b64_tr_b16 v[30:31], v2 offset:34592
    v_mfma_f32_16x16x32_bf16 a[64:67], v[32:35], v[64:67], a[64:67]
    buffer_load_dwordx4 v3, s[12:15], s47 offen offset:2048 lds
    v_mfma_f32_16x16x32_bf16 a[68:71], v[32:35], v[72:75], a[68:71]
    s_add_u32 m0, m0, 0x220
    v_exp_f32 v97, v97
    v_mfma_f32_16x16x32_bf16 a[72:75], v[32:35], v[80:83], a[72:75]
    v_exp_f32 v98, v98
    v_mfma_f32_16x16x32_bf16 a[76:79], v[32:35], v[88:91], a[76:79]
    s_waitcnt lgkmcnt(8)
    ds_read_b64_tr_b16 v[32:33], v2 offset:34112
    ds_read_b64_tr_b16 v[34:35], v2 offset:34624
    v_mfma_f32_16x16x32_bf16 a[80:83], v[36:39], v[64:67], a[80:83]
    v_add_f32 v4, v4, v96
    v_add_f32 v4, v4, v97
    v_mfma_f32_16x16x32_bf16 a[84:87], v[36:39], v[72:75], a[84:87]
    v_exp_f32 v99, v99
    v_mfma_f32_16x16x32_bf16 a[88:91], v[36:39], v[80:83], a[88:91]
    v_cvt_pk_bf16_f32 v96, v96, v97
    v_add_f32 v4, v4, v98
    v_mfma_f32_16x16x32_bf16 a[92:95], v[36:39], v[88:91], a[92:95]
    s_waitcnt lgkmcnt(8)
    buffer_load_dwordx4 v3, s[12:15], s47 offen offset:2560 lds
    v_mfma_f32_16x16x32_bf16 a[96:99], v[16:19], v[64:67], a[96:99]
    s_add_u32 m0, m0, 0x220
    v_add_f32 v4, v4, v99
    v_cvt_pk_bf16_f32 v97, v98, v99
    v_mfma_f32_16x16x32_bf16 a[100:103], v[16:19], v[72:75], a[100:103]
    v_exp_f32 v100, v100
    v_mfma_f32_16x16x32_bf16 a[104:107], v[16:19], v[80:83], a[104:107]
    v_exp_f32 v101, v101
    v_mfma_f32_16x16x32_bf16 a[108:111], v[16:19], v[88:91], a[108:111]
    s_waitcnt lgkmcnt(6)
    ds_read_b64_tr_b16 v[16:17], v2 offset:34144
    ds_read_b64_tr_b16 v[18:19], v2 offset:34656
    v_mfma_f32_16x16x32_bf16 a[112:115], v[20:23], v[64:67], a[112:115]
    v_exp_f32 v102, v102
    v_mfma_f32_16x16x32_bf16 a[116:119], v[20:23], v[72:75], a[116:119]
    v_add_f32 v4, v4, v100
    v_add_f32 v4, v4, v101
    v_mfma_f32_16x16x32_bf16 a[120:123], v[20:23], v[80:83], a[120:123]
    v_exp_f32 v103, v103
    v_mfma_f32_16x16x32_bf16 a[124:127], v[20:23], v[88:91], a[124:127]
    s_waitcnt lgkmcnt(6)
    ds_read_b64_tr_b16 v[20:21], v2 offset:34176
    ds_read_b64_tr_b16 v[22:23], v2 offset:34688
    v_mfma_f32_16x16x32_bf16 a[128:131], v[24:27], v[64:67], a[128:131]
    buffer_load_dwordx4 v3, s[12:15], s47 offen offset:3072 lds
    v_mfma_f32_16x16x32_bf16 a[132:135], v[24:27], v[72:75], a[132:135]
    s_add_u32 m0, m0, 0x220
    v_cvt_pk_bf16_f32 v98, v100, v101
    v_add_f32 v4, v4, v102
    v_mfma_f32_16x16x32_bf16 a[136:139], v[24:27], v[80:83], a[136:139]
    v_add_f32 v4, v4, v103
    v_cvt_pk_bf16_f32 v99, v102, v103
    v_mfma_f32_16x16x32_bf16 a[140:143], v[24:27], v[88:91], a[140:143]
    s_waitcnt lgkmcnt(6)
    ds_read_b64_tr_b16 v[24:25], v2 offset:34208
    ds_read_b64_tr_b16 v[26:27], v2 offset:34720
    v_mfma_f32_16x16x32_bf16 a[144:147], v[28:31], v[64:67], a[144:147]
    v_exp_f32 v104, v104
    v_mfma_f32_16x16x32_bf16 a[148:151], v[28:31], v[72:75], a[148:151]
    v_exp_f32 v105, v105
    v_mfma_f32_16x16x32_bf16 a[152:155], v[28:31], v[80:83], a[152:155]
    buffer_load_dwordx4 v3, s[12:15], s47 offen offset:3584 lds
    v_mfma_f32_16x16x32_bf16 a[156:159], v[28:31], v[88:91], a[156:159]
    s_waitcnt lgkmcnt(6)
    ds_read_b64_tr_b16 v[28:29], v2 offset:34240
    ds_read_b64_tr_b16 v[30:31], v2 offset:34752
    v_mfma_f32_16x16x32_bf16 a[160:163], v[32:35], v[64:67], a[160:163]
    s_add_u32 m0, s45, 0x8400
    s_add_u32 s47, s47, 0x8000
    v_mfma_f32_16x16x32_bf16 a[164:167], v[32:35], v[72:75], a[164:167]
    v_exp_f32 v106, v106
    v_mfma_f32_16x16x32_bf16 a[168:171], v[32:35], v[80:83], a[168:171]
    v_add_f32 v5, v5, v104
    v_add_f32 v5, v5, v105
    v_mfma_f32_16x16x32_bf16 a[172:175], v[32:35], v[88:91], a[172:175]
    s_waitcnt lgkmcnt(6)
    ds_read_b64_tr_b16 v[32:33], v2 offset:34272
    ds_read_b64_tr_b16 v[34:35], v2 offset:34784
    v_mfma_f32_16x16x32_bf16 a[176:179], v[16:19], v[64:67], a[176:179]
    v_exp_f32 v107, v107
    v_mfma_f32_16x16x32_bf16 a[180:183], v[16:19], v[72:75], a[180:183]
    v_cvt_pk_bf16_f32 v104, v104, v105
    v_add_f32 v5, v5, v106
    v_mfma_f32_16x16x32_bf16 a[184:187], v[16:19], v[80:83], a[184:187]
    v_add_f32 v5, v5, v107
    v_cvt_pk_bf16_f32 v105, v106, v107
    v_mfma_f32_16x16x32_bf16 a[188:191], v[16:19], v[88:91], a[188:191]
    s_waitcnt lgkmcnt(6)
    s_waitcnt vmcnt(17) lgkmcnt(0)
    s_barrier
    v_mfma_f32_16x16x32_bf16 a[192:195], v[20:23], v[64:67], a[192:195]
    ds_read_b128 v[16:19], v1 offset:33792
    v_mfma_f32_16x16x32_bf16 a[196:199], v[20:23], v[72:75], a[196:199]
    v_exp_f32 v108, v108
    v_mfma_f32_16x16x32_bf16 a[200:203], v[20:23], v[80:83], a[200:203]
    v_exp_f32 v109, v109
    v_mfma_f32_16x16x32_bf16 a[204:207], v[20:23], v[88:91], a[204:207]
    ds_read_b128 v[20:23], v1 offset:33856
    v_mfma_f32_16x16x32_bf16 a[208:211], v[24:27], v[64:67], a[208:211]
    v_exp_f32 v110, v110
    v_mfma_f32_16x16x32_bf16 a[212:215], v[24:27], v[72:75], a[212:215]
    v_add_f32 v5, v5, v108
    v_add_f32 v5, v5, v109
    v_mfma_f32_16x16x32_bf16 a[216:219], v[24:27], v[80:83], a[216:219]
    v_exp_f32 v111, v111
    v_mfma_f32_16x16x32_bf16 a[220:223], v[24:27], v[88:91], a[220:223]
    ds_read_b128 v[24:27], v1 offset:33920
    v_cvt_pk_bf16_f32 v106, v108, v109
    v_mfma_f32_16x16x32_bf16 a[224:227], v[28:31], v[64:67], a[224:227]
    v_add_f32 v5, v5, v110
    v_add_f32 v5, v5, v111
    v_mfma_f32_16x16x32_bf16 a[228:231], v[28:31], v[72:75], a[228:231]
    v_cvt_pk_bf16_f32 v107, v110, v111
    v_mfma_f32_16x16x32_bf16 a[232:235], v[28:31], v[80:83], a[232:235]
    v_mfma_f32_16x16x32_bf16 a[236:239], v[28:31], v[88:91], a[236:239]
    ds_read_b128 v[28:31], v1 offset:33984
    v_mfma_f32_16x16x32_bf16 a[240:243], v[32:35], v[64:67], a[240:243]
    v_mfma_f32_16x16x32_bf16 a[244:247], v[32:35], v[72:75], a[244:247]
    v_mfma_f32_16x16x32_bf16 a[248:251], v[32:35], v[80:83], a[248:251]
    v_mfma_f32_16x16x32_bf16 a[252:255], v[32:35], v[88:91], a[252:255]
    s_waitcnt lgkmcnt(3)
    ds_read_b128 v[32:35], v1 offset:34048
    s_cbranch_vccnz L_stub_r2_1
L_ret_r2_1:
    v_mfma_f32_16x16x32_bf16 v[64:67], v[16:19], v[128:131], v[48:51]
    s_waitcnt lgkmcnt(3)
    ds_read_b128 v[36:39], v1 offset:34112
    v_mfma_f32_16x16x32_bf16 v[64:67], v[20:23], v[132:135], v[64:67]
    buffer_load_dwordx4 v3, s[16:19], s48 offen lds
    v_mfma_f32_16x16x32_bf16 v[72:75], v[16:19], v[160:163], v[52:55]
    s_add_u32 m0, m0, 0x220
    v_exp_f32 v112, v112
    v_mfma_f32_16x16x32_bf16 v[72:75], v[20:23], v[164:167], v[72:75]
    v_exp_f32 v113, v113
    v_mfma_f32_16x16x32_bf16 v[80:83], v[16:19], v[192:195], v[56:59]
    v_exp_f32 v114, v114
    v_mfma_f32_16x16x32_bf16 v[80:83], v[20:23], v[196:199], v[80:83]
    v_add_f32 v6, v6, v112
    v_add_f32 v6, v6, v113
    v_mfma_f32_16x16x32_bf16 v[88:91], v[16:19], v[224:227], v[60:63]
    ds_read_b128 v[16:19], v1 offset:34176
    v_mfma_f32_16x16x32_bf16 v[88:91], v[20:23], v[228:231], v[88:91]
    s_waitcnt lgkmcnt(4)
    ds_read_b128 v[20:23], v1 offset:34240
    v_mfma_f32_16x16x32_bf16 v[88:91], v[24:27], v[232:235], v[88:91]
    s_waitcnt lgkmcnt(4)
    buffer_load_dwordx4 v3, s[16:19], s48 offen offset:512 lds
    v_mfma_f32_16x16x32_bf16 v[88:91], v[28:31], v[236:239], v[88:91]
    s_add_u32 m0, m0, 0x220
    v_exp_f32 v115, v115
    v_mfma_f32_16x16x32_bf16 v[80:83], v[24:27], v[200:203], v[80:83]
    v_cvt_pk_bf16_f32 v112, v112, v113
    v_add_f32 v6, v6, v114
    v_mfma_f32_16x16x32_bf16 v[80:83], v[28:31], v[204:207], v[80:83]
    v_add_f32 v6, v6, v115
    v_cvt_pk_bf16_f32 v113, v114, v115
    v_mfma_f32_16x16x32_bf16 v[72:75], v[24:27], v[168:171], v[72:75]
    buffer_load_dwordx4 v3, s[16:19], s48 offen offset:1024 lds
    v_mfma_f32_16x16x32_bf16 v[72:75], v[28:31], v[172:175], v[72:75]
    s_add_u32 m0, m0, 0x220
    v_exp_f32 v116, v116
    v_mfma_f32_16x16x32_bf16 v[64:67], v[24:27], v[136:139], v[64:67]
    ds_read_b128 v[24:27], v1 offset:34304
    v_mfma_f32_16x16x32_bf16 v[64:67], v[28:31], v[140:143], v[64:67]
    s_waitcnt lgkmcnt(4)
    ds_read_b128 v[28:31], v1 offset:34368
    v_mfma_f32_16x16x32_bf16 v[64:67], v[32:35], v[144:147], v[64:67]
    s_waitcnt lgkmcnt(4)
    v_exp_f32 v117, v117
    v_mfma_f32_16x16x32_bf16 v[64:67], v[36:39], v[148:151], v[64:67]
    v_exp_f32 v118, v118
    v_mfma_f32_16x16x32_bf16 v[72:75], v[32:35], v[176:179], v[72:75]
    buffer_load_dwordx4 v3, s[16:19], s48 offen offset:1536 lds
    v_mfma_f32_16x16x32_bf16 v[72:75], v[36:39], v[180:183], v[72:75]
    s_add_u32 m0, m0, 0x220
    v_add_f32 v6, v6, v116
    v_add_f32 v6, v6, v117
    v_mfma_f32_16x16x32_bf16 v[80:83], v[32:35], v[208:211], v[80:83]
    v_exp_f32 v119, v119
    v_mfma_f32_16x16x32_bf16 v[80:83], v[36:39], v[212:215], v[80:83]
    v_cvt_pk_bf16_f32 v114, v116, v117
    v_add_f32 v6, v6, v118
    v_mfma_f32_16x16x32_bf16 v[88:91], v[32:35], v[240:243], v[88:91]
    ds_read_b128 v[32:35], v1 offset:34432
    v_add_f32 v6, v6, v119
    v_mfma_f32_16x16x32_bf16 v[88:91], v[36:39], v[244:247], v[88:91]
    s_waitcnt lgkmcnt(4)
    v_cvt_pk_bf16_f32 v115, v118, v119
    v_mfma_f32_16x16x32_bf16 v[88:91], v[16:19], v[248:251], v[88:91]
    s_waitcnt lgkmcnt(3)
    buffer_load_dwordx4 v3, s[16:19], s48 offen offset:2048 lds
    v_mfma_f32_16x16x32_bf16 v[88:91], v[20:23], v[252:255], v[88:91]
    s_add_u32 m0, m0, 0x220
    v_exp_f32 v120, v120
    v_mfma_f32_16x16x32_bf16 v[80:83], v[16:19], v[216:219], v[80:83]
    v_exp_f32 v121, v121
    v_mfma_f32_16x16x32_bf16 v[80:83], v[20:23], v[220:223], v[80:83]
    v_exp_f32 v122, v122
    v_mfma_f32_16x16x32_bf16 v[72:75], v[16:19], v[184:187], v[72:75]
    v_add_f32 v7, v7, v120
    v_add_f32 v7, v7, v121
    v_mfma_f32_16x16x32_bf16 v[72:75], v[20:23], v[188:191], v[72:75]
    v_exp_f32 v123, v123
    v_mfma_f32_16x16x32_bf16 v[64:67], v[16:19], v[152:155], v[64:67]
    ds_read_b128 v[16:19], v1 offset:34496
    v_cvt_pk_bf16_f32 v120, v120, v121
    v_mfma_f32_16x16x32_bf16 v[64:67], v[20:23], v[156:159], v[64:67]
    s_waitcnt lgkmcnt(3)
    ds_read_b128 v[20:23], v1 offset:34560
    v_add_f32 v7, v7, v122
    v_mfma_f32_16x16x32_bf16 v[68:71], v[24:27], v[128:131], v[48:51]
    s_waitcnt lgkmcnt(3)
    buffer_load_dwordx4 v3, s[16:19], s48 offen offset:2560 lds
    v_mfma_f32_16x16x32_bf16 v[68:71], v[28:31], v[132:135], v[68:71]
    s_add_u32 m0, m0, 0x220
    v_add_f32 v7, v7, v123
    v_cvt_pk_bf16_f32 v121, v122, v123
    v_mfma_f32_16x16x32_bf16 v[76:79], v[24:27], v[160:163], v[52:55]
    v_exp_f32 v124, v124
    v_mfma_f32_16x16x32_bf16 v[76:79], v[28:31], v[164:167], v[76:79]
    v_exp_f32 v125, v125
    v_mfma_f32_16x16x32_bf16 v[84:87], v[24:27], v[192:195], v[56:59]
    buffer_load_dwordx4 v3, s[16:19], s48 offen offset:3072 lds
    v_mfma_f32_16x16x32_bf16 v[84:87], v[28:31], v[196:199], v[84:87]
    s_add_u32 m0, m0, 0x220
    v_exp_f32 v126, v126
    v_mfma_f32_16x16x32_bf16 v[92:95], v[24:27], v[224:227], v[60:63]
    ds_read_b128 v[24:27], v1 offset:34624
    v_add_f32 v7, v7, v124
    v_mfma_f32_16x16x32_bf16 v[92:95], v[28:31], v[228:231], v[92:95]
    s_waitcnt lgkmcnt(3)
    ds_read_b128 v[28:31], v1 offset:34688
    v_add_f32 v7, v7, v125
    v_mfma_f32_16x16x32_bf16 v[92:95], v[32:35], v[232:235], v[92:95]
    s_waitcnt lgkmcnt(3)
    v_exp_f32 v127, v127
    v_mfma_f32_16x16x32_bf16 v[92:95], v[16:19], v[236:239], v[92:95]
    v_cvt_pk_bf16_f32 v122, v124, v125
    v_add_f32 v7, v7, v126
    v_mfma_f32_16x16x32_bf16 v[84:87], v[32:35], v[200:203], v[84:87]
    buffer_load_dwordx4 v3, s[16:19], s48 offen offset:3584 lds
    v_mfma_f32_16x16x32_bf16 v[84:87], v[16:19], v[204:207], v[84:87]
    s_add_u32 m0, s45, 0x18c00
    s_add_u32 s48, s48, 0x8000
    v_add_f32 v7, v7, v127
    v_mfma_f32_16x16x32_bf16 v[76:79], v[32:35], v[168:171], v[76:79]
    v_cvt_pk_bf16_f32 v123, v126, v127
    v_max3_f32 v8, v64, v65, v66
    v_mfma_f32_16x16x32_bf16 v[76:79], v[16:19], v[172:175], v[76:79]
    v_max3_f32 v8, v8, v67, v72
    v_max3_f32 v8, v8, v73, v74
    v_mfma_f32_16x16x32_bf16 v[68:71], v[32:35], v[136:139], v[68:71]
    ds_read_b128 v[32:35], v1 offset:34752
    v_max3_f32 v8, v8, v75, v80
    v_mfma_f32_16x16x32_bf16 v[68:71], v[16:19], v[140:143], v[68:71]
    s_waitcnt lgkmcnt(3)
    v_max3_f32 v8, v8, v81, v82
    v_max3_f32 v8, v8, v83, v88
    v_mfma_f32_16x16x32_bf16 v[68:71], v[20:23], v[144:147], v[68:71]
    s_waitcnt lgkmcnt(2)
    v_max3_f32 v8, v8, v89, v90
    v_mfma_f32_16x16x32_bf16 v[68:71], v[24:27], v[148:151], v[68:71]
    v_mfma_f32_16x16x32_bf16 v[76:79], v[20:23], v[176:179], v[76:79]
    s_waitcnt vmcnt(17) lgkmcnt(0)
    s_barrier
    ds_read_b64_tr_b16 v[16:17], v2
    v_mfma_f32_16x16x32_bf16 v[76:79], v[24:27], v[180:183], v[76:79]
    ds_read_b64_tr_b16 v[18:19], v2 offset:512
    v_mfma_f32_16x16x32_bf16 v[84:87], v[20:23], v[208:211], v[84:87]
    buffer_load_dwordx4 v3, s[12:15], s47 offen lds
    v_mfma_f32_16x16x32_bf16 v[84:87], v[24:27], v[212:215], v[84:87]
    s_add_u32 m0, m0, 0x220
    v_mfma_f32_16x16x32_bf16 v[92:95], v[20:23], v[240:243], v[92:95]
    ds_read_b64_tr_b16 v[20:21], v2 offset:32
    ds_read_b64_tr_b16 v[22:23], v2 offset:544
    v_mfma_f32_16x16x32_bf16 v[92:95], v[24:27], v[244:247], v[92:95]
    ds_read_b64_tr_b16 v[24:25], v2 offset:64
    ds_read_b64_tr_b16 v[26:27], v2 offset:576
    v_mfma_f32_16x16x32_bf16 v[92:95], v[28:31], v[248:251], v[92:95]
    v_mfma_f32_16x16x32_bf16 v[92:95], v[32:35], v[252:255], v[92:95]
    v_mfma_f32_16x16x32_bf16 v[84:87], v[28:31], v[216:219], v[84:87]
    buffer_load_dwordx4 v3, s[12:15], s47 offen offset:512 lds
    v_mfma_f32_16x16x32_bf16 v[84:87], v[32:35], v[220:223], v[84:87]
    s_add_u32 m0, m0, 0x220
    v_mfma_f32_16x16x32_bf16 v[76:79], v[28:31], v[184:187], v[76:79]
    v_mfma_f32_16x16x32_bf16 v[76:79], v[32:35], v[188:191], v[76:79]
    v_mfma_f32_16x16x32_bf16 v[68:71], v[28:31], v[152:155], v[68:71]
    ds_read_b64_tr_b16 v[28:29], v2 offset:96
    ds_read_b64_tr_b16 v[30:31], v2 offset:608
    v_mfma_f32_16x16x32_bf16 v[68:71], v[32:35], v[156:159], v[68:71]
    s_waitcnt lgkmcnt(6)
    ds_read_b64_tr_b16 v[32:33], v2 offset:128
    ds_read_b64_tr_b16 v[34:35], v2 offset:640
    v_mfma_f32_16x16x32_bf16 a[0:3], v[16:19], v[96:99], a[0:3]
    ds_read_b64_tr_b16 v[36:37], v2 offset:160
    ds_read_b64_tr_b16 v[38:39], v2 offset:672
    v_mfma_f32_16x16x32_bf16 a[4:7], v[16:19], v[104:107], a[4:7]
    buffer_load_dwordx4 v3, s[12:15], s47 offen offset:1024 lds
    v_mfma_f32_16x16x32_bf16 a[8:11], v[16:19], v[112:115], a[8:11]
    s_add_u32 m0, m0, 0x220
    v_mfma_f32_16x16x32_bf16 a[12:15], v[16:19], v[120:123], a[12:15]
    s_waitcnt lgkmcnt(8)
    ds_read_b64_tr_b16 v[16:17], v2 offset:192
    ds_read_b64_tr_b16 v[18:19], v2 offset:704
    v_mfma_f32_16x16x32_bf16 a[16:19], v[20:23], v[96:99], a[16:19]
    v_max3_f32 v8, v8, v91, v68
    v_max3_f32 v8, v8, v69, v70
    v_mfma_f32_16x16x32_bf16 a[20:23], v[20:23], v[104:107], a[20:23]
    v_max3_f32 v8, v8, v71, v76
    v_max3_f32 v8, v8, v77, v78
    v_mfma_f32_16x16x32_bf16 a[24:27], v[20:23], v[112:115], a[24:27]
    v_max3_f32 v8, v8, v79, v84
    v_max3_f32 v8, v8, v85, v86
    v_mfma_f32_16x16x32_bf16 a[28:31], v[20:23], v[120:123], a[28:31]
    s_waitcnt lgkmcnt(8)
    ds_read_b64_tr_b16 v[20:21], v2 offset:224
    ds_read_b64_tr_b16 v[22:23], v2 offset:736
    v_mfma_f32_16x16x32_bf16 a[32:35], v[24:27], v[96:99], a[32:35]
    v_max3_f32 v8, v8, v87, v92
    v_max3_f32 v8, v8, v93, v94
    v_mfma_f32_16x16x32_bf16 a[36:39], v[24:27], v[104:107], a[36:39]
    buffer_load_dwordx4 v3, s[12:15], s47 offen offset:1536 lds
    v_mfma_f32_16x16x32_bf16 a[40:43], v[24:27], v[112:115], a[40:43]
    s_add_u32 m0, m0, 0x220
    v_max_f32 v8, v8, v95
    v_cmp_lt_f32 vcc, 0x41800000, v8
    v_mfma_f32_16x16x32_bf16 a[44:47], v[24:27], v[120:123], a[44:47]
    s_waitcnt lgkmcnt(8)
    ds_read_b64_tr_b16 v[24:25], v2 offset:256
    ds_read_b64_tr_b16 v[26:27], v2 offset:768
    v_mfma_f32_16x16x32_bf16 a[48:51], v[28:31], v[96:99], a[48:51]
    v_mfma_f32_16x16x32_bf16 a[52:55], v[28:31], v[104:107], a[52:55]
    v_mfma_f32_16x16x32_bf16 a[56:59], v[28:31], v[112:115], a[56:59]
    s_cbranch_vccnz L_stub_r1_1
L_ret_r1_1:
    v_exp_f32 v64, v64
    v_mfma_f32_16x16x32_bf16 a[60:63], v[28:31], v[120:123], a[60:63]
    s_waitcnt lgkmcnt(8)
    ds_read_b64_tr_b16 v[28:29], v2 offset:288
    ds_read_b64_tr_b16 v[30:31], v2 offset:800
    v_mfma_f32_16x16x32_bf16 a[64:67], v[32:35], v[96:99], a[64:67]
    buffer_load_dwordx4 v3, s[12:15], s47 offen offset:2048 lds
    v_mfma_f32_16x16x32_bf16 a[68:71], v[32:35], v[104:107], a[68:71]
    s_add_u32 m0, m0, 0x220
    v_exp_f32 v65, v65
    v_mfma_f32_16x16x32_bf16 a[72:75], v[32:35], v[112:115], a[72:75]
    v_exp_f32 v66, v66
    v_mfma_f32_16x16x32_bf16 a[76:79], v[32:35], v[120:123], a[76:79]
    s_waitcnt lgkmcnt(8)
    ds_read_b64_tr_b16 v[32:33], v2 offset:320
    ds_read_b64_tr_b16 v[34:35], v2 offset:832
    v_mfma_f32_16x16x32_bf16 a[80:83], v[36:39], v[96:99], a[80:83]
    v_add_f32 v4, v4, v64
    v_add_f32 v4, v4, v65
    v_mfma_f32_16x16x32_bf16 a[84:87], v[36:39], v[104:107], a[84:87]
    v_exp_f32 v67, v67
    v_mfma_f32_16x16x32_bf16 a[88:91], v[36:39], v[112:115], a[88:91]
    v_cvt_pk_bf16_f32 v64, v64, v65
    v_add_f32 v4, v4, v66
    v_mfma_f32_16x16x32_bf16 a[92:95], v[36:39], v[120:123], a[92:95]
    s_waitcnt lgkmcnt(8)
    buffer_load_dwordx4 v3, s[12:15], s47 offen offset:2560 lds
    v_mfma_f32_16x16x32_bf16 a[96:99], v[16:19], v[96:99], a[96:99]
    s_add_u32 m0, m0, 0x220
    v_add_f32 v4, v4, v67
    v_cvt_pk_bf16_f32 v65, v66, v67
    v_mfma_f32_16x16x32_bf16 a[100:103], v[16:19], v[104:107], a[100:103]
    v_exp_f32 v68, v68
    v_mfma_f32_16x16x32_bf16 a[104:107], v[16:19], v[112:115], a[104:107]
    v_exp_f32 v69, v69
    v_mfma_f32_16x16x32_bf16 a[108:111], v[16:19], v[120:123], a[108:111]
    s_waitcnt lgkmcnt(6)
    ds_read_b64_tr_b16 v[16:17], v2 offset:352
    ds_read_b64_tr_b16 v[18:19], v2 offset:864
    v_mfma_f32_16x16x32_bf16 a[112:115], v[20:23], v[96:99], a[112:115]
    v_exp_f32 v70, v70
    v_mfma_f32_16x16x32_bf16 a[116:119], v[20:23], v[104:107], a[116:119]
    v_add_f32 v4, v4, v68
    v_add_f32 v4, v4, v69
    v_mfma_f32_16x16x32_bf16 a[120:123], v[20:23], v[112:115], a[120:123]
    v_exp_f32 v71, v71
    v_mfma_f32_16x16x32_bf16 a[124:127], v[20:23], v[120:123], a[124:127]
    s_waitcnt lgkmcnt(6)
    ds_read_b64_tr_b16 v[20:21], v2 offset:384
    ds_read_b64_tr_b16 v[22:23], v2 offset:896
    v_mfma_f32_16x16x32_bf16 a[128:131], v[24:27], v[96:99], a[128:131]
    buffer_load_dwordx4 v3, s[12:15], s47 offen offset:3072 lds
    v_mfma_f32_16x16x32_bf16 a[132:135], v[24:27], v[104:107], a[132:135]
    s_add_u32 m0, m0, 0x220
    v_cvt_pk_bf16_f32 v66, v68, v69
    v_add_f32 v4, v4, v70
    v_mfma_f32_16x16x32_bf16 a[136:139], v[24:27], v[112:115], a[136:139]
    v_add_f32 v4, v4, v71
    v_cvt_pk_bf16_f32 v67, v70, v71
    v_mfma_f32_16x16x32_bf16 a[140:143], v[24:27], v[120:123], a[140:143]
    s_waitcnt lgkmcnt(6)
    ds_read_b64_tr_b16 v[24:25], v2 offset:416
    ds_read_b64_tr_b16 v[26:27], v2 offset:928
    v_mfma_f32_16x16x32_bf16 a[144:147], v[28:31], v[96:99], a[144:147]
    v_exp_f32 v72, v72
    v_mfma_f32_16x16x32_bf16 a[148:151], v[28:31], v[104:107], a[148:151]
    v_exp_f32 v73, v73
    v_mfma_f32_16x16x32_bf16 a[152:155], v[28:31], v[112:115], a[152:155]
    buffer_load_dwordx4 v3, s[12:15], s47 offen offset:3584 lds
    v_mfma_f32_16x16x32_bf16 a[156:159], v[28:31], v[120:123], a[156:159]
    s_waitcnt lgkmcnt(6)
    ds_read_b64_tr_b16 v[28:29], v2 offset:448
    ds_read_b64_tr_b16 v[30:31], v2 offset:960
    v_mfma_f32_16x16x32_bf16 a[160:163], v[32:35], v[96:99], a[160:163]
    s_add_u32 m0, s45, 0
    s_add_u32 s47, s47, 0x8000
    v_mfma_f32_16x16x32_bf16 a[164:167], v[32:35], v[104:107], a[164:167]
    v_exp_f32 v74, v74
    v_mfma_f32_16x16x32_bf16 a[168:171], v[32:35], v[112:115], a[168:171]
    v_add_f32 v5, v5, v72
    v_add_f32 v5, v5, v73
    v_mfma_f32_16x16x32_bf16 a[172:175], v[32:35], v[120:123], a[172:175]
    s_waitcnt lgkmcnt(6)
    ds_read_b64_tr_b16 v[32:33], v2 offset:480
    ds_read_b64_tr_b16 v[34:35], v2 offset:992
    v_mfma_f32_16x16x32_bf16 a[176:179], v[16:19], v[96:99], a[176:179]
    v_exp_f32 v75, v75
    v_mfma_f32_16x16x32_bf16 a[180:183], v[16:19], v[104:107], a[180:183]
    v_cvt_pk_bf16_f32 v72, v72, v73
    v_add_f32 v5, v5, v74
    v_mfma_f32_16x16x32_bf16 a[184:187], v[16:19], v[112:115], a[184:187]
    v_add_f32 v5, v5, v75
    v_cvt_pk_bf16_f32 v73, v74, v75
    v_mfma_f32_16x16x32_bf16 a[188:191], v[16:19], v[120:123], a[188:191]
    s_waitcnt lgkmcnt(6)
    s_waitcnt vmcnt(16) lgkmcnt(0)
    s_barrier
    v_mfma_f32_16x16x32_bf16 a[192:195], v[20:23], v[96:99], a[192:195]
    ds_read_b128 v[16:19], v1
    v_mfma_f32_16x16x32_bf16 a[196:199], v[20:23], v[104:107], a[196:199]
    v_exp_f32 v76, v76
    v_mfma_f32_16x16x32_bf16 a[200:203], v[20:23], v[112:115], a[200:203]
    v_exp_f32 v77, v77
    v_mfma_f32_16x16x32_bf16 a[204:207], v[20:23], v[120:123], a[204:207]
    ds_read_b128 v[20:23], v1 offset:64
    v_mfma_f32_16x16x32_bf16 a[208:211], v[24:27], v[96:99], a[208:211]
    v_exp_f32 v78, v78
    v_mfma_f32_16x16x32_bf16 a[212:215], v[24:27], v[104:107], a[212:215]
    v_add_f32 v5, v5, v76
    v_add_f32 v5, v5, v77
    v_mfma_f32_16x16x32_bf16 a[216:219], v[24:27], v[112:115], a[216:219]
    v_exp_f32 v79, v79
    v_mfma_f32_16x16x32_bf16 a[220:223], v[24:27], v[120:123], a[220:223]
    ds_read_b128 v[24:27], v1 offset:128
    v_cvt_pk_bf16_f32 v74, v76, v77
    v_mfma_f32_16x16x32_bf16 a[224:227], v[28:31], v[96:99], a[224:227]
    v_add_f32 v5, v5, v78
    v_add_f32 v5, v5, v79
    v_mfma_f32_16x16x32_bf16 a[228:231], v[28:31], v[104:107], a[228:231]
    v_cvt_pk_bf16_f32 v75, v78, v79
    v_mfma_f32_16x16x32_bf16 a[232:235], v[28:31], v[112:115], a[232:235]
    v_mfma_f32_16x16x32_bf16 a[236:239], v[28:31], v[120:123], a[236:239]
    ds_read_b128 v[28:31], v1 offset:192
    v_mfma_f32_16x16x32_bf16 a[240:243], v[32:35], v[96:99], a[240:243]
    v_mfma_f32_16x16x32_bf16 a[244:247], v[32:35], v[104:107], a[244:247]
    v_mfma_f32_16x16x32_bf16 a[248:251], v[32:35], v[112:115], a[248:251]
    v_mfma_f32_16x16x32_bf16 a[252:255], v[32:35], v[120:123], a[252:255]
    s_waitcnt lgkmcnt(3)
    ds_read_b128 v[32:35], v1 offset:256
    s_sub_u32 s46, s46, 1
    s_cmp_lg_u32 s46, 0
    s_cbranch_scc1 L_loop
    s_cbranch_vccnz L_stub_r2_p28
L_ret_r2_p28:
    v_mfma_f32_16x16x32_bf16 v[96:99], v[16:19], v[128:131], v[48:51]
    s_waitcnt lgkmcnt(3)
    ds_read_b128 v[36:39], v1 offset:320
    v_mfma_f32_16x16x32_bf16 v[96:99], v[20:23], v[132:135], v[96:99]
    buffer_load_dwordx4 v3, s[16:19], s48 offen lds
    v_mfma_f32_16x16x32_bf16 v[104:107], v[16:19], v[160:163], v[52:55]
    s_add_u32 m0, m0, 0x220
    v_exp_f32 v80, v80
    v_mfma_f32_16x16x32_bf16 v[104:107], v[20:23], v[164:167], v[104:107]
    v_exp_f32 v81, v81
    v_mfma_f32_16x16x32_bf16 v[112:115], v[16:19], v[192:195], v[56:59]
    v_exp_f32 v82, v82
    v_mfma_f32_16x16x32_bf16 v[112:115], v[20:23], v[196:199], v[112:115]
    v_add_f32 v6, v6, v80
    v_add_f32 v6, v6, v81
    v_mfma_f32_16x16x32_bf16 v[120:123], v[16:19], v[224:227], v[60:63]
    ds_read_b128 v[16:19], v1 offset:384
    v_mfma_f32_16x16x32_bf16 v[120:123], v[20:23], v[228:231], v[120:123]
    s_waitcnt lgkmcnt(4)
    ds_read_b128 v[20:23], v1 offset:448
    v_mfma_f32_16x16x32_bf16 v[120:123], v[24:27], v[232:235], v[120:123]
    s_waitcnt lgkmcnt(4)
    buffer_load_dwordx4 v3, s[16:19], s48 offen offset:512 lds
    v_mfma_f32_16x16x32_bf16 v[120:123], v[28:31], v[236:239], v[120:123]
    s_add_u32 m0, m0, 0x220
    v_exp_f32 v83, v83
    v_mfma_f32_16x16x32_bf16 v[112:115], v[24:27], v[200:203], v[112:115]
    s_lshl_b32 s57, s44, 2
    s_add_u32 s57, s57, s42
    s_mul_i32 s57, s57, 0xe00
    v_mfma_f32_16x16x32_bf16 v[112:115], v[28:31], v[204:207], v[112:115]
    s_mul_i32 s58, s43, 0x38000
    s_add_u32 s57, s57, s58
    v_and_b32 v9, 62, v0
    v_mfma_f32_16x16x32_bf16 v[104:107], v[24:27], v[168:171], v[104:107]
    buffer_load_dwordx4 v3, s[16:19], s48 offen offset:1024 lds
    v_mfma_f32_16x16x32_bf16 v[104:107], v[28:31], v[172:175], v[104:107]
    s_add_u32 m0, m0, 0x220
    v_lshlrev_b32 v9, 6, v9
    v_cvt_pk_bf16_f32 v80, v80, v81
    v_mfma_f32_16x16x32_bf16 v[96:99], v[24:27], v[136:139], v[96:99]
    ds_read_b128 v[24:27], v1 offset:512
    v_add_f32 v6, v6, v82
    v_mfma_f32_16x16x32_bf16 v[96:99], v[28:31], v[140:143], v[96:99]
    s_waitcnt lgkmcnt(4)
    ds_read_b128 v[28:31], v1 offset:576
    v_add_f32 v6, v6, v83
    v_mfma_f32_16x16x32_bf16 v[96:99], v[32:35], v[144:147], v[96:99]
    s_waitcnt lgkmcnt(4)
    v_cvt_pk_bf16_f32 v81, v82, v83
    v_mfma_f32_16x16x32_bf16 v[96:99], v[36:39], v[148:151], v[96:99]
    v_exp_f32 v84, v84
    v_mfma_f32_16x16x32_bf16 v[104:107], v[32:35], v[176:179], v[104:107]
    buffer_load_dwordx4 v3, s[16:19], s48 offen offset:1536 lds
    v_mfma_f32_16x16x32_bf16 v[104:107], v[36:39], v[180:183], v[104:107]
    s_add_u32 m0, m0, 0x220
    v_exp_f32 v85, v85
    v_mfma_f32_16x16x32_bf16 v[112:115], v[32:35], v[208:211], v[112:115]
    v_exp_f32 v86, v86
    v_mfma_f32_16x16x32_bf16 v[112:115], v[36:39], v[212:215], v[112:115]
    v_add_f32 v6, v6, v84
    v_add_f32 v6, v6, v85
    v_mfma_f32_16x16x32_bf16 v[120:123], v[32:35], v[240:243], v[120:123]
    ds_read_b128 v[32:35], v1 offset:640
    v_mfma_f32_16x16x32_bf16 v[120:123], v[36:39], v[244:247], v[120:123]
    s_waitcnt lgkmcnt(4)
    v_exp_f32 v87, v87
    v_mfma_f32_16x16x32_bf16 v[120:123], v[16:19], v[248:251], v[120:123]
    s_waitcnt lgkmcnt(3)
    buffer_load_dwordx4 v3, s[16:19], s48 offen offset:2048 lds
    v_mfma_f32_16x16x32_bf16 v[120:123], v[20:23], v[252:255], v[120:123]
    s_add_u32 m0, m0, 0x220
    v_cvt_pk_bf16_f32 v82, v84, v85
    v_add_f32 v6, v6, v86
    v_mfma_f32_16x16x32_bf16 v[112:115], v[16:19], v[216:219], v[112:115]
    v_add_f32 v6, v6, v87
    v_cvt_pk_bf16_f32 v83, v86, v87
    v_mfma_f32_16x16x32_bf16 v[112:115], v[20:23], v[220:223], v[112:115]
    v_exp_f32 v88, v88
    v_mfma_f32_16x16x32_bf16 v[104:107], v[16:19], v[184:187], v[104:107]
    v_exp_f32 v89, v89
    v_mfma_f32_16x16x32_bf16 v[104:107], v[20:23], v[188:191], v[104:107]
    v_exp_f32 v90, v90
    v_mfma_f32_16x16x32_bf16 v[96:99], v[16:19], v[152:155], v[96:99]
    ds_read_b128 v[16:19], v1 offset:704
    v_add_f32 v7, v7, v88
    v_mfma_f32_16x16x32_bf16 v[96:99], v[20:23], v[156:159], v[96:99]
    s_waitcnt lgkmcnt(3)
    ds_read_b128 v[20:23], v1 offset:768
    v_add_f32 v7, v7, v89
    v_mfma_f32_16x16x32_bf16 v[100:103], v[24:27], v[128:131], v[48:51]
    s_waitcnt lgkmcnt(3)
    buffer_load_dwordx4 v3, s[16:19], s48 offen offset:2560 lds
    v_mfma_f32_16x16x32_bf16 v[100:103], v[28:31], v[132:135], v[100:103]
    s_add_u32 m0, m0, 0x220
    v_exp_f32 v91, v91
    v_mfma_f32_16x16x32_bf16 v[108:111], v[24:27], v[160:163], v[52:55]
    v_cvt_pk_bf16_f32 v88, v88, v89
    v_add_f32 v7, v7, v90
    v_mfma_f32_16x16x32_bf16 v[108:111], v[28:31], v[164:167], v[108:111]
    v_add_f32 v7, v7, v91
    v_cvt_pk_bf16_f32 v89, v90, v91
    v_mfma_f32_16x16x32_bf16 v[116:119], v[24:27], v[192:195], v[56:59]
    buffer_load_dwordx4 v3, s[16:19], s48 offen offset:3072 lds
    v_mfma_f32_16x16x32_bf16 v[116:119], v[28:31], v[196:199], v[116:119]
    s_add_u32 m0, m0, 0x220
    v_exp_f32 v92, v92
    v_mfma_f32_16x16x32_bf16 v[124:127], v[24:27], v[224:227], v[60:63]
    ds_read_b128 v[24:27], v1 offset:832
    v_max3_f32 v8, v96, v97, v98
    v_mfma_f32_16x16x32_bf16 v[124:127], v[28:31], v[228:231], v[124:127]
    s_waitcnt lgkmcnt(3)
    ds_read_b128 v[28:31], v1 offset:896
    v_max3_f32 v8, v8, v99, v104
    v_mfma_f32_16x16x32_bf16 v[124:127], v[32:35], v[232:235], v[124:127]
    s_waitcnt lgkmcnt(3)
    v_exp_f32 v93, v93
    v_mfma_f32_16x16x32_bf16 v[124:127], v[16:19], v[236:239], v[124:127]
    v_exp_f32 v94, v94
    v_mfma_f32_16x16x32_bf16 v[116:119], v[32:35], v[200:203], v[116:119]
    buffer_load_dwordx4 v3, s[16:19], s48 offen offset:3584 lds
    v_mfma_f32_16x16x32_bf16 v[116:119], v[16:19], v[204:207], v[116:119]
    s_add_u32 m0, s45, 0x10800
    s_add_u32 s48, s48, 0x8000
    v_add_f32 v7, v7, v92
    v_mfma_f32_16x16x32_bf16 v[108:111], v[32:35], v[168:171], v[108:111]
    v_add_f32 v7, v7, v93
    v_max3_f32 v8, v8, v105, v106
    v_mfma_f32_16x16x32_bf16 v[108:111], v[16:19], v[172:175], v[108:111]
    v_exp_f32 v95, v95
    v_mfma_f32_16x16x32_bf16 v[100:103], v[32:35], v[136:139], v[100:103]
    ds_read_b128 v[32:35], v1 offset:960
    v_cvt_pk_bf16_f32 v90, v92, v93
    v_mfma_f32_16x16x32_bf16 v[100:103], v[16:19], v[140:143], v[100:103]
    s_waitcnt lgkmcnt(3)
    v_add_f32 v7, v7, v94
    v_add_f32 v7, v7, v95
    v_mfma_f32_16x16x32_bf16 v[100:103], v[20:23], v[144:147], v[100:103]
    s_waitcnt lgkmcnt(2)
    v_cvt_pk_bf16_f32 v91, v94, v95
    v_max3_f32 v8, v8, v107, v112
    v_mfma_f32_16x16x32_bf16 v[100:103], v[24:27], v[148:151], v[100:103]
    v_max3_f32 v8, v8, v113, v114
    v_max3_f32 v8, v8, v115, v120
    v_mfma_f32_16x16x32_bf16 v[108:111], v[20:23], v[176:179], v[108:111]
    s_waitcnt vmcnt(16) lgkmcnt(0)
    s_barrier
    ds_read_b64_tr_b16 v[16:17], v2 offset:33792
    v_mfma_f32_16x16x32_bf16 v[108:111], v[24:27], v[180:183], v[108:111]
    ds_read_b64_tr_b16 v[18:19], v2 offset:34304
    v_max3_f32 v8, v8, v121, v122
    v_mfma_f32_16x16x32_bf16 v[116:119], v[20:23], v[208:211], v[116:119]
    buffer_load_dwordx4 v3, s[12:15], s47 offen lds
    v_mfma_f32_16x16x32_bf16 v[116:119], v[24:27], v[212:215], v[116:119]
    s_add_u32 m0, m0, 0x220
    v_mfma_f32_16x16x32_bf16 v[124:127], v[20:23], v[240:243], v[124:127]
    ds_read_b64_tr_b16 v[20:21], v2 offset:33824
    ds_read_b64_tr_b16 v[22:23], v2 offset:34336
    v_mfma_f32_16x16x32_bf16 v[124:127], v[24:27], v[244:247], v[124:127]
    ds_read_b64_tr_b16 v[24:25], v2 offset:33856
    ds_read_b64_tr_b16 v[26:27], v2 offset:34368
    v_mfma_f32_16x16x32_bf16 v[124:127], v[28:31], v[248:251], v[124:127]
    buffer_load_dword v13, v9, s[24:27], s57 offen
    v_mfma_f32_16x16x32_bf16 v[124:127], v[32:35], v[252:255], v[124:127]
    v_mfma_f32_16x16x32_bf16 v[116:119], v[28:31], v[216:219], v[116:119]
    buffer_load_dwordx4 v3, s[12:15], s47 offen offset:512 lds
    v_mfma_f32_16x16x32_bf16 v[116:119], v[32:35], v[220:223], v[116:119]
    s_add_u32 m0, m0, 0x220
    v_mfma_f32_16x16x32_bf16 v[108:111], v[28:31], v[184:187], v[108:111]
    v_mfma_f32_16x16x32_bf16 v[108:111], v[32:35], v[188:191], v[108:111]
    v_mfma_f32_16x16x32_bf16 v[100:103], v[28:31], v[152:155], v[100:103]
    ds_read_b64_tr_b16 v[28:29], v2 offset:33888
    ds_read_b64_tr_b16 v[30:31], v2 offset:34400
    v_mfma_f32_16x16x32_bf16 v[100:103], v[32:35], v[156:159], v[100:103]
    s_waitcnt lgkmcnt(6)
    ds_read_b64_tr_b16 v[32:33], v2 offset:33920
    ds_read_b64_tr_b16 v[34:35], v2 offset:34432
    v_mfma_f32_16x16x32_bf16 a[0:3], v[16:19], v[64:67], a[0:3]
    ds_read_b64_tr_b16 v[36:37], v2 offset:33952
    ds_read_b64_tr_b16 v[38:39], v2 offset:34464
    v_mfma_f32_16x16x32_bf16 a[4:7], v[16:19], v[72:75], a[4:7]
    buffer_load_dwordx4 v3, s[12:15], s47 offen offset:1024 lds
    v_mfma_f32_16x16x32_bf16 a[8:11], v[16:19], v[80:83], a[8:11]
    s_add_u32 m0, m0, 0x220
    v_mfma_f32_16x16x32_bf16 a[12:15], v[16:19], v[88:91], a[12:15]
    s_waitcnt lgkmcnt(8)
    ds_read_b64_tr_b16 v[16:17], v2 offset:33984
    ds_read_b64_tr_b16 v[18:19], v2 offset:34496
    v_mfma_f32_16x16x32_bf16 a[16:19], v[20:23], v[64:67], a[16:19]
    v_max3_f32 v8, v8, v123, v100
    v_max3_f32 v8, v8, v101, v102
    v_mfma_f32_16x16x32_bf16 a[20:23], v[20:23], v[72:75], a[20:23]
    v_max3_f32 v8, v8, v103, v108
    v_max3_f32 v8, v8, v109, v110
    v_mfma_f32_16x16x32_bf16 a[24:27], v[20:23], v[80:83], a[24:27]
    v_max3_f32 v8, v8, v111, v116
    v_max3_f32 v8, v8, v117, v118
    v_mfma_f32_16x16x32_bf16 a[28:31], v[20:23], v[88:91], a[28:31]
    s_waitcnt lgkmcnt(8)
    ds_read_b64_tr_b16 v[20:21], v2 offset:34016
    ds_read_b64_tr_b16 v[22:23], v2 offset:34528
    v_mfma_f32_16x16x32_bf16 a[32:35], v[24:27], v[64:67], a[32:35]
    v_max3_f32 v8, v8, v119, v124
    v_max3_f32 v8, v8, v125, v126
    v_mfma_f32_16x16x32_bf16 a[36:39], v[24:27], v[72:75], a[36:39]
    buffer_load_dwordx4 v3, s[12:15], s47 offen offset:1536 lds
    v_mfma_f32_16x16x32_bf16 a[40:43], v[24:27], v[80:83], a[40:43]
    s_add_u32 m0, m0, 0x220
    v_max_f32 v8, v8, v127
    v_cmp_lt_f32 vcc, 0x41800000, v8
    v_mfma_f32_16x16x32_bf16 a[44:47], v[24:27], v[88:91], a[44:47]
    s_waitcnt lgkmcnt(8)
    ds_read_b64_tr_b16 v[24:25], v2 offset:34048
    ds_read_b64_tr_b16 v[26:27], v2 offset:34560
    v_mfma_f32_16x16x32_bf16 a[48:51], v[28:31], v[64:67], a[48:51]
    v_mfma_f32_16x16x32_bf16 a[52:55], v[28:31], v[72:75], a[52:55]
    v_mfma_f32_16x16x32_bf16 a[56:59], v[28:31], v[80:83], a[56:59]
    s_cbranch_vccnz L_stub_r1_p28
L_ret_r1_p28:
    v_exp_f32 v96, v96
    v_mfma_f32_16x16x32_bf16 a[60:63], v[28:31], v[88:91], a[60:63]
    s_waitcnt lgkmcnt(8)
    ds_read_b64_tr_b16 v[28:29], v2 offset:34080
    ds_read_b64_tr_b16 v[30:31], v2 offset:34592
    v_mfma_f32_16x16x32_bf16 a[64:67], v[32:35], v[64:67], a[64:67]
    buffer_load_dwordx4 v3, s[12:15], s47 offen offset:2048 lds
    v_mfma_f32_16x16x32_bf16 a[68:71], v[32:35], v[72:75], a[68:71]
    s_add_u32 m0, m0, 0x220
    v_exp_f32 v97, v97
    v_mfma_f32_16x16x32_bf16 a[72:75], v[32:35], v[80:83], a[72:75]
    v_exp_f32 v98, v98
    v_mfma_f32_16x16x32_bf16 a[76:79], v[32:35], v[88:91], a[76:79]
    s_waitcnt lgkmcnt(8)
    ds_read_b64_tr_b16 v[32:33], v2 offset:34112
    ds_read_b64_tr_b16 v[34:35], v2 offset:34624
    v_mfma_f32_16x16x32_bf16 a[80:83], v[36:39], v[64:67], a[80:83]
    v_add_f32 v4, v4, v96
    v_add_f32 v4, v4, v97
    v_mfma_f32_16x16x32_bf16 a[84:87], v[36:39], v[72:75], a[84:87]
    v_exp_f32 v99, v99
    v_mfma_f32_16x16x32_bf16 a[88:91], v[36:39], v[80:83], a[88:91]
    v_cvt_pk_bf16_f32 v96, v96, v97
    v_add_f32 v4, v4, v98
    v_mfma_f32_16x16x32_bf16 a[92:95], v[36:39], v[88:91], a[92:95]
    s_waitcnt lgkmcnt(8)
    buffer_load_dwordx4 v3, s[12:15], s47 offen offset:2560 lds
    v_mfma_f32_16x16x32_bf16 a[96:99], v[16:19], v[64:67], a[96:99]
    s_add_u32 m0, m0, 0x220
    v_add_f32 v4, v4, v99
    v_cvt_pk_bf16_f32 v97, v98, v99
    v_mfma_f32_16x16x32_bf16 a[100:103], v[16:19], v[72:75], a[100:103]
    v_exp_f32 v100, v100
    v_mfma_f32_16x16x32_bf16 a[104:107], v[16:19], v[80:83], a[104:107]
    v_exp_f32 v101, v101
    v_mfma_f32_16x16x32_bf16 a[108:111], v[16:19], v[88:91], a[108:111]
    s_waitcnt lgkmcnt(6)
    ds_read_b64_tr_b16 v[16:17], v2 offset:34144
    ds_read_b64_tr_b16 v[18:19], v2 offset:34656
    v_mfma_f32_16x16x32_bf16 a[112:115], v[20:23], v[64:67], a[112:115]
    v_exp_f32 v102, v102
    v_mfma_f32_16x16x32_bf16 a[116:119], v[20:23], v[72:75], a[116:119]
    v_add_f32 v4, v4, v100
    v_add_f32 v4, v4, v101
    v_mfma_f32_16x16x32_bf16 a[120:123], v[20:23], v[80:83], a[120:123]
    v_exp_f32 v103, v103
    v_mfma_f32_16x16x32_bf16 a[124:127], v[20:23], v[88:91], a[124:127]
    s_waitcnt lgkmcnt(6)
    ds_read_b64_tr_b16 v[20:21], v2 offset:34176
    ds_read_b64_tr_b16 v[22:23], v2 offset:34688
    v_mfma_f32_16x16x32_bf16 a[128:131], v[24:27], v[64:67], a[128:131]
    buffer_load_dwordx4 v3, s[12:15], s47 offen offset:3072 lds
    v_mfma_f32_16x16x32_bf16 a[132:135], v[24:27], v[72:75], a[132:135]
    s_add_u32 m0, m0, 0x220
    v_cvt_pk_bf16_f32 v98, v100, v101
    v_add_f32 v4, v4, v102
    v_mfma_f32_16x16x32_bf16 a[136:139], v[24:27], v[80:83], a[136:139]
    v_add_f32 v4, v4, v103
    v_cvt_pk_bf16_f32 v99, v102, v103
    v_mfma_f32_16x16x32_bf16 a[140:143], v[24:27], v[88:91], a[140:143]
    s_waitcnt lgkmcnt(6)
    ds_read_b64_tr_b16 v[24:25], v2 offset:34208
    ds_read_b64_tr_b16 v[26:27], v2 offset:34720
    v_mfma_f32_16x16x32_bf16 a[144:147], v[28:31], v[64:67], a[144:147]
    v_exp_f32 v104, v104
    v_mfma_f32_16x16x32_bf16 a[148:151], v[28:31], v[72:75], a[148:151]
    v_exp_f32 v105, v105
    v_mfma_f32_16x16x32_bf16 a[152:155], v[28:31], v[80:83], a[152:155]
    buffer_load_dwordx4 v3, s[12:15], s47 offen offset:3584 lds
    v_mfma_f32_16x16x32_bf16 a[156:159], v[28:31], v[88:91], a[156:159]
    s_waitcnt lgkmcnt(6)
    ds_read_b64_tr_b16 v[28:29], v2 offset:34240
    ds_read_b64_tr_b16 v[30:31], v2 offset:34752
    v_mfma_f32_16x16x32_bf16 a[160:163], v[32:35], v[64:67], a[160:163]
    s_add_u32 m0, s45, 0x8400
    s_add_u32 s47, s47, 0x8000
    v_mfma_f32_16x16x32_bf16 a[164:167], v[32:35], v[72:75], a[164:167]
    v_exp_f32 v106, v106
    v_mfma_f32_16x16x32_bf16 a[168:171], v[32:35], v[80:83], a[168:171]
    v_add_f32 v5, v5, v104
    v_add_f32 v5, v5, v105
    v_mfma_f32_16x16x32_bf16 a[172:175], v[32:35], v[88:91], a[172:175]
    s_waitcnt lgkmcnt(6)
    ds_read_b64_tr_b16 v[32:33], v2 offset:34272
    ds_read_b64_tr_b16 v[34:35], v2 offset:34784
    v_mfma_f32_16x16x32_bf16 a[176:179], v[16:19], v[64:67], a[176:179]
    v_exp_f32 v107, v107
    v_mfma_f32_16x16x32_bf16 a[180:183], v[16:19], v[72:75], a[180:183]
    v_cvt_pk_bf16_f32 v104, v104, v105
    v_add_f32 v5, v5, v106
    v_mfma_f32_16x16x32_bf16 a[184:187], v[16:19], v[80:83], a[184:187]
    v_add_f32 v5, v5, v107
    v_cvt_pk_bf16_f32 v105, v106, v107
    v_mfma_f32_16x16x32_bf16 a[188:191], v[16:19], v[88:91], a[188:191]
    s_waitcnt lgkmcnt(6)
    s_waitcnt vmcnt(17) lgkmcnt(0)
    s_barrier
    v_mfma_f32_16x16x32_bf16 a[192:195], v[20:23], v[64:67], a[192:195]
    ds_read_b128 v[16:19], v1 offset:33792
    v_mfma_f32_16x16x32_bf16 a[196:199], v[20:23], v[72:75], a[196:199]
    v_exp_f32 v108, v108
    v_mfma_f32_16x16x32_bf16 a[200:203], v[20:23], v[80:83], a[200:203]
    v_exp_f32 v109, v109
    v_mfma_f32_16x16x32_bf16 a[204:207], v[20:23], v[88:91], a[204:207]
    ds_read_b128 v[20:23], v1 offset:33856
    v_mfma_f32_16x16x32_bf16 a[208:211], v[24:27], v[64:67], a[208:211]
    v_exp_f32 v110, v110
    v_mfma_f32_16x16x32_bf16 a[212:215], v[24:27], v[72:75], a[212:215]
    v_add_f32 v5, v5, v108
    v_add_f32 v5, v5, v109
    v_mfma_f32_16x16x32_bf16 a[216:219], v[24:27], v[80:83], a[216:219]
    v_exp_f32 v111, v111
    v_mfma_f32_16x16x32_bf16 a[220:223], v[24:27], v[88:91], a[220:223]
    ds_read_b128 v[24:27], v1 offset:33920
    v_cvt_pk_bf16_f32 v106, v108, v109
    v_mfma_f32_16x16x32_bf16 a[224:227], v[28:31], v[64:67], a[224:227]
    v_add_f32 v5, v5, v110
    v_add_f32 v5, v5, v111
    v_mfma_f32_16x16x32_bf16 a[228:231], v[28:31], v[72:75], a[228:231]
    v_cvt_pk_bf16_f32 v107, v110, v111
    v_mfma_f32_16x16x32_bf16 a[232:235], v[28:31], v[80:83], a[232:235]
    v_mfma_f32_16x16x32_bf16 a[236:239], v[28:31], v[88:91], a[236:239]
    ds_read_b128 v[28:31], v1 offset:33984
    v_mfma_f32_16x16x32_bf16 a[240:243], v[32:35], v[64:67], a[240:243]
    v_mfma_f32_16x16x32_bf16 a[244:247], v[32:35], v[72:75], a[244:247]
    v_mfma_f32_16x16x32_bf16 a[248:251], v[32:35], v[80:83], a[248:251]
    v_mfma_f32_16x16x32_bf16 a[252:255], v[32:35], v[88:91], a[252:255]
    s_waitcnt lgkmcnt(3)
    ds_read_b128 v[32:35], v1 offset:34048
    s_cbranch_vccnz L_stub_r2_p29
L_ret_r2_p29:
    v_mfma_f32_16x16x32_bf16 v[64:67], v[16:19], v[128:131], v[48:51]
    s_waitcnt lgkmcnt(3)
    ds_read_b128 v[36:39], v1 offset:34112
    v_mfma_f32_16x16x32_bf16 v[64:67], v[20:23], v[132:135], v[64:67]
    buffer_load_dwordx4 v3, s[16:19], s48 offen lds
    v_mfma_f32_16x16x32_bf16 v[72:75], v[16:19], v[160:163], v[52:55]
    s_add_u32 m0, m0, 0x220
    v_exp_f32 v112, v112
    v_mfma_f32_16x16x32_bf16 v[72:75], v[20:23], v[164:167], v[72:75]
    v_exp_f32 v113, v113
    v_mfma_f32_16x16x32_bf16 v[80:83], v[16:19], v[192:195], v[56:59]
    v_exp_f32 v114, v114
    v_mfma_f32_16x16x32_bf16 v[80:83], v[20:23], v[196:199], v[80:83]
    v_add_f32 v6, v6, v112
    v_add_f32 v6, v6, v113
    v_mfma_f32_16x16x32_bf16 v[88:91], v[16:19], v[224:227], v[60:63]
    ds_read_b128 v[16:19], v1 offset:34176
    v_mfma_f32_16x16x32_bf16 v[88:91], v[20:23], v[228:231], v[88:91]
    s_waitcnt lgkmcnt(4)
    ds_read_b128 v[20:23], v1 offset:34240
    v_mfma_f32_16x16x32_bf16 v[88:91], v[24:27], v[232:235], v[88:91]
    s_waitcnt lgkmcnt(4)
    buffer_load_dwordx4 v3, s[16:19], s48 offen offset:512 lds
    v_mfma_f32_16x16x32_bf16 v[88:91], v[28:31], v[236:239], v[88:91]
    s_add_u32 m0, m0, 0x220
    v_exp_f32 v115, v115
    v_mfma_f32_16x16x32_bf16 v[80:83], v[24:27], v[200:203], v[80:83]
    v_cvt_pk_bf16_f32 v112, v112, v113
    v_add_f32 v6, v6, v114
    v_mfma_f32_16x16x32_bf16 v[80:83], v[28:31], v[204:207], v[80:83]
    v_add_f32 v6, v6, v115
    v_cvt_pk_bf16_f32 v113, v114, v115
    v_mfma_f32_16x16x32_bf16 v[72:75], v[24:27], v[168:171], v[72:75]
    buffer_load_dwordx4 v3, s[16:19], s48 offen offset:1024 lds
    v_mfma_f32_16x16x32_bf16 v[72:75], v[28:31], v[172:175], v[72:75]
    s_add_u32 m0, m0, 0x220
    v_exp_f32 v116, v116
    v_mfma_f32_16x16x32_bf16 v[64:67], v[24:27], v[136:139], v[64:67]
    ds_read_b128 v[24:27], v1 offset:34304
    v_mfma_f32_16x16x32_bf16 v[64:67], v[28:31], v[140:143], v[64:67]
    s_waitcnt lgkmcnt(4)
    ds_read_b128 v[28:31], v1 offset:34368
    v_mfma_f32_16x16x32_bf16 v[64:67], v[32:35], v[144:147], v[64:67]
    s_waitcnt lgkmcnt(4)
    v_exp_f32 v117, v117
    v_mfma_f32_16x16x32_bf16 v[64:67], v[36:39], v[148:151], v[64:67]
    v_exp_f32 v118, v118
    v_mfma_f32_16x16x32_bf16 v[72:75], v[32:35], v[176:179], v[72:75]
    buffer_load_dwordx4 v3, s[16:19], s48 offen offset:1536 lds
    v_mfma_f32_16x16x32_bf16 v[72:75], v[36:39], v[180:183], v[72:75]
    s_add_u32 m0, m0, 0x220
    v_add_f32 v6, v6, v116
    v_add_f32 v6, v6, v117
    v_mfma_f32_16x16x32_bf16 v[80:83], v[32:35], v[208:211], v[80:83]
    v_exp_f32 v119, v119
    v_mfma_f32_16x16x32_bf16 v[80:83], v[36:39], v[212:215], v[80:83]
    v_cvt_pk_bf16_f32 v114, v116, v117
    v_add_f32 v6, v6, v118
    v_mfma_f32_16x16x32_bf16 v[88:91], v[32:35], v[240:243], v[88:91]
    ds_read_b128 v[32:35], v1 offset:34432
    v_add_f32 v6, v6, v119
    v_mfma_f32_16x16x32_bf16 v[88:91], v[36:39], v[244:247], v[88:91]
    s_waitcnt lgkmcnt(4)
    v_cvt_pk_bf16_f32 v115, v118, v119
    v_mfma_f32_16x16x32_bf16 v[88:91], v[16:19], v[248:251], v[88:91]
    s_waitcnt lgkmcnt(3)
    buffer_load_dwordx4 v3, s[16:19], s48 offen offset:2048 lds
    v_mfma_f32_16x16x32_bf16 v[88:91], v[20:23], v[252:255], v[88:91]
    s_add_u32 m0, m0, 0x220
    v_exp_f32 v120, v120
    v_mfma_f32_16x16x32_bf16 v[80:83], v[16:19], v[216:219], v[80:83]
    v_exp_f32 v121, v121
    v_mfma_f32_16x16x32_bf16 v[80:83], v[20:23], v[220:223], v[80:83]
    v_exp_f32 v122, v122
    v_mfma_f32_16x16x32_bf16 v[72:75], v[16:19], v[184:187], v[72:75]
    v_add_f32 v7, v7, v120
    v_add_f32 v7, v7, v121
    v_mfma_f32_16x16x32_bf16 v[72:75], v[20:23], v[188:191], v[72:75]
    v_exp_f32 v123, v123
    v_mfma_f32_16x16x32_bf16 v[64:67], v[16:19], v[152:155], v[64:67]
    ds_read_b128 v[16:19], v1 offset:34496
    v_cvt_pk_bf16_f32 v120, v120, v121
    v_mfma_f32_16x16x32_bf16 v[64:67], v[20:23], v[156:159], v[64:67]
    s_waitcnt lgkmcnt(3)
    ds_read_b128 v[20:23], v1 offset:34560
    v_add_f32 v7, v7, v122
    v_mfma_f32_16x16x32_bf16 v[68:71], v[24:27], v[128:131], v[48:51]
    s_waitcnt lgkmcnt(3)
    buffer_load_dwordx4 v3, s[16:19], s48 offen offset:2560 lds
    v_mfma_f32_16x16x32_bf16 v[68:71], v[28:31], v[132:135], v[68:71]
    s_add_u32 m0, m0, 0x220
    v_add_f32 v7, v7, v123
    v_cvt_pk_bf16_f32 v121, v122, v123
    v_mfma_f32_16x16x32_bf16 v[76:79], v[24:27], v[160:163], v[52:55]
    v_exp_f32 v124, v124
    v_mfma_f32_16x16x32_bf16 v[76:79], v[28:31], v[164:167], v[76:79]
    v_exp_f32 v125, v125
    v_mfma_f32_16x16x32_bf16 v[84:87], v[24:27], v[192:195], v[56:59]
    buffer_load_dwordx4 v3, s[16:19], s48 offen offset:3072 lds
    v_mfma_f32_16x16x32_bf16 v[84:87], v[28:31], v[196:199], v[84:87]
    s_add_u32 m0, m0, 0x220
    v_exp_f32 v126, v126
    v_mfma_f32_16x16x32_bf16 v[92:95], v[24:27], v[224:227], v[60:63]
    ds_read_b128 v[24:27], v1 offset:34624
    v_add_f32 v7, v7, v124
    v_mfma_f32_16x16x32_bf16 v[92:95], v[28:31], v[228:231], v[92:95]
    s_waitcnt lgkmcnt(3)
    ds_read_b128 v[28:31], v1 offset:34688
    v_add_f32 v7, v7, v125
    v_mfma_f32_16x16x32_bf16 v[92:95], v[32:35], v[232:235], v[92:95]
    s_waitcnt lgkmcnt(3)
    v_exp_f32 v127, v127
    v_mfma_f32_16x16x32_bf16 v[92:95], v[16:19], v[236:239], v[92:95]
    v_cvt_pk_bf16_f32 v122, v124, v125
    v_add_f32 v7, v7, v126
    v_mfma_f32_16x16x32_bf16 v[84:87], v[32:35], v[200:203], v[84:87]
    buffer_load_dwordx4 v3, s[16:19], s48 offen offset:3584 lds
    v_mfma_f32_16x16x32_bf16 v[84:87], v[16:19], v[204:207], v[84:87]
    s_add_u32 m0, s45, 0x18c00
    s_add_u32 s48, s48, 0x8000
    v_add_f32 v7, v7, v127
    v_mfma_f32_16x16x32_bf16 v[76:79], v[32:35], v[168:171], v[76:79]
    v_cvt_pk_bf16_f32 v123, v126, v127
    v_max3_f32 v8, v64, v65, v66
    v_mfma_f32_16x16x32_bf16 v[76:79], v[16:19], v[172:175], v[76:79]
    v_max3_f32 v8, v8, v67, v72
    v_max3_f32 v8, v8, v73, v74
    v_mfma_f32_16x16x32_bf16 v[68:71], v[32:35], v[136:139], v[68:71]
    ds_read_b128 v[32:35], v1 offset:34752
    v_max3_f32 v8, v8, v75, v80
    v_mfma_f32_16x16x32_bf16 v[68:71], v[16:19], v[140:143], v[68:71]
    s_waitcnt lgkmcnt(3)
    v_max3_f32 v8, v8, v81, v82
    v_max3_f32 v8, v8, v83, v88
    v_mfma_f32_16x16x32_bf16 v[68:71], v[20:23], v[144:147], v[68:71]
    s_waitcnt lgkmcnt(2)
    v_max3_f32 v8, v8, v89, v90
    v_mfma_f32_16x16x32_bf16 v[68:71], v[24:27], v[148:151], v[68:71]
    v_mfma_f32_16x16x32_bf16 v[76:79], v[20:23], v[176:179], v[76:79]
    s_waitcnt vmcnt(17) lgkmcnt(0)
    s_barrier
    ds_read_b64_tr_b16 v[16:17], v2
    v_mfma_f32_16x16x32_bf16 v[76:79], v[24:27], v[180:183], v[76:79]
    ds_read_b64_tr_b16 v[18:19], v2 offset:512
    v_mfma_f32_16x16x32_bf16 v[84:87], v[20:23], v[208:211], v[84:87]
    buffer_load_dwordx4 v3, s[16:19], s48 offen lds
    v_mfma_f32_16x16x32_bf16 v[84:87], v[24:27], v[212:215], v[84:87]
    s_add_u32 m0, m0, 0x220
    v_mfma_f32_16x16x32_bf16 v[92:95], v[20:23], v[240:243], v[92:95]
    ds_read_b64_tr_b16 v[20:21], v2 offset:32
    ds_read_b64_tr_b16 v[22:23], v2 offset:544
    v_mfma_f32_16x16x32_bf16 v[92:95], v[24:27], v[244:247], v[92:95]
    ds_read_b64_tr_b16 v[24:25], v2 offset:64
    ds_read_b64_tr_b16 v[26:27], v2 offset:576
    v_mfma_f32_16x16x32_bf16 v[92:95], v[28:31], v[248:251], v[92:95]
    v_mfma_f32_16x16x32_bf16 v[92:95], v[32:35], v[252:255], v[92:95]
    v_mfma_f32_16x16x32_bf16 v[84:87], v[28:31], v[216:219], v[84:87]
    buffer_load_dwordx4 v3, s[16:19], s48 offen offset:512 lds
    v_mfma_f32_16x16x32_bf16 v[84:87], v[32:35], v[220:223], v[84:87]
    s_add_u32 m0, m0, 0x220
    v_mfma_f32_16x16x32_bf16 v[76:79], v[28:31], v[184:187], v[76:79]
    v_mfma_f32_16x16x32_bf16 v[76:79], v[32:35], v[188:191], v[76:79]
    v_mfma_f32_16x16x32_bf16 v[68:71], v[28:31], v[152:155], v[68:71]
    ds_read_b64_tr_b16 v[28:29], v2 offset:96
    ds_read_b64_tr_b16 v[30:31], v2 offset:608
    v_mfma_f32_16x16x32_bf16 v[68:71], v[32:35], v[156:159], v[68:71]
    s_waitcnt lgkmcnt(6)
    ds_read_b64_tr_b16 v[32:33], v2 offset:128
    ds_read_b64_tr_b16 v[34:35], v2 offset:640
    v_mfma_f32_16x16x32_bf16 a[0:3], v[16:19], v[96:99], a[0:3]
    ds_read_b64_tr_b16 v[36:37], v2 offset:160
    ds_read_b64_tr_b16 v[38:39], v2 offset:672
    v_mfma_f32_16x16x32_bf16 a[4:7], v[16:19], v[104:107], a[4:7]
    buffer_load_dwordx4 v3, s[16:19], s48 offen offset:1024 lds
    v_mfma_f32_16x16x32_bf16 a[8:11], v[16:19], v[112:115], a[8:11]
    s_add_u32 m0, m0, 0x220
    v_mfma_f32_16x16x32_bf16 a[12:15], v[16:19], v[120:123], a[12:15]
    s_waitcnt lgkmcnt(8)
    ds_read_b64_tr_b16 v[16:17], v2 offset:192
    ds_read_b64_tr_b16 v[18:19], v2 offset:704
    v_mfma_f32_16x16x32_bf16 a[16:19], v[20:23], v[96:99], a[16:19]
    v_max3_f32 v8, v8, v91, v68
    v_max3_f32 v8, v8, v69, v70
    v_mfma_f32_16x16x32_bf16 a[20:23], v[20:23], v[104:107], a[20:23]
    v_max3_f32 v8, v8, v71, v76
    v_max3_f32 v8, v8, v77, v78
    v_mfma_f32_16x16x32_bf16 a[24:27], v[20:23], v[112:115], a[24:27]
    v_max3_f32 v8, v8, v79, v84
    v_max3_f32 v8, v8, v85, v86
    v_mfma_f32_16x16x32_bf16 a[28:31], v[20:23], v[120:123], a[28:31]
    s_waitcnt lgkmcnt(8)
    ds_read_b64_tr_b16 v[20:21], v2 offset:224
    ds_read_b64_tr_b16 v[22:23], v2 offset:736
    v_mfma_f32_16x16x32_bf16 a[32:35], v[24:27], v[96:99], a[32:35]
    v_max3_f32 v8, v8, v87, v92
    v_max3_f32 v8, v8, v93, v94
    v_mfma_f32_16x16x32_bf16 a[36:39], v[24:27], v[104:107], a[36:39]
    buffer_load_dwordx4 v3, s[16:19], s48 offen offset:1536 lds
    v_mfma_f32_16x16x32_bf16 a[40:43], v[24:27], v[112:115], a[40:43]
    s_add_u32 m0, m0, 0x220
    v_max_f32 v8, v8, v95
    v_cmp_lt_f32 vcc, 0x41800000, v8
    v_mfma_f32_16x16x32_bf16 a[44:47], v[24:27], v[120:123], a[44:47]
    s_waitcnt lgkmcnt(8)
    ds_read_b64_tr_b16 v[24:25], v2 offset:256
    ds_read_b64_tr_b16 v[26:27], v2 offset:768
    v_mfma_f32_16x16x32_bf16 a[48:51], v[28:31], v[96:99], a[48:51]
    v_mfma_f32_16x16x32_bf16 a[52:55], v[28:31], v[104:107], a[52:55]
    v_mfma_f32_16x16x32_bf16 a[56:59], v[28:31], v[112:115], a[56:59]
    s_cbranch_vccnz L_stub_r1_p29
L_ret_r1_p29:
    v_exp_f32 v64, v64
    v_mfma_f32_16x16x32_bf16 a[60:63], v[28:31], v[120:123], a[60:63]
    s_waitcnt lgkmcnt(8)
    ds_read_b64_tr_b16 v[28:29], v2 offset:288
    ds_read_b64_tr_b16 v[30:31], v2 offset:800
    v_mfma_f32_16x16x32_bf16 a[64:67], v[32:35], v[96:99], a[64:67]
    buffer_load_dwordx4 v3, s[16:19], s48 offen offset:2048 lds
    v_mfma_f32_16x16x32_bf16 a[68:71], v[32:35], v[104:107], a[68:71]
    s_add_u32 m0, m0, 0x220
    v_exp_f32 v65, v65
    v_mfma_f32_16x16x32_bf16 a[72:75], v[32:35], v[112:115], a[72:75]
    v_exp_f32 v66, v66
    v_mfma_f32_16x16x32_bf16 a[76:79], v[32:35], v[120:123], a[76:79]
    s_waitcnt lgkmcnt(8)
    ds_read_b64_tr_b16 v[32:33], v2 offset:320
    ds_read_b64_tr_b16 v[34:35], v2 offset:832
    v_mfma_f32_16x16x32_bf16 a[80:83], v[36:39], v[96:99], a[80:83]
    v_add_f32 v4, v4, v64
    v_add_f32 v4, v4, v65
    v_mfma_f32_16x16x32_bf16 a[84:87], v[36:39], v[104:107], a[84:87]
    v_exp_f32 v67, v67
    v_mfma_f32_16x16x32_bf16 a[88:91], v[36:39], v[112:115], a[88:91]
    v_cvt_pk_bf16_f32 v64, v64, v65
    v_add_f32 v4, v4, v66
    v_mfma_f32_16x16x32_bf16 a[92:95], v[36:39], v[120:123], a[92:95]
    s_waitcnt lgkmcnt(8)
    buffer_load_dwordx4 v3, s[16:19], s48 offen offset:2560 lds
    v_mfma_f32_16x16x32_bf16 a[96:99], v[16:19], v[96:99], a[96:99]
    s_add_u32 m0, m0, 0x220
    v_add_f32 v4, v4, v67
    v_cvt_pk_bf16_f32 v65, v66, v67
    v_mfma_f32_16x16x32_bf16 a[100:103], v[16:19], v[104:107], a[100:103]
    v_exp_f32 v68, v68
    v_mfma_f32_16x16x32_bf16 a[104:107], v[16:19], v[112:115], a[104:107]
    v_exp_f32 v69, v69
    v_mfma_f32_16x16x32_bf16 a[108:111], v[16:19], v[120:123], a[108:111]
    s_waitcnt lgkmcnt(6)
    ds_read_b64_tr_b16 v[16:17], v2 offset:352
    ds_read_b64_tr_b16 v[18:19], v2 offset:864
    v_mfma_f32_16x16x32_bf16 a[112:115], v[20:23], v[96:99], a[112:115]
    v_exp_f32 v70, v70
    v_mfma_f32_16x16x32_bf16 a[116:119], v[20:23], v[104:107], a[116:119]
    v_add_f32 v4, v4, v68
    v_add_f32 v4, v4, v69
    v_mfma_f32_16x16x32_bf16 a[120:123], v[20:23], v[112:115], a[120:123]
    v_exp_f32 v71, v71
    v_mfma_f32_16x16x32_bf16 a[124:127], v[20:23], v[120:123], a[124:127]
    s_waitcnt lgkmcnt(6)
    ds_read_b64_tr_b16 v[20:21], v2 offset:384
    ds_read_b64_tr_b16 v[22:23], v2 offset:896
    v_mfma_f32_16x16x32_bf16 a[128:131], v[24:27], v[96:99], a[128:131]
    buffer_load_dwordx4 v3, s[16:19], s48 offen offset:3072 lds
    v_mfma_f32_16x16x32_bf16 a[132:135], v[24:27], v[104:107], a[132:135]
    s_add_u32 m0, m0, 0x220
    v_cvt_pk_bf16_f32 v66, v68, v69
    v_add_f32 v4, v4, v70
    v_mfma_f32_16x16x32_bf16 a[136:139], v[24:27], v[112:115], a[136:139]
    v_add_f32 v4, v4, v71
    v_cvt_pk_bf16_f32 v67, v70, v71
    v_mfma_f32_16x16x32_bf16 a[140:143], v[24:27], v[120:123], a[140:143]
    s_waitcnt lgkmcnt(6)
    ds_read_b64_tr_b16 v[24:25], v2 offset:416
    ds_read_b64_tr_b16 v[26:27], v2 offset:928
    v_mfma_f32_16x16x32_bf16 a[144:147], v[28:31], v[96:99], a[144:147]
    v_exp_f32 v72, v72
    v_mfma_f32_16x16x32_bf16 a[148:151], v[28:31], v[104:107], a[148:151]
    v_exp_f32 v73, v73
    v_mfma_f32_16x16x32_bf16 a[152:155], v[28:31], v[112:115], a[152:155]
    buffer_load_dwordx4 v3, s[16:19], s48 offen offset:3584 lds
    v_mfma_f32_16x16x32_bf16 a[156:159], v[28:31], v[120:123], a[156:159]
    s_waitcnt lgkmcnt(6)
    ds_read_b64_tr_b16 v[28:29], v2 offset:448
    ds_read_b64_tr_b16 v[30:31], v2 offset:960
    v_mfma_f32_16x16x32_bf16 a[160:163], v[32:35], v[96:99], a[160:163]
    s_add_u32 m0, s45, 0
    s_add_u32 s48, s48, 0x8000
    v_mfma_f32_16x16x32_bf16 a[164:167], v[32:35], v[104:107], a[164:167]
    v_exp_f32 v74, v74
    v_mfma_f32_16x16x32_bf16 a[168:171], v[32:35], v[112:115], a[168:171]
    v_add_f32 v5, v5, v72
    v_add_f32 v5, v5, v73
    v_mfma_f32_16x16x32_bf16 a[172:175], v[32:35], v[120:123], a[172:175]
    s_waitcnt lgkmcnt(6)
    ds_read_b64_tr_b16 v[32:33], v2 offset:480
    ds_read_b64_tr_b16 v[34:35], v2 offset:992
    v_mfma_f32_16x16x32_bf16 a[176:179], v[16:19], v[96:99], a[176:179]
    v_exp_f32 v75, v75
    v_mfma_f32_16x16x32_bf16 a[180:183], v[16:19], v[104:107], a[180:183]
    v_cvt_pk_bf16_f32 v72, v72, v73
    v_add_f32 v5, v5, v74
    v_mfma_f32_16x16x32_bf16 a[184:187], v[16:19], v[112:115], a[184:187]
    v_add_f32 v5, v5, v75
    v_cvt_pk_bf16_f32 v73, v74, v75
    v_mfma_f32_16x16x32_bf16 a[188:191], v[16:19], v[120:123], a[188:191]
    s_waitcnt lgkmcnt(6)
    s_waitcnt vmcnt(16) lgkmcnt(0)
    s_barrier
    v_mfma_f32_16x16x32_bf16 a[192:195], v[20:23], v[96:99], a[192:195]
    ds_read_b128 v[16:19], v1
    v_mfma_f32_16x16x32_bf16 a[196:199], v[20:23], v[104:107], a[196:199]
    v_exp_f32 v76, v76
    v_mfma_f32_16x16x32_bf16 a[200:203], v[20:23], v[112:115], a[200:203]
    v_exp_f32 v77, v77
    v_mfma_f32_16x16x32_bf16 a[204:207], v[20:23], v[120:123], a[204:207]
    ds_read_b128 v[20:23], v1 offset:64
    v_mfma_f32_16x16x32_bf16 a[208:211], v[24:27], v[96:99], a[208:211]
    v_exp_f32 v78, v78
    v_mfma_f32_16x16x32_bf16 a[212:215], v[24:27], v[104:107], a[212:215]
    v_add_f32 v5, v5, v76
    v_add_f32 v5, v5, v77
    v_mfma_f32_16x16x32_bf16 a[216:219], v[24:27], v[112:115], a[216:219]
    v_exp_f32 v79, v79
    v_mfma_f32_16x16x32_bf16 a[220:223], v[24:27], v[120:123], a[220:223]
    ds_read_b128 v[24:27], v1 offset:128
    v_cvt_pk_bf16_f32 v74, v76, v77
    v_mfma_f32_16x16x32_bf16 a[224:227], v[28:31], v[96:99], a[224:227]
    v_add_f32 v5, v5, v78
    v_add_f32 v5, v5, v79
    v_mfma_f32_16x16x32_bf16 a[228:231], v[28:31], v[104:107], a[228:231]
    v_cvt_pk_bf16_f32 v75, v78, v79
    v_mfma_f32_16x16x32_bf16 a[232:235], v[28:31], v[112:115], a[232:235]
    v_mfma_f32_16x16x32_bf16 a[236:239], v[28:31], v[120:123], a[236:239]
    ds_read_b128 v[28:31], v1 offset:192
    v_mfma_f32_16x16x32_bf16 a[240:243], v[32:35], v[96:99], a[240:243]
    v_mfma_f32_16x16x32_bf16 a[244:247], v[32:35], v[104:107], a[244:247]
    v_mfma_f32_16x16x32_bf16 a[248:251], v[32:35], v[112:115], a[248:251]
    v_mfma_f32_16x16x32_bf16 a[252:255], v[32:35], v[120:123], a[252:255]
    s_waitcnt lgkmcnt(3)
    ds_read_b128 v[32:35], v1 offset:256
    s_cbranch_vccnz L_stub_r2_p30
L_ret_r2_p30:
    v_mfma_f32_16x16x32_bf16 v[96:99], v[16:19], v[128:131], v[48:51]
    s_waitcnt lgkmcnt(3)
    ds_read_b128 v[36:39], v1 offset:320
    v_mfma_f32_16x16x32_bf16 v[96:99], v[20:23], v[132:135], v[96:99]
    v_exp_f32 v80, v80
    v_mfma_f32_16x16x32_bf16 v[104:107], v[16:19], v[160:163], v[52:55]
    v_exp_f32 v81, v81
    v_mfma_f32_16x16x32_bf16 v[104:107], v[20:23], v[164:167], v[104:107]
    v_exp_f32 v82, v82
    v_mfma_f32_16x16x32_bf16 v[112:115], v[16:19], v[192:195], v[56:59]
    v_add_f32 v6, v6, v80
    v_add_f32 v6, v6, v81
    v_mfma_f32_16x16x32_bf16 v[112:115], v[20:23], v[196:199], v[112:115]
    v_exp_f32 v83, v83
    v_mfma_f32_16x16x32_bf16 v[120:123], v[16:19], v[224:227], v[60:63]
    ds_read_b128 v[16:19], v1 offset:384
    v_cvt_pk_bf16_f32 v80, v80, v81
    v_mfma_f32_16x16x32_bf16 v[120:123], v[20:23], v[228:231], v[120:123]
    s_waitcnt lgkmcnt(4)
    ds_read_b128 v[20:23], v1 offset:448
    v_add_f32 v6, v6, v82
    v_mfma_f32_16x16x32_bf16 v[120:123], v[24:27], v[232:235], v[120:123]
    s_waitcnt lgkmcnt(4)
    v_add_f32 v6, v6, v83
    v_cvt_pk_bf16_f32 v81, v82, v83
    v_mfma_f32_16x16x32_bf16 v[120:123], v[28:31], v[236:239], v[120:123]
    v_exp_f32 v84, v84
    v_mfma_f32_16x16x32_bf16 v[112:115], v[24:27], v[200:203], v[112:115]
    s_lshl_b32 s57, s44, 4
    v_exp_f32 v85, v85
    v_mfma_f32_16x16x32_bf16 v[112:115], v[28:31], v[204:207], v[112:115]
    v_exp_f32 v86, v86
    v_mfma_f32_16x16x32_bf16 v[104:107], v[24:27], v[168:171], v[104:107]
    v_and_b32 v10, 0, v0
    v_lshlrev_b32 v10, 2, v10
    v_mfma_f32_16x16x32_bf16 v[104:107], v[28:31], v[172:175], v[104:107]
    v_add_f32 v6, v6, v84
    v_add_f32 v6, v6, v85
    v_mfma_f32_16x16x32_bf16 v[96:99], v[24:27], v[136:139], v[96:99]
    ds_read_b128 v[24:27], v1 offset:512
    v_mfma_f32_16x16x32_bf16 v[96:99], v[28:31], v[140:143], v[96:99]
    s_waitcnt lgkmcnt(4)
    ds_read_b128 v[28:31], v1 offset:576
    v_mfma_f32_16x16x32_bf16 v[96:99], v[32:35], v[144:147], v[96:99]
    s_waitcnt lgkmcnt(4)
    v_exp_f32 v87, v87
    v_mfma_f32_16x16x32_bf16 v[96:99], v[36:39], v[148:151], v[96:99]
    v_cvt_pk_bf16_f32 v82, v84, v85
    v_add_f32 v6, v6, v86
    v_mfma_f32_16x16x32_bf16 v[104:107], v[32:35], v[176:179], v[104:107]
    v_add_f32 v6, v6, v87
    v_cvt_pk_bf16_f32 v83, v86, v87
    v_mfma_f32_16x16x32_bf16 v[104:107], v[36:39], v[180:183], v[104:107]
    v_exp_f32 v88, v88
    v_mfma_f32_16x16x32_bf16 v[112:115], v[32:35], v[208:211], v[112:115]
    v_exp_f32 v89, v89
    v_mfma_f32_16x16x32_bf16 v[112:115], v[36:39], v[212:215], v[112:115]
    v_exp_f32 v90, v90
    v_mfma_f32_16x16x32_bf16 v[120:123], v[32:35], v[240:243], v[120:123]
    ds_read_b128 v[32:35], v1 offset:640
    v_add_f32 v7, v7, v88
    v_mfma_f32_16x16x32_bf16 v[120:123], v[36:39], v[244:247], v[120:123]
    s_waitcnt lgkmcnt(4)
    v_add_f32 v7, v7, v89
    v_mfma_f32_16x16x32_bf16 v[120:123], v[16:19], v[248:251], v[120:123]
    s_waitcnt lgkmcnt(3)
    v_exp_f32 v91, v91
    v_mfma_f32_16x16x32_bf16 v[120:123], v[20:23], v[252:255], v[120:123]
    v_cvt_pk_bf16_f32 v88, v88, v89
    v_add_f32 v7, v7, v90
    v_mfma_f32_16x16x32_bf16 v[112:115], v[16:19], v[216:219], v[112:115]
    v_add_f32 v7, v7, v91
    v_cvt_pk_bf16_f32 v89, v90, v91
    v_mfma_f32_16x16x32_bf16 v[112:115], v[20:23], v[220:223], v[112:115]
    v_exp_f32 v92, v92
    v_mfma_f32_16x16x32_bf16 v[104:107], v[16:19], v[184:187], v[104:107]
    v_exp_f32 v93, v93
    v_mfma_f32_16x16x32_bf16 v[104:107], v[20:23], v[188:191], v[104:107]
    v_exp_f32 v94, v94
    v_mfma_f32_16x16x32_bf16 v[96:99], v[16:19], v[152:155], v[96:99]
    ds_read_b128 v[16:19], v1 offset:704
    v_add_f32 v7, v7, v92
    v_mfma_f32_16x16x32_bf16 v[96:99], v[20:23], v[156:159], v[96:99]
    s_waitcnt lgkmcnt(3)
    ds_read_b128 v[20:23], v1 offset:768
    v_add_f32 v7, v7, v93
    v_mfma_f32_16x16x32_bf16 v[100:103], v[24:27], v[128:131], v[48:51]
    s_waitcnt lgkmcnt(3)
    v_exp_f32 v95, v95
    v_mfma_f32_16x16x32_bf16 v[100:103], v[28:31], v[132:135], v[100:103]
    v_cvt_pk_bf16_f32 v90, v92, v93
    v_add_f32 v7, v7, v94
    v_mfma_f32_16x16x32_bf16 v[108:111], v[24:27], v[160:163], v[52:55]
    v_add_f32 v7, v7, v95
    v_cvt_pk_bf16_f32 v91, v94, v95
    v_mfma_f32_16x16x32_bf16 v[108:111], v[28:31], v[164:167], v[108:111]
    v_mfma_f32_16x16x32_bf16 v[116:119], v[24:27], v[192:195], v[56:59]
    v_max3_f32 v8, v96, v97, v98
    v_max3_f32 v8, v8, v99, v104
    v_mfma_f32_16x16x32_bf16 v[116:119], v[28:31], v[196:199], v[116:119]
    v_max3_f32 v8, v8, v105, v106
    v_max3_f32 v8, v8, v107, v112
    v_mfma_f32_16x16x32_bf16 v[124:127], v[24:27], v[224:227], v[60:63]
    ds_read_b128 v[24:27], v1 offset:832
    v_max3_f32 v8, v8, v113, v114
    v_mfma_f32_16x16x32_bf16 v[124:127], v[28:31], v[228:231], v[124:127]
    s_waitcnt lgkmcnt(3)
    ds_read_b128 v[28:31], v1 offset:896
    v_max3_f32 v8, v8, v115, v120
    v_mfma_f32_16x16x32_bf16 v[124:127], v[32:35], v[232:235], v[124:127]
    s_waitcnt lgkmcnt(3)
    v_max3_f32 v8, v8, v121, v122
    v_mfma_f32_16x16x32_bf16 v[124:127], v[16:19], v[236:239], v[124:127]
    v_mfma_f32_16x16x32_bf16 v[116:119], v[32:35], v[200:203], v[116:119]
    v_mfma_f32_16x16x32_bf16 v[116:119], v[16:19], v[204:207], v[116:119]
    v_mfma_f32_16x16x32_bf16 v[108:111], v[32:35], v[168:171], v[108:111]
    v_mfma_f32_16x16x32_bf16 v[108:111], v[16:19], v[172:175], v[108:111]
    v_mfma_f32_16x16x32_bf16 v[100:103], v[32:35], v[136:139], v[100:103]
    ds_read_b128 v[32:35], v1 offset:960
    v_mfma_f32_16x16x32_bf16 v[100:103], v[16:19], v[140:143], v[100:103]
    s_waitcnt lgkmcnt(3)
    v_mfma_f32_16x16x32_bf16 v[100:103], v[20:23], v[144:147], v[100:103]
    s_waitcnt lgkmcnt(2)
    v_mfma_f32_16x16x32_bf16 v[100:103], v[24:27], v[148:151], v[100:103]
    v_mfma_f32_16x16x32_bf16 v[108:111], v[20:23], v[176:179], v[108:111]
    s_waitcnt vmcnt(8) lgkmcnt(0)
    s_barrier
    ds_read_b64_tr_b16 v[16:17], v2 offset:33792
    v_mfma_f32_16x16x32_bf16 v[108:111], v[24:27], v[180:183], v[108:111]
    ds_read_b64_tr_b16 v[18:19], v2 offset:34304
    v_mfma_f32_16x16x32_bf16 v[116:119], v[20:23], v[208:211], v[116:119]
    v_mfma_f32_16x16x32_bf16 v[116:119], v[24:27], v[212:215], v[116:119]
    v_mfma_f32_16x16x32_bf16 v[124:127], v[20:23], v[240:243], v[124:127]
    ds_read_b64_tr_b16 v[20:21], v2 offset:33824
    ds_read_b64_tr_b16 v[22:23], v2 offset:34336
    v_mfma_f32_16x16x32_bf16 v[124:127], v[24:27], v[244:247], v[124:127]
    ds_read_b64_tr_b16 v[24:25], v2 offset:33856
    ds_read_b64_tr_b16 v[26:27], v2 offset:34368
    v_mfma_f32_16x16x32_bf16 v[124:127], v[28:31], v[248:251], v[124:127]
    buffer_load_dword v11, v10, s[64:67], s57 offen sc1
    v_mfma_f32_16x16x32_bf16 v[124:127], v[32:35], v[252:255], v[124:127]
    v_mfma_f32_16x16x32_bf16 v[116:119], v[28:31], v[216:219], v[116:119]
    v_mfma_f32_16x16x32_bf16 v[116:119], v[32:35], v[220:223], v[116:119]
    v_mfma_f32_16x16x32_bf16 v[108:111], v[28:31], v[184:187], v[108:111]
    v_mfma_f32_16x16x32_bf16 v[108:111], v[32:35], v[188:191], v[108:111]
    v_mfma_f32_16x16x32_bf16 v[100:103], v[28:31], v[152:155], v[100:103]
    ds_read_b64_tr_b16 v[28:29], v2 offset:33888
    ds_read_b64_tr_b16 v[30:31], v2 offset:34400
    v_mfma_f32_16x16x32_bf16 v[100:103], v[32:35], v[156:159], v[100:103]
    s_waitcnt lgkmcnt(6)
    ds_read_b64_tr_b16 v[32:33], v2 offset:33920
    ds_read_b64_tr_b16 v[34:35], v2 offset:34432
    v_mfma_f32_16x16x32_bf16 a[0:3], v[16:19], v[64:67], a[0:3]
    ds_read_b64_tr_b16 v[36:37], v2 offset:33952
    ds_read_b64_tr_b16 v[38:39], v2 offset:34464
    v_mfma_f32_16x16x32_bf16 a[4:7], v[16:19], v[72:75], a[4:7]
    v_mfma_f32_16x16x32_bf16 a[8:11], v[16:19], v[80:83], a[8:11]
    v_mfma_f32_16x16x32_bf16 a[12:15], v[16:19], v[88:91], a[12:15]
    s_waitcnt lgkmcnt(8)
    ds_read_b64_tr_b16 v[16:17], v2 offset:33984
    ds_read_b64_tr_b16 v[18:19], v2 offset:34496
    v_mfma_f32_16x16x32_bf16 a[16:19], v[20:23], v[64:67], a[16:19]
    v_max3_f32 v8, v8, v123, v100
    v_max3_f32 v8, v8, v101, v102
    v_mfma_f32_16x16x32_bf16 a[20:23], v[20:23], v[72:75], a[20:23]
    v_max3_f32 v8, v8, v103, v108
    v_max3_f32 v8, v8, v109, v110
    v_mfma_f32_16x16x32_bf16 a[24:27], v[20:23], v[80:83], a[24:27]
    v_max3_f32 v8, v8, v111, v116
    v_max3_f32 v8, v8, v117, v118
    v_mfma_f32_16x16x32_bf16 a[28:31], v[20:23], v[88:91], a[28:31]
    s_waitcnt lgkmcnt(8)
    ds_read_b64_tr_b16 v[20:21], v2 offset:34016
    ds_read_b64_tr_b16 v[22:23], v2 offset:34528
    v_mfma_f32_16x16x32_bf16 a[32:35], v[24:27], v[64:67], a[32:35]
    v_max3_f32 v8, v8, v119, v124
    v_max3_f32 v8, v8, v125, v126
    v_mfma_f32_16x16x32_bf16 a[36:39], v[24:27], v[72:75], a[36:39]
    v_max_f32 v8, v8, v127
    v_cmp_lt_f32 vcc, 0x41800000, v8
    v_mfma_f32_16x16x32_bf16 a[40:43], v[24:27], v[80:83], a[40:43]
    v_mfma_f32_16x16x32_bf16 a[44:47], v[24:27], v[88:91], a[44:47]
    s_waitcnt lgkmcnt(8)
    ds_read_b64_tr_b16 v[24:25], v2 offset:34048
    ds_read_b64_tr_b16 v[26:27], v2 offset:34560
    v_mfma_f32_16x16x32_bf16 a[48:51], v[28:31], v[64:67], a[48:51]
    v_mfma_f32_16x16x32_bf16 a[52:55], v[28:31], v[72:75], a[52:55]
    v_mfma_f32_16x16x32_bf16 a[56:59], v[28:31], v[80:83], a[56:59]
    s_cbranch_vccnz L_stub_r1_p30
L_ret_r1_p30:
    v_exp_f32 v96, v96
    v_mfma_f32_16x16x32_bf16 a[60:63], v[28:31], v[88:91], a[60:63]
    s_waitcnt lgkmcnt(8)
    ds_read_b64_tr_b16 v[28:29], v2 offset:34080
    ds_read_b64_tr_b16 v[30:31], v2 offset:34592
    v_mfma_f32_16x16x32_bf16 a[64:67], v[32:35], v[64:67], a[64:67]
    v_exp_f32 v97, v97
    v_mfma_f32_16x16x32_bf16 a[68:71], v[32:35], v[72:75], a[68:71]
    v_exp_f32 v98, v98
    v_mfma_f32_16x16x32_bf16 a[72:75], v[32:35], v[80:83], a[72:75]
    v_add_f32 v4, v4, v96
    v_add_f32 v4, v4, v97
    v_mfma_f32_16x16x32_bf16 a[76:79], v[32:35], v[88:91], a[76:79]
    s_waitcnt lgkmcnt(8)
    ds_read_b64_tr_b16 v[32:33], v2 offset:34112
    ds_read_b64_tr_b16 v[34:35], v2 offset:34624
    v_mfma_f32_16x16x32_bf16 a[80:83], v[36:39], v[64:67], a[80:83]
    v_exp_f32 v99, v99
    v_mfma_f32_16x16x32_bf16 a[84:87], v[36:39], v[72:75], a[84:87]
    v_cvt_pk_bf16_f32 v96, v96, v97
    v_add_f32 v4, v4, v98
    v_mfma_f32_16x16x32_bf16 a[88:91], v[36:39], v[80:83], a[88:91]
    v_add_f32 v4, v4, v99
    v_cvt_pk_bf16_f32 v97, v98, v99
    v_mfma_f32_16x16x32_bf16 a[92:95], v[36:39], v[88:91], a[92:95]
    s_waitcnt lgkmcnt(8)
    v_exp_f32 v100, v100
    v_mfma_f32_16x16x32_bf16 a[96:99], v[16:19], v[64:67], a[96:99]
    v_exp_f32 v101, v101
    v_mfma_f32_16x16x32_bf16 a[100:103], v[16:19], v[72:75], a[100:103]
    v_exp_f32 v102, v102
    v_mfma_f32_16x16x32_bf16 a[104:107], v[16:19], v[80:83], a[104:107]
    v_add_f32 v4, v4, v100
    v_add_f32 v4, v4, v101
    v_mfma_f32_16x16x32_bf16 a[108:111], v[16:19], v[88:91], a[108:111]
    s_waitcnt lgkmcnt(6)
    ds_read_b64_tr_b16 v[16:17], v2 offset:34144
    ds_read_b64_tr_b16 v[18:19], v2 offset:34656
    v_mfma_f32_16x16x32_bf16 a[112:115], v[20:23], v[64:67], a[112:115]
    v_exp_f32 v103, v103
    v_mfma_f32_16x16x32_bf16 a[116:119], v[20:23], v[72:75], a[116:119]
    v_cvt_pk_bf16_f32 v98, v100, v101
    v_add_f32 v4, v4, v102
    v_mfma_f32_16x16x32_bf16 a[120:123], v[20:23], v[80:83], a[120:123]
    v_add_f32 v4, v4, v103
    v_cvt_pk_bf16_f32 v99, v102, v103
    v_mfma_f32_16x16x32_bf16 a[124:127], v[20:23], v[88:91], a[124:127]
    s_waitcnt lgkmcnt(6)
    ds_read_b64_tr_b16 v[20:21], v2 offset:34176
    ds_read_b64_tr_b16 v[22:23], v2 offset:34688
    v_mfma_f32_16x16x32_bf16 a[128:131], v[24:27], v[64:67], a[128:131]
    v_exp_f32 v104, v104
    v_mfma_f32_16x16x32_bf16 a[132:135], v[24:27], v[72:75], a[132:135]
    v_exp_f32 v105, v105
    v_mfma_f32_16x16x32_bf16 a[136:139], v[24:27], v[80:83], a[136:139]
    v_exp_f32 v106, v106
    v_mfma_f32_16x16x32_bf16 a[140:143], v[24:27], v[88:91], a[140:143]
    s_waitcnt lgkmcnt(6)
    ds_read_b64_tr_b16 v[24:25], v2 offset:34208
    ds_read_b64_tr_b16 v[26:27], v2 offset:34720
    v_mfma_f32_16x16x32_bf16 a[144:147], v[28:31], v[64:67], a[144:147]
    v_add_f32 v5, v5, v104
    v_add_f32 v5, v5, v105
    v_mfma_f32_16x16x32_bf16 a[148:151], v[28:31], v[72:75], a[148:151]
    v_exp_f32 v107, v107
    v_mfma_f32_16x16x32_bf16 a[152:155], v[28:31], v[80:83], a[152:155]
    v_cvt_pk_bf16_f32 v104, v104, v105
    v_add_f32 v5, v5, v106
    v_mfma_f32_16x16x32_bf16 a[156:159], v[28:31], v[88:91], a[156:159]
    s_waitcnt lgkmcnt(6)
    ds_read_b64_tr_b16 v[28:29], v2 offset:34240
    ds_read_b64_tr_b16 v[30:31], v2 offset:34752
    v_mfma_f32_16x16x32_bf16 a[160:163], v[32:35], v[64:67], a[160:163]
    v_add_f32 v5, v5, v107
    v_cvt_pk_bf16_f32 v105, v106, v107
    v_mfma_f32_16x16x32_bf16 a[164:167], v[32:35], v[72:75], a[164:167]
    v_exp_f32 v108, v108
    v_mfma_f32_16x16x32_bf16 a[168:171], v[32:35], v[80:83], a[168:171]
    v_exp_f32 v109, v109
    v_mfma_f32_16x16x32_bf16 a[172:175], v[32:35], v[88:91], a[172:175]
    s_waitcnt lgkmcnt(6)
    ds_read_b64_tr_b16 v[32:33], v2 offset:34272
    ds_read_b64_tr_b16 v[34:35], v2 offset:34784
    v_mfma_f32_16x16x32_bf16 a[176:179], v[16:19], v[64:67], a[176:179]
    v_exp_f32 v110, v110
    v_mfma_f32_16x16x32_bf16 a[180:183], v[16:19], v[72:75], a[180:183]
    v_add_f32 v5, v5, v108
    v_add_f32 v5, v5, v109
    v_mfma_f32_16x16x32_bf16 a[184:187], v[16:19], v[80:83], a[184:187]
    v_exp_f32 v111, v111
    v_mfma_f32_16x16x32_bf16 a[188:191], v[16:19], v[88:91], a[188:191]
    s_waitcnt lgkmcnt(6)
    s_waitcnt vmcnt(1) lgkmcnt(0)
    s_barrier
    v_mfma_f32_16x16x32_bf16 a[192:195], v[20:23], v[64:67], a[192:195]
    ds_read_b64_tr_b16 v[16:17], v15 offset:33792
    ds_read_b64_tr_b16 v[18:19], v15 offset:34304
    v_mfma_f32_16x16x32_bf16 a[196:199], v[20:23], v[72:75], a[196:199]
    v_cvt_pk_bf16_f32 v106, v108, v109
    v_add_f32 v5, v5, v110
    v_mfma_f32_16x16x32_bf16 a[200:203], v[20:23], v[80:83], a[200:203]
    v_add_f32 v5, v5, v111
    v_cvt_pk_bf16_f32 v107, v110, v111
    v_mfma_f32_16x16x32_bf16 a[204:207], v[20:23], v[88:91], a[204:207]
    ds_read_b64_tr_b16 v[20:21], v15 offset:33824
    ds_read_b64_tr_b16 v[22:23], v15 offset:34336
    v_mfma_f32_16x16x32_bf16 a[208:211], v[24:27], v[64:67], a[208:211]
    v_mfma_f32_16x16x32_bf16 a[212:215], v[24:27], v[72:75], a[212:215]
    v_mfma_f32_16x16x32_bf16 a[216:219], v[24:27], v[80:83], a[216:219]
    v_mfma_f32_16x16x32_bf16 a[220:223], v[24:27], v[88:91], a[220:223]
    ds_read_b64_tr_b16 v[24:25], v15 offset:33856
    ds_read_b64_tr_b16 v[26:27], v15 offset:34368
    v_mfma_f32_16x16x32_bf16 a[224:227], v[28:31], v[64:67], a[224:227]
    v_mfma_f32_16x16x32_bf16 a[228:231], v[28:31], v[72:75], a[228:231]
    v_mfma_f32_16x16x32_bf16 a[232:235], v[28:31], v[80:83], a[232:235]
    v_mfma_f32_16x16x32_bf16 a[236:239], v[28:31], v[88:91], a[236:239]
    ds_read_b64_tr_b16 v[28:29], v15 offset:33888
    ds_read_b64_tr_b16 v[30:31], v15 offset:34400
    v_mfma_f32_16x16x32_bf16 a[240:243], v[32:35], v[64:67], a[240:243]
    v_mfma_f32_16x16x32_bf16 a[244:247], v[32:35], v[72:75], a[244:247]
    v_mfma_f32_16x16x32_bf16 a[248:251], v[32:35], v[80:83], a[248:251]
    v_mfma_f32_16x16x32_bf16 a[252:255], v[32:35], v[88:91], a[252:255]
    s_waitcnt lgkmcnt(6)
    ds_read_b64_tr_b16 v[32:33], v15 offset:33920
    ds_read_b64_tr_b16 v[34:35], v15 offset:34432
    s_cbranch_vccnz L_stub_r2_p31
L_ret_r2_p31:
    v_lshlrev_b32 v12, 4, v0
    s_mul_i32 s57, s42, 0x6000
    s_lshl_b32 s58, s42, 13
    s_add_u32 s58, s58, 0x18c00
    v_add_u32 v14, s58, v12
    v_add_u32 v12, s57, v12
    v_exp_f32 v112, v112
    v_exp_f32 v113, v113
    v_exp_f32 v114, v114
    v_add_f32 v6, v6, v112
    v_add_f32 v6, v6, v113
    v_exp_f32 v115, v115
    v_cvt_pk_bf16_f32 v112, v112, v113
    v_add_f32 v6, v6, v114
    v_add_f32 v6, v6, v115
    v_cvt_pk_bf16_f32 v113, v114, v115
    v_exp_f32 v116, v116
    v_exp_f32 v117, v117
    v_exp_f32 v118, v118
    v_add_f32 v6, v6, v116
    v_add_f32 v6, v6, v117
    v_exp_f32 v119, v119
    v_cvt_pk_bf16_f32 v114, v116, v117
    v_add_f32 v6, v6, v118
    v_add_f32 v6, v6, v119
    v_cvt_pk_bf16_f32 v115, v118, v119
    v_exp_f32 v120, v120
    v_exp_f32 v121, v121
    v_exp_f32 v122, v122
    v_add_f32 v7, v7, v120
    v_add_f32 v7, v7, v121
    v_exp_f32 v123, v123
    v_cvt_pk_bf16_f32 v120, v120, v121
    v_add_f32 v7, v7, v122
    v_add_f32 v7, v7, v123
    v_cvt_pk_bf16_f32 v121, v122, v123
    v_exp_f32 v124, v124
    v_exp_f32 v125, v125
    v_exp_f32 v126, v126
    v_add_f32 v7, v7, v124
    v_add_f32 v7, v7, v125
    v_exp_f32 v127, v127
    v_cvt_pk_bf16_f32 v122, v124, v125
    v_add_f32 v7, v7, v126
    v_add_f32 v7, v7, v127
    v_cvt_pk_bf16_f32 v123, v126, v127
    v_mfma_f32_16x16x32_bf16 a[0:3], v[16:19], v[96:99], a[0:3]
    ds_read_b64_tr_b16 v[36:37], v15 offset:33952
    ds_read_b64_tr_b16 v[38:39], v15 offset:34464
    v_mfma_f32_16x16x32_bf16 a[4:7], v[16:19], v[104:107], a[4:7]
    v_mfma_f32_16x16x32_bf16 a[8:11], v[16:19], v[112:115], a[8:11]
    v_mfma_f32_16x16x32_bf16 a[12:15], v[16:19], v[120:123], a[12:15]
    s_waitcnt lgkmcnt(8)
    ds_read_b64_tr_b16 v[16:17], v15 offset:33984
    ds_read_b64_tr_b16 v[18:19], v15 offset:34496
    v_mfma_f32_16x16x32_bf16 a[16:19], v[20:23], v[96:99], a[16:19]
    v_mfma_f32_16x16x32_bf16 a[20:23], v[20:23], v[104:107], a[20:23]
    v_mfma_f32_16x16x32_bf16 a[24:27], v[20:23], v[112:115], a[24:27]
    v_mfma_f32_16x16x32_bf16 a[28:31], v[20:23], v[120:123], a[28:31]
    s_waitcnt lgkmcnt(8)
    ds_read_b64_tr_b16 v[20:21], v15 offset:34016
    ds_read_b64_tr_b16 v[22:23], v15 offset:34528
    v_mfma_f32_16x16x32_bf16 a[32:35], v[24:27], v[96:99], a[32:35]
    v_mfma_f32_16x16x32_bf16 a[36:39], v[24:27], v[104:107], a[36:39]
    ds_write_b128 v12, a[8:11]
    v_mfma_f32_16x16x32_bf16 a[40:43], v[24:27], v[112:115], a[40:43]
    ds_write_b128 v12, a[12:15] offset:1024
    v_mfma_f32_16x16x32_bf16 a[44:47], v[24:27], v[120:123], a[44:47]
    s_waitcnt lgkmcnt(10)
    ds_read_b64_tr_b16 v[24:25], v15 offset:34048
    ds_read_b64_tr_b16 v[26:27], v15 offset:34560
    v_mfma_f32_16x16x32_bf16 a[48:51], v[28:31], v[96:99], a[48:51]
    v_mfma_f32_16x16x32_bf16 a[52:55], v[28:31], v[104:107], a[52:55]
    ds_write_b128 v12, a[24:27] offset:2048
    v_mfma_f32_16x16x32_bf16 a[56:59], v[28:31], v[112:115], a[56:59]
    ds_write_b128 v12, a[28:31] offset:3072
    v_mfma_f32_16x16x32_bf16 a[60:63], v[28:31], v[120:123], a[60:63]
    s_waitcnt lgkmcnt(12)
    ds_read_b64_tr_b16 v[28:29], v15 offset:34080
    ds_read_b64_tr_b16 v[30:31], v15 offset:34592
    v_mfma_f32_16x16x32_bf16 a[64:67], v[32:35], v[96:99], a[64:67]
    v_mfma_f32_16x16x32_bf16 a[68:71], v[32:35], v[104:107], a[68:71]
    ds_write_b128 v12, a[40:43] offset:4096
    v_mfma_f32_16x16x32_bf16 a[72:75], v[32:35], v[112:115], a[72:75]
    s_waitcnt lgkmcnt(12)
    ds_write_b128 v12, a[44:47] offset:5120
    v_mfma_f32_16x16x32_bf16 a[76:79], v[32:35], v[120:123], a[76:79]
    ds_read_b64_tr_b16 v[32:33], v15 offset:34112
    ds_read_b64_tr_b16 v[34:35], v15 offset:34624
    v_mfma_f32_16x16x32_bf16 a[80:83], v[36:39], v[96:99], a[80:83]
    v_mfma_f32_16x16x32_bf16 a[84:87], v[36:39], v[104:107], a[84:87]
    s_waitcnt lgkmcnt(12)
    ds_write_b128 v12, a[56:59] offset:6144
    v_mfma_f32_16x16x32_bf16 a[88:91], v[36:39], v[112:115], a[88:91]
    ds_write_b128 v12, a[60:63] offset:7168
    v_mfma_f32_16x16x32_bf16 a[92:95], v[36:39], v[120:123], a[92:95]
    v_mfma_f32_16x16x32_bf16 a[96:99], v[16:19], v[96:99], a[96:99]
    v_mfma_f32_16x16x32_bf16 a[100:103], v[16:19], v[104:107], a[100:103]
    ds_write_b128 v12, a[72:75] offset:8192
    v_mfma_f32_16x16x32_bf16 a[104:107], v[16:19], v[112:115], a[104:107]
    s_waitcnt lgkmcnt(12)
    ds_write_b128 v12, a[76:79] offset:9216
    v_mfma_f32_16x16x32_bf16 a[108:111], v[16:19], v[120:123], a[108:111]
    ds_read_b64_tr_b16 v[16:17], v15 offset:34144
    ds_read_b64_tr_b16 v[18:19], v15 offset:34656
    v_mfma_f32_16x16x32_bf16 a[112:115], v[20:23], v[96:99], a[112:115]
    v_mfma_f32_16x16x32_bf16 a[116:119], v[20:23], v[104:107], a[116:119]
    s_waitcnt lgkmcnt(12)
    ds_write_b128 v12, a[88:91] offset:10240
    v_mfma_f32_16x16x32_bf16 a[120:123], v[20:23], v[112:115], a[120:123]
    ds_write_b128 v12, a[92:95] offset:11264
    v_mfma_f32_16x16x32_bf16 a[124:127], v[20:23], v[120:123], a[124:127]
    ds_read_b64_tr_b16 v[20:21], v15 offset:34176
    s_waitcnt lgkmcnt(12)
    ds_read_b64_tr_b16 v[22:23], v15 offset:34688
    v_mfma_f32_16x16x32_bf16 a[128:131], v[24:27], v[96:99], a[128:131]
    v_mfma_f32_16x16x32_bf16 a[132:135], v[24:27], v[104:107], a[132:135]
    ds_write_b128 v12, a[104:107] offset:12288
    v_mfma_f32_16x16x32_bf16 a[136:139], v[24:27], v[112:115], a[136:139]
    ds_write_b128 v12, a[108:111] offset:13312
    v_mfma_f32_16x16x32_bf16 a[140:143], v[24:27], v[120:123], a[140:143]
    s_waitcnt lgkmcnt(12)
    ds_read_b64_tr_b16 v[24:25], v15 offset:34208
    ds_read_b64_tr_b16 v[26:27], v15 offset:34720
    v_mfma_f32_16x16x32_bf16 a[144:147], v[28:31], v[96:99], a[144:147]
    v_mfma_f32_16x16x32_bf16 a[148:151], v[28:31], v[104:107], a[148:151]
    ds_write_b128 v12, a[120:123] offset:14336
    v_mfma_f32_16x16x32_bf16 a[152:155], v[28:31], v[112:115], a[152:155]
    s_waitcnt lgkmcnt(12)
    ds_write_b128 v12, a[124:127] offset:15360
    v_mfma_f32_16x16x32_bf16 a[156:159], v[28:31], v[120:123], a[156:159]
    ds_read_b64_tr_b16 v[28:29], v15 offset:34240
    ds_read_b64_tr_b16 v[30:31], v15 offset:34752
    v_mfma_f32_16x16x32_bf16 a[160:163], v[32:35], v[96:99], a[160:163]
    v_mfma_f32_16x16x32_bf16 a[164:167], v[32:35], v[104:107], a[164:167]
    s_waitcnt lgkmcnt(12)
    ds_write_b128 v12, a[136:139] offset:16384
    v_mfma_f32_16x16x32_bf16 a[168:171], v[32:35], v[112:115], a[168:171]
    ds_write_b128 v12, a[140:143] offset:17408
    v_mfma_f32_16x16x32_bf16 a[172:175], v[32:35], v[120:123], a[172:175]
    ds_read_b64_tr_b16 v[32:33], v15 offset:34272
    s_waitcnt lgkmcnt(12)
    ds_read_b64_tr_b16 v[34:35], v15 offset:34784
    v_mfma_f32_16x16x32_bf16 a[176:179], v[16:19], v[96:99], a[176:179]
    v_mfma_f32_16x16x32_bf16 a[180:183], v[16:19], v[104:107], a[180:183]
    ds_write_b128 v12, a[152:155] offset:18432
    v_mfma_f32_16x16x32_bf16 a[184:187], v[16:19], v[112:115], a[184:187]
    ds_write_b128 v12, a[156:159] offset:19456
    v_mfma_f32_16x16x32_bf16 a[188:191], v[16:19], v[120:123], a[188:191]
    s_waitcnt lgkmcnt(14)
    v_mfma_f32_16x16x32_bf16 a[192:195], v[20:23], v[96:99], a[192:195]
    v_mfma_f32_16x16x32_bf16 a[196:199], v[20:23], v[104:107], a[196:199]
    ds_write_b128 v12, a[168:171] offset:20480
    v_mfma_f32_16x16x32_bf16 a[200:203], v[20:23], v[112:115], a[200:203]
    s_waitcnt lgkmcnt(12)
    ds_write_b128 v12, a[172:175] offset:21504
    v_mfma_f32_16x16x32_bf16 a[204:207], v[20:23], v[120:123], a[204:207]
    s_waitcnt lgkmcnt(12)
    v_mfma_f32_16x16x32_bf16 a[208:211], v[24:27], v[96:99], a[208:211]
    v_mfma_f32_16x16x32_bf16 a[212:215], v[24:27], v[104:107], a[212:215]
    ds_write_b128 v12, a[184:187] offset:22528
    v_mfma_f32_16x16x32_bf16 a[216:219], v[24:27], v[112:115], a[216:219]
    ds_write_b128 v12, a[188:191] offset:23552
    v_mfma_f32_16x16x32_bf16 a[220:223], v[24:27], v[120:123], a[220:223]
    s_waitcnt lgkmcnt(10)
    v_mfma_f32_16x16x32_bf16 a[224:227], v[28:31], v[96:99], a[224:227]
    v_mfma_f32_16x16x32_bf16 a[228:231], v[28:31], v[104:107], a[228:231]
    v_mfma_f32_16x16x32_bf16 a[232:235], v[28:31], v[112:115], a[232:235]
    v_mfma_f32_16x16x32_bf16 a[236:239], v[28:31], v[120:123], a[236:239]
    s_waitcnt lgkmcnt(6)
    v_mfma_f32_16x16x32_bf16 a[240:243], v[32:35], v[96:99], a[240:243]
    v_mfma_f32_16x16x32_bf16 a[244:247], v[32:35], v[104:107], a[244:247]
    v_mfma_f32_16x16x32_bf16 a[248:251], v[32:35], v[112:115], a[248:251]
    v_mfma_f32_16x16x32_bf16 a[252:255], v[32:35], v[120:123], a[252:255]
    s_waitcnt lgkmcnt(0)
    s_barrier
    ds_write_b128 v14, a[200:203]
    ds_write_b128 v14, a[204:207] offset:1024
    ds_write_b128 v14, a[216:219] offset:2048
    ds_write_b128 v14, a[220:223] offset:3072
    ds_write_b128 v14, a[232:235] offset:4096
    ds_write_b128 v14, a[236:239] offset:5120
    ds_write_b128 v14, a[248:251] offset:6144
    ds_write_b128 v14, a[252:255] offset:7168
    s_waitcnt vmcnt(0)
    v_readfirstlane_b32 s76, v11
    s_nop 3
    v_mov_b32 v44, v4
    s_nop 1
    v_permlane16_swap_b32 v4, v44
    v_add_f32 v4, v4, v44
    v_mov_b32 v44, v4
    s_nop 1
    v_permlane32_swap_b32 v4, v44
    v_add_f32 v4, v4, v44
    v_mov_b32 v44, v5
    s_nop 1
    v_permlane16_swap_b32 v5, v44
    v_add_f32 v5, v5, v44
    v_mov_b32 v44, v5
    s_nop 1
    v_permlane32_swap_b32 v5, v44
    v_add_f32 v5, v5, v44
    v_mov_b32 v44, v6
    s_nop 1
    v_permlane16_swap_b32 v6, v44
    v_add_f32 v6, v6, v44
    v_mov_b32 v44, v6
    s_nop 1
    v_permlane32_swap_b32 v6, v44
    v_add_f32 v6, v6, v44
    v_mov_b32 v44, v7
    s_nop 1
    v_permlane16_swap_b32 v7, v44
    v_add_f32 v7, v7, v44
    v_mov_b32 v44, v7
    s_nop 1
    v_permlane32_swap_b32 v7, v44
    v_add_f32 v7, v7, v44
    v_mov_b32 v36, v56
    v_mov_b32 v37, v6
    v_mov_b32 v38, v60
    v_mov_b32 v39, v7
    s_lshl_b32 s57, s42, 10
    s_add_u32 s57, s57, 0x21000
    v_lshlrev_b32 v11, 4, v0
    v_add_u32 v45, s57, v11
    ds_write_b128 v45, v[36:39]
    s_xor_b32 s59, s42, 1
    s_lshl_b32 s57, s59, 10
    s_add_u32 s57, s57, 0x21000
    v_add_u32 v45, s57, v11
    s_mul_i32 s57, s59, 0x6000
    v_add_u32 v46, s57, v11
    s_lshl_b32 s58, s59, 13
    s_add_u32 s58, s58, 0x18c00
    v_add_u32 v47, s58, v11
    s_cmp_ge_u32 s76, 16
    s_cbranch_scc1 L_pdone_F
    s_lshl_b32 s57, s44, 4
    v_and_b32 v64, 0, v0
    v_lshlrev_b32 v64, 2, v64
    s_mov_b32 s58, 0
L_poll_F:
    buffer_load_dword v65, v64, s[64:67], s57 offen sc1
    s_waitcnt vmcnt(0)
    v_readfirstlane_b32 s59, v65
    s_nop 3
    s_add_u32 s58, s58, 1
    s_cmp_ge_u32 s59, 16
    s_cbranch_scc1 L_pdone_F
    s_sleep 2
    s_cmp_lt_u32 s58, 0x40000
    s_cbranch_scc1 L_poll_F
L_pdone_F:
    s_waitcnt lgkmcnt(0)
    s_barrier
    s_lshl_b32 s57, s43, 2
    s_add_u32 s57, s57, s42
    s_lshl_b32 s58, s57, 10
    s_mul_i32 s59, s57, 0x300
    s_add_u32 s59, s59, 0x10000
    v_lshlrev_b32 v14, 4, v0
    v_add_u32 v12, s58, v14
    v_add_u32 v14, s59, v14
    v_cmp_gt_u32 vcc, 48, v0
    v_mov_b32 v64, 0x7f000000
    s_nop 0
    v_cndmask_b32 v14, v64, v14, vcc
    s_mul_i32 s61, s44, 0x1c0000
    s_add_u32 s61, s61, 0
    buffer_load_dwordx4 a[8:11], v12, s[36:39], s61 offen sc1
    ds_read_b128 v[36:39], v45
    ds_read_b128 v[128:131], v46
    ds_read_b128 v[132:135], v46 offset:1024
    ds_read_b128 v[136:139], v46 offset:2048
    ds_read_b128 v[140:143], v46 offset:3072
    ds_read_b128 v[144:147], v46 offset:4096
    ds_read_b128 v[148:151], v46 offset:5120
    buffer_load_dwordx4 a[12:15], v14, s[36:39], s61 offen sc1
    ds_read_b128 v[152:155], v46 offset:6144
    ds_read_b128 v[156:159], v46 offset:7168
    ds_read_b128 v[160:163], v46 offset:8192
    ds_read_b128 v[164:167], v46 offset:9216
    ds_read_b128 v[168:171], v46 offset:10240
    ds_read_b128 v[172:175], v46 offset:11264
    s_add_u32 s62, s61, 0x1c000
    buffer_load_dwordx4 a[24:27], v12, s[36:39], s62 offen sc1
    ds_read_b128 v[176:179], v46 offset:12288
    ds_read_b128 v[180:183], v46 offset:13312
    s_waitcnt lgkmcnt(12)
    ds_read_b128 v[184:187], v46 offset:14336
    ds_read_b128 v[188:191], v46 offset:15360
    ds_read_b128 v[192:195], v46 offset:16384
    s_waitcnt lgkmcnt(12)
    ds_read_b128 v[196:199], v46 offset:17408
    buffer_load_dwordx4 a[28:31], v14, s[36:39], s62 offen sc1
    ds_read_b128 v[200:203], v46 offset:18432
    ds_read_b128 v[204:207], v46 offset:19456
    s_waitcnt lgkmcnt(12)
    ds_read_b128 v[208:211], v46 offset:20480
    ds_read_b128 v[212:215], v46 offset:21504
    ds_read_b128 v[216:219], v46 offset:22528
    s_waitcnt lgkmcnt(12)
    ds_read_b128 v[220:223], v46 offset:23552
    s_add_u32 s61, s62, 0x1c000
    buffer_load_dwordx4 a[40:43], v12, s[36:39], s61 offen sc1
    ds_read_b128 v[224:227], v47
    ds_read_b128 v[228:231], v47 offset:1024
    s_waitcnt lgkmcnt(12)
    ds_read_b128 v[232:235], v47 offset:2048
    ds_read_b128 v[236:239], v47 offset:3072
    ds_read_b128 v[240:243], v47 offset:4096
    s_waitcnt lgkmcnt(12)
    ds_read_b128 v[244:247], v47 offset:5120
    buffer_load_dwordx4 a[44:47], v14, s[36:39], s61 offen sc1
    ds_read_b128 v[248:251], v47 offset:6144
    ds_read_b128 v[252:255], v47 offset:7168
    v_min_f32 v9, v48, v36
    v_sub_f32 v10, v9, v48
    v_sub_f32 v11, v9, v36
    v_exp_f32 v10, v10
    v_exp_f32 v11, v11
    v_mul_f32 v9, v10, v4
    v_fma_f32 v9, v11, v37, v9
    v_rcp_f32 v9, v9
    s_nop 0
    v_mul_f32 v40, v10, v9
    v_mul_f32 v42, v11, v9
    v_min_f32 v9, v52, v38
    v_sub_f32 v10, v9, v52
    v_sub_f32 v11, v9, v38
    v_exp_f32 v10, v10
    v_exp_f32 v11, v11
    v_mul_f32 v9, v10, v5
    v_fma_f32 v9, v11, v39, v9
    v_rcp_f32 v9, v9
    s_nop 0
    v_mul_f32 v41, v10, v9
    v_mul_f32 v43, v11, v9
    s_waitcnt lgkmcnt(0)
    s_barrier
    v_lshrrev_b32 v44, 3, v0
    v_and_b32 v45, 7, v0
    v_mul_u32_u24 v10, 0x3800, v44
    v_lshl_add_u32 v10, v45, 4, v10
    s_add_u32 m0, s45, 0
    s_nop 0
    buffer_load_dwordx4 v10, s[24:27], s52 offen lds
    s_add_u32 m0, m0, 0x420
    s_add_u32 s52, s52, 0x380
    buffer_load_dwordx4 v10, s[24:27], s52 offen lds
    s_add_u32 m0, m0, 0x420
    s_add_u32 s52, s52, 0x380
    buffer_load_dwordx4 v10, s[24:27], s52 offen lds
    s_add_u32 m0, m0, 0x420
    s_add_u32 s52, s52, 0x380
    buffer_load_dwordx4 v10, s[24:27], s52 offen lds
    s_add_u32 m0, m0, 0x420
    s_add_u32 s52, s52, 0x380
    buffer_load_dwordx4 v10, s[24:27], s52 offen lds
    s_add_u32 m0, m0, 0x420
    s_add_u32 s52, s52, 0x380
    buffer_load_dwordx4 v10, s[24:27], s52 offen lds
    s_add_u32 m0, m0, 0x420
    s_add_u32 s52, s52, 0x380
    buffer_load_dwordx4 v10, s[24:27], s52 offen lds
    s_add_u32 m0, m0, 0x420
    s_add_u32 s52, s52, 0x380
    buffer_load_dwordx4 v10, s[24:27], s52 offen lds
    s_add_u32 m0, s45, 0x10800
    s_add_u32 s52, s52, 0xffffe800
    buffer_load_dwordx4 v10, s[24:27], s52 offen lds
    s_add_u32 m0, m0, 0x420
    s_add_u32 s52, s52, 0x380
    buffer_load_dwordx4 v10, s[24:27], s52 offen lds
    s_add_u32 m0, m0, 0x420
    s_add_u32 s52, s52, 0x380
    buffer_load_dwordx4 v10, s[24:27], s52 offen lds
    s_add_u32 m0, m0, 0x420
    s_add_u32 s52, s52, 0x380
    buffer_load_dwordx4 v10, s[24:27], s52 offen lds
    s_add_u32 m0, m0, 0x420
    s_add_u32 s52, s52, 0x380
    buffer_load_dwordx4 v10, s[24:27], s52 offen lds
    s_add_u32 m0, m0, 0x420
    s_add_u32 s52, s52, 0x380
    buffer_load_dwordx4 v10, s[24:27], s52 offen lds
    s_add_u32 m0, m0, 0x420
    s_add_u32 s52, s52, 0x380
    buffer_load_dwordx4 v10, s[24:27], s52 offen lds
    s_add_u32 m0, m0, 0x420
    s_add_u32 s52, s52, 0x380
    buffer_load_dwordx4 v10, s[24:27], s52 offen lds
    s_add_u32 m0, s45, 0x8400
    s_add_u32 s52, s52, 0xffffe800
    buffer_load_dwordx4 v10, s[24:27], s52 offen lds
    s_add_u32 m0, m0, 0x420
    s_add_u32 s52, s52, 0x380
    buffer_load_dwordx4 v10, s[24:27], s52 offen lds
    s_add_u32 m0, m0, 0x420
    s_add_u32 s52, s52, 0x380
    buffer_load_dwordx4 v10, s[24:27], s52 offen lds
    s_add_u32 m0, m0, 0x420
    s_add_u32 s52, s52, 0x380
    buffer_load_dwordx4 v10, s[24:27], s52 offen lds
    s_add_u32 m0, m0, 0x420
    s_add_u32 s52, s52, 0x380
    buffer_load_dwordx4 v10, s[24:27], s52 offen lds
    s_add_u32 m0, m0, 0x420
    s_add_u32 s52, s52, 0x380
    buffer_load_dwordx4 v10, s[24:27], s52 offen lds
    s_add_u32 m0, m0, 0x420
    s_add_u32 s52, s52, 0x380
    buffer_load_dwordx4 v10, s[24:27], s52 offen lds
    s_add_u32 m0, m0, 0x420
    s_add_u32 s52, s52, 0x380
    buffer_load_dwordx4 v10, s[24:27], s52 offen lds
    s_add_u32 m0, s45, 0x18c00
    s_add_u32 s52, s52, 0xffffe800
    v_sub_u32 v6, v2, s80
    v_add_u32 v7, 0x10800, v6
    v_lshlrev_b32 v11, 4, v0
    v_accvgpr_read_b32 v64, a0
    v_accvgpr_read_b32 v65, a1
    v_accvgpr_read_b32 v66, a2
    v_accvgpr_read_b32 v67, a3
    v_pk_mul_f32 v[64:65], v[64:65], v[40:41] op_sel:[0,0] op_sel_hi:[1,0]
    v_pk_mul_f32 v[66:67], v[66:67], v[40:41] op_sel:[0,0] op_sel_hi:[1,0]
    v_pk_fma_f32 v[64:65], v[128:129], v[42:43], v[64:65] op_sel:[0,0,0] op_sel_hi:[1,0,1]
    v_pk_fma_f32 v[66:67], v[130:131], v[42:43], v[66:67] op_sel:[0,0,0] op_sel_hi:[1,0,1]
    v_cvt_pk_bf16_f32 v128, v64, v65
    v_cvt_pk_bf16_f32 v129, v66, v67
    v_accvgpr_read_b32 v68, a4
    v_accvgpr_read_b32 v69, a5
    v_accvgpr_read_b32 v70, a6
    v_accvgpr_read_b32 v71, a7
    v_pk_mul_f32 v[68:69], v[68:69], v[40:41] op_sel:[0,1] op_sel_hi:[1,1]
    v_pk_mul_f32 v[70:71], v[70:71], v[40:41] op_sel:[0,1] op_sel_hi:[1,1]
    v_pk_fma_f32 v[68:69], v[132:133], v[42:43], v[68:69] op_sel:[0,1,0] op_sel_hi:[1,1,1]
    v_pk_fma_f32 v[70:71], v[134:135], v[42:43], v[70:71] op_sel:[0,1,0] op_sel_hi:[1,1,1]
    v_cvt_pk_bf16_f32 v132, v68, v69
    v_cvt_pk_bf16_f32 v133, v70, v71
    s_add_u32 s62, s61, 0x1c000
    buffer_load_dwordx4 a[56:59], v12, s[36:39], s62 offen sc1
    v_accvgpr_read_b32 v72, a16
    v_accvgpr_read_b32 v73, a17
    v_accvgpr_read_b32 v74, a18
    v_accvgpr_read_b32 v75, a19
    v_pk_mul_f32 v[72:73], v[72:73], v[40:41] op_sel:[0,0] op_sel_hi:[1,0]
    v_pk_mul_f32 v[74:75], v[74:75], v[40:41] op_sel:[0,0] op_sel_hi:[1,0]
    v_pk_fma_f32 v[72:73], v[136:137], v[42:43], v[72:73] op_sel:[0,0,0] op_sel_hi:[1,0,1]
    v_pk_fma_f32 v[74:75], v[138:139], v[42:43], v[74:75] op_sel:[0,0,0] op_sel_hi:[1,0,1]
    v_cvt_pk_bf16_f32 v130, v72, v73
    v_cvt_pk_bf16_f32 v131, v74, v75
    v_accvgpr_read_b32 v76, a20
    v_accvgpr_read_b32 v77, a21
    v_accvgpr_read_b32 v78, a22
    v_accvgpr_read_b32 v79, a23
    v_pk_mul_f32 v[76:77], v[76:77], v[40:41] op_sel:[0,1] op_sel_hi:[1,1]
    v_pk_mul_f32 v[78:79], v[78:79], v[40:41] op_sel:[0,1] op_sel_hi:[1,1]
    v_pk_fma_f32 v[76:77], v[140:141], v[42:43], v[76:77] op_sel:[0,1,0] op_sel_hi:[1,1,1]
    v_pk_fma_f32 v[78:79], v[142:143], v[42:43], v[78:79] op_sel:[0,1,0] op_sel_hi:[1,1,1]
    v_cvt_pk_bf16_f32 v134, v76, v77
    v_cvt_pk_bf16_f32 v135, v78, v79
    v_accvgpr_read_b32 v64, a32
    v_accvgpr_read_b32 v65, a33
    v_accvgpr_read_b32 v66, a34
    v_accvgpr_read_b32 v67, a35
    v_pk_mul_f32 v[64:65], v[64:65], v[40:41] op_sel:[0,0] op_sel_hi:[1,0]
    v_pk_mul_f32 v[66:67], v[66:67], v[40:41] op_sel:[0,0] op_sel_hi:[1,0]
    v_pk_fma_f32 v[64:65], v[144:145], v[42:43], v[64:65] op_sel:[0,0,0] op_sel_hi:[1,0,1]
    v_pk_fma_f32 v[66:67], v[146:147], v[42:43], v[66:67] op_sel:[0,0,0] op_sel_hi:[1,0,1]
    v_cvt_pk_bf16_f32 v144, v64, v65
    v_cvt_pk_bf16_f32 v145, v66, v67
    buffer_load_dwordx4 a[60:63], v14, s[36:39], s62 offen sc1
    v_accvgpr_read_b32 v68, a36
    v_accvgpr_read_b32 v69, a37
    v_accvgpr_read_b32 v70, a38
    v_accvgpr_read_b32 v71, a39
    v_pk_mul_f32 v[68:69], v[68:69], v[40:41] op_sel:[0,1] op_sel_hi:[1,1]
    v_pk_mul_f32 v[70:71], v[70:71], v[40:41] op_sel:[0,1] op_sel_hi:[1,1]
    v_pk_fma_f32 v[68:69], v[148:149], v[42:43], v[68:69] op_sel:[0,1,0] op_sel_hi:[1,1,1]
    v_pk_fma_f32 v[70:71], v[150:151], v[42:43], v[70:71] op_sel:[0,1,0] op_sel_hi:[1,1,1]
    v_cvt_pk_bf16_f32 v148, v68, v69
    v_cvt_pk_bf16_f32 v149, v70, v71
    v_accvgpr_read_b32 v72, a48
    v_accvgpr_read_b32 v73, a49
    v_accvgpr_read_b32 v74, a50
    v_accvgpr_read_b32 v75, a51
    v_pk_mul_f32 v[72:73], v[72:73], v[40:41] op_sel:[0,0] op_sel_hi:[1,0]
    v_pk_mul_f32 v[74:75], v[74:75], v[40:41] op_sel:[0,0] op_sel_hi:[1,0]
    v_pk_fma_f32 v[72:73], v[152:153], v[42:43], v[72:73] op_sel:[0,0,0] op_sel_hi:[1,0,1]
    v_pk_fma_f32 v[74:75], v[154:155], v[42:43], v[74:75] op_sel:[0,0,0] op_sel_hi:[1,0,1]
    v_cvt_pk_bf16_f32 v146, v72, v73
    v_cvt_pk_bf16_f32 v147, v74, v75
    s_add_u32 s61, s62, 0x1c000
    buffer_load_dwordx4 a[72:75], v12, s[36:39], s61 offen sc1
    v_accvgpr_read_b32 v76, a52
    v_accvgpr_read_b32 v77, a53
    v_accvgpr_read_b32 v78, a54
    v_accvgpr_read_b32 v79, a55
    v_pk_mul_f32 v[76:77], v[76:77], v[40:41] op_sel:[0,1] op_sel_hi:[1,1]
    v_pk_mul_f32 v[78:79], v[78:79], v[40:41] op_sel:[0,1] op_sel_hi:[1,1]
    v_pk_fma_f32 v[76:77], v[156:157], v[42:43], v[76:77] op_sel:[0,1,0] op_sel_hi:[1,1,1]
    v_pk_fma_f32 v[78:79], v[158:159], v[42:43], v[78:79] op_sel:[0,1,0] op_sel_hi:[1,1,1]
    v_cvt_pk_bf16_f32 v150, v76, v77
    v_cvt_pk_bf16_f32 v151, v78, v79
    v_accvgpr_read_b32 v64, a64
    v_accvgpr_read_b32 v65, a65
    v_accvgpr_read_b32 v66, a66
    v_accvgpr_read_b32 v67, a67
    v_pk_mul_f32 v[64:65], v[64:65], v[40:41] op_sel:[0,0] op_sel_hi:[1,0]
    v_pk_mul_f32 v[66:67], v[66:67], v[40:41] op_sel:[0,0] op_sel_hi:[1,0]
    v_pk_fma_f32 v[64:65], v[160:161], v[42:43], v[64:65] op_sel:[0,0,0] op_sel_hi:[1,0,1]
    v_pk_fma_f32 v[66:67], v[162:163], v[42:43], v[66:67] op_sel:[0,0,0] op_sel_hi:[1,0,1]
    v_cvt_pk_bf16_f32 v160, v64, v65
    v_cvt_pk_bf16_f32 v161, v66, v67
    v_accvgpr_read_b32 v68, a68
    v_accvgpr_read_b32 v69, a69
    v_accvgpr_read_b32 v70, a70
    v_accvgpr_read_b32 v71, a71
    v_pk_mul_f32 v[68:69], v[68:69], v[40:41] op_sel:[0,1] op_sel_hi:[1,1]
    v_pk_mul_f32 v[70:71], v[70:71], v[40:41] op_sel:[0,1] op_sel_hi:[1,1]
    v_pk_fma_f32 v[68:69], v[164:165], v[42:43], v[68:69] op_sel:[0,1,0] op_sel_hi:[1,1,1]
    v_pk_fma_f32 v[70:71], v[166:167], v[42:43], v[70:71] op_sel:[0,1,0] op_sel_hi:[1,1,1]
    v_cvt_pk_bf16_f32 v164, v68, v69
    v_cvt_pk_bf16_f32 v165, v70, v71
    buffer_load_dwordx4 a[76:79], v14, s[36:39], s61 offen sc1
    v_accvgpr_read_b32 v72, a80
    v_accvgpr_read_b32 v73, a81
    v_accvgpr_read_b32 v74, a82
    v_accvgpr_read_b32 v75, a83
    v_pk_mul_f32 v[72:73], v[72:73], v[40:41] op_sel:[0,0] op_sel_hi:[1,0]
    v_pk_mul_f32 v[74:75], v[74:75], v[40:41] op_sel:[0,0] op_sel_hi:[1,0]
    v_pk_fma_f32 v[72:73], v[168:169], v[42:43], v[72:73] op_sel:[0,0,0] op_sel_hi:[1,0,1]
    v_pk_fma_f32 v[74:75], v[170:171], v[42:43], v[74:75] op_sel:[0,0,0] op_sel_hi:[1,0,1]
    v_cvt_pk_bf16_f32 v162, v72, v73
    v_cvt_pk_bf16_f32 v163, v74, v75
    v_accvgpr_read_b32 v76, a84
    v_accvgpr_read_b32 v77, a85
    v_accvgpr_read_b32 v78, a86
    v_accvgpr_read_b32 v79, a87
    v_pk_mul_f32 v[76:77], v[76:77], v[40:41] op_sel:[0,1] op_sel_hi:[1,1]
    v_pk_mul_f32 v[78:79], v[78:79], v[40:41] op_sel:[0,1] op_sel_hi:[1,1]
    v_pk_fma_f32 v[76:77], v[172:173], v[42:43], v[76:77] op_sel:[0,1,0] op_sel_hi:[1,1,1]
    v_pk_fma_f32 v[78:79], v[174:175], v[42:43], v[78:79] op_sel:[0,1,0] op_sel_hi:[1,1,1]
    v_cvt_pk_bf16_f32 v166, v76, v77
    v_cvt_pk_bf16_f32 v167, v78, v79
    v_accvgpr_read_b32 v64, a96
    v_accvgpr_read_b32 v65, a97
    v_accvgpr_read_b32 v66, a98
    v_accvgpr_read_b32 v67, a99
    v_pk_mul_f32 v[64:65], v[64:65], v[40:41] op_sel:[0,0] op_sel_hi:[1,0]
    v_pk_mul_f32 v[66:67], v[66:67], v[40:41] op_sel:[0,0] op_sel_hi:[1,0]
    v_pk_fma_f32 v[64:65], v[176:177], v[42:43], v[64:65] op_sel:[0,0,0] op_sel_hi:[1,0,1]
    v_pk_fma_f32 v[66:67], v[178:179], v[42:43], v[66:67] op_sel:[0,0,0] op_sel_hi:[1,0,1]
    v_cvt_pk_bf16_f32 v176, v64, v65
    v_cvt_pk_bf16_f32 v177, v66, v67
    s_add_u32 s62, s61, 0x1c000
    buffer_load_dwordx4 a[88:91], v12, s[36:39], s62 offen sc1
    v_accvgpr_read_b32 v68, a100
    v_accvgpr_read_b32 v69, a101
    v_accvgpr_read_b32 v70, a102
    v_accvgpr_read_b32 v71, a103
    v_pk_mul_f32 v[68:69], v[68:69], v[40:41] op_sel:[0,1] op_sel_hi:[1,1]
    v_pk_mul_f32 v[70:71], v[70:71], v[40:41] op_sel:[0,1] op_sel_hi:[1,1]
    v_pk_fma_f32 v[68:69], v[180:181], v[42:43], v[68:69] op_sel:[0,1,0] op_sel_hi:[1,1,1]
    v_pk_fma_f32 v[70:71], v[182:183], v[42:43], v[70:71] op_sel:[0,1,0] op_sel_hi:[1,1,1]
    v_cvt_pk_bf16_f32 v180, v68, v69
    v_cvt_pk_bf16_f32 v181, v70, v71
    v_accvgpr_read_b32 v72, a112
    v_accvgpr_read_b32 v73, a113
    v_accvgpr_read_b32 v74, a114
    v_accvgpr_read_b32 v75, a115
    v_pk_mul_f32 v[72:73], v[72:73], v[40:41] op_sel:[0,0] op_sel_hi:[1,0]
    v_pk_mul_f32 v[74:75], v[74:75], v[40:41] op_sel:[0,0] op_sel_hi:[1,0]
    v_pk_fma_f32 v[72:73], v[184:185], v[42:43], v[72:73] op_sel:[0,0,0] op_sel_hi:[1,0,1]
    v_pk_fma_f32 v[74:75], v[186:187], v[42:43], v[74:75] op_sel:[0,0,0] op_sel_hi:[1,0,1]
    v_cvt_pk_bf16_f32 v178, v72, v73
    v_cvt_pk_bf16_f32 v179, v74, v75
    buffer_load_dwordx4 a[92:95], v14, s[36:39], s62 offen sc1
    v_accvgpr_read_b32 v76, a116
    v_accvgpr_read_b32 v77, a117
    v_accvgpr_read_b32 v78, a118
    v_accvgpr_read_b32 v79, a119
    v_pk_mul_f32 v[76:77], v[76:77], v[40:41] op_sel:[0,1] op_sel_hi:[1,1]
    v_pk_mul_f32 v[78:79], v[78:79], v[40:41] op_sel:[0,1] op_sel_hi:[1,1]
    v_pk_fma_f32 v[76:77], v[188:189], v[42:43], v[76:77] op_sel:[0,1,0] op_sel_hi:[1,1,1]
    v_pk_fma_f32 v[78:79], v[190:191], v[42:43], v[78:79] op_sel:[0,1,0] op_sel_hi:[1,1,1]
    v_cvt_pk_bf16_f32 v182, v76, v77
    v_cvt_pk_bf16_f32 v183, v78, v79
    v_accvgpr_read_b32 v64, a128
    v_accvgpr_read_b32 v65, a129
    v_accvgpr_read_b32 v66, a130
    v_accvgpr_read_b32 v67, a131
    v_pk_mul_f32 v[64:65], v[64:65], v[40:41] op_sel:[0,0] op_sel_hi:[1,0]
    v_pk_mul_f32 v[66:67], v[66:67], v[40:41] op_sel:[0,0] op_sel_hi:[1,0]
    v_pk_fma_f32 v[64:65], v[192:193], v[42:43], v[64:65] op_sel:[0,0,0] op_sel_hi:[1,0,1]
    v_pk_fma_f32 v[66:67], v[194:195], v[42:43], v[66:67] op_sel:[0,0,0] op_sel_hi:[1,0,1]
    v_cvt_pk_bf16_f32 v192, v64, v65
    v_cvt_pk_bf16_f32 v193, v66, v67
    v_accvgpr_read_b32 v68, a132
    v_accvgpr_read_b32 v69, a133
    v_accvgpr_read_b32 v70, a134
    v_accvgpr_read_b32 v71, a135
    v_pk_mul_f32 v[68:69], v[68:69], v[40:41] op_sel:[0,1] op_sel_hi:[1,1]
    v_pk_mul_f32 v[70:71], v[70:71], v[40:41] op_sel:[0,1] op_sel_hi:[1,1]
    v_pk_fma_f32 v[68:69], v[196:197], v[42:43], v[68:69] op_sel:[0,1,0] op_sel_hi:[1,1,1]
    v_pk_fma_f32 v[70:71], v[198:199], v[42:43], v[70:71] op_sel:[0,1,0] op_sel_hi:[1,1,1]
    v_cvt_pk_bf16_f32 v196, v68, v69
    v_cvt_pk_bf16_f32 v197, v70, v71
    s_add_u32 s61, s62, 0x1c000
    buffer_load_dwordx4 a[104:107], v12, s[36:39], s61 offen sc1
    v_accvgpr_read_b32 v72, a144
    v_accvgpr_read_b32 v73, a145
    v_accvgpr_read_b32 v74, a146
    v_accvgpr_read_b32 v75, a147
    v_pk_mul_f32 v[72:73], v[72:73], v[40:41] op_sel:[0,0] op_sel_hi:[1,0]
    v_pk_mul_f32 v[74:75], v[74:75], v[40:41] op_sel:[0,0] op_sel_hi:[1,0]
    v_pk_fma_f32 v[72:73], v[200:201], v[42:43], v[72:73] op_sel:[0,0,0] op_sel_hi:[1,0,1]
    v_pk_fma_f32 v[74:75], v[202:203], v[42:43], v[74:75] op_sel:[0,0,0] op_sel_hi:[1,0,1]
    v_cvt_pk_bf16_f32 v194, v72, v73
    v_cvt_pk_bf16_f32 v195, v74, v75
    v_accvgpr_read_b32 v76, a148
    v_accvgpr_read_b32 v77, a149
    v_accvgpr_read_b32 v78, a150
    v_accvgpr_read_b32 v79, a151
    v_pk_mul_f32 v[76:77], v[76:77], v[40:41] op_sel:[0,1] op_sel_hi:[1,1]
    v_pk_mul_f32 v[78:79], v[78:79], v[40:41] op_sel:[0,1] op_sel_hi:[1,1]
    v_pk_fma_f32 v[76:77], v[204:205], v[42:43], v[76:77] op_sel:[0,1,0] op_sel_hi:[1,1,1]
    v_pk_fma_f32 v[78:79], v[206:207], v[42:43], v[78:79] op_sel:[0,1,0] op_sel_hi:[1,1,1]
    v_cvt_pk_bf16_f32 v198, v76, v77
    v_cvt_pk_bf16_f32 v199, v78, v79
    v_accvgpr_read_b32 v64, a160
    v_accvgpr_read_b32 v65, a161
    v_accvgpr_read_b32 v66, a162
    v_accvgpr_read_b32 v67, a163
    v_pk_mul_f32 v[64:65], v[64:65], v[40:41] op_sel:[0,0] op_sel_hi:[1,0]
    v_pk_mul_f32 v[66:67], v[66:67], v[40:41] op_sel:[0,0] op_sel_hi:[1,0]
    v_pk_fma_f32 v[64:65], v[208:209], v[42:43], v[64:65] op_sel:[0,0,0] op_sel_hi:[1,0,1]
    v_pk_fma_f32 v[66:67], v[210:211], v[42:43], v[66:67] op_sel:[0,0,0] op_sel_hi:[1,0,1]
    v_cvt_pk_bf16_f32 v208, v64, v65
    v_cvt_pk_bf16_f32 v209, v66, v67
    buffer_load_dwordx4 a[108:111], v14, s[36:39], s61 offen sc1
    v_accvgpr_read_b32 v68, a164
    v_accvgpr_read_b32 v69, a165
    v_accvgpr_read_b32 v70, a166
    v_accvgpr_read_b32 v71, a167
    v_pk_mul_f32 v[68:69], v[68:69], v[40:41] op_sel:[0,1] op_sel_hi:[1,1]
    v_pk_mul_f32 v[70:71], v[70:71], v[40:41] op_sel:[0,1] op_sel_hi:[1,1]
    v_pk_fma_f32 v[68:69], v[212:213], v[42:43], v[68:69] op_sel:[0,1,0] op_sel_hi:[1,1,1]
    v_pk_fma_f32 v[70:71], v[214:215], v[42:43], v[70:71] op_sel:[0,1,0] op_sel_hi:[1,1,1]
    v_cvt_pk_bf16_f32 v212, v68, v69
    v_cvt_pk_bf16_f32 v213, v70, v71
    v_accvgpr_read_b32 v72, a176
    v_accvgpr_read_b32 v73, a177
    v_accvgpr_read_b32 v74, a178
    v_accvgpr_read_b32 v75, a179
    v_pk_mul_f32 v[72:73], v[72:73], v[40:41] op_sel:[0,0] op_sel_hi:[1,0]
    v_pk_mul_f32 v[74:75], v[74:75], v[40:41] op_sel:[0,0] op_sel_hi:[1,0]
    v_pk_fma_f32 v[72:73], v[216:217], v[42:43], v[72:73] op_sel:[0,0,0] op_sel_hi:[1,0,1]
    v_pk_fma_f32 v[74:75], v[218:219], v[42:43], v[74:75] op_sel:[0,0,0] op_sel_hi:[1,0,1]
    v_cvt_pk_bf16_f32 v210, v72, v73
    v_cvt_pk_bf16_f32 v211, v74, v75
    s_add_u32 s62, s61, 0x1c000
    buffer_load_dwordx4 a[120:123], v12, s[36:39], s62 offen sc1
    v_accvgpr_read_b32 v76, a180
    v_accvgpr_read_b32 v77, a181
    v_accvgpr_read_b32 v78, a182
    v_accvgpr_read_b32 v79, a183
    v_pk_mul_f32 v[76:77], v[76:77], v[40:41] op_sel:[0,1] op_sel_hi:[1,1]
    v_pk_mul_f32 v[78:79], v[78:79], v[40:41] op_sel:[0,1] op_sel_hi:[1,1]
    v_pk_fma_f32 v[76:77], v[220:221], v[42:43], v[76:77] op_sel:[0,1,0] op_sel_hi:[1,1,1]
    v_pk_fma_f32 v[78:79], v[222:223], v[42:43], v[78:79] op_sel:[0,1,0] op_sel_hi:[1,1,1]
    v_cvt_pk_bf16_f32 v214, v76, v77
    v_cvt_pk_bf16_f32 v215, v78, v79
    v_accvgpr_read_b32 v64, a192
    v_accvgpr_read_b32 v65, a193
    v_accvgpr_read_b32 v66, a194
    v_accvgpr_read_b32 v67, a195
    v_pk_mul_f32 v[64:65], v[64:65], v[40:41] op_sel:[0,0] op_sel_hi:[1,0]
    v_pk_mul_f32 v[66:67], v[66:67], v[40:41] op_sel:[0,0] op_sel_hi:[1,0]
    v_pk_fma_f32 v[64:65], v[224:225], v[42:43], v[64:65] op_sel:[0,0,0] op_sel_hi:[1,0,1]
    v_pk_fma_f32 v[66:67], v[226:227], v[42:43], v[66:67] op_sel:[0,0,0] op_sel_hi:[1,0,1]
    v_cvt_pk_bf16_f32 v224, v64, v65
    v_cvt_pk_bf16_f32 v225, v66, v67
    v_accvgpr_read_b32 v68, a196
    v_accvgpr_read_b32 v69, a197
    v_accvgpr_read_b32 v70, a198
    v_accvgpr_read_b32 v71, a199
    v_pk_mul_f32 v[68:69], v[68:69], v[40:41] op_sel:[0,1] op_sel_hi:[1,1]
    v_pk_mul_f32 v[70:71], v[70:71], v[40:41] op_sel:[0,1] op_sel_hi:[1,1]
    v_pk_fma_f32 v[68:69], v[228:229], v[42:43], v[68:69] op_sel:[0,1,0] op_sel_hi:[1,1,1]
    v_pk_fma_f32 v[70:71], v[230:231], v[42:43], v[70:71] op_sel:[0,1,0] op_sel_hi:[1,1,1]
    v_cvt_pk_bf16_f32 v228, v68, v69
    v_cvt_pk_bf16_f32 v229, v70, v71
    buffer_load_dwordx4 a[124:127], v14, s[36:39], s62 offen sc1
    v_accvgpr_read_b32 v72, a208
    v_accvgpr_read_b32 v73, a209
    v_accvgpr_read_b32 v74, a210
    v_accvgpr_read_b32 v75, a211
    v_pk_mul_f32 v[72:73], v[72:73], v[40:41] op_sel:[0,0] op_sel_hi:[1,0]
    v_pk_mul_f32 v[74:75], v[74:75], v[40:41] op_sel:[0,0] op_sel_hi:[1,0]
    v_pk_fma_f32 v[72:73], v[232:233], v[42:43], v[72:73] op_sel:[0,0,0] op_sel_hi:[1,0,1]
    v_pk_fma_f32 v[74:75], v[234:235], v[42:43], v[74:75] op_sel:[0,0,0] op_sel_hi:[1,0,1]
    v_cvt_pk_bf16_f32 v226, v72, v73
    v_cvt_pk_bf16_f32 v227, v74, v75
    v_accvgpr_read_b32 v76, a212
    v_accvgpr_read_b32 v77, a213
    v_accvgpr_read_b32 v78, a214
    v_accvgpr_read_b32 v79, a215
    v_pk_mul_f32 v[76:77], v[76:77], v[40:41] op_sel:[0,1] op_sel_hi:[1,1]
    v_pk_mul_f32 v[78:79], v[78:79], v[40:41] op_sel:[0,1] op_sel_hi:[1,1]
    v_pk_fma_f32 v[76:77], v[236:237], v[42:43], v[76:77] op_sel:[0,1,0] op_sel_hi:[1,1,1]
    v_pk_fma_f32 v[78:79], v[238:239], v[42:43], v[78:79] op_sel:[0,1,0] op_sel_hi:[1,1,1]
    v_cvt_pk_bf16_f32 v230, v76, v77
    v_cvt_pk_bf16_f32 v231, v78, v79
    v_accvgpr_read_b32 v64, a224
    v_accvgpr_read_b32 v65, a225
    v_accvgpr_read_b32 v66, a226
    v_accvgpr_read_b32 v67, a227
    v_pk_mul_f32 v[64:65], v[64:65], v[40:41] op_sel:[0,0] op_sel_hi:[1,0]
    v_pk_mul_f32 v[66:67], v[66:67], v[40:41] op_sel:[0,0] op_sel_hi:[1,0]
    v_pk_fma_f32 v[64:65], v[240:241], v[42:43], v[64:65] op_sel:[0,0,0] op_sel_hi:[1,0,1]
    v_pk_fma_f32 v[66:67], v[242:243], v[42:43], v[66:67] op_sel:[0,0,0] op_sel_hi:[1,0,1]
    v_cvt_pk_bf16_f32 v240, v64, v65
    v_cvt_pk_bf16_f32 v241, v66, v67
    s_add_u32 s61, s62, 0x1c000
    buffer_load_dwordx4 a[136:139], v12, s[36:39], s61 offen sc1
    v_accvgpr_read_b32 v68, a228
    v_accvgpr_read_b32 v69, a229
    v_accvgpr_read_b32 v70, a230
    v_accvgpr_read_b32 v71, a231
    v_pk_mul_f32 v[68:69], v[68:69], v[40:41] op_sel:[0,1] op_sel_hi:[1,1]
    v_pk_mul_f32 v[70:71], v[70:71], v[40:41] op_sel:[0,1] op_sel_hi:[1,1]
    v_pk_fma_f32 v[68:69], v[244:245], v[42:43], v[68:69] op_sel:[0,1,0] op_sel_hi:[1,1,1]
    v_pk_fma_f32 v[70:71], v[246:247], v[42:43], v[70:71] op_sel:[0,1,0] op_sel_hi:[1,1,1]
    v_cvt_pk_bf16_f32 v244, v68, v69
    v_cvt_pk_bf16_f32 v245, v70, v71
    v_accvgpr_read_b32 v72, a240
    v_accvgpr_read_b32 v73, a241
    v_accvgpr_read_b32 v74, a242
    v_accvgpr_read_b32 v75, a243
    v_pk_mul_f32 v[72:73], v[72:73], v[40:41] op_sel:[0,0] op_sel_hi:[1,0]
    v_pk_mul_f32 v[74:75], v[74:75], v[40:41] op_sel:[0,0] op_sel_hi:[1,0]
    v_pk_fma_f32 v[72:73], v[248:249], v[42:43], v[72:73] op_sel:[0,0,0] op_sel_hi:[1,0,1]
    v_pk_fma_f32 v[74:75], v[250:251], v[42:43], v[74:75] op_sel:[0,0,0] op_sel_hi:[1,0,1]
    v_cvt_pk_bf16_f32 v242, v72, v73
    v_cvt_pk_bf16_f32 v243, v74, v75
    buffer_load_dwordx4 a[140:143], v14, s[36:39], s61 offen sc1
    v_accvgpr_read_b32 v76, a244
    v_accvgpr_read_b32 v77, a245
    v_accvgpr_read_b32 v78, a246
    v_accvgpr_read_b32 v79, a247
    v_pk_mul_f32 v[76:77], v[76:77], v[40:41] op_sel:[0,1] op_sel_hi:[1,1]
    v_pk_mul_f32 v[78:79], v[78:79], v[40:41] op_sel:[0,1] op_sel_hi:[1,1]
    v_pk_fma_f32 v[76:77], v[252:253], v[42:43], v[76:77] op_sel:[0,1,0] op_sel_hi:[1,1,1]
    v_pk_fma_f32 v[78:79], v[254:255], v[42:43], v[78:79] op_sel:[0,1,0] op_sel_hi:[1,1,1]
    v_cvt_pk_bf16_f32 v246, v76, v77
    v_cvt_pk_bf16_f32 v247, v78, v79
    s_waitcnt vmcnt(28)
    s_barrier
    ds_read_b64_tr_b16 v[96:97], v6
    ds_read_b64_tr_b16 v[98:99], v6 offset:128
    ds_read_b64_tr_b16 v[100:101], v6 offset:256
    ds_read_b64_tr_b16 v[102:103], v6 offset:384
    ds_read_b64_tr_b16 v[104:105], v6 offset:32
    ds_read_b64_tr_b16 v[106:107], v6 offset:160
    ds_read_b64_tr_b16 v[108:109], v6 offset:288
    ds_read_b64_tr_b16 v[110:111], v6 offset:416
    ds_read_b64_tr_b16 v[112:113], v6 offset:64
    ds_read_b64_tr_b16 v[114:115], v6 offset:192
    ds_read_b64_tr_b16 v[116:117], v6 offset:320
    ds_read_b64_tr_b16 v[118:119], v6 offset:448
    ds_read_b64_tr_b16 v[120:121], v6 offset:96
    ds_read_b64_tr_b16 v[122:123], v6 offset:224
    ds_read_b64_tr_b16 v[124:125], v6 offset:352
    s_waitcnt lgkmcnt(12)
    ds_read_b64_tr_b16 v[126:127], v6 offset:480
    v_mfma_f32_16x16x32_bf16 v[16:19], v[96:99], v[128:131], 0
    s_waitcnt lgkmcnt(12)
    buffer_load_dwordx4 v10, s[24:27], s52 offen lds
    v_mfma_f32_16x16x32_bf16 v[16:19], v[100:103], v[144:147], v[16:19]
    s_add_u32 m0, m0, 0x420
    s_add_u32 s52, s52, 0x380
    v_mfma_f32_16x16x32_bf16 v[20:23], v[96:99], v[132:135], 0
    s_add_u32 s62, s61, 0x1c000
    ds_read_b64_tr_b16 v[96:97], v6 offset:512
    ds_read_b64_tr_b16 v[98:99], v6 offset:640
    v_mfma_f32_16x16x32_bf16 v[20:23], v[100:103], v[148:151], v[20:23]
    s_waitcnt lgkmcnt(12)
    ds_read_b64_tr_b16 v[100:101], v6 offset:768
    ds_read_b64_tr_b16 v[102:103], v6 offset:896
    v_mfma_f32_16x16x32_bf16 v[24:27], v[104:107], v[128:131], 0
    s_waitcnt lgkmcnt(12)
    buffer_load_dwordx4 a[152:155], v12, s[36:39], s62 offen sc1
    v_mfma_f32_16x16x32_bf16 v[24:27], v[108:111], v[144:147], v[24:27]
    v_mfma_f32_16x16x32_bf16 v[28:31], v[104:107], v[132:135], 0
    ds_read_b64_tr_b16 v[104:105], v6 offset:544
    ds_read_b64_tr_b16 v[106:107], v6 offset:672
    v_mfma_f32_16x16x32_bf16 v[28:31], v[108:111], v[148:151], v[28:31]
    s_waitcnt lgkmcnt(12)
    ds_read_b64_tr_b16 v[108:109], v6 offset:800
    ds_read_b64_tr_b16 v[110:111], v6 offset:928
    v_mfma_f32_16x16x32_bf16 v[32:35], v[112:115], v[128:131], 0
    s_waitcnt lgkmcnt(12)
    buffer_load_dwordx4 v10, s[24:27], s52 offen lds
    v_mfma_f32_16x16x32_bf16 v[32:35], v[116:119], v[144:147], v[32:35]
    s_add_u32 m0, m0, 0x420
    s_add_u32 s52, s52, 0x380
    v_mfma_f32_16x16x32_bf16 v[36:39], v[112:115], v[132:135], 0
    ds_read_b64_tr_b16 v[112:113], v6 offset:576
    ds_read_b64_tr_b16 v[114:115], v6 offset:704
    v_mfma_f32_16x16x32_bf16 v[36:39], v[116:119], v[148:151], v[36:39]
    s_waitcnt lgkmcnt(12)
    ds_read_b64_tr_b16 v[116:117], v6 offset:832
    ds_read_b64_tr_b16 v[118:119], v6 offset:960
    v_mfma_f32_16x16x32_bf16 v[40:43], v[120:123], v[128:131], 0
    s_waitcnt lgkmcnt(12)
    buffer_load_dwordx4 v10, s[24:27], s52 offen lds
    v_mfma_f32_16x16x32_bf16 v[40:43], v[124:127], v[144:147], v[40:43]
    s_add_u32 m0, m0, 0x420
    s_add_u32 s52, s52, 0x380
    v_mfma_f32_16x16x32_bf16 v[44:47], v[120:123], v[132:135], 0
    ds_read_b64_tr_b16 v[120:121], v6 offset:608
    ds_read_b64_tr_b16 v[122:123], v6 offset:736
    v_mfma_f32_16x16x32_bf16 v[44:47], v[124:127], v[148:151], v[44:47]
    s_waitcnt lgkmcnt(12)
    ds_read_b64_tr_b16 v[124:125], v6 offset:864
    ds_read_b64_tr_b16 v[126:127], v6 offset:992
    v_mfma_f32_16x16x32_bf16 v[16:19], v[96:99], v[160:163], v[16:19]
    s_waitcnt lgkmcnt(12)
    buffer_load_dwordx4 a[156:159], v14, s[36:39], s62 offen sc1
    v_mfma_f32_16x16x32_bf16 v[16:19], v[100:103], v[176:179], v[16:19]
    v_mfma_f32_16x16x32_bf16 v[20:23], v[96:99], v[164:167], v[20:23]
    ds_read_b64_tr_b16 v[96:97], v6 offset:16896
    ds_read_b64_tr_b16 v[98:99], v6 offset:17024
    v_mfma_f32_16x16x32_bf16 v[20:23], v[100:103], v[180:183], v[20:23]
    s_waitcnt lgkmcnt(12)
    ds_read_b64_tr_b16 v[100:101], v6 offset:17152
    ds_read_b64_tr_b16 v[102:103], v6 offset:17280
    v_mfma_f32_16x16x32_bf16 v[24:27], v[104:107], v[160:163], v[24:27]
    s_waitcnt lgkmcnt(12)
    buffer_load_dwordx4 v10, s[24:27], s52 offen lds
    v_mfma_f32_16x16x32_bf16 v[24:27], v[108:111], v[176:179], v[24:27]
    s_add_u32 m0, m0, 0x420
    s_add_u32 s52, s52, 0x380
    v_mfma_f32_16x16x32_bf16 v[28:31], v[104:107], v[164:167], v[28:31]
    ds_read_b64_tr_b16 v[104:105], v6 offset:16928
    ds_read_b64_tr_b16 v[106:107], v6 offset:17056
    v_mfma_f32_16x16x32_bf16 v[28:31], v[108:111], v[180:183], v[28:31]
    s_waitcnt lgkmcnt(12)
    ds_read_b64_tr_b16 v[108:109], v6 offset:17184
    ds_read_b64_tr_b16 v[110:111], v6 offset:17312
    v_mfma_f32_16x16x32_bf16 v[32:35], v[112:115], v[160:163], v[32:35]
    s_waitcnt lgkmcnt(12)
    v_mfma_f32_16x16x32_bf16 v[32:35], v[116:119], v[176:179], v[32:35]
    buffer_load_dwordx4 v10, s[24:27], s52 offen lds
    v_mfma_f32_16x16x32_bf16 v[36:39], v[112:115], v[164:167], v[36:39]
    s_add_u32 m0, m0, 0x420
    ds_read_b64_tr_b16 v[112:113], v6 offset:16960
    ds_read_b64_tr_b16 v[114:115], v6 offset:17088
    v_mfma_f32_16x16x32_bf16 v[36:39], v[116:119], v[180:183], v[36:39]
    s_waitcnt lgkmcnt(12)
    ds_read_b64_tr_b16 v[116:117], v6 offset:17216
    ds_read_b64_tr_b16 v[118:119], v6 offset:17344
    v_mfma_f32_16x16x32_bf16 v[40:43], v[120:123], v[160:163], v[40:43]
    s_waitcnt lgkmcnt(12)
    s_add_u32 s52, s52, 0x380
    s_add_u32 s61, s62, 0x1c000
    v_mfma_f32_16x16x32_bf16 v[40:43], v[124:127], v[176:179], v[40:43]
    buffer_load_dwordx4 a[168:171], v12, s[36:39], s61 offen sc1
    v_mfma_f32_16x16x32_bf16 v[44:47], v[120:123], v[164:167], v[44:47]
    ds_read_b64_tr_b16 v[120:121], v6 offset:16992
    ds_read_b64_tr_b16 v[122:123], v6 offset:17120
    v_mfma_f32_16x16x32_bf16 v[44:47], v[124:127], v[180:183], v[44:47]
    s_waitcnt lgkmcnt(12)
    ds_read_b64_tr_b16 v[124:125], v6 offset:17248
    ds_read_b64_tr_b16 v[126:127], v6 offset:17376
    v_mfma_f32_16x16x32_bf16 v[16:19], v[96:99], v[192:195], v[16:19]
    s_waitcnt lgkmcnt(12)
    buffer_load_dwordx4 v10, s[24:27], s52 offen lds
    v_mfma_f32_16x16x32_bf16 v[16:19], v[100:103], v[208:211], v[16:19]
    s_add_u32 m0, m0, 0x420
    s_add_u32 s52, s52, 0x380
    v_mfma_f32_16x16x32_bf16 v[20:23], v[96:99], v[196:199], v[20:23]
    ds_read_b64_tr_b16 v[96:97], v6 offset:17408
    ds_read_b64_tr_b16 v[98:99], v6 offset:17536
    v_mfma_f32_16x16x32_bf16 v[20:23], v[100:103], v[212:215], v[20:23]
    s_waitcnt lgkmcnt(12)
    ds_read_b64_tr_b16 v[100:101], v6 offset:17664
    ds_read_b64_tr_b16 v[102:103], v6 offset:17792
    v_mfma_f32_16x16x32_bf16 v[24:27], v[104:107], v[192:195], v[24:27]
    s_waitcnt lgkmcnt(12)
    v_mfma_f32_16x16x32_bf16 v[24:27], v[108:111], v[208:211], v[24:27]
    buffer_load_dwordx4 v10, s[24:27], s52 offen lds
    v_mfma_f32_16x16x32_bf16 v[28:31], v[104:107], v[196:199], v[28:31]
    s_add_u32 m0, m0, 0x420
    ds_read_b64_tr_b16 v[104:105], v6 offset:17440
    ds_read_b64_tr_b16 v[106:107], v6 offset:17568
    v_mfma_f32_16x16x32_bf16 v[28:31], v[108:111], v[212:215], v[28:31]
    s_waitcnt lgkmcnt(12)
    ds_read_b64_tr_b16 v[108:109], v6 offset:17696
    ds_read_b64_tr_b16 v[110:111], v6 offset:17824
    v_mfma_f32_16x16x32_bf16 v[32:35], v[112:115], v[192:195], v[32:35]
    s_waitcnt lgkmcnt(12)
    s_add_u32 s52, s52, 0x380
    v_mfma_f32_16x16x32_bf16 v[32:35], v[116:119], v[208:211], v[32:35]
    buffer_load_dwordx4 a[172:175], v14, s[36:39], s61 offen sc1
    v_mfma_f32_16x16x32_bf16 v[36:39], v[112:115], v[196:199], v[36:39]
    ds_read_b64_tr_b16 v[112:113], v6 offset:17472
    ds_read_b64_tr_b16 v[114:115], v6 offset:17600
    v_mfma_f32_16x16x32_bf16 v[36:39], v[116:119], v[212:215], v[36:39]
    s_waitcnt lgkmcnt(12)
    ds_read_b64_tr_b16 v[116:117], v6 offset:17728
    ds_read_b64_tr_b16 v[118:119], v6 offset:17856
    v_mfma_f32_16x16x32_bf16 v[40:43], v[120:123], v[192:195], v[40:43]
    s_waitcnt lgkmcnt(12)
    buffer_load_dwordx4 v10, s[24:27], s52 offen lds
    v_mfma_f32_16x16x32_bf16 v[40:43], v[124:127], v[208:211], v[40:43]
    s_add_u32 m0, s45, 0
    s_add_u32 s52, s52, 0xffffe800
    v_mfma_f32_16x16x32_bf16 v[44:47], v[120:123], v[196:199], v[44:47]
    ds_read_b64_tr_b16 v[120:121], v6 offset:17504
    ds_read_b64_tr_b16 v[122:123], v6 offset:17632
    v_mfma_f32_16x16x32_bf16 v[44:47], v[124:127], v[212:215], v[44:47]
    s_waitcnt lgkmcnt(12)
    ds_read_b64_tr_b16 v[124:125], v6 offset:17760
    ds_read_b64_tr_b16 v[126:127], v6 offset:17888
    v_mfma_f32_16x16x32_bf16 v[16:19], v[96:99], v[224:227], v[16:19]
    s_waitcnt lgkmcnt(12)
    v_mfma_f32_16x16x32_bf16 v[16:19], v[100:103], v[240:243], v[16:19]
    v_mfma_f32_16x16x32_bf16 v[20:23], v[96:99], v[228:231], v[20:23]
    s_add_u32 s62, s61, 0x1c000
    buffer_load_dwordx4 a[184:187], v12, s[36:39], s62 offen sc1
    v_mfma_f32_16x16x32_bf16 v[20:23], v[100:103], v[244:247], v[20:23]
    s_waitcnt lgkmcnt(10)
    s_waitcnt vmcnt(33) lgkmcnt(0)
    s_barrier
    v_mfma_f32_16x16x32_bf16 v[24:27], v[104:107], v[224:227], v[24:27]
    ds_read_b64_tr_b16 v[96:97], v7
    ds_read_b64_tr_b16 v[98:99], v7 offset:128
    v_mfma_f32_16x16x32_bf16 v[24:27], v[108:111], v[240:243], v[24:27]
    ds_read_b64_tr_b16 v[100:101], v7 offset:256
    ds_read_b64_tr_b16 v[102:103], v7 offset:384
    v_mfma_f32_16x16x32_bf16 v[28:31], v[104:107], v[228:231], v[28:31]
    buffer_load_dwordx4 v10, s[24:27], s52 offen lds
    v_mfma_f32_16x16x32_bf16 v[28:31], v[108:111], v[244:247], v[28:31]
    ds_read_b64_tr_b16 v[104:105], v7 offset:32
    ds_read_b64_tr_b16 v[106:107], v7 offset:160
    v_mfma_f32_16x16x32_bf16 v[32:35], v[112:115], v[224:227], v[32:35]
    ds_read_b64_tr_b16 v[108:109], v7 offset:288
    ds_read_b64_tr_b16 v[110:111], v7 offset:416
    v_mfma_f32_16x16x32_bf16 v[32:35], v[116:119], v[240:243], v[32:35]
    s_add_u32 m0, m0, 0x420
    s_add_u32 s52, s52, 0x380
    v_mfma_f32_16x16x32_bf16 v[36:39], v[112:115], v[228:231], v[36:39]
    ds_read_b64_tr_b16 v[112:113], v7 offset:64
    ds_read_b64_tr_b16 v[114:115], v7 offset:192
    v_mfma_f32_16x16x32_bf16 v[36:39], v[116:119], v[244:247], v[36:39]
    ds_read_b64_tr_b16 v[116:117], v7 offset:320
    ds_read_b64_tr_b16 v[118:119], v7 offset:448
    v_mfma_f32_16x16x32_bf16 v[40:43], v[120:123], v[224:227], v[40:43]
    buffer_load_dwordx4 v10, s[24:27], s52 offen lds
    v_mfma_f32_16x16x32_bf16 v[40:43], v[124:127], v[240:243], v[40:43]
    s_add_u32 m0, m0, 0x420
    s_add_u32 s52, s52, 0x380
    v_mfma_f32_16x16x32_bf16 v[44:47], v[120:123], v[228:231], v[44:47]
    ds_read_b64_tr_b16 v[120:121], v7 offset:96
    ds_read_b64_tr_b16 v[122:123], v7 offset:224
    v_mfma_f32_16x16x32_bf16 v[44:47], v[124:127], v[244:247], v[44:47]
    s_waitcnt lgkmcnt(12)
    ds_read_b64_tr_b16 v[124:125], v7 offset:352
    ds_read_b64_tr_b16 v[126:127], v7 offset:480
    v_mfma_f32_16x16x32_bf16 v[48:51], v[96:99], v[128:131], 0
    s_waitcnt lgkmcnt(12)
    buffer_load_dwordx4 a[188:191], v14, s[36:39], s62 offen sc1
    v_mfma_f32_16x16x32_bf16 v[48:51], v[100:103], v[144:147], v[48:51]
    v_mfma_f32_16x16x32_bf16 v[52:55], v[96:99], v[132:135], 0
    ds_read_b64_tr_b16 v[96:97], v7 offset:512
    ds_read_b64_tr_b16 v[98:99], v7 offset:640
    v_mfma_f32_16x16x32_bf16 v[52:55], v[100:103], v[148:151], v[52:55]
    s_waitcnt lgkmcnt(12)
    ds_read_b64_tr_b16 v[100:101], v7 offset:768
    ds_read_b64_tr_b16 v[102:103], v7 offset:896
    v_mfma_f32_16x16x32_bf16 v[56:59], v[104:107], v[128:131], 0
    s_waitcnt lgkmcnt(12)
    buffer_load_dwordx4 v10, s[24:27], s52 offen lds
    v_mfma_f32_16x16x32_bf16 v[56:59], v[108:111], v[144:147], v[56:59]
    s_add_u32 m0, m0, 0x420
    s_add_u32 s52, s52, 0x380
    v_cvt_pk_bf16_f32 v80, v16, v17
    v_mfma_f32_16x16x32_bf16 v[60:63], v[104:107], v[132:135], 0
    ds_read_b64_tr_b16 v[104:105], v7 offset:544
    ds_read_b64_tr_b16 v[106:107], v7 offset:672
    v_mfma_f32_16x16x32_bf16 v[60:63], v[108:111], v[148:151], v[60:63]
    s_waitcnt lgkmcnt(12)
    ds_read_b64_tr_b16 v[108:109], v7 offset:800
    ds_read_b64_tr_b16 v[110:111], v7 offset:928
    v_mfma_f32_16x16x32_bf16 v[64:67], v[112:115], v[128:131], 0
    s_waitcnt lgkmcnt(12)
    v_cvt_pk_bf16_f32 v81, v18, v19
    v_cvt_pk_bf16_f32 v82, v24, v25
    v_mfma_f32_16x16x32_bf16 v[64:67], v[116:119], v[144:147], v[64:67]
    v_cvt_pk_bf16_f32 v83, v26, v27
    v_cvt_pk_bf16_f32 v84, v32, v33
    v_mfma_f32_16x16x32_bf16 v[68:71], v[112:115], v[132:135], 0
    s_add_u32 s61, s62, 0x1c000
    ds_read_b64_tr_b16 v[112:113], v7 offset:576
    ds_read_b64_tr_b16 v[114:115], v7 offset:704
    v_mfma_f32_16x16x32_bf16 v[68:71], v[116:119], v[148:151], v[68:71]
    s_waitcnt lgkmcnt(12)
    ds_read_b64_tr_b16 v[116:117], v7 offset:832
    ds_read_b64_tr_b16 v[118:119], v7 offset:960
    v_mfma_f32_16x16x32_bf16 v[72:75], v[120:123], v[128:131], 0
    s_waitcnt lgkmcnt(12)
    buffer_load_dwordx4 v10, s[24:27], s52 offen lds
    v_mfma_f32_16x16x32_bf16 v[72:75], v[124:127], v[144:147], v[72:75]
    s_add_u32 m0, m0, 0x420
    s_add_u32 s52, s52, 0x380
    v_cvt_pk_bf16_f32 v85, v34, v35
    v_mfma_f32_16x16x32_bf16 v[76:79], v[120:123], v[132:135], 0
    ds_read_b64_tr_b16 v[120:121], v7 offset:608
    ds_read_b64_tr_b16 v[122:123], v7 offset:736
    v_mfma_f32_16x16x32_bf16 v[76:79], v[124:127], v[148:151], v[76:79]
    s_waitcnt lgkmcnt(12)
    v_cvt_pk_bf16_f32 v86, v40, v41
    v_cvt_pk_bf16_f32 v87, v42, v43
    v_mfma_f32_16x16x32_bf16 v[48:51], v[96:99], v[160:163], v[48:51]
    s_waitcnt lgkmcnt(10)
    buffer_load_dwordx4 a[200:203], v12, s[36:39], s61 offen sc1
    v_cvt_pk_bf16_f32 v88, v20, v21
    v_cvt_pk_bf16_f32 v89, v22, v23
    v_cvt_pk_bf16_f32 v90, v28, v29
    v_cvt_pk_bf16_f32 v91, v30, v31
    v_cvt_pk_bf16_f32 v92, v36, v37
    v_cvt_pk_bf16_f32 v93, v38, v39
    v_cvt_pk_bf16_f32 v94, v44, v45
    v_cvt_pk_bf16_f32 v95, v46, v47
    v_mfma_f32_16x16x32_bf16 v[48:51], v[100:103], v[176:179], v[48:51]
    s_add_u32 s57, s55, 0
    ds_read_b64_tr_b16 v[124:125], v7 offset:864
    ds_read_b64_tr_b16 v[126:127], v7 offset:992
    v_mfma_f32_16x16x32_bf16 v[52:55], v[96:99], v[164:167], v[52:55]
    buffer_store_dwordx4 v[80:83], v11, s[36:39], s57 offen sc1
    v_mfma_f32_16x16x32_bf16 v[52:55], v[100:103], v[180:183], v[52:55]
    s_waitcnt lgkmcnt(10)
    ds_read_b64_tr_b16 v[96:97], v7 offset:16896
    ds_read_b64_tr_b16 v[98:99], v7 offset:17024
    v_mfma_f32_16x16x32_bf16 v[56:59], v[104:107], v[160:163], v[56:59]
    s_waitcnt lgkmcnt(10)
    ds_read_b64_tr_b16 v[100:101], v7 offset:17152
    ds_read_b64_tr_b16 v[102:103], v7 offset:17280
    v_mfma_f32_16x16x32_bf16 v[56:59], v[108:111], v[176:179], v[56:59]
    buffer_load_dwordx4 v10, s[24:27], s52 offen lds
    v_mfma_f32_16x16x32_bf16 v[60:63], v[104:107], v[164:167], v[60:63]
    s_add_u32 m0, m0, 0x420
    ds_read_b64_tr_b16 v[104:105], v7 offset:16928
    ds_read_b64_tr_b16 v[106:107], v7 offset:17056
    v_mfma_f32_16x16x32_bf16 v[60:63], v[108:111], v[180:183], v[60:63]
    s_waitcnt lgkmcnt(12)
    s_add_u32 s52, s52, 0x380
    ds_read_b64_tr_b16 v[108:109], v7 offset:17184
    v_mfma_f32_16x16x32_bf16 v[64:67], v[112:115], v[160:163], v[64:67]
    s_waitcnt lgkmcnt(11)
    ds_read_b64_tr_b16 v[110:111], v7 offset:17312
    v_mfma_f32_16x16x32_bf16 v[64:67], v[116:119], v[176:179], v[64:67]
    buffer_load_dwordx4 a[204:207], v14, s[36:39], s61 offen sc1
    v_mfma_f32_16x16x32_bf16 v[68:71], v[112:115], v[164:167], v[68:71]
    ds_read_b64_tr_b16 v[112:113], v7 offset:16960
    ds_read_b64_tr_b16 v[114:115], v7 offset:17088
    v_mfma_f32_16x16x32_bf16 v[68:71], v[116:119], v[180:183], v[68:71]
    s_waitcnt lgkmcnt(12)
    ds_read_b64_tr_b16 v[116:117], v7 offset:17216
    ds_read_b64_tr_b16 v[118:119], v7 offset:17344
    v_mfma_f32_16x16x32_bf16 v[72:75], v[120:123], v[160:163], v[72:75]
    s_waitcnt lgkmcnt(12)
    buffer_load_dwordx4 v10, s[24:27], s52 offen lds
    v_mfma_f32_16x16x32_bf16 v[72:75], v[124:127], v[176:179], v[72:75]
    s_add_u32 m0, m0, 0x420
    s_add_u32 s52, s52, 0x380
    v_mfma_f32_16x16x32_bf16 v[76:79], v[120:123], v[164:167], v[76:79]
    ds_read_b64_tr_b16 v[120:121], v7 offset:16992
    ds_read_b64_tr_b16 v[122:123], v7 offset:17120
    v_mfma_f32_16x16x32_bf16 v[76:79], v[124:127], v[180:183], v[76:79]
    s_waitcnt lgkmcnt(12)
    ds_read_b64_tr_b16 v[124:125], v7 offset:17248
    ds_read_b64_tr_b16 v[126:127], v7 offset:17376
    v_mfma_f32_16x16x32_bf16 v[48:51], v[96:99], v[192:195], v[48:51]
    s_waitcnt lgkmcnt(12)
    s_add_u32 s58, s55, 0x400
    v_mfma_f32_16x16x32_bf16 v[48:51], v[100:103], v[208:211], v[48:51]
    buffer_store_dwordx4 v[84:87], v11, s[36:39], s58 offen sc1
    v_mfma_f32_16x16x32_bf16 v[52:55], v[96:99], v[196:199], v[52:55]
    s_add_u32 s62, s61, 0x1c000
    ds_read_b64_tr_b16 v[96:97], v7 offset:17408
    ds_read_b64_tr_b16 v[98:99], v7 offset:17536
    v_mfma_f32_16x16x32_bf16 v[52:55], v[100:103], v[212:215], v[52:55]
    s_waitcnt lgkmcnt(12)
    ds_read_b64_tr_b16 v[100:101], v7 offset:17664
    ds_read_b64_tr_b16 v[102:103], v7 offset:17792
    v_mfma_f32_16x16x32_bf16 v[56:59], v[104:107], v[192:195], v[56:59]
    s_waitcnt lgkmcnt(12)
    buffer_load_dwordx4 v10, s[24:27], s52 offen lds
    v_mfma_f32_16x16x32_bf16 v[56:59], v[108:111], v[208:211], v[56:59]
    s_add_u32 m0, m0, 0x420
    s_add_u32 s52, s52, 0x380
    v_mfma_f32_16x16x32_bf16 v[60:63], v[104:107], v[196:199], v[60:63]
    ds_read_b64_tr_b16 v[104:105], v7 offset:17440
    ds_read_b64_tr_b16 v[106:107], v7 offset:17568
    v_mfma_f32_16x16x32_bf16 v[60:63], v[108:111], v[212:215], v[60:63]
    s_waitcnt lgkmcnt(12)
    buffer_load_dwordx4 a[216:219], v12, s[36:39], s62 offen sc1
    v_mfma_f32_16x16x32_bf16 v[64:67], v[112:115], v[192:195], v[64:67]
    s_waitcnt lgkmcnt(10)
    ds_read_b64_tr_b16 v[108:109], v7 offset:17696
    ds_read_b64_tr_b16 v[110:111], v7 offset:17824
    v_mfma_f32_16x16x32_bf16 v[64:67], v[116:119], v[208:211], v[64:67]
    v_mfma_f32_16x16x32_bf16 v[68:71], v[112:115], v[196:199], v[68:71]
    ds_read_b64_tr_b16 v[112:113], v7 offset:17472
    ds_read_b64_tr_b16 v[114:115], v7 offset:17600
    v_mfma_f32_16x16x32_bf16 v[68:71], v[116:119], v[212:215], v[68:71]
    s_waitcnt lgkmcnt(12)
    ds_read_b64_tr_b16 v[116:117], v7 offset:17728
    ds_read_b64_tr_b16 v[118:119], v7 offset:17856
    v_mfma_f32_16x16x32_bf16 v[72:75], v[120:123], v[192:195], v[72:75]
    s_waitcnt lgkmcnt(12)
    buffer_load_dwordx4 v10, s[24:27], s52 offen lds
    v_mfma_f32_16x16x32_bf16 v[72:75], v[124:127], v[208:211], v[72:75]
    s_add_u32 m0, s45, 0x10800
    s_add_u32 s52, s52, 0xffffe800
    v_mfma_f32_16x16x32_bf16 v[76:79], v[120:123], v[196:199], v[76:79]
    s_add_u32 s59, s55, 0x2000
    ds_read_b64_tr_b16 v[120:121], v7 offset:17504
    ds_read_b64_tr_b16 v[122:123], v7 offset:17632
    v_mfma_f32_16x16x32_bf16 v[76:79], v[124:127], v[212:215], v[76:79]
    s_waitcnt lgkmcnt(12)
    ds_read_b64_tr_b16 v[124:125], v7 offset:17760
    ds_read_b64_tr_b16 v[126:127], v7 offset:17888
    v_mfma_f32_16x16x32_bf16 v[48:51], v[96:99], v[224:227], v[48:51]
    s_waitcnt lgkmcnt(12)
    buffer_store_dwordx4 v[88:91], v11, s[36:39], s59 offen sc1
    v_mfma_f32_16x16x32_bf16 v[48:51], v[100:103], v[240:243], v[48:51]
    buffer_load_dwordx4 a[220:223], v14, s[36:39], s62 offen sc1
    v_mfma_f32_16x16x32_bf16 v[52:55], v[96:99], v[228:231], v[52:55]
    v_mfma_f32_16x16x32_bf16 v[52:55], v[100:103], v[244:247], v[52:55]
    s_waitcnt lgkmcnt(10)
    s_waitcnt vmcnt(41) lgkmcnt(0)
    s_barrier
    v_mfma_f32_16x16x32_bf16 v[56:59], v[104:107], v[224:227], v[56:59]
    ds_read_b64_tr_b16 v[96:97], v6 offset:33792
    ds_read_b64_tr_b16 v[98:99], v6 offset:33920
    v_mfma_f32_16x16x32_bf16 v[56:59], v[108:111], v[240:243], v[56:59]
    ds_read_b64_tr_b16 v[100:101], v6 offset:34048
    ds_read_b64_tr_b16 v[102:103], v6 offset:34176
    v_mfma_f32_16x16x32_bf16 v[60:63], v[104:107], v[228:231], v[60:63]
    buffer_load_dwordx4 v10, s[24:27], s52 offen lds
    v_mfma_f32_16x16x32_bf16 v[60:63], v[108:111], v[244:247], v[60:63]
    ds_read_b64_tr_b16 v[104:105], v6 offset:33824
    ds_read_b64_tr_b16 v[106:107], v6 offset:33952
    v_mfma_f32_16x16x32_bf16 v[64:67], v[112:115], v[224:227], v[64:67]
    ds_read_b64_tr_b16 v[108:109], v6 offset:34080
    ds_read_b64_tr_b16 v[110:111], v6 offset:34208
    v_mfma_f32_16x16x32_bf16 v[64:67], v[116:119], v[240:243], v[64:67]
    s_add_u32 m0, m0, 0x420
    s_add_u32 s52, s52, 0x380
    v_mfma_f32_16x16x32_bf16 v[68:71], v[112:115], v[228:231], v[68:71]
    s_add_u32 s61, s62, 0x1c000
    ds_read_b64_tr_b16 v[112:113], v6 offset:33856
    ds_read_b64_tr_b16 v[114:115], v6 offset:33984
    v_mfma_f32_16x16x32_bf16 v[68:71], v[116:119], v[244:247], v[68:71]
    ds_read_b64_tr_b16 v[116:117], v6 offset:34112
    ds_read_b64_tr_b16 v[118:119], v6 offset:34240
    v_mfma_f32_16x16x32_bf16 v[72:75], v[120:123], v[224:227], v[72:75]
    buffer_load_dwordx4 v10, s[24:27], s52 offen lds
    v_mfma_f32_16x16x32_bf16 v[72:75], v[124:127], v[240:243], v[72:75]
    s_add_u32 s60, s55, 0x2400
    s_add_u32 m0, m0, 0x420
    s_add_u32 s52, s52, 0x380
    v_mfma_f32_16x16x32_bf16 v[76:79], v[120:123], v[228:231], v[76:79]
    ds_read_b64_tr_b16 v[120:121], v6 offset:33888
    ds_read_b64_tr_b16 v[122:123], v6 offset:34016
    v_mfma_f32_16x16x32_bf16 v[76:79], v[124:127], v[244:247], v[76:79]
    s_waitcnt lgkmcnt(12)
    buffer_store_dwordx4 v[92:95], v11, s[36:39], s60 offen sc1
    v_mfma_f32_16x16x32_bf16 v[16:19], v[96:99], v[128:131], 0
    s_waitcnt lgkmcnt(10)
    buffer_load_dwordx4 a[232:235], v12, s[36:39], s61 offen sc1
    v_mfma_f32_16x16x32_bf16 v[16:19], v[100:103], v[144:147], v[16:19]
    ds_read_b64_tr_b16 v[124:125], v6 offset:34144
    ds_read_b64_tr_b16 v[126:127], v6 offset:34272
    v_mfma_f32_16x16x32_bf16 v[20:23], v[96:99], v[132:135], 0
    ds_read_b64_tr_b16 v[96:97], v6 offset:34304
    ds_read_b64_tr_b16 v[98:99], v6 offset:34432
    v_mfma_f32_16x16x32_bf16 v[20:23], v[100:103], v[148:151], v[20:23]
    s_waitcnt lgkmcnt(12)
    ds_read_b64_tr_b16 v[100:101], v6 offset:34560
    ds_read_b64_tr_b16 v[102:103], v6 offset:34688
    v_mfma_f32_16x16x32_bf16 v[24:27], v[104:107], v[128:131], 0
    s_waitcnt lgkmcnt(12)
    buffer_load_dwordx4 v10, s[24:27], s52 offen lds
    v_mfma_f32_16x16x32_bf16 v[24:27], v[108:111], v[144:147], v[24:27]
    s_add_u32 m0, m0, 0x420
    s_add_u32 s52, s52, 0x380
    v_cvt_pk_bf16_f32 v200, v48, v49
    v_mfma_f32_16x16x32_bf16 v[28:31], v[104:107], v[132:135], 0
    ds_read_b64_tr_b16 v[104:105], v6 offset:34336
    ds_read_b64_tr_b16 v[106:107], v6 offset:34464
    v_mfma_f32_16x16x32_bf16 v[28:31], v[108:111], v[148:151], v[28:31]
    s_waitcnt lgkmcnt(12)
    ds_read_b64_tr_b16 v[108:109], v6 offset:34592
    ds_read_b64_tr_b16 v[110:111], v6 offset:34720
    v_mfma_f32_16x16x32_bf16 v[32:35], v[112:115], v[128:131], 0
    s_waitcnt lgkmcnt(12)
    buffer_load_dwordx4 a[236:239], v14, s[36:39], s61 offen sc1
    v_mfma_f32_16x16x32_bf16 v[32:35], v[116:119], v[144:147], v[32:35]
    v_cvt_pk_bf16_f32 v201, v50, v51
    v_cvt_pk_bf16_f32 v202, v56, v57
    v_mfma_f32_16x16x32_bf16 v[36:39], v[112:115], v[132:135], 0
    ds_read_b64_tr_b16 v[112:113], v6 offset:34368
    ds_read_b64_tr_b16 v[114:115], v6 offset:34496
    v_mfma_f32_16x16x32_bf16 v[36:39], v[116:119], v[148:151], v[36:39]
    s_waitcnt lgkmcnt(12)
    ds_read_b64_tr_b16 v[116:117], v6 offset:34624
    ds_read_b64_tr_b16 v[118:119], v6 offset:34752
    v_mfma_f32_16x16x32_bf16 v[40:43], v[120:123], v[128:131], 0
    s_waitcnt lgkmcnt(12)
    buffer_load_dwordx4 v10, s[24:27], s52 offen lds
    v_mfma_f32_16x16x32_bf16 v[40:43], v[124:127], v[144:147], v[40:43]
    s_add_u32 m0, m0, 0x420
    s_add_u32 s52, s52, 0x380
    v_cvt_pk_bf16_f32 v203, v58, v59
    v_mfma_f32_16x16x32_bf16 v[44:47], v[120:123], v[132:135], 0
    ds_read_b64_tr_b16 v[120:121], v6 offset:34400
    ds_read_b64_tr_b16 v[122:123], v6 offset:34528
    v_mfma_f32_16x16x32_bf16 v[44:47], v[124:127], v[148:151], v[44:47]
    s_waitcnt lgkmcnt(12)
    v_cvt_pk_bf16_f32 v204, v64, v65
    v_cvt_pk_bf16_f32 v205, v66, v67
    v_mfma_f32_16x16x32_bf16 v[16:19], v[96:99], v[160:163], v[16:19]
    s_waitcnt lgkmcnt(10)
    v_cvt_pk_bf16_f32 v206, v72, v73
    v_cvt_pk_bf16_f32 v207, v74, v75
    v_cvt_pk_bf16_f32 v216, v52, v53
    v_cvt_pk_bf16_f32 v217, v54, v55
    v_cvt_pk_bf16_f32 v218, v60, v61
    v_cvt_pk_bf16_f32 v219, v62, v63
    v_cvt_pk_bf16_f32 v220, v68, v69
    v_cvt_pk_bf16_f32 v221, v70, v71
    v_cvt_pk_bf16_f32 v222, v76, v77
    v_cvt_pk_bf16_f32 v223, v78, v79
    v_mfma_f32_16x16x32_bf16 v[16:19], v[100:103], v[176:179], v[16:19]
    s_add_u32 s57, s55, 0x800
    ds_read_b64_tr_b16 v[124:125], v6 offset:34656
    ds_read_b64_tr_b16 v[126:127], v6 offset:34784
    v_mfma_f32_16x16x32_bf16 v[20:23], v[96:99], v[164:167], v[20:23]
    s_add_u32 s62, s61, 0x1c000
    buffer_store_dwordx4 v[200:203], v11, s[36:39], s57 offen sc1
    v_mfma_f32_16x16x32_bf16 v[20:23], v[100:103], v[180:183], v[20:23]
    s_waitcnt lgkmcnt(10)
    ds_read_b64_tr_b16 v[96:97], v6 offset:50688
    ds_read_b64_tr_b16 v[98:99], v6 offset:50816
    v_mfma_f32_16x16x32_bf16 v[24:27], v[104:107], v[160:163], v[24:27]
    s_waitcnt lgkmcnt(10)
    ds_read_b64_tr_b16 v[100:101], v6 offset:50944
    ds_read_b64_tr_b16 v[102:103], v6 offset:51072
    v_mfma_f32_16x16x32_bf16 v[24:27], v[108:111], v[176:179], v[24:27]
    buffer_load_dwordx4 v10, s[24:27], s52 offen lds
    v_mfma_f32_16x16x32_bf16 v[28:31], v[104:107], v[164:167], v[28:31]
    s_add_u32 m0, m0, 0x420
    ds_read_b64_tr_b16 v[104:105], v6 offset:50720
    ds_read_b64_tr_b16 v[106:107], v6 offset:50848
    v_mfma_f32_16x16x32_bf16 v[28:31], v[108:111], v[180:183], v[28:31]
    s_waitcnt lgkmcnt(12)
    s_add_u32 s52, s52, 0x380
    ds_read_b64_tr_b16 v[108:109], v6 offset:50976
    v_mfma_f32_16x16x32_bf16 v[32:35], v[112:115], v[160:163], v[32:35]
    s_waitcnt lgkmcnt(11)
    buffer_load_dwordx4 a[248:251], v12, s[36:39], s62 offen sc1
    v_mfma_f32_16x16x32_bf16 v[32:35], v[116:119], v[176:179], v[32:35]
    ds_read_b64_tr_b16 v[110:111], v6 offset:51104
    v_mfma_f32_16x16x32_bf16 v[36:39], v[112:115], v[164:167], v[36:39]
    ds_read_b64_tr_b16 v[112:113], v6 offset:50752
    ds_read_b64_tr_b16 v[114:115], v6 offset:50880
    v_mfma_f32_16x16x32_bf16 v[36:39], v[116:119], v[180:183], v[36:39]
    s_waitcnt lgkmcnt(12)
    ds_read_b64_tr_b16 v[116:117], v6 offset:51008
    ds_read_b64_tr_b16 v[118:119], v6 offset:51136
    v_mfma_f32_16x16x32_bf16 v[40:43], v[120:123], v[160:163], v[40:43]
    s_waitcnt lgkmcnt(12)
    buffer_load_dwordx4 v10, s[24:27], s52 offen lds
    v_mfma_f32_16x16x32_bf16 v[40:43], v[124:127], v[176:179], v[40:43]
    s_add_u32 m0, m0, 0x420
    s_add_u32 s52, s52, 0x380
    v_mfma_f32_16x16x32_bf16 v[44:47], v[120:123], v[164:167], v[44:47]
    ds_read_b64_tr_b16 v[120:121], v6 offset:50784
    ds_read_b64_tr_b16 v[122:123], v6 offset:50912
    v_mfma_f32_16x16x32_bf16 v[44:47], v[124:127], v[180:183], v[44:47]
    s_waitcnt lgkmcnt(12)
    ds_read_b64_tr_b16 v[124:125], v6 offset:51040
    ds_read_b64_tr_b16 v[126:127], v6 offset:51168
    v_mfma_f32_16x16x32_bf16 v[16:19], v[96:99], v[192:195], v[16:19]
    s_waitcnt lgkmcnt(12)
    s_add_u32 s58, s55, 0xc00
    v_mfma_f32_16x16x32_bf16 v[16:19], v[100:103], v[208:211], v[16:19]
    buffer_store_dwordx4 v[204:207], v11, s[36:39], s58 offen sc1
    v_mfma_f32_16x16x32_bf16 v[20:23], v[96:99], v[196:199], v[20:23]
    ds_read_b64_tr_b16 v[96:97], v6 offset:51200
    ds_read_b64_tr_b16 v[98:99], v6 offset:51328
    v_mfma_f32_16x16x32_bf16 v[20:23], v[100:103], v[212:215], v[20:23]
    s_waitcnt lgkmcnt(12)
    buffer_load_dwordx4 a[252:255], v14, s[36:39], s62 offen sc1
    v_mfma_f32_16x16x32_bf16 v[24:27], v[104:107], v[192:195], v[24:27]
    s_waitcnt lgkmcnt(10)
    ds_read_b64_tr_b16 v[100:101], v6 offset:51456
    ds_read_b64_tr_b16 v[102:103], v6 offset:51584
    v_mfma_f32_16x16x32_bf16 v[24:27], v[108:111], v[208:211], v[24:27]
    buffer_load_dwordx4 v10, s[24:27], s52 offen lds
    v_mfma_f32_16x16x32_bf16 v[28:31], v[104:107], v[196:199], v[28:31]
    s_add_u32 m0, m0, 0x420
    s_add_u32 s52, s52, 0x380
    ds_read_b64_tr_b16 v[104:105], v6 offset:51232
    v_mfma_f32_16x16x32_bf16 v[28:31], v[108:111], v[212:215], v[28:31]
    s_waitcnt lgkmcnt(11)
    ds_read_b64_tr_b16 v[106:107], v6 offset:51360
    ds_read_b64_tr_b16 v[108:109], v6 offset:51488
    v_mfma_f32_16x16x32_bf16 v[32:35], v[112:115], v[192:195], v[32:35]
    s_waitcnt lgkmcnt(11)
    ds_read_b64_tr_b16 v[110:111], v6 offset:51616
    v_mfma_f32_16x16x32_bf16 v[32:35], v[116:119], v[208:211], v[32:35]
    v_mfma_f32_16x16x32_bf16 v[36:39], v[112:115], v[196:199], v[36:39]
    ds_read_b64_tr_b16 v[112:113], v6 offset:51264
    ds_read_b64_tr_b16 v[114:115], v6 offset:51392
    v_mfma_f32_16x16x32_bf16 v[36:39], v[116:119], v[212:215], v[36:39]
    s_waitcnt lgkmcnt(12)
    ds_read_b64_tr_b16 v[116:117], v6 offset:51520
    ds_read_b64_tr_b16 v[118:119], v6 offset:51648
    v_mfma_f32_16x16x32_bf16 v[40:43], v[120:123], v[192:195], v[40:43]
    s_waitcnt lgkmcnt(12)
    buffer_load_dwordx4 v10, s[24:27], s52 offen lds
    v_mfma_f32_16x16x32_bf16 v[40:43], v[124:127], v[208:211], v[40:43]
    s_add_u32 m0, s45, 0x8400
    s_add_u32 s52, s52, 0xffffe800
    v_mfma_f32_16x16x32_bf16 v[44:47], v[120:123], v[196:199], v[44:47]
    s_add_u32 s59, s55, 0x2800
    ds_read_b64_tr_b16 v[120:121], v6 offset:51296
    ds_read_b64_tr_b16 v[122:123], v6 offset:51424
    v_mfma_f32_16x16x32_bf16 v[44:47], v[124:127], v[212:215], v[44:47]
    s_waitcnt lgkmcnt(12)
    ds_read_b64_tr_b16 v[124:125], v6 offset:51552
    ds_read_b64_tr_b16 v[126:127], v6 offset:51680
    v_mfma_f32_16x16x32_bf16 v[16:19], v[96:99], v[224:227], v[16:19]
    s_waitcnt lgkmcnt(12)
    buffer_store_dwordx4 v[216:219], v11, s[36:39], s59 offen sc1
    v_mfma_f32_16x16x32_bf16 v[16:19], v[100:103], v[240:243], v[16:19]
    v_mfma_f32_16x16x32_bf16 v[20:23], v[96:99], v[228:231], v[20:23]
    v_mfma_f32_16x16x32_bf16 v[20:23], v[100:103], v[244:247], v[20:23]
    s_waitcnt lgkmcnt(10)
    s_waitcnt vmcnt(33) lgkmcnt(0)
    s_barrier
    v_mfma_f32_16x16x32_bf16 v[24:27], v[104:107], v[224:227], v[24:27]
    ds_read_b64_tr_b16 v[96:97], v7 offset:33792
    ds_read_b64_tr_b16 v[98:99], v7 offset:33920
    v_mfma_f32_16x16x32_bf16 v[24:27], v[108:111], v[240:243], v[24:27]
    ds_read_b64_tr_b16 v[100:101], v7 offset:34048
    ds_read_b64_tr_b16 v[102:103], v7 offset:34176
    v_mfma_f32_16x16x32_bf16 v[28:31], v[104:107], v[228:231], v[28:31]
    buffer_load_dwordx4 v10, s[24:27], s52 offen lds
    v_mfma_f32_16x16x32_bf16 v[28:31], v[108:111], v[244:247], v[28:31]
    ds_read_b64_tr_b16 v[104:105], v7 offset:33824
    ds_read_b64_tr_b16 v[106:107], v7 offset:33952
    v_mfma_f32_16x16x32_bf16 v[32:35], v[112:115], v[224:227], v[32:35]
    ds_read_b64_tr_b16 v[108:109], v7 offset:34080
    ds_read_b64_tr_b16 v[110:111], v7 offset:34208
    v_mfma_f32_16x16x32_bf16 v[32:35], v[116:119], v[240:243], v[32:35]
    s_add_u32 m0, m0, 0x420
    s_add_u32 s52, s52, 0x380
    v_mfma_f32_16x16x32_bf16 v[36:39], v[112:115], v[228:231], v[36:39]
    ds_read_b64_tr_b16 v[112:113], v7 offset:33856
    ds_read_b64_tr_b16 v[114:115], v7 offset:33984
    v_mfma_f32_16x16x32_bf16 v[36:39], v[116:119], v[244:247], v[36:39]
    ds_read_b64_tr_b16 v[116:117], v7 offset:34112
    ds_read_b64_tr_b16 v[118:119], v7 offset:34240
    v_mfma_f32_16x16x32_bf16 v[40:43], v[120:123], v[224:227], v[40:43]
    buffer_load_dwordx4 v10, s[24:27], s52 offen lds
    v_mfma_f32_16x16x32_bf16 v[40:43], v[124:127], v[240:243], v[40:43]
    s_add_u32 s60, s55, 0x2c00
    s_add_u32 m0, m0, 0x420
    s_add_u32 s52, s52, 0x380
    v_mfma_f32_16x16x32_bf16 v[44:47], v[120:123], v[228:231], v[44:47]
    ds_read_b64_tr_b16 v[120:121], v7 offset:33888
    ds_read_b64_tr_b16 v[122:123], v7 offset:34016
    v_mfma_f32_16x16x32_bf16 v[44:47], v[124:127], v[244:247], v[44:47]
    s_waitcnt lgkmcnt(12)
    buffer_store_dwordx4 v[220:223], v11, s[36:39], s60 offen sc1
    v_mfma_f32_16x16x32_bf16 v[48:51], v[96:99], v[128:131], 0
    s_waitcnt lgkmcnt(10)
    ds_read_b64_tr_b16 v[124:125], v7 offset:34144
    ds_read_b64_tr_b16 v[126:127], v7 offset:34272
    v_mfma_f32_16x16x32_bf16 v[48:51], v[100:103], v[144:147], v[48:51]
    v_mfma_f32_16x16x32_bf16 v[52:55], v[96:99], v[132:135], 0
    ds_read_b64_tr_b16 v[96:97], v7 offset:34304
    ds_read_b64_tr_b16 v[98:99], v7 offset:34432
    v_mfma_f32_16x16x32_bf16 v[52:55], v[100:103], v[148:151], v[52:55]
    s_waitcnt lgkmcnt(12)
    ds_read_b64_tr_b16 v[100:101], v7 offset:34560
    ds_read_b64_tr_b16 v[102:103], v7 offset:34688
    v_mfma_f32_16x16x32_bf16 v[56:59], v[104:107], v[128:131], 0
    s_waitcnt lgkmcnt(12)
    buffer_load_dwordx4 v10, s[24:27], s52 offen lds
    v_mfma_f32_16x16x32_bf16 v[56:59], v[108:111], v[144:147], v[56:59]
    s_add_u32 m0, m0, 0x420
    s_add_u32 s52, s52, 0x380
    v_cvt_pk_bf16_f32 v232, v16, v17
    v_mfma_f32_16x16x32_bf16 v[60:63], v[104:107], v[132:135], 0
    ds_read_b64_tr_b16 v[104:105], v7 offset:34336
    ds_read_b64_tr_b16 v[106:107], v7 offset:34464
    v_mfma_f32_16x16x32_bf16 v[60:63], v[108:111], v[148:151], v[60:63]
    s_waitcnt lgkmcnt(12)
    ds_read_b64_tr_b16 v[108:109], v7 offset:34592
    ds_read_b64_tr_b16 v[110:111], v7 offset:34720
    v_mfma_f32_16x16x32_bf16 v[64:67], v[112:115], v[128:131], 0
    s_waitcnt lgkmcnt(12)
    v_cvt_pk_bf16_f32 v233, v18, v19
    v_cvt_pk_bf16_f32 v234, v24, v25
    v_mfma_f32_16x16x32_bf16 v[64:67], v[116:119], v[144:147], v[64:67]
    v_cvt_pk_bf16_f32 v235, v26, v27
    v_cvt_pk_bf16_f32 v236, v32, v33
    v_mfma_f32_16x16x32_bf16 v[68:71], v[112:115], v[132:135], 0
    ds_read_b64_tr_b16 v[112:113], v7 offset:34368
    ds_read_b64_tr_b16 v[114:115], v7 offset:34496
    v_mfma_f32_16x16x32_bf16 v[68:71], v[116:119], v[148:151], v[68:71]
    s_waitcnt lgkmcnt(12)
    ds_read_b64_tr_b16 v[116:117], v7 offset:34624
    ds_read_b64_tr_b16 v[118:119], v7 offset:34752
    v_mfma_f32_16x16x32_bf16 v[72:75], v[120:123], v[128:131], 0
    s_waitcnt lgkmcnt(12)
    buffer_load_dwordx4 v10, s[24:27], s52 offen lds
    v_mfma_f32_16x16x32_bf16 v[72:75], v[124:127], v[144:147], v[72:75]
    s_add_u32 m0, m0, 0x420
    s_add_u32 s52, s52, 0x380
    v_cvt_pk_bf16_f32 v237, v34, v35
    v_mfma_f32_16x16x32_bf16 v[76:79], v[120:123], v[132:135], 0
    ds_read_b64_tr_b16 v[120:121], v7 offset:34400
    ds_read_b64_tr_b16 v[122:123], v7 offset:34528
    v_mfma_f32_16x16x32_bf16 v[76:79], v[124:127], v[148:151], v[76:79]
    s_waitcnt lgkmcnt(12)
    v_cvt_pk_bf16_f32 v238, v40, v41
    v_cvt_pk_bf16_f32 v239, v42, v43
    v_mfma_f32_16x16x32_bf16 v[48:51], v[96:99], v[160:163], v[48:51]
    s_waitcnt lgkmcnt(10)
    v_cvt_pk_bf16_f32 v80, v20, v21
    v_cvt_pk_bf16_f32 v81, v22, v23
    v_cvt_pk_bf16_f32 v82, v28, v29
    v_cvt_pk_bf16_f32 v83, v30, v31
    v_cvt_pk_bf16_f32 v84, v36, v37
    v_cvt_pk_bf16_f32 v85, v38, v39
    v_cvt_pk_bf16_f32 v86, v44, v45
    v_cvt_pk_bf16_f32 v87, v46, v47
    v_mfma_f32_16x16x32_bf16 v[48:51], v[100:103], v[176:179], v[48:51]
    s_add_u32 s57, s55, 0x1000
    ds_read_b64_tr_b16 v[124:125], v7 offset:34656
    ds_read_b64_tr_b16 v[126:127], v7 offset:34784
    v_mfma_f32_16x16x32_bf16 v[52:55], v[96:99], v[164:167], v[52:55]
    buffer_store_dwordx4 v[232:235], v11, s[36:39], s57 offen sc1
    v_mfma_f32_16x16x32_bf16 v[52:55], v[100:103], v[180:183], v[52:55]
    s_waitcnt lgkmcnt(10)
    ds_read_b64_tr_b16 v[96:97], v7 offset:50688
    ds_read_b64_tr_b16 v[98:99], v7 offset:50816
    v_mfma_f32_16x16x32_bf16 v[56:59], v[104:107], v[160:163], v[56:59]
    s_waitcnt lgkmcnt(10)
    ds_read_b64_tr_b16 v[100:101], v7 offset:50944
    ds_read_b64_tr_b16 v[102:103], v7 offset:51072
    v_mfma_f32_16x16x32_bf16 v[56:59], v[108:111], v[176:179], v[56:59]
    buffer_load_dwordx4 v10, s[24:27], s52 offen lds
    v_mfma_f32_16x16x32_bf16 v[60:63], v[104:107], v[164:167], v[60:63]
    s_add_u32 m0, m0, 0x420
    ds_read_b64_tr_b16 v[104:105], v7 offset:50720
    ds_read_b64_tr_b16 v[106:107], v7 offset:50848
    v_mfma_f32_16x16x32_bf16 v[60:63], v[108:111], v[180:183], v[60:63]
    s_waitcnt lgkmcnt(12)
    s_add_u32 s52, s52, 0x380
    ds_read_b64_tr_b16 v[108:109], v7 offset:50976
    v_mfma_f32_16x16x32_bf16 v[64:67], v[112:115], v[160:163], v[64:67]
    s_waitcnt lgkmcnt(11)
    ds_read_b64_tr_b16 v[110:111], v7 offset:51104
    v_mfma_f32_16x16x32_bf16 v[64:67], v[116:119], v[176:179], v[64:67]
    v_mfma_f32_16x16x32_bf16 v[68:71], v[112:115], v[164:167], v[68:71]
    ds_read_b64_tr_b16 v[112:113], v7 offset:50752
    ds_read_b64_tr_b16 v[114:115], v7 offset:50880
    v_mfma_f32_16x16x32_bf16 v[68:71], v[116:119], v[180:183], v[68:71]
    s_waitcnt lgkmcnt(12)
    ds_read_b64_tr_b16 v[116:117], v7 offset:51008
    ds_read_b64_tr_b16 v[118:119], v7 offset:51136
    v_mfma_f32_16x16x32_bf16 v[72:75], v[120:123], v[160:163], v[72:75]
    s_waitcnt lgkmcnt(12)
    buffer_load_dwordx4 v10, s[24:27], s52 offen lds
    v_mfma_f32_16x16x32_bf16 v[72:75], v[124:127], v[176:179], v[72:75]
    s_add_u32 m0, m0, 0x420
    s_add_u32 s52, s52, 0x380
    v_mfma_f32_16x16x32_bf16 v[76:79], v[120:123], v[164:167], v[76:79]
    ds_read_b64_tr_b16 v[120:121], v7 offset:50784
    ds_read_b64_tr_b16 v[122:123], v7 offset:50912
    v_mfma_f32_16x16x32_bf16 v[76:79], v[124:127], v[180:183], v[76:79]
    s_waitcnt lgkmcnt(12)
    ds_read_b64_tr_b16 v[124:125], v7 offset:51040
    ds_read_b64_tr_b16 v[126:127], v7 offset:51168
    v_mfma_f32_16x16x32_bf16 v[48:51], v[96:99], v[192:195], v[48:51]
    s_waitcnt lgkmcnt(12)
    s_add_u32 s58, s55, 0x1400
    v_mfma_f32_16x16x32_bf16 v[48:51], v[100:103], v[208:211], v[48:51]
    buffer_store_dwordx4 v[236:239], v11, s[36:39], s58 offen sc1
    v_mfma_f32_16x16x32_bf16 v[52:55], v[96:99], v[196:199], v[52:55]
    ds_read_b64_tr_b16 v[96:97], v7 offset:51200
    ds_read_b64_tr_b16 v[98:99], v7 offset:51328
    v_mfma_f32_16x16x32_bf16 v[52:55], v[100:103], v[212:215], v[52:55]
    s_waitcnt lgkmcnt(12)
    ds_read_b64_tr_b16 v[100:101], v7 offset:51456
    ds_read_b64_tr_b16 v[102:103], v7 offset:51584
    v_mfma_f32_16x16x32_bf16 v[56:59], v[104:107], v[192:195], v[56:59]
    s_waitcnt lgkmcnt(12)
    buffer_load_dwordx4 v10, s[24:27], s52 offen lds
    v_mfma_f32_16x16x32_bf16 v[56:59], v[108:111], v[208:211], v[56:59]
    s_add_u32 m0, m0, 0x420
    s_add_u32 s52, s52, 0x380
    v_mfma_f32_16x16x32_bf16 v[60:63], v[104:107], v[196:199], v[60:63]
    ds_read_b64_tr_b16 v[104:105], v7 offset:51232
    ds_read_b64_tr_b16 v[106:107], v7 offset:51360
    v_mfma_f32_16x16x32_bf16 v[60:63], v[108:111], v[212:215], v[60:63]
    s_waitcnt lgkmcnt(12)
    ds_read_b64_tr_b16 v[108:109], v7 offset:51488
    ds_read_b64_tr_b16 v[110:111], v7 offset:51616
    v_mfma_f32_16x16x32_bf16 v[64:67], v[112:115], v[192:195], v[64:67]
    s_waitcnt lgkmcnt(12)
    v_mfma_f32_16x16x32_bf16 v[64:67], v[116:119], v[208:211], v[64:67]
    v_mfma_f32_16x16x32_bf16 v[68:71], v[112:115], v[196:199], v[68:71]
    ds_read_b64_tr_b16 v[112:113], v7 offset:51264
    ds_read_b64_tr_b16 v[114:115], v7 offset:51392
    v_mfma_f32_16x16x32_bf16 v[68:71], v[116:119], v[212:215], v[68:71]
    s_waitcnt lgkmcnt(12)
    ds_read_b64_tr_b16 v[116:117], v7 offset:51520
    ds_read_b64_tr_b16 v[118:119], v7 offset:51648
    v_mfma_f32_16x16x32_bf16 v[72:75], v[120:123], v[192:195], v[72:75]
    s_waitcnt lgkmcnt(12)
    buffer_load_dwordx4 v10, s[24:27], s52 offen lds
    v_mfma_f32_16x16x32_bf16 v[72:75], v[124:127], v[208:211], v[72:75]
    s_add_u32 s52, s52, 0xffffe800
    v_mfma_f32_16x16x32_bf16 v[76:79], v[120:123], v[196:199], v[76:79]
    s_add_u32 s59, s55, 0x3000
    ds_read_b64_tr_b16 v[120:121], v7 offset:51296
    ds_read_b64_tr_b16 v[122:123], v7 offset:51424
    v_mfma_f32_16x16x32_bf16 v[76:79], v[124:127], v[212:215], v[76:79]
    s_waitcnt lgkmcnt(12)
    ds_read_b64_tr_b16 v[124:125], v7 offset:51552
    ds_read_b64_tr_b16 v[126:127], v7 offset:51680
    v_mfma_f32_16x16x32_bf16 v[48:51], v[96:99], v[224:227], v[48:51]
    s_waitcnt lgkmcnt(12)
    buffer_store_dwordx4 v[80:83], v11, s[36:39], s59 offen sc1
    v_mfma_f32_16x16x32_bf16 v[48:51], v[100:103], v[240:243], v[48:51]
    v_mfma_f32_16x16x32_bf16 v[52:55], v[96:99], v[228:231], v[52:55]
    v_mfma_f32_16x16x32_bf16 v[52:55], v[100:103], v[244:247], v[52:55]
    s_waitcnt lgkmcnt(10)
    s_waitcnt vmcnt(30) lgkmcnt(0)
    s_barrier
    v_mfma_f32_16x16x32_bf16 v[56:59], v[104:107], v[224:227], v[56:59]
    ds_read_b64_tr_b16 v[96:97], v6
    ds_read_b64_tr_b16 v[98:99], v6 offset:128
    v_mfma_f32_16x16x32_bf16 v[56:59], v[108:111], v[240:243], v[56:59]
    ds_read_b64_tr_b16 v[100:101], v6 offset:256
    ds_read_b64_tr_b16 v[102:103], v6 offset:384
    v_mfma_f32_16x16x32_bf16 v[60:63], v[104:107], v[228:231], v[60:63]
    ds_read_b64_tr_b16 v[104:105], v6 offset:32
    ds_read_b64_tr_b16 v[106:107], v6 offset:160
    v_mfma_f32_16x16x32_bf16 v[60:63], v[108:111], v[244:247], v[60:63]
    ds_read_b64_tr_b16 v[108:109], v6 offset:288
    ds_read_b64_tr_b16 v[110:111], v6 offset:416
    v_mfma_f32_16x16x32_bf16 v[64:67], v[112:115], v[224:227], v[64:67]
    v_mfma_f32_16x16x32_bf16 v[64:67], v[116:119], v[240:243], v[64:67]
    v_mfma_f32_16x16x32_bf16 v[68:71], v[112:115], v[228:231], v[68:71]
    ds_read_b64_tr_b16 v[112:113], v6 offset:64
    ds_read_b64_tr_b16 v[114:115], v6 offset:192
    v_mfma_f32_16x16x32_bf16 v[68:71], v[116:119], v[244:247], v[68:71]
    ds_read_b64_tr_b16 v[116:117], v6 offset:320
    ds_read_b64_tr_b16 v[118:119], v6 offset:448
    v_mfma_f32_16x16x32_bf16 v[72:75], v[120:123], v[224:227], v[72:75]
    v_mfma_f32_16x16x32_bf16 v[72:75], v[124:127], v[240:243], v[72:75]
    s_add_u32 s60, s55, 0x3400
    v_mfma_f32_16x16x32_bf16 v[76:79], v[120:123], v[228:231], v[76:79]
    ds_read_b64_tr_b16 v[120:121], v6 offset:96
    ds_read_b64_tr_b16 v[122:123], v6 offset:224
    v_mfma_f32_16x16x32_bf16 v[76:79], v[124:127], v[244:247], v[76:79]
    s_waitcnt lgkmcnt(12)
    buffer_store_dwordx4 v[84:87], v11, s[36:39], s60 offen sc1
    v_mfma_f32_16x16x32_bf16 v[16:19], v[96:99], v[128:131], 0
    s_waitcnt lgkmcnt(10)
    ds_read_b64_tr_b16 v[124:125], v6 offset:352
    ds_read_b64_tr_b16 v[126:127], v6 offset:480
    v_mfma_f32_16x16x32_bf16 v[16:19], v[100:103], v[144:147], v[16:19]
    v_mfma_f32_16x16x32_bf16 v[20:23], v[96:99], v[132:135], 0
    ds_read_b64_tr_b16 v[96:97], v6 offset:512
    ds_read_b64_tr_b16 v[98:99], v6 offset:640
    v_mfma_f32_16x16x32_bf16 v[20:23], v[100:103], v[148:151], v[20:23]
    s_waitcnt lgkmcnt(12)
    ds_read_b64_tr_b16 v[100:101], v6 offset:768
    ds_read_b64_tr_b16 v[102:103], v6 offset:896
    v_mfma_f32_16x16x32_bf16 v[24:27], v[104:107], v[128:131], 0
    s_waitcnt lgkmcnt(12)
    v_cvt_pk_bf16_f32 v88, v48, v49
    v_cvt_pk_bf16_f32 v89, v50, v51
    v_mfma_f32_16x16x32_bf16 v[24:27], v[108:111], v[144:147], v[24:27]
    v_cvt_pk_bf16_f32 v90, v56, v57
    v_cvt_pk_bf16_f32 v91, v58, v59
    v_mfma_f32_16x16x32_bf16 v[28:31], v[104:107], v[132:135], 0
    ds_read_b64_tr_b16 v[104:105], v6 offset:544
    ds_read_b64_tr_b16 v[106:107], v6 offset:672
    v_mfma_f32_16x16x32_bf16 v[28:31], v[108:111], v[148:151], v[28:31]
    s_waitcnt lgkmcnt(12)
    ds_read_b64_tr_b16 v[108:109], v6 offset:800
    ds_read_b64_tr_b16 v[110:111], v6 offset:928
    v_mfma_f32_16x16x32_bf16 v[32:35], v[112:115], v[128:131], 0
    s_waitcnt lgkmcnt(12)
    v_cvt_pk_bf16_f32 v92, v64, v65
    v_cvt_pk_bf16_f32 v93, v66, v67
    v_mfma_f32_16x16x32_bf16 v[32:35], v[116:119], v[144:147], v[32:35]
    v_cvt_pk_bf16_f32 v94, v72, v73
    v_cvt_pk_bf16_f32 v95, v74, v75
    v_mfma_f32_16x16x32_bf16 v[36:39], v[112:115], v[132:135], 0
    ds_read_b64_tr_b16 v[112:113], v6 offset:576
    ds_read_b64_tr_b16 v[114:115], v6 offset:704
    v_mfma_f32_16x16x32_bf16 v[36:39], v[116:119], v[148:151], v[36:39]
    s_waitcnt lgkmcnt(12)
    ds_read_b64_tr_b16 v[116:117], v6 offset:832
    ds_read_b64_tr_b16 v[118:119], v6 offset:960
    v_mfma_f32_16x16x32_bf16 v[40:43], v[120:123], v[128:131], 0
    s_waitcnt lgkmcnt(12)
    v_cvt_pk_bf16_f32 v200, v52, v53
    v_cvt_pk_bf16_f32 v201, v54, v55
    v_mfma_f32_16x16x32_bf16 v[40:43], v[124:127], v[144:147], v[40:43]
    v_cvt_pk_bf16_f32 v202, v60, v61
    v_cvt_pk_bf16_f32 v203, v62, v63
    v_mfma_f32_16x16x32_bf16 v[44:47], v[120:123], v[132:135], 0
    ds_read_b64_tr_b16 v[120:121], v6 offset:608
    ds_read_b64_tr_b16 v[122:123], v6 offset:736
    v_mfma_f32_16x16x32_bf16 v[44:47], v[124:127], v[148:151], v[44:47]
    s_waitcnt lgkmcnt(12)
    v_cvt_pk_bf16_f32 v204, v68, v69
    v_cvt_pk_bf16_f32 v205, v70, v71
    v_mfma_f32_16x16x32_bf16 v[16:19], v[96:99], v[160:163], v[16:19]
    s_waitcnt lgkmcnt(10)
    v_cvt_pk_bf16_f32 v206, v76, v77
    v_cvt_pk_bf16_f32 v207, v78, v79
    v_mfma_f32_16x16x32_bf16 v[16:19], v[100:103], v[176:179], v[16:19]
    s_add_u32 s57, s55, 0x1800
    ds_read_b64_tr_b16 v[124:125], v6 offset:864
    ds_read_b64_tr_b16 v[126:127], v6 offset:992
    v_mfma_f32_16x16x32_bf16 v[20:23], v[96:99], v[164:167], v[20:23]
    buffer_store_dwordx4 v[88:91], v11, s[36:39], s57 offen sc1
    v_mfma_f32_16x16x32_bf16 v[20:23], v[100:103], v[180:183], v[20:23]
    s_waitcnt lgkmcnt(10)
    ds_read_b64_tr_b16 v[96:97], v6 offset:16896
    ds_read_b64_tr_b16 v[98:99], v6 offset:17024
    v_mfma_f32_16x16x32_bf16 v[24:27], v[104:107], v[160:163], v[24:27]
    s_waitcnt lgkmcnt(10)
    ds_read_b64_tr_b16 v[100:101], v6 offset:17152
    ds_read_b64_tr_b16 v[102:103], v6 offset:17280
    v_mfma_f32_16x16x32_bf16 v[24:27], v[108:111], v[176:179], v[24:27]
    v_mfma_f32_16x16x32_bf16 v[28:31], v[104:107], v[164:167], v[28:31]
    ds_read_b64_tr_b16 v[104:105], v6 offset:16928
    ds_read_b64_tr_b16 v[106:107], v6 offset:17056
    v_mfma_f32_16x16x32_bf16 v[28:31], v[108:111], v[180:183], v[28:31]
    s_waitcnt lgkmcnt(12)
    ds_read_b64_tr_b16 v[108:109], v6 offset:17184
    ds_read_b64_tr_b16 v[110:111], v6 offset:17312
    v_mfma_f32_16x16x32_bf16 v[32:35], v[112:115], v[160:163], v[32:35]
    s_waitcnt lgkmcnt(12)
    v_mfma_f32_16x16x32_bf16 v[32:35], v[116:119], v[176:179], v[32:35]
    v_mfma_f32_16x16x32_bf16 v[36:39], v[112:115], v[164:167], v[36:39]
    ds_read_b64_tr_b16 v[112:113], v6 offset:16960
    ds_read_b64_tr_b16 v[114:115], v6 offset:17088
    v_mfma_f32_16x16x32_bf16 v[36:39], v[116:119], v[180:183], v[36:39]
    s_waitcnt lgkmcnt(12)
    ds_read_b64_tr_b16 v[116:117], v6 offset:17216
    ds_read_b64_tr_b16 v[118:119], v6 offset:17344
    v_mfma_f32_16x16x32_bf16 v[40:43], v[120:123], v[160:163], v[40:43]
    s_waitcnt lgkmcnt(12)
    v_mfma_f32_16x16x32_bf16 v[40:43], v[124:127], v[176:179], v[40:43]
    v_mfma_f32_16x16x32_bf16 v[44:47], v[120:123], v[164:167], v[44:47]
    ds_read_b64_tr_b16 v[120:121], v6 offset:16992
    ds_read_b64_tr_b16 v[122:123], v6 offset:17120
    v_mfma_f32_16x16x32_bf16 v[44:47], v[124:127], v[180:183], v[44:47]
    s_waitcnt lgkmcnt(12)
    ds_read_b64_tr_b16 v[124:125], v6 offset:17248
    ds_read_b64_tr_b16 v[126:127], v6 offset:17376
    v_mfma_f32_16x16x32_bf16 v[16:19], v[96:99], v[192:195], v[16:19]
    s_waitcnt lgkmcnt(12)
    s_add_u32 s58, s55, 0x1c00
    v_mfma_f32_16x16x32_bf16 v[16:19], v[100:103], v[208:211], v[16:19]
    buffer_store_dwordx4 v[92:95], v11, s[36:39], s58 offen sc1
    v_mfma_f32_16x16x32_bf16 v[20:23], v[96:99], v[196:199], v[20:23]
    ds_read_b64_tr_b16 v[96:97], v6 offset:17408
    ds_read_b64_tr_b16 v[98:99], v6 offset:17536
    v_mfma_f32_16x16x32_bf16 v[20:23], v[100:103], v[212:215], v[20:23]
    s_waitcnt lgkmcnt(12)
    ds_read_b64_tr_b16 v[100:101], v6 offset:17664
    ds_read_b64_tr_b16 v[102:103], v6 offset:17792
    v_mfma_f32_16x16x32_bf16 v[24:27], v[104:107], v[192:195], v[24:27]
    s_waitcnt lgkmcnt(12)
    v_mfma_f32_16x16x32_bf16 v[24:27], v[108:111], v[208:211], v[24:27]
    v_mfma_f32_16x16x32_bf16 v[28:31], v[104:107], v[196:199], v[28:31]
    ds_read_b64_tr_b16 v[104:105], v6 offset:17440
    ds_read_b64_tr_b16 v[106:107], v6 offset:17568
    v_mfma_f32_16x16x32_bf16 v[28:31], v[108:111], v[212:215], v[28:31]
    s_waitcnt lgkmcnt(12)
    ds_read_b64_tr_b16 v[108:109], v6 offset:17696
    ds_read_b64_tr_b16 v[110:111], v6 offset:17824
    v_mfma_f32_16x16x32_bf16 v[32:35], v[112:115], v[192:195], v[32:35]
    s_waitcnt lgkmcnt(12)
    v_mfma_f32_16x16x32_bf16 v[32:35], v[116:119], v[208:211], v[32:35]
    v_mfma_f32_16x16x32_bf16 v[36:39], v[112:115], v[196:199], v[36:39]
    ds_read_b64_tr_b16 v[112:113], v6 offset:17472
    ds_read_b64_tr_b16 v[114:115], v6 offset:17600
    v_mfma_f32_16x16x32_bf16 v[36:39], v[116:119], v[212:215], v[36:39]
    s_waitcnt lgkmcnt(12)
    ds_read_b64_tr_b16 v[116:117], v6 offset:17728
    ds_read_b64_tr_b16 v[118:119], v6 offset:17856
    v_mfma_f32_16x16x32_bf16 v[40:43], v[120:123], v[192:195], v[40:43]
    s_waitcnt lgkmcnt(12)
    v_mfma_f32_16x16x32_bf16 v[40:43], v[124:127], v[208:211], v[40:43]
    v_mfma_f32_16x16x32_bf16 v[44:47], v[120:123], v[196:199], v[44:47]
    s_add_u32 s59, s55, 0x3800
    ds_read_b64_tr_b16 v[120:121], v6 offset:17504
    ds_read_b64_tr_b16 v[122:123], v6 offset:17632
    v_mfma_f32_16x16x32_bf16 v[44:47], v[124:127], v[212:215], v[44:47]
    s_waitcnt lgkmcnt(12)
    ds_read_b64_tr_b16 v[124:125], v6 offset:17760
    ds_read_b64_tr_b16 v[126:127], v6 offset:17888
    v_mfma_f32_16x16x32_bf16 v[16:19], v[96:99], v[224:227], v[16:19]
    s_waitcnt lgkmcnt(12)
    buffer_store_dwordx4 v[200:203], v11, s[36:39], s59 offen sc1
    v_mfma_f32_16x16x32_bf16 v[16:19], v[100:103], v[240:243], v[16:19]
    v_mfma_f32_16x16x32_bf16 v[20:23], v[96:99], v[228:231], v[20:23]
    v_mfma_f32_16x16x32_bf16 v[20:23], v[100:103], v[244:247], v[20:23]
    s_waitcnt lgkmcnt(10)
    s_waitcnt vmcnt(17) lgkmcnt(0)
    s_barrier
    v_mfma_f32_16x16x32_bf16 v[24:27], v[104:107], v[224:227], v[24:27]
    ds_read_b64_tr_b16 v[96:97], v7
    ds_read_b64_tr_b16 v[98:99], v7 offset:128
    v_mfma_f32_16x16x32_bf16 v[24:27], v[108:111], v[240:243], v[24:27]
    ds_read_b64_tr_b16 v[100:101], v7 offset:256
    ds_read_b64_tr_b16 v[102:103], v7 offset:384
    v_mfma_f32_16x16x32_bf16 v[28:31], v[104:107], v[228:231], v[28:31]
    ds_read_b64_tr_b16 v[104:105], v7 offset:32
    ds_read_b64_tr_b16 v[106:107], v7 offset:160
    v_mfma_f32_16x16x32_bf16 v[28:31], v[108:111], v[244:247], v[28:31]
    ds_read_b64_tr_b16 v[108:109], v7 offset:288
    ds_read_b64_tr_b16 v[110:111], v7 offset:416
    v_mfma_f32_16x16x32_bf16 v[32:35], v[112:115], v[224:227], v[32:35]
    v_mfma_f32_16x16x32_bf16 v[32:35], v[116:119], v[240:243], v[32:35]
    v_mfma_f32_16x16x32_bf16 v[36:39], v[112:115], v[228:231], v[36:39]
    ds_read_b64_tr_b16 v[112:113], v7 offset:64
    ds_read_b64_tr_b16 v[114:115], v7 offset:192
    v_mfma_f32_16x16x32_bf16 v[36:39], v[116:119], v[244:247], v[36:39]
    ds_read_b64_tr_b16 v[116:117], v7 offset:320
    ds_read_b64_tr_b16 v[118:119], v7 offset:448
    v_mfma_f32_16x16x32_bf16 v[40:43], v[120:123], v[224:227], v[40:43]
    v_mfma_f32_16x16x32_bf16 v[40:43], v[124:127], v[240:243], v[40:43]
    s_add_u32 s60, s55, 0x3c00
    v_mfma_f32_16x16x32_bf16 v[44:47], v[120:123], v[228:231], v[44:47]
    ds_read_b64_tr_b16 v[120:121], v7 offset:96
    ds_read_b64_tr_b16 v[122:123], v7 offset:224
    v_mfma_f32_16x16x32_bf16 v[44:47], v[124:127], v[244:247], v[44:47]
    s_waitcnt lgkmcnt(12)
    buffer_store_dwordx4 v[204:207], v11, s[36:39], s60 offen sc1
    v_mfma_f32_16x16x32_bf16 v[48:51], v[96:99], v[128:131], 0
    s_waitcnt lgkmcnt(10)
    ds_read_b64_tr_b16 v[124:125], v7 offset:352
    ds_read_b64_tr_b16 v[126:127], v7 offset:480
    v_mfma_f32_16x16x32_bf16 v[48:51], v[100:103], v[144:147], v[48:51]
    v_mfma_f32_16x16x32_bf16 v[52:55], v[96:99], v[132:135], 0
    ds_read_b64_tr_b16 v[96:97], v7 offset:512
    ds_read_b64_tr_b16 v[98:99], v7 offset:640
    v_mfma_f32_16x16x32_bf16 v[52:55], v[100:103], v[148:151], v[52:55]
    s_waitcnt lgkmcnt(12)
    ds_read_b64_tr_b16 v[100:101], v7 offset:768
    ds_read_b64_tr_b16 v[102:103], v7 offset:896
    v_mfma_f32_16x16x32_bf16 v[56:59], v[104:107], v[128:131], 0
    s_waitcnt lgkmcnt(12)
    v_cvt_pk_bf16_f32 v216, v16, v17
    v_cvt_pk_bf16_f32 v217, v18, v19
    v_mfma_f32_16x16x32_bf16 v[56:59], v[108:111], v[144:147], v[56:59]
    v_cvt_pk_bf16_f32 v218, v24, v25
    v_cvt_pk_bf16_f32 v219, v26, v27
    v_mfma_f32_16x16x32_bf16 v[60:63], v[104:107], v[132:135], 0
    ds_read_b64_tr_b16 v[104:105], v7 offset:544
    ds_read_b64_tr_b16 v[106:107], v7 offset:672
    v_mfma_f32_16x16x32_bf16 v[60:63], v[108:111], v[148:151], v[60:63]
    s_waitcnt lgkmcnt(12)
    ds_read_b64_tr_b16 v[108:109], v7 offset:800
    ds_read_b64_tr_b16 v[110:111], v7 offset:928
    v_mfma_f32_16x16x32_bf16 v[64:67], v[112:115], v[128:131], 0
    s_waitcnt lgkmcnt(12)
    v_cvt_pk_bf16_f32 v220, v32, v33
    v_cvt_pk_bf16_f32 v221, v34, v35
    v_mfma_f32_16x16x32_bf16 v[64:67], v[116:119], v[144:147], v[64:67]
    v_cvt_pk_bf16_f32 v222, v40, v41
    v_cvt_pk_bf16_f32 v223, v42, v43
    v_mfma_f32_16x16x32_bf16 v[68:71], v[112:115], v[132:135], 0
    ds_read_b64_tr_b16 v[112:113], v7 offset:576
    ds_read_b64_tr_b16 v[114:115], v7 offset:704
    v_mfma_f32_16x16x32_bf16 v[68:71], v[116:119], v[148:151], v[68:71]
    s_waitcnt lgkmcnt(12)
    ds_read_b64_tr_b16 v[116:117], v7 offset:832
    ds_read_b64_tr_b16 v[118:119], v7 offset:960
    v_mfma_f32_16x16x32_bf16 v[72:75], v[120:123], v[128:131], 0
    s_waitcnt lgkmcnt(12)
    v_cvt_pk_bf16_f32 v232, v20, v21
    v_cvt_pk_bf16_f32 v233, v22, v23
    v_mfma_f32_16x16x32_bf16 v[72:75], v[124:127], v[144:147], v[72:75]
    v_cvt_pk_bf16_f32 v234, v28, v29
    v_cvt_pk_bf16_f32 v235, v30, v31
    v_mfma_f32_16x16x32_bf16 v[76:79], v[120:123], v[132:135], 0
    ds_read_b64_tr_b16 v[120:121], v7 offset:608
    ds_read_b64_tr_b16 v[122:123], v7 offset:736
    v_mfma_f32_16x16x32_bf16 v[76:79], v[124:127], v[148:151], v[76:79]
    s_waitcnt lgkmcnt(12)
    v_cvt_pk_bf16_f32 v236, v36, v37
    v_cvt_pk_bf16_f32 v237, v38, v39
    v_mfma_f32_16x16x32_bf16 v[48:51], v[96:99], v[160:163], v[48:51]
    s_waitcnt lgkmcnt(10)
    v_cvt_pk_bf16_f32 v238, v44, v45
    v_cvt_pk_bf16_f32 v239, v46, v47
    v_mfma_f32_16x16x32_bf16 v[48:51], v[100:103], v[176:179], v[48:51]
    s_add_u32 s57, s56, 0
    ds_read_b64_tr_b16 v[124:125], v7 offset:864
    ds_read_b64_tr_b16 v[126:127], v7 offset:992
    v_mfma_f32_16x16x32_bf16 v[52:55], v[96:99], v[164:167], v[52:55]
    buffer_store_dwordx4 v[216:219], v11, s[36:39], s57 offen sc1
    v_mfma_f32_16x16x32_bf16 v[52:55], v[100:103], v[180:183], v[52:55]
    s_waitcnt lgkmcnt(10)
    ds_read_b64_tr_b16 v[96:97], v7 offset:16896
    ds_read_b64_tr_b16 v[98:99], v7 offset:17024
    v_mfma_f32_16x16x32_bf16 v[56:59], v[104:107], v[160:163], v[56:59]
    s_waitcnt lgkmcnt(10)
    ds_read_b64_tr_b16 v[100:101], v7 offset:17152
    ds_read_b64_tr_b16 v[102:103], v7 offset:17280
    v_mfma_f32_16x16x32_bf16 v[56:59], v[108:111], v[176:179], v[56:59]
    v_mfma_f32_16x16x32_bf16 v[60:63], v[104:107], v[164:167], v[60:63]
    ds_read_b64_tr_b16 v[104:105], v7 offset:16928
    ds_read_b64_tr_b16 v[106:107], v7 offset:17056
    v_mfma_f32_16x16x32_bf16 v[60:63], v[108:111], v[180:183], v[60:63]
    s_waitcnt lgkmcnt(12)
    ds_read_b64_tr_b16 v[108:109], v7 offset:17184
    ds_read_b64_tr_b16 v[110:111], v7 offset:17312
    v_mfma_f32_16x16x32_bf16 v[64:67], v[112:115], v[160:163], v[64:67]
    s_waitcnt lgkmcnt(12)
    v_mfma_f32_16x16x32_bf16 v[64:67], v[116:119], v[176:179], v[64:67]
    v_mfma_f32_16x16x32_bf16 v[68:71], v[112:115], v[164:167], v[68:71]
    ds_read_b64_tr_b16 v[112:113], v7 offset:16960
    ds_read_b64_tr_b16 v[114:115], v7 offset:17088
    v_mfma_f32_16x16x32_bf16 v[68:71], v[116:119], v[180:183], v[68:71]
    s_waitcnt lgkmcnt(12)
    ds_read_b64_tr_b16 v[116:117], v7 offset:17216
    ds_read_b64_tr_b16 v[118:119], v7 offset:17344
    v_mfma_f32_16x16x32_bf16 v[72:75], v[120:123], v[160:163], v[72:75]
    s_waitcnt lgkmcnt(12)
    v_mfma_f32_16x16x32_bf16 v[72:75], v[124:127], v[176:179], v[72:75]
    v_mfma_f32_16x16x32_bf16 v[76:79], v[120:123], v[164:167], v[76:79]
    ds_read_b64_tr_b16 v[120:121], v7 offset:16992
    ds_read_b64_tr_b16 v[122:123], v7 offset:17120
    v_mfma_f32_16x16x32_bf16 v[76:79], v[124:127], v[180:183], v[76:79]
    s_waitcnt lgkmcnt(12)
    ds_read_b64_tr_b16 v[124:125], v7 offset:17248
    ds_read_b64_tr_b16 v[126:127], v7 offset:17376
    v_mfma_f32_16x16x32_bf16 v[48:51], v[96:99], v[192:195], v[48:51]
    s_waitcnt lgkmcnt(12)
    s_add_u32 s58, s56, 0x400
    v_mfma_f32_16x16x32_bf16 v[48:51], v[100:103], v[208:211], v[48:51]
    buffer_store_dwordx4 v[220:223], v11, s[36:39], s58 offen sc1
    v_mfma_f32_16x16x32_bf16 v[52:55], v[96:99], v[196:199], v[52:55]
    ds_read_b64_tr_b16 v[96:97], v7 offset:17408
    ds_read_b64_tr_b16 v[98:99], v7 offset:17536
    v_mfma_f32_16x16x32_bf16 v[52:55], v[100:103], v[212:215], v[52:55]
    s_waitcnt lgkmcnt(12)
    ds_read_b64_tr_b16 v[100:101], v7 offset:17664
    ds_read_b64_tr_b16 v[102:103], v7 offset:17792
    v_mfma_f32_16x16x32_bf16 v[56:59], v[104:107], v[192:195], v[56:59]
    s_waitcnt lgkmcnt(12)
    v_mfma_f32_16x16x32_bf16 v[56:59], v[108:111], v[208:211], v[56:59]
    v_mfma_f32_16x16x32_bf16 v[60:63], v[104:107], v[196:199], v[60:63]
    ds_read_b64_tr_b16 v[104:105], v7 offset:17440
    ds_read_b64_tr_b16 v[106:107], v7 offset:17568
    v_mfma_f32_16x16x32_bf16 v[60:63], v[108:111], v[212:215], v[60:63]
    s_waitcnt lgkmcnt(12)
    ds_read_b64_tr_b16 v[108:109], v7 offset:17696
    ds_read_b64_tr_b16 v[110:111], v7 offset:17824
    v_mfma_f32_16x16x32_bf16 v[64:67], v[112:115], v[192:195], v[64:67]
    s_waitcnt lgkmcnt(12)
    v_mfma_f32_16x16x32_bf16 v[64:67], v[116:119], v[208:211], v[64:67]
    v_mfma_f32_16x16x32_bf16 v[68:71], v[112:115], v[196:199], v[68:71]
    ds_read_b64_tr_b16 v[112:113], v7 offset:17472
    ds_read_b64_tr_b16 v[114:115], v7 offset:17600
    v_mfma_f32_16x16x32_bf16 v[68:71], v[116:119], v[212:215], v[68:71]
    s_waitcnt lgkmcnt(12)
    ds_read_b64_tr_b16 v[116:117], v7 offset:17728
    ds_read_b64_tr_b16 v[118:119], v7 offset:17856
    v_mfma_f32_16x16x32_bf16 v[72:75], v[120:123], v[192:195], v[72:75]
    s_waitcnt lgkmcnt(12)
    v_mfma_f32_16x16x32_bf16 v[72:75], v[124:127], v[208:211], v[72:75]
    v_mfma_f32_16x16x32_bf16 v[76:79], v[120:123], v[196:199], v[76:79]
    s_add_u32 s59, s56, 0x1800
    ds_read_b64_tr_b16 v[120:121], v7 offset:17504
    ds_read_b64_tr_b16 v[122:123], v7 offset:17632
    v_mfma_f32_16x16x32_bf16 v[76:79], v[124:127], v[212:215], v[76:79]
    s_waitcnt lgkmcnt(12)
    ds_read_b64_tr_b16 v[124:125], v7 offset:17760
    ds_read_b64_tr_b16 v[126:127], v7 offset:17888
    v_mfma_f32_16x16x32_bf16 v[48:51], v[96:99], v[224:227], v[48:51]
    s_waitcnt lgkmcnt(12)
    buffer_store_dwordx4 v[232:235], v11, s[36:39], s59 offen sc1
    v_mfma_f32_16x16x32_bf16 v[48:51], v[100:103], v[240:243], v[48:51]
    v_mfma_f32_16x16x32_bf16 v[52:55], v[96:99], v[228:231], v[52:55]
    v_mfma_f32_16x16x32_bf16 v[52:55], v[100:103], v[244:247], v[52:55]
    s_waitcnt lgkmcnt(10)
    s_waitcnt vmcnt(3) lgkmcnt(0)
    s_barrier
    v_mfma_f32_16x16x32_bf16 v[56:59], v[104:107], v[224:227], v[56:59]
    s_lshl_b32 s63, s44, 12
    s_add_u32 s63, s63, 0x3900000
    s_cmp_eq_u32 s42, 0
    s_cselect_b32 s63, s63, 0x7ff00000
    v_lshlrev_b32 v248, 8, v0
    v_add_u32 v248, s63, v248
    v_mov_b32 v249, 1
    s_lshl_b32 s63, 1, s43
    s_xor_b32 s63, s63, 0xffff
    s_mov_b32 exec_lo, s63
    s_mov_b32 exec_hi, 0
    buffer_atomic_add v249, v248, s[36:39], 0 offen
    s_mov_b64 exec, -1
    v_mfma_f32_16x16x32_bf16 v[56:59], v[108:111], v[240:243], v[56:59]
    ds_read_b64_tr_b16 v[96:97], v6 offset:33792
    ds_read_b64_tr_b16 v[98:99], v6 offset:33920
    ds_read_b64_tr_b16 v[100:101], v6 offset:34048
    ds_read_b64_tr_b16 v[102:103], v6 offset:34176
    v_mfma_f32_16x16x32_bf16 v[60:63], v[104:107], v[228:231], v[60:63]
    ds_read_b64_tr_b16 v[104:105], v6 offset:33824
    ds_read_b64_tr_b16 v[106:107], v6 offset:33952
    v_mfma_f32_16x16x32_bf16 v[60:63], v[108:111], v[244:247], v[60:63]
    ds_read_b64_tr_b16 v[108:109], v6 offset:34080
    ds_read_b64_tr_b16 v[110:111], v6 offset:34208
    v_mfma_f32_16x16x32_bf16 v[64:67], v[112:115], v[224:227], v[64:67]
    v_mfma_f32_16x16x32_bf16 v[64:67], v[116:119], v[240:243], v[64:67]
    v_mfma_f32_16x16x32_bf16 v[68:71], v[112:115], v[228:231], v[68:71]
    ds_read_b64_tr_b16 v[112:113], v6 offset:33856
    ds_read_b64_tr_b16 v[114:115], v6 offset:33984
    v_mfma_f32_16x16x32_bf16 v[68:71], v[116:119], v[244:247], v[68:71]
    ds_read_b64_tr_b16 v[116:117], v6 offset:34112
    ds_read_b64_tr_b16 v[118:119], v6 offset:34240
    v_mfma_f32_16x16x32_bf16 v[72:75], v[120:123], v[224:227], v[72:75]
    v_mfma_f32_16x16x32_bf16 v[72:75], v[124:127], v[240:243], v[72:75]
    s_add_u32 s60, s56, 0x1c00
    v_mfma_f32_16x16x32_bf16 v[76:79], v[120:123], v[228:231], v[76:79]
    ds_read_b64_tr_b16 v[120:121], v6 offset:33888
    ds_read_b64_tr_b16 v[122:123], v6 offset:34016
    v_mfma_f32_16x16x32_bf16 v[76:79], v[124:127], v[244:247], v[76:79]
    s_waitcnt lgkmcnt(12)
    buffer_store_dwordx4 v[236:239], v11, s[36:39], s60 offen sc1
    v_mfma_f32_16x16x32_bf16 v[16:19], v[96:99], v[128:131], 0
    s_waitcnt lgkmcnt(10)
    ds_read_b64_tr_b16 v[124:125], v6 offset:34144
    ds_read_b64_tr_b16 v[126:127], v6 offset:34272
    v_mfma_f32_16x16x32_bf16 v[16:19], v[100:103], v[144:147], v[16:19]
    v_mfma_f32_16x16x32_bf16 v[20:23], v[96:99], v[132:135], 0
    ds_read_b64_tr_b16 v[96:97], v6 offset:34304
    ds_read_b64_tr_b16 v[98:99], v6 offset:34432
    v_mfma_f32_16x16x32_bf16 v[20:23], v[100:103], v[148:151], v[20:23]
    s_waitcnt lgkmcnt(12)
    ds_read_b64_tr_b16 v[100:101], v6 offset:34560
    ds_read_b64_tr_b16 v[102:103], v6 offset:34688
    v_mfma_f32_16x16x32_bf16 v[24:27], v[104:107], v[128:131], 0
    s_waitcnt lgkmcnt(12)
    v_cvt_pk_bf16_f32 v80, v48, v49
    v_cvt_pk_bf16_f32 v81, v50, v51
    v_mfma_f32_16x16x32_bf16 v[24:27], v[108:111], v[144:147], v[24:27]
    v_cvt_pk_bf16_f32 v82, v56, v57
    v_cvt_pk_bf16_f32 v83, v58, v59
    v_mfma_f32_16x16x32_bf16 v[28:31], v[104:107], v[132:135], 0
    ds_read_b64_tr_b16 v[104:105], v6 offset:34336
    ds_read_b64_tr_b16 v[106:107], v6 offset:34464
    v_mfma_f32_16x16x32_bf16 v[28:31], v[108:111], v[148:151], v[28:31]
    s_waitcnt lgkmcnt(12)
    ds_read_b64_tr_b16 v[108:109], v6 offset:34592
    ds_read_b64_tr_b16 v[110:111], v6 offset:34720
    v_mfma_f32_16x16x32_bf16 v[32:35], v[112:115], v[128:131], 0
    s_waitcnt lgkmcnt(12)
    v_cvt_pk_bf16_f32 v84, v64, v65
    v_cvt_pk_bf16_f32 v85, v66, v67
    v_mfma_f32_16x16x32_bf16 v[32:35], v[116:119], v[144:147], v[32:35]
    v_cvt_pk_bf16_f32 v86, v72, v73
    v_cvt_pk_bf16_f32 v87, v74, v75
    v_mfma_f32_16x16x32_bf16 v[36:39], v[112:115], v[132:135], 0
    ds_read_b64_tr_b16 v[112:113], v6 offset:34368
    ds_read_b64_tr_b16 v[114:115], v6 offset:34496
    v_mfma_f32_16x16x32_bf16 v[36:39], v[116:119], v[148:151], v[36:39]
    s_waitcnt lgkmcnt(12)
    ds_read_b64_tr_b16 v[116:117], v6 offset:34624
    ds_read_b64_tr_b16 v[118:119], v6 offset:34752
    v_mfma_f32_16x16x32_bf16 v[40:43], v[120:123], v[128:131], 0
    s_waitcnt lgkmcnt(12)
    v_cvt_pk_bf16_f32 v88, v52, v53
    v_cvt_pk_bf16_f32 v89, v54, v55
    v_mfma_f32_16x16x32_bf16 v[40:43], v[124:127], v[144:147], v[40:43]
    v_cvt_pk_bf16_f32 v90, v60, v61
    v_cvt_pk_bf16_f32 v91, v62, v63
    v_mfma_f32_16x16x32_bf16 v[44:47], v[120:123], v[132:135], 0
    ds_read_b64_tr_b16 v[120:121], v6 offset:34400
    ds_read_b64_tr_b16 v[122:123], v6 offset:34528
    v_mfma_f32_16x16x32_bf16 v[44:47], v[124:127], v[148:151], v[44:47]
    s_waitcnt lgkmcnt(12)
    v_cvt_pk_bf16_f32 v92, v68, v69
    v_cvt_pk_bf16_f32 v93, v70, v71
    v_mfma_f32_16x16x32_bf16 v[16:19], v[96:99], v[160:163], v[16:19]
    s_waitcnt lgkmcnt(10)
    v_cvt_pk_bf16_f32 v94, v76, v77
    v_cvt_pk_bf16_f32 v95, v78, v79
    v_mfma_f32_16x16x32_bf16 v[16:19], v[100:103], v[176:179], v[16:19]
    s_add_u32 s57, s56, 0x800
    ds_read_b64_tr_b16 v[124:125], v6 offset:34656
    ds_read_b64_tr_b16 v[126:127], v6 offset:34784
    v_mfma_f32_16x16x32_bf16 v[20:23], v[96:99], v[164:167], v[20:23]
    buffer_store_dwordx4 v[80:83], v11, s[36:39], s57 offen sc1
    v_mfma_f32_16x16x32_bf16 v[20:23], v[100:103], v[180:183], v[20:23]
    s_waitcnt lgkmcnt(10)
    ds_read_b64_tr_b16 v[96:97], v6 offset:50688
    ds_read_b64_tr_b16 v[98:99], v6 offset:50816
    v_mfma_f32_16x16x32_bf16 v[24:27], v[104:107], v[160:163], v[24:27]
    s_waitcnt lgkmcnt(10)
    ds_read_b64_tr_b16 v[100:101], v6 offset:50944
    ds_read_b64_tr_b16 v[102:103], v6 offset:51072
    v_mfma_f32_16x16x32_bf16 v[24:27], v[108:111], v[176:179], v[24:27]
    v_mfma_f32_16x16x32_bf16 v[28:31], v[104:107], v[164:167], v[28:31]
    ds_read_b64_tr_b16 v[104:105], v6 offset:50720
    ds_read_b64_tr_b16 v[106:107], v6 offset:50848
    v_mfma_f32_16x16x32_bf16 v[28:31], v[108:111], v[180:183], v[28:31]
    s_waitcnt lgkmcnt(12)
    ds_read_b64_tr_b16 v[108:109], v6 offset:50976
    ds_read_b64_tr_b16 v[110:111], v6 offset:51104
    v_mfma_f32_16x16x32_bf16 v[32:35], v[112:115], v[160:163], v[32:35]
    s_waitcnt lgkmcnt(12)
    v_mov_b32 v250, 0
    v_mfma_f32_16x16x32_bf16 v[32:35], v[116:119], v[176:179], v[32:35]
    v_mfma_f32_16x16x32_bf16 v[36:39], v[112:115], v[164:167], v[36:39]
    ds_read_b64_tr_b16 v[112:113], v6 offset:50752
    ds_read_b64_tr_b16 v[114:115], v6 offset:50880
    v_mfma_f32_16x16x32_bf16 v[36:39], v[116:119], v[180:183], v[36:39]
    s_waitcnt lgkmcnt(12)
    ds_read_b64_tr_b16 v[116:117], v6 offset:51008
    ds_read_b64_tr_b16 v[118:119], v6 offset:51136
    v_mfma_f32_16x16x32_bf16 v[40:43], v[120:123], v[160:163], v[40:43]
    s_waitcnt lgkmcnt(12)
    v_mfma_f32_16x16x32_bf16 v[40:43], v[124:127], v[176:179], v[40:43]
    v_mfma_f32_16x16x32_bf16 v[44:47], v[120:123], v[164:167], v[44:47]
    ds_read_b64_tr_b16 v[120:121], v6 offset:50784
    ds_read_b64_tr_b16 v[122:123], v6 offset:50912
    v_mfma_f32_16x16x32_bf16 v[44:47], v[124:127], v[180:183], v[44:47]
    s_waitcnt lgkmcnt(12)
    ds_read_b64_tr_b16 v[124:125], v6 offset:51040
    ds_read_b64_tr_b16 v[126:127], v6 offset:51168
    v_mfma_f32_16x16x32_bf16 v[16:19], v[96:99], v[192:195], v[16:19]
    s_waitcnt lgkmcnt(12)
    s_add_u32 s58, s56, 0xc00
    v_mfma_f32_16x16x32_bf16 v[16:19], v[100:103], v[208:211], v[16:19]
    buffer_store_dwordx4 v[84:87], v11, s[36:39], s58 offen sc1
    v_mfma_f32_16x16x32_bf16 v[20:23], v[96:99], v[196:199], v[20:23]
    buffer_load_dwordx2 v[252:253], v250, s[36:39], s97 offen sc1
    v_mfma_f32_16x16x32_bf16 v[20:23], v[100:103], v[212:215], v[20:23]
    s_waitcnt lgkmcnt(10)
    ds_read_b64_tr_b16 v[96:97], v6 offset:51200
    ds_read_b64_tr_b16 v[98:99], v6 offset:51328
    v_mfma_f32_16x16x32_bf16 v[24:27], v[104:107], v[192:195], v[24:27]
    s_waitcnt lgkmcnt(10)
    ds_read_b64_tr_b16 v[100:101], v6 offset:51456
    ds_read_b64_tr_b16 v[102:103], v6 offset:51584
    v_mfma_f32_16x16x32_bf16 v[24:27], v[108:111], v[208:211], v[24:27]
    v_mfma_f32_16x16x32_bf16 v[28:31], v[104:107], v[196:199], v[28:31]
    ds_read_b64_tr_b16 v[104:105], v6 offset:51232
    ds_read_b64_tr_b16 v[106:107], v6 offset:51360
    v_mfma_f32_16x16x32_bf16 v[28:31], v[108:111], v[212:215], v[28:31]
    s_waitcnt lgkmcnt(12)
    ds_read_b64_tr_b16 v[108:109], v6 offset:51488
    ds_read_b64_tr_b16 v[110:111], v6 offset:51616
    v_mfma_f32_16x16x32_bf16 v[32:35], v[112:115], v[192:195], v[32:35]
    s_waitcnt lgkmcnt(12)
    v_mfma_f32_16x16x32_bf16 v[32:35], v[116:119], v[208:211], v[32:35]
    v_mfma_f32_16x16x32_bf16 v[36:39], v[112:115], v[196:199], v[36:39]
    ds_read_b64_tr_b16 v[112:113], v6 offset:51264
    ds_read_b64_tr_b16 v[114:115], v6 offset:51392
    v_mfma_f32_16x16x32_bf16 v[36:39], v[116:119], v[212:215], v[36:39]
    s_waitcnt lgkmcnt(12)
    ds_read_b64_tr_b16 v[116:117], v6 offset:51520
    ds_read_b64_tr_b16 v[118:119], v6 offset:51648
    v_mfma_f32_16x16x32_bf16 v[40:43], v[120:123], v[192:195], v[40:43]
    s_waitcnt lgkmcnt(12)
    v_mfma_f32_16x16x32_bf16 v[40:43], v[124:127], v[208:211], v[40:43]
    v_mfma_f32_16x16x32_bf16 v[44:47], v[120:123], v[196:199], v[44:47]
    s_add_u32 s59, s56, 0x2000
    ds_read_b64_tr_b16 v[120:121], v6 offset:51296
    ds_read_b64_tr_b16 v[122:123], v6 offset:51424
    v_mfma_f32_16x16x32_bf16 v[44:47], v[124:127], v[212:215], v[44:47]
    s_waitcnt lgkmcnt(12)
    ds_read_b64_tr_b16 v[124:125], v6 offset:51552
    ds_read_b64_tr_b16 v[126:127], v6 offset:51680
    v_mfma_f32_16x16x32_bf16 v[16:19], v[96:99], v[224:227], v[16:19]
    s_waitcnt lgkmcnt(12)
    buffer_store_dwordx4 v[88:91], v11, s[36:39], s59 offen sc1
    v_mfma_f32_16x16x32_bf16 v[16:19], v[100:103], v[240:243], v[16:19]
    v_mfma_f32_16x16x32_bf16 v[20:23], v[96:99], v[228:231], v[20:23]
    v_mfma_f32_16x16x32_bf16 v[20:23], v[100:103], v[244:247], v[20:23]
    s_waitcnt lgkmcnt(10)
    v_mfma_f32_16x16x32_bf16 v[24:27], v[104:107], v[224:227], v[24:27]
    s_waitcnt lgkmcnt(8)
    v_mfma_f32_16x16x32_bf16 v[24:27], v[108:111], v[240:243], v[24:27]
    v_mfma_f32_16x16x32_bf16 v[28:31], v[104:107], v[228:231], v[28:31]
    v_mfma_f32_16x16x32_bf16 v[28:31], v[108:111], v[244:247], v[28:31]
    s_waitcnt lgkmcnt(6)
    v_mfma_f32_16x16x32_bf16 v[32:35], v[112:115], v[224:227], v[32:35]
    s_waitcnt lgkmcnt(4)
    v_mfma_f32_16x16x32_bf16 v[32:35], v[116:119], v[240:243], v[32:35]
    v_mfma_f32_16x16x32_bf16 v[36:39], v[112:115], v[228:231], v[36:39]
    v_mfma_f32_16x16x32_bf16 v[36:39], v[116:119], v[244:247], v[36:39]
    s_waitcnt lgkmcnt(2)
    v_mfma_f32_16x16x32_bf16 v[40:43], v[120:123], v[224:227], v[40:43]
    s_waitcnt lgkmcnt(0)
    v_mfma_f32_16x16x32_bf16 v[40:43], v[124:127], v[240:243], v[40:43]
    v_mfma_f32_16x16x32_bf16 v[44:47], v[120:123], v[228:231], v[44:47]
    v_mfma_f32_16x16x32_bf16 v[44:47], v[124:127], v[244:247], v[44:47]
    v_cvt_pk_bf16_f32 v200, v16, v17
    v_cvt_pk_bf16_f32 v201, v18, v19
    v_cvt_pk_bf16_f32 v202, v24, v25
    v_cvt_pk_bf16_f32 v203, v26, v27
    v_cvt_pk_bf16_f32 v204, v32, v33
    v_cvt_pk_bf16_f32 v205, v34, v35
    v_cvt_pk_bf16_f32 v206, v40, v41
    v_cvt_pk_bf16_f32 v207, v42, v43
    v_cvt_pk_bf16_f32 v216, v20, v21
    v_cvt_pk_bf16_f32 v217, v22, v23
    v_cvt_pk_bf16_f32 v218, v28, v29
    v_cvt_pk_bf16_f32 v219, v30, v31
    v_cvt_pk_bf16_f32 v220, v36, v37
    v_cvt_pk_bf16_f32 v221, v38, v39
    v_cvt_pk_bf16_f32 v222, v44, v45
    v_cvt_pk_bf16_f32 v223, v46, v47
    s_add_u32 s60, s56, 0x2400
    buffer_store_dwordx4 v[92:95], v11, s[36:39], s60 offen sc1
    s_add_u32 s57, s56, 0x1000
    buffer_store_dwordx4 v[200:203], v11, s[36:39], s57 offen sc1
    s_add_u32 s58, s56, 0x1400
    buffer_store_dwordx4 v[204:207], v11, s[36:39], s58 offen sc1
    s_add_u32 s59, s56, 0x2800
    buffer_store_dwordx4 v[216:219], v11, s[36:39], s59 offen sc1
    s_add_u32 s60, s56, 0x2c00
    buffer_store_dwordx4 v[220:223], v11, s[36:39], s60 offen sc1
    s_mov_b32 s72, 0x3f80
    s_mov_b32 s73, 0x3f800000
    s_waitcnt vmcnt(6)
    v_readfirstlane_b32 s74, v252
    v_readfirstlane_b32 s75, v253
    s_lshl_b32 s57, s43, 2
    s_add_u32 s57, s57, s42
    s_mul_i32 s58, s44, 0x1c000
    s_lshr_b32 s59, s57, 3
    s_mul_i32 s59, s59, 0x3800
    s_add_u32 s59, s59, s58
    s_and_b32 s60, s57, 7
    s_lshl_b32 s60, s60, 6
    s_add_u32 s59, s59, s60
    v_and_b32 v70, 15, v0
    v_mul_u32_u24 v70, 0x380, v70
    v_lshrrev_b32 v73, 4, v0
    v_lshl_add_u32 v70, v73, 3, v70
    v_add_u32 v70, s59, v70
    s_mul_i32 s57, s57, 48
    s_add_u32 s58, s58, 0x200
    v_add_u32 v72, s57, v0
    v_lshrrev_b32 v73, 6, v72
    v_mul_u32_u24 v74, 43, v73
    v_lshrrev_b32 v74, 8, v74
    v_mul_u32_u24 v71, 6, v74
    v_sub_u32 v73, v73, v71
    v_and_b32 v71, 15, v72
    v_lshl_add_u32 v71, v74, 4, v71
    v_mul_u32_u24 v71, 0x380, v71
    v_lshl_add_u32 v71, v73, 6, v71
    v_bfe_u32 v73, v72, 4, 2
    v_lshl_add_u32 v71, v73, 3, v71
    v_add_u32 v71, s58, v71
    v_cmp_gt_u32 vcc, 48, v0
    v_mov_b32 v73, 0x7fffff00
    s_nop 0
    v_cndmask_b32 v71, v73, v71, vcc
    buffer_load_dwordx2 v[62:63], v70, s[8:11], 0 offen
    buffer_load_dwordx2 v[64:65], v70, s[8:11], 0 offen offset:32
    buffer_load_dwordx2 v[66:67], v71, s[8:11], 0 offen
    buffer_load_dwordx2 v[68:69], v71, s[8:11], 0 offen offset:32
    s_waitcnt vmcnt(4)
    s_barrier
    s_lshl_b32 s57, s44, 12
    s_add_u32 s57, s57, 0x3900004
    s_cmp_eq_u32 s42, 0
    s_cselect_b32 s57, s57, 0x7ff00000
    v_lshlrev_b32 v75, 8, v0
    v_add_u32 v75, s57, v75
    v_mov_b32 v76, 1
    s_lshl_b32 s57, 1, s43
    s_xor_b32 s57, s57, 0xffff
    s_mov_b32 exec_lo, s57
    s_mov_b32 exec_hi, 0
    buffer_atomic_add v76, v75, s[36:39], 0 offen
    s_mov_b64 exec, -1
    s_cmp_ge_u32 s74, 15
    s_cbranch_scc1 L_haveA
    v_accvgpr_read_b32 v96, a8
    v_accvgpr_read_b32 v97, a9
    v_accvgpr_read_b32 v98, a10
    v_accvgpr_read_b32 v99, a11
    v_dot2_f32_bf16 v16, v96, s72, 0
    v_dot2_f32_bf16 v17, v96, s73, 0
    v_dot2_f32_bf16 v18, v97, s72, 0
    v_dot2_f32_bf16 v19, v97, s73, 0
    v_dot2_f32_bf16 v20, v98, s72, 0
    v_dot2_f32_bf16 v21, v98, s73, 0
    v_dot2_f32_bf16 v22, v99, s72, 0
    v_dot2_f32_bf16 v23, v99, s73, 0
    v_accvgpr_read_b32 v100, a24
    v_accvgpr_read_b32 v101, a25
    v_accvgpr_read_b32 v102, a26
    v_accvgpr_read_b32 v103, a27
    v_dot2_f32_bf16 v16, v100, s72, v16
    v_dot2_f32_bf16 v17, v100, s73, v17
    v_dot2_f32_bf16 v18, v101, s72, v18
    v_dot2_f32_bf16 v19, v101, s73, v19
    v_dot2_f32_bf16 v20, v102, s72, v20
    v_dot2_f32_bf16 v21, v102, s73, v21
    v_dot2_f32_bf16 v22, v103, s72, v22
    v_dot2_f32_bf16 v23, v103, s73, v23
    v_accvgpr_read_b32 v96, a40
    v_accvgpr_read_b32 v97, a41
    v_accvgpr_read_b32 v98, a42
    v_accvgpr_read_b32 v99, a43
    v_dot2_f32_bf16 v16, v96, s72, v16
    v_dot2_f32_bf16 v17, v96, s73, v17
    v_dot2_f32_bf16 v18, v97, s72, v18
    v_dot2_f32_bf16 v19, v97, s73, v19
    v_dot2_f32_bf16 v20, v98, s72, v20
    v_dot2_f32_bf16 v21, v98, s73, v21
    v_dot2_f32_bf16 v22, v99, s72, v22
    v_dot2_f32_bf16 v23, v99, s73, v23
    v_accvgpr_read_b32 v100, a56
    v_accvgpr_read_b32 v101, a57
    v_accvgpr_read_b32 v102, a58
    v_accvgpr_read_b32 v103, a59
    v_dot2_f32_bf16 v16, v100, s72, v16
    v_dot2_f32_bf16 v17, v100, s73, v17
    v_dot2_f32_bf16 v18, v101, s72, v18
    v_dot2_f32_bf16 v19, v101, s73, v19
    v_dot2_f32_bf16 v20, v102, s72, v20
    v_dot2_f32_bf16 v21, v102, s73, v21
    v_dot2_f32_bf16 v22, v103, s72, v22
    v_dot2_f32_bf16 v23, v103, s73, v23
    v_accvgpr_read_b32 v96, a72
    v_accvgpr_read_b32 v97, a73
    v_accvgpr_read_b32 v98, a74
    v_accvgpr_read_b32 v99, a75
    v_dot2_f32_bf16 v16, v96, s72, v16
    v_dot2_f32_bf16 v17, v96, s73, v17
    v_dot2_f32_bf16 v18, v97, s72, v18
    v_dot2_f32_bf16 v19, v97, s73, v19
    v_dot2_f32_bf16 v20, v98, s72, v20
    v_dot2_f32_bf16 v21, v98, s73, v21
    v_dot2_f32_bf16 v22, v99, s72, v22
    v_dot2_f32_bf16 v23, v99, s73, v23
    v_accvgpr_read_b32 v100, a88
    v_accvgpr_read_b32 v101, a89
    v_accvgpr_read_b32 v102, a90
    v_accvgpr_read_b32 v103, a91
    v_dot2_f32_bf16 v16, v100, s72, v16
    v_dot2_f32_bf16 v17, v100, s73, v17
    v_dot2_f32_bf16 v18, v101, s72, v18
    v_dot2_f32_bf16 v19, v101, s73, v19
    v_dot2_f32_bf16 v20, v102, s72, v20
    v_dot2_f32_bf16 v21, v102, s73, v21
    v_dot2_f32_bf16 v22, v103, s72, v22
    v_dot2_f32_bf16 v23, v103, s73, v23
    v_accvgpr_read_b32 v96, a104
    v_accvgpr_read_b32 v97, a105
    v_accvgpr_read_b32 v98, a106
    v_accvgpr_read_b32 v99, a107
    v_dot2_f32_bf16 v16, v96, s72, v16
    v_dot2_f32_bf16 v17, v96, s73, v17
    v_dot2_f32_bf16 v18, v97, s72, v18
    v_dot2_f32_bf16 v19, v97, s73, v19
    v_dot2_f32_bf16 v20, v98, s72, v20
    v_dot2_f32_bf16 v21, v98, s73, v21
    v_dot2_f32_bf16 v22, v99, s72, v22
    v_dot2_f32_bf16 v23, v99, s73, v23
    v_accvgpr_read_b32 v100, a120
    v_accvgpr_read_b32 v101, a121
    v_accvgpr_read_b32 v102, a122
    v_accvgpr_read_b32 v103, a123
    v_dot2_f32_bf16 v16, v100, s72, v16
    v_dot2_f32_bf16 v17, v100, s73, v17
    v_dot2_f32_bf16 v18, v101, s72, v18
    v_dot2_f32_bf16 v19, v101, s73, v19
    v_dot2_f32_bf16 v20, v102, s72, v20
    v_dot2_f32_bf16 v21, v102, s73, v21
    v_dot2_f32_bf16 v22, v103, s72, v22
    v_dot2_f32_bf16 v23, v103, s73, v23
    v_accvgpr_read_b32 v96, a136
    v_accvgpr_read_b32 v97, a137
    v_accvgpr_read_b32 v98, a138
    v_accvgpr_read_b32 v99, a139
    v_dot2_f32_bf16 v16, v96, s72, v16
    v_dot2_f32_bf16 v17, v96, s73, v17
    v_dot2_f32_bf16 v18, v97, s72, v18
    v_dot2_f32_bf16 v19, v97, s73, v19
    v_dot2_f32_bf16 v20, v98, s72, v20
    v_dot2_f32_bf16 v21, v98, s73, v21
    v_dot2_f32_bf16 v22, v99, s72, v22
    v_dot2_f32_bf16 v23, v99, s73, v23
    v_accvgpr_read_b32 v100, a152
    v_accvgpr_read_b32 v101, a153
    v_accvgpr_read_b32 v102, a154
    v_accvgpr_read_b32 v103, a155
    v_dot2_f32_bf16 v16, v100, s72, v16
    v_dot2_f32_bf16 v17, v100, s73, v17
    v_dot2_f32_bf16 v18, v101, s72, v18
    v_dot2_f32_bf16 v19, v101, s73, v19
    v_dot2_f32_bf16 v20, v102, s72, v20
    v_dot2_f32_bf16 v21, v102, s73, v21
    v_dot2_f32_bf16 v22, v103, s72, v22
    v_dot2_f32_bf16 v23, v103, s73, v23
    v_accvgpr_read_b32 v96, a168
    v_accvgpr_read_b32 v97, a169
    v_accvgpr_read_b32 v98, a170
    v_accvgpr_read_b32 v99, a171
    v_dot2_f32_bf16 v16, v96, s72, v16
    v_dot2_f32_bf16 v17, v96, s73, v17
    v_dot2_f32_bf16 v18, v97, s72, v18
    v_dot2_f32_bf16 v19, v97, s73, v19
    v_dot2_f32_bf16 v20, v98, s72, v20
    v_dot2_f32_bf16 v21, v98, s73, v21
    v_dot2_f32_bf16 v22, v99, s72, v22
    v_dot2_f32_bf16 v23, v99, s73, v23
    v_accvgpr_read_b32 v100, a184
    v_accvgpr_read_b32 v101, a185
    v_accvgpr_read_b32 v102, a186
    v_accvgpr_read_b32 v103, a187
    v_dot2_f32_bf16 v16, v100, s72, v16
    v_dot2_f32_bf16 v17, v100, s73, v17
    v_dot2_f32_bf16 v18, v101, s72, v18
    v_dot2_f32_bf16 v19, v101, s73, v19
    v_dot2_f32_bf16 v20, v102, s72, v20
    v_dot2_f32_bf16 v21, v102, s73, v21
    v_dot2_f32_bf16 v22, v103, s72, v22
    v_dot2_f32_bf16 v23, v103, s73, v23
    v_accvgpr_read_b32 v96, a200
    v_accvgpr_read_b32 v97, a201
    v_accvgpr_read_b32 v98, a202
    v_accvgpr_read_b32 v99, a203
    v_dot2_f32_bf16 v16, v96, s72, v16
    v_dot2_f32_bf16 v17, v96, s73, v17
    v_dot2_f32_bf16 v18, v97, s72, v18
    v_dot2_f32_bf16 v19, v97, s73, v19
    v_dot2_f32_bf16 v20, v98, s72, v20
    v_dot2_f32_bf16 v21, v98, s73, v21
    v_dot2_f32_bf16 v22, v99, s72, v22
    v_dot2_f32_bf16 v23, v99, s73, v23
    v_accvgpr_read_b32 v100, a216
    v_accvgpr_read_b32 v101, a217
    v_accvgpr_read_b32 v102, a218
    v_accvgpr_read_b32 v103, a219
    v_dot2_f32_bf16 v16, v100, s72, v16
    v_dot2_f32_bf16 v17, v100, s73, v17
    v_dot2_f32_bf16 v18, v101, s72, v18
    v_dot2_f32_bf16 v19, v101, s73, v19
    v_dot2_f32_bf16 v20, v102, s72, v20
    v_dot2_f32_bf16 v21, v102, s73, v21
    v_dot2_f32_bf16 v22, v103, s72, v22
    v_dot2_f32_bf16 v23, v103, s73, v23
    v_accvgpr_read_b32 v96, a232
    v_accvgpr_read_b32 v97, a233
    v_accvgpr_read_b32 v98, a234
    v_accvgpr_read_b32 v99, a235
    v_dot2_f32_bf16 v16, v96, s72, v16
    v_dot2_f32_bf16 v17, v96, s73, v17
    v_dot2_f32_bf16 v18, v97, s72, v18
    v_dot2_f32_bf16 v19, v97, s73, v19
    v_dot2_f32_bf16 v20, v98, s72, v20
    v_dot2_f32_bf16 v21, v98, s73, v21
    v_dot2_f32_bf16 v22, v99, s72, v22
    v_dot2_f32_bf16 v23, v99, s73, v23
    v_accvgpr_read_b32 v100, a248
    v_accvgpr_read_b32 v101, a249
    v_accvgpr_read_b32 v102, a250
    v_accvgpr_read_b32 v103, a251
    v_dot2_f32_bf16 v16, v100, s72, v16
    v_dot2_f32_bf16 v17, v100, s73, v17
    v_dot2_f32_bf16 v18, v101, s72, v18
    v_dot2_f32_bf16 v19, v101, s73, v19
    v_dot2_f32_bf16 v20, v102, s72, v20
    v_dot2_f32_bf16 v21, v102, s73, v21
    v_dot2_f32_bf16 v22, v103, s72, v22
    v_dot2_f32_bf16 v23, v103, s73, v23
    v_mov_b32 v75, 0
    s_mov_b32 s58, 0
L_poll_A:
    buffer_load_dwordx2 v[76:77], v75, s[36:39], s97 offen sc1
    s_waitcnt vmcnt(0)
    v_readfirstlane_b32 s59, v76
    v_readfirstlane_b32 s60, v77
    s_add_u32 s58, s58, 1
    s_nop 3
    s_cmp_ge_u32 s59, 15
    s_cbranch_scc1 L_pdone_A
    s_sleep 2
    s_cmp_lt_u32 s58, 0x40000
    s_cbranch_scc1 L_poll_A
L_pdone_A:
    s_mov_b32 s75, s60
    s_mul_i32 s61, s44, 0x1c0000
    s_add_u32 s61, s61, 0x1c00000
    buffer_load_dwordx4 v[128:131], v12, s[36:39], s61 offen sc1
    s_add_u32 s62, s61, 0x1c000
    buffer_load_dwordx4 v[132:135], v12, s[36:39], s62 offen sc1
    s_add_u32 s61, s62, 0x1c000
    buffer_load_dwordx4 v[136:139], v12, s[36:39], s61 offen sc1
    s_add_u32 s62, s61, 0x1c000
    buffer_load_dwordx4 v[140:143], v12, s[36:39], s62 offen sc1
    s_add_u32 s61, s62, 0x1c000
    buffer_load_dwordx4 v[144:147], v12, s[36:39], s61 offen sc1
    s_add_u32 s62, s61, 0x1c000
    buffer_load_dwordx4 v[148:151], v12, s[36:39], s62 offen sc1
    s_add_u32 s61, s62, 0x1c000
    buffer_load_dwordx4 v[152:155], v12, s[36:39], s61 offen sc1
    s_add_u32 s62, s61, 0x1c000
    buffer_load_dwordx4 v[156:159], v12, s[36:39], s62 offen sc1
    s_add_u32 s61, s62, 0x1c000
    buffer_load_dwordx4 v[160:163], v12, s[36:39], s61 offen sc1
    s_add_u32 s62, s61, 0x1c000
    buffer_load_dwordx4 v[164:167], v12, s[36:39], s62 offen sc1
    s_add_u32 s61, s62, 0x1c000
    buffer_load_dwordx4 v[168:171], v12, s[36:39], s61 offen sc1
    s_add_u32 s62, s61, 0x1c000
    buffer_load_dwordx4 v[172:175], v12, s[36:39], s62 offen sc1
    s_add_u32 s61, s62, 0x1c000
    buffer_load_dwordx4 v[176:179], v12, s[36:39], s61 offen sc1
    s_add_u32 s62, s61, 0x1c000
    buffer_load_dwordx4 v[180:183], v12, s[36:39], s62 offen sc1
    s_add_u32 s61, s62, 0x1c000
    buffer_load_dwordx4 v[184:187], v12, s[36:39], s61 offen sc1
    s_add_u32 s62, s61, 0x1c000
    buffer_load_dwordx4 v[188:191], v12, s[36:39], s62 offen sc1
    s_branch L_joinA
L_haveA:
    s_mul_i32 s61, s44, 0x1c0000
    s_add_u32 s61, s61, 0x1c00000
    buffer_load_dwordx4 v[128:131], v12, s[36:39], s61 offen sc1
    s_add_u32 s62, s61, 0x1c000
    buffer_load_dwordx4 v[132:135], v12, s[36:39], s62 offen sc1
    s_add_u32 s61, s62, 0x1c000
    buffer_load_dwordx4 v[136:139], v12, s[36:39], s61 offen sc1
    s_add_u32 s62, s61, 0x1c000
    buffer_load_dwordx4 v[140:143], v12, s[36:39], s62 offen sc1
    s_add_u32 s61, s62, 0x1c000
    buffer_load_dwordx4 v[144:147], v12, s[36:39], s61 offen sc1
    s_add_u32 s62, s61, 0x1c000
    buffer_load_dwordx4 v[148:151], v12, s[36:39], s62 offen sc1
    s_add_u32 s61, s62, 0x1c000
    buffer_load_dwordx4 v[152:155], v12, s[36:39], s61 offen sc1
    s_add_u32 s62, s61, 0x1c000
    buffer_load_dwordx4 v[156:159], v12, s[36:39], s62 offen sc1
    s_add_u32 s61, s62, 0x1c000
    buffer_load_dwordx4 v[160:163], v12, s[36:39], s61 offen sc1
    s_add_u32 s62, s61, 0x1c000
    buffer_load_dwordx4 v[164:167], v12, s[36:39], s62 offen sc1
    s_add_u32 s61, s62, 0x1c000
    buffer_load_dwordx4 v[168:171], v12, s[36:39], s61 offen sc1
    s_add_u32 s62, s61, 0x1c000
    buffer_load_dwordx4 v[172:175], v12, s[36:39], s62 offen sc1
    s_add_u32 s61, s62, 0x1c000
    buffer_load_dwordx4 v[176:179], v12, s[36:39], s61 offen sc1
    s_add_u32 s62, s61, 0x1c000
    buffer_load_dwordx4 v[180:183], v12, s[36:39], s62 offen sc1
    s_add_u32 s61, s62, 0x1c000
    buffer_load_dwordx4 v[184:187], v12, s[36:39], s61 offen sc1
    s_add_u32 s62, s61, 0x1c000
    buffer_load_dwordx4 v[188:191], v12, s[36:39], s62 offen sc1
    s_cmp_ge_u32 s75, 15
    s_cbranch_scc0 L_noB1
    s_mul_i32 s61, s44, 0x1c0000
    s_add_u32 s61, s61, 0x1c00000
    buffer_load_dwordx4 v[192:195], v14, s[36:39], s61 offen sc1
    s_add_u32 s62, s61, 0x1c000
    buffer_load_dwordx4 v[196:199], v14, s[36:39], s62 offen sc1
    s_add_u32 s61, s62, 0x1c000
    buffer_load_dwordx4 v[200:203], v14, s[36:39], s61 offen sc1
    s_add_u32 s62, s61, 0x1c000
    buffer_load_dwordx4 v[204:207], v14, s[36:39], s62 offen sc1
    s_add_u32 s61, s62, 0x1c000
    buffer_load_dwordx4 v[208:211], v14, s[36:39], s61 offen sc1
    s_add_u32 s62, s61, 0x1c000
    buffer_load_dwordx4 v[212:215], v14, s[36:39], s62 offen sc1
    s_add_u32 s61, s62, 0x1c000
    buffer_load_dwordx4 v[216:219], v14, s[36:39], s61 offen sc1
    s_add_u32 s62, s61, 0x1c000
    buffer_load_dwordx4 v[220:223], v14, s[36:39], s62 offen sc1
    s_add_u32 s61, s62, 0x1c000
    buffer_load_dwordx4 v[224:227], v14, s[36:39], s61 offen sc1
    s_add_u32 s62, s61, 0x1c000
    buffer_load_dwordx4 v[228:231], v14, s[36:39], s62 offen sc1
    s_add_u32 s61, s62, 0x1c000
    buffer_load_dwordx4 v[232:235], v14, s[36:39], s61 offen sc1
    s_add_u32 s62, s61, 0x1c000
    buffer_load_dwordx4 v[236:239], v14, s[36:39], s62 offen sc1
    s_add_u32 s61, s62, 0x1c000
    buffer_load_dwordx4 v[240:243], v14, s[36:39], s61 offen sc1
    s_add_u32 s62, s61, 0x1c000
    buffer_load_dwordx4 v[244:247], v14, s[36:39], s62 offen sc1
    s_add_u32 s61, s62, 0x1c000
    buffer_load_dwordx4 v[248:251], v14, s[36:39], s61 offen sc1
    s_add_u32 s62, s61, 0x1c000
    buffer_load_dwordx4 v[252:255], v14, s[36:39], s62 offen sc1
    s_mov_b32 s74, 0x63
L_noB1:
    v_accvgpr_read_b32 v96, a8
    v_accvgpr_read_b32 v97, a9
    v_accvgpr_read_b32 v98, a10
    v_accvgpr_read_b32 v99, a11
    v_dot2_f32_bf16 v16, v96, s72, 0
    v_dot2_f32_bf16 v17, v96, s73, 0
    v_dot2_f32_bf16 v18, v97, s72, 0
    v_dot2_f32_bf16 v19, v97, s73, 0
    v_dot2_f32_bf16 v20, v98, s72, 0
    v_dot2_f32_bf16 v21, v98, s73, 0
    v_dot2_f32_bf16 v22, v99, s72, 0
    v_dot2_f32_bf16 v23, v99, s73, 0
    v_accvgpr_read_b32 v100, a24
    v_accvgpr_read_b32 v101, a25
    v_accvgpr_read_b32 v102, a26
    v_accvgpr_read_b32 v103, a27
    v_dot2_f32_bf16 v16, v100, s72, v16
    v_dot2_f32_bf16 v17, v100, s73, v17
    v_dot2_f32_bf16 v18, v101, s72, v18
    v_dot2_f32_bf16 v19, v101, s73, v19
    v_dot2_f32_bf16 v20, v102, s72, v20
    v_dot2_f32_bf16 v21, v102, s73, v21
    v_dot2_f32_bf16 v22, v103, s72, v22
    v_dot2_f32_bf16 v23, v103, s73, v23
    v_accvgpr_read_b32 v96, a40
    v_accvgpr_read_b32 v97, a41
    v_accvgpr_read_b32 v98, a42
    v_accvgpr_read_b32 v99, a43
    v_dot2_f32_bf16 v16, v96, s72, v16
    v_dot2_f32_bf16 v17, v96, s73, v17
    v_dot2_f32_bf16 v18, v97, s72, v18
    v_dot2_f32_bf16 v19, v97, s73, v19
    v_dot2_f32_bf16 v20, v98, s72, v20
    v_dot2_f32_bf16 v21, v98, s73, v21
    v_dot2_f32_bf16 v22, v99, s72, v22
    v_dot2_f32_bf16 v23, v99, s73, v23
    v_accvgpr_read_b32 v100, a56
    v_accvgpr_read_b32 v101, a57
    v_accvgpr_read_b32 v102, a58
    v_accvgpr_read_b32 v103, a59
    v_dot2_f32_bf16 v16, v100, s72, v16
    v_dot2_f32_bf16 v17, v100, s73, v17
    v_dot2_f32_bf16 v18, v101, s72, v18
    v_dot2_f32_bf16 v19, v101, s73, v19
    v_dot2_f32_bf16 v20, v102, s72, v20
    v_dot2_f32_bf16 v21, v102, s73, v21
    v_dot2_f32_bf16 v22, v103, s72, v22
    v_dot2_f32_bf16 v23, v103, s73, v23
    v_accvgpr_read_b32 v96, a72
    v_accvgpr_read_b32 v97, a73
    v_accvgpr_read_b32 v98, a74
    v_accvgpr_read_b32 v99, a75
    v_dot2_f32_bf16 v16, v96, s72, v16
    v_dot2_f32_bf16 v17, v96, s73, v17
    v_dot2_f32_bf16 v18, v97, s72, v18
    v_dot2_f32_bf16 v19, v97, s73, v19
    v_dot2_f32_bf16 v20, v98, s72, v20
    v_dot2_f32_bf16 v21, v98, s73, v21
    v_dot2_f32_bf16 v22, v99, s72, v22
    v_dot2_f32_bf16 v23, v99, s73, v23
    v_accvgpr_read_b32 v100, a88
    v_accvgpr_read_b32 v101, a89
    v_accvgpr_read_b32 v102, a90
    v_accvgpr_read_b32 v103, a91
    v_dot2_f32_bf16 v16, v100, s72, v16
    v_dot2_f32_bf16 v17, v100, s73, v17
    v_dot2_f32_bf16 v18, v101, s72, v18
    v_dot2_f32_bf16 v19, v101, s73, v19
    v_dot2_f32_bf16 v20, v102, s72, v20
    v_dot2_f32_bf16 v21, v102, s73, v21
    v_dot2_f32_bf16 v22, v103, s72, v22
    v_dot2_f32_bf16 v23, v103, s73, v23
    v_accvgpr_read_b32 v96, a104
    v_accvgpr_read_b32 v97, a105
    v_accvgpr_read_b32 v98, a106
    v_accvgpr_read_b32 v99, a107
    v_dot2_f32_bf16 v16, v96, s72, v16
    v_dot2_f32_bf16 v17, v96, s73, v17
    v_dot2_f32_bf16 v18, v97, s72, v18
    v_dot2_f32_bf16 v19, v97, s73, v19
    v_dot2_f32_bf16 v20, v98, s72, v20
    v_dot2_f32_bf16 v21, v98, s73, v21
    v_dot2_f32_bf16 v22, v99, s72, v22
    v_dot2_f32_bf16 v23, v99, s73, v23
    v_accvgpr_read_b32 v100, a120
    v_accvgpr_read_b32 v101, a121
    v_accvgpr_read_b32 v102, a122
    v_accvgpr_read_b32 v103, a123
    v_dot2_f32_bf16 v16, v100, s72, v16
    v_dot2_f32_bf16 v17, v100, s73, v17
    v_dot2_f32_bf16 v18, v101, s72, v18
    v_dot2_f32_bf16 v19, v101, s73, v19
    v_dot2_f32_bf16 v20, v102, s72, v20
    v_dot2_f32_bf16 v21, v102, s73, v21
    v_dot2_f32_bf16 v22, v103, s72, v22
    v_dot2_f32_bf16 v23, v103, s73, v23
    v_accvgpr_read_b32 v96, a136
    v_accvgpr_read_b32 v97, a137
    v_accvgpr_read_b32 v98, a138
    v_accvgpr_read_b32 v99, a139
    v_dot2_f32_bf16 v16, v96, s72, v16
    v_dot2_f32_bf16 v17, v96, s73, v17
    v_dot2_f32_bf16 v18, v97, s72, v18
    v_dot2_f32_bf16 v19, v97, s73, v19
    v_dot2_f32_bf16 v20, v98, s72, v20
    v_dot2_f32_bf16 v21, v98, s73, v21
    v_dot2_f32_bf16 v22, v99, s72, v22
    v_dot2_f32_bf16 v23, v99, s73, v23
    v_accvgpr_read_b32 v100, a152
    v_accvgpr_read_b32 v101, a153
    v_accvgpr_read_b32 v102, a154
    v_accvgpr_read_b32 v103, a155
    v_dot2_f32_bf16 v16, v100, s72, v16
    v_dot2_f32_bf16 v17, v100, s73, v17
    v_dot2_f32_bf16 v18, v101, s72, v18
    v_dot2_f32_bf16 v19, v101, s73, v19
    v_dot2_f32_bf16 v20, v102, s72, v20
    v_dot2_f32_bf16 v21, v102, s73, v21
    v_dot2_f32_bf16 v22, v103, s72, v22
    v_dot2_f32_bf16 v23, v103, s73, v23
    v_accvgpr_read_b32 v96, a168
    v_accvgpr_read_b32 v97, a169
    v_accvgpr_read_b32 v98, a170
    v_accvgpr_read_b32 v99, a171
    v_dot2_f32_bf16 v16, v96, s72, v16
    v_dot2_f32_bf16 v17, v96, s73, v17
    v_dot2_f32_bf16 v18, v97, s72, v18
    v_dot2_f32_bf16 v19, v97, s73, v19
    v_dot2_f32_bf16 v20, v98, s72, v20
    v_dot2_f32_bf16 v21, v98, s73, v21
    v_dot2_f32_bf16 v22, v99, s72, v22
    v_dot2_f32_bf16 v23, v99, s73, v23
    v_accvgpr_read_b32 v100, a184
    v_accvgpr_read_b32 v101, a185
    v_accvgpr_read_b32 v102, a186
    v_accvgpr_read_b32 v103, a187
    v_dot2_f32_bf16 v16, v100, s72, v16
    v_dot2_f32_bf16 v17, v100, s73, v17
    v_dot2_f32_bf16 v18, v101, s72, v18
    v_dot2_f32_bf16 v19, v101, s73, v19
    v_dot2_f32_bf16 v20, v102, s72, v20
    v_dot2_f32_bf16 v21, v102, s73, v21
    v_dot2_f32_bf16 v22, v103, s72, v22
    v_dot2_f32_bf16 v23, v103, s73, v23
    v_accvgpr_read_b32 v96, a200
    v_accvgpr_read_b32 v97, a201
    v_accvgpr_read_b32 v98, a202
    v_accvgpr_read_b32 v99, a203
    v_dot2_f32_bf16 v16, v96, s72, v16
    v_dot2_f32_bf16 v17, v96, s73, v17
    v_dot2_f32_bf16 v18, v97, s72, v18
    v_dot2_f32_bf16 v19, v97, s73, v19
    v_dot2_f32_bf16 v20, v98, s72, v20
    v_dot2_f32_bf16 v21, v98, s73, v21
    v_dot2_f32_bf16 v22, v99, s72, v22
    v_dot2_f32_bf16 v23, v99, s73, v23
    v_accvgpr_read_b32 v100, a216
    v_accvgpr_read_b32 v101, a217
    v_accvgpr_read_b32 v102, a218
    v_accvgpr_read_b32 v103, a219
    v_dot2_f32_bf16 v16, v100, s72, v16
    v_dot2_f32_bf16 v17, v100, s73, v17
    v_dot2_f32_bf16 v18, v101, s72, v18
    v_dot2_f32_bf16 v19, v101, s73, v19
    v_dot2_f32_bf16 v20, v102, s72, v20
    v_dot2_f32_bf16 v21, v102, s73, v21
    v_dot2_f32_bf16 v22, v103, s72, v22
    v_dot2_f32_bf16 v23, v103, s73, v23
    v_accvgpr_read_b32 v96, a232
    v_accvgpr_read_b32 v97, a233
    v_accvgpr_read_b32 v98, a234
    v_accvgpr_read_b32 v99, a235
    v_dot2_f32_bf16 v16, v96, s72, v16
    v_dot2_f32_bf16 v17, v96, s73, v17
    v_dot2_f32_bf16 v18, v97, s72, v18
    v_dot2_f32_bf16 v19, v97, s73, v19
    v_dot2_f32_bf16 v20, v98, s72, v20
    v_dot2_f32_bf16 v21, v98, s73, v21
    v_dot2_f32_bf16 v22, v99, s72, v22
    v_dot2_f32_bf16 v23, v99, s73, v23
    v_accvgpr_read_b32 v100, a248
    v_accvgpr_read_b32 v101, a249
    v_accvgpr_read_b32 v102, a250
    v_accvgpr_read_b32 v103, a251
    v_dot2_f32_bf16 v16, v100, s72, v16
    v_dot2_f32_bf16 v17, v100, s73, v17
    v_dot2_f32_bf16 v18, v101, s72, v18
    v_dot2_f32_bf16 v19, v101, s73, v19
    v_dot2_f32_bf16 v20, v102, s72, v20
    v_dot2_f32_bf16 v21, v102, s73, v21
    v_dot2_f32_bf16 v22, v103, s72, v22
    v_dot2_f32_bf16 v23, v103, s73, v23
L_joinA:
    v_cvt_pk_bf16_f32 v16, v16, v16
    v_and_b32 v16, 0xffff0000, v16
    v_cvt_pk_bf16_f32 v17, v17, v17
    v_and_b32 v17, 0xffff0000, v17
    v_cvt_pk_bf16_f32 v18, v18, v18
    v_and_b32 v18, 0xffff0000, v18
    v_cvt_pk_bf16_f32 v19, v19, v19
    v_and_b32 v19, 0xffff0000, v19
    v_cvt_pk_bf16_f32 v20, v20, v20
    v_and_b32 v20, 0xffff0000, v20
    v_cvt_pk_bf16_f32 v21, v21, v21
    v_and_b32 v21, 0xffff0000, v21
    v_cvt_pk_bf16_f32 v22, v22, v22
    v_and_b32 v22, 0xffff0000, v22
    v_cvt_pk_bf16_f32 v23, v23, v23
    v_and_b32 v23, 0xffff0000, v23
    v_mul_f32 v54, 0xbfb8aa3b, v16
    v_mul_f32 v55, 0xbfb8aa3b, v17
    v_mul_f32 v56, 0xbfb8aa3b, v18
    v_mul_f32 v57, 0xbfb8aa3b, v19
    v_mul_f32 v58, 0xbfb8aa3b, v20
    v_mul_f32 v59, 0xbfb8aa3b, v21
    v_mul_f32 v60, 0xbfb8aa3b, v22
    v_mul_f32 v61, 0xbfb8aa3b, v23
    v_exp_f32 v54, v54
    v_exp_f32 v55, v55
    v_exp_f32 v56, v56
    v_exp_f32 v57, v57
    v_exp_f32 v58, v58
    v_exp_f32 v59, v59
    v_exp_f32 v60, v60
    v_exp_f32 v61, v61
    v_add_f32 v54, 1.0, v54
    v_add_f32 v55, 1.0, v55
    v_add_f32 v56, 1.0, v56
    v_add_f32 v57, 1.0, v57
    v_add_f32 v58, 1.0, v58
    v_add_f32 v59, 1.0, v59
    v_add_f32 v60, 1.0, v60
    v_add_f32 v61, 1.0, v61
    v_rcp_f32 v54, v54
    v_rcp_f32 v55, v55
    v_rcp_f32 v56, v56
    v_rcp_f32 v57, v57
    v_rcp_f32 v58, v58
    v_rcp_f32 v59, v59
    v_rcp_f32 v60, v60
    v_rcp_f32 v61, v61
    v_mul_f32 v16, v16, v54
    v_mul_f32 v17, v17, v55
    v_mul_f32 v18, v18, v56
    v_mul_f32 v19, v19, v57
    v_mul_f32 v20, v20, v58
    v_mul_f32 v21, v21, v59
    v_mul_f32 v22, v22, v60
    v_mul_f32 v23, v23, v61
    v_cvt_pk_bf16_f32 v16, v16, v16
    v_and_b32 v16, 0xffff0000, v16
    v_cvt_pk_bf16_f32 v17, v17, v17
    v_and_b32 v17, 0xffff0000, v17
    v_cvt_pk_bf16_f32 v18, v18, v18
    v_and_b32 v18, 0xffff0000, v18
    v_cvt_pk_bf16_f32 v19, v19, v19
    v_and_b32 v19, 0xffff0000, v19
    v_cvt_pk_bf16_f32 v20, v20, v20
    v_and_b32 v20, 0xffff0000, v20
    v_cvt_pk_bf16_f32 v21, v21, v21
    v_and_b32 v21, 0xffff0000, v21
    v_cvt_pk_bf16_f32 v22, v22, v22
    v_and_b32 v22, 0xffff0000, v22
    v_cvt_pk_bf16_f32 v23, v23, v23
    v_and_b32 v23, 0xffff0000, v23
    v_accvgpr_read_b32 v96, a12
    v_accvgpr_read_b32 v97, a13
    v_accvgpr_read_b32 v98, a14
    v_accvgpr_read_b32 v99, a15
    v_dot2_f32_bf16 v24, v96, s72, 0
    v_dot2_f32_bf16 v25, v96, s73, 0
    v_dot2_f32_bf16 v26, v97, s72, 0
    v_dot2_f32_bf16 v27, v97, s73, 0
    v_dot2_f32_bf16 v28, v98, s72, 0
    v_dot2_f32_bf16 v29, v98, s73, 0
    v_dot2_f32_bf16 v30, v99, s72, 0
    v_dot2_f32_bf16 v31, v99, s73, 0
    v_accvgpr_read_b32 v100, a28
    v_accvgpr_read_b32 v101, a29
    v_accvgpr_read_b32 v102, a30
    v_accvgpr_read_b32 v103, a31
    v_dot2_f32_bf16 v24, v100, s72, v24
    v_dot2_f32_bf16 v25, v100, s73, v25
    v_dot2_f32_bf16 v26, v101, s72, v26
    v_dot2_f32_bf16 v27, v101, s73, v27
    v_dot2_f32_bf16 v28, v102, s72, v28
    v_dot2_f32_bf16 v29, v102, s73, v29
    v_dot2_f32_bf16 v30, v103, s72, v30
    v_dot2_f32_bf16 v31, v103, s73, v31
    v_accvgpr_read_b32 v96, a44
    v_accvgpr_read_b32 v97, a45
    v_accvgpr_read_b32 v98, a46
    v_accvgpr_read_b32 v99, a47
    v_dot2_f32_bf16 v24, v96, s72, v24
    v_dot2_f32_bf16 v25, v96, s73, v25
    v_dot2_f32_bf16 v26, v97, s72, v26
    v_dot2_f32_bf16 v27, v97, s73, v27
    v_dot2_f32_bf16 v28, v98, s72, v28
    v_dot2_f32_bf16 v29, v98, s73, v29
    v_dot2_f32_bf16 v30, v99, s72, v30
    v_dot2_f32_bf16 v31, v99, s73, v31
    v_accvgpr_read_b32 v100, a60
    v_accvgpr_read_b32 v101, a61
    v_accvgpr_read_b32 v102, a62
    v_accvgpr_read_b32 v103, a63
    v_dot2_f32_bf16 v24, v100, s72, v24
    v_dot2_f32_bf16 v25, v100, s73, v25
    v_dot2_f32_bf16 v26, v101, s72, v26
    v_dot2_f32_bf16 v27, v101, s73, v27
    v_dot2_f32_bf16 v28, v102, s72, v28
    v_dot2_f32_bf16 v29, v102, s73, v29
    v_dot2_f32_bf16 v30, v103, s72, v30
    v_dot2_f32_bf16 v31, v103, s73, v31
    v_accvgpr_read_b32 v96, a76
    v_accvgpr_read_b32 v97, a77
    v_accvgpr_read_b32 v98, a78
    v_accvgpr_read_b32 v99, a79
    v_dot2_f32_bf16 v24, v96, s72, v24
    v_dot2_f32_bf16 v25, v96, s73, v25
    v_dot2_f32_bf16 v26, v97, s72, v26
    v_dot2_f32_bf16 v27, v97, s73, v27
    v_dot2_f32_bf16 v28, v98, s72, v28
    v_dot2_f32_bf16 v29, v98, s73, v29
    v_dot2_f32_bf16 v30, v99, s72, v30
    v_dot2_f32_bf16 v31, v99, s73, v31
    v_accvgpr_read_b32 v100, a92
    v_accvgpr_read_b32 v101, a93
    v_accvgpr_read_b32 v102, a94
    v_accvgpr_read_b32 v103, a95
    v_dot2_f32_bf16 v24, v100, s72, v24
    v_dot2_f32_bf16 v25, v100, s73, v25
    v_dot2_f32_bf16 v26, v101, s72, v26
    v_dot2_f32_bf16 v27, v101, s73, v27
    v_dot2_f32_bf16 v28, v102, s72, v28
    v_dot2_f32_bf16 v29, v102, s73, v29
    v_dot2_f32_bf16 v30, v103, s72, v30
    v_dot2_f32_bf16 v31, v103, s73, v31
    v_accvgpr_read_b32 v96, a108
    v_accvgpr_read_b32 v97, a109
    v_accvgpr_read_b32 v98, a110
    v_accvgpr_read_b32 v99, a111
    v_dot2_f32_bf16 v24, v96, s72, v24
    v_dot2_f32_bf16 v25, v96, s73, v25
    v_dot2_f32_bf16 v26, v97, s72, v26
    v_dot2_f32_bf16 v27, v97, s73, v27
    v_dot2_f32_bf16 v28, v98, s72, v28
    v_dot2_f32_bf16 v29, v98, s73, v29
    v_dot2_f32_bf16 v30, v99, s72, v30
    v_dot2_f32_bf16 v31, v99, s73, v31
    v_accvgpr_read_b32 v100, a124
    v_accvgpr_read_b32 v101, a125
    v_accvgpr_read_b32 v102, a126
    v_accvgpr_read_b32 v103, a127
    v_dot2_f32_bf16 v24, v100, s72, v24
    v_dot2_f32_bf16 v25, v100, s73, v25
    v_dot2_f32_bf16 v26, v101, s72, v26
    v_dot2_f32_bf16 v27, v101, s73, v27
    v_dot2_f32_bf16 v28, v102, s72, v28
    v_dot2_f32_bf16 v29, v102, s73, v29
    v_dot2_f32_bf16 v30, v103, s72, v30
    v_dot2_f32_bf16 v31, v103, s73, v31
    v_accvgpr_read_b32 v96, a140
    v_accvgpr_read_b32 v97, a141
    v_accvgpr_read_b32 v98, a142
    v_accvgpr_read_b32 v99, a143
    v_dot2_f32_bf16 v24, v96, s72, v24
    v_dot2_f32_bf16 v25, v96, s73, v25
    v_dot2_f32_bf16 v26, v97, s72, v26
    v_dot2_f32_bf16 v27, v97, s73, v27
    v_dot2_f32_bf16 v28, v98, s72, v28
    v_dot2_f32_bf16 v29, v98, s73, v29
    v_dot2_f32_bf16 v30, v99, s72, v30
    v_dot2_f32_bf16 v31, v99, s73, v31
    v_accvgpr_read_b32 v100, a156
    v_accvgpr_read_b32 v101, a157
    v_accvgpr_read_b32 v102, a158
    v_accvgpr_read_b32 v103, a159
    v_dot2_f32_bf16 v24, v100, s72, v24
    v_dot2_f32_bf16 v25, v100, s73, v25
    v_dot2_f32_bf16 v26, v101, s72, v26
    v_dot2_f32_bf16 v27, v101, s73, v27
    v_dot2_f32_bf16 v28, v102, s72, v28
    v_dot2_f32_bf16 v29, v102, s73, v29
    v_dot2_f32_bf16 v30, v103, s72, v30
    v_dot2_f32_bf16 v31, v103, s73, v31
    v_accvgpr_read_b32 v96, a172
    v_accvgpr_read_b32 v97, a173
    v_accvgpr_read_b32 v98, a174
    v_accvgpr_read_b32 v99, a175
    v_dot2_f32_bf16 v24, v96, s72, v24
    v_dot2_f32_bf16 v25, v96, s73, v25
    v_dot2_f32_bf16 v26, v97, s72, v26
    v_dot2_f32_bf16 v27, v97, s73, v27
    v_dot2_f32_bf16 v28, v98, s72, v28
    v_dot2_f32_bf16 v29, v98, s73, v29
    v_dot2_f32_bf16 v30, v99, s72, v30
    v_dot2_f32_bf16 v31, v99, s73, v31
    v_accvgpr_read_b32 v100, a188
    v_accvgpr_read_b32 v101, a189
    v_accvgpr_read_b32 v102, a190
    v_accvgpr_read_b32 v103, a191
    v_dot2_f32_bf16 v24, v100, s72, v24
    v_dot2_f32_bf16 v25, v100, s73, v25
    v_dot2_f32_bf16 v26, v101, s72, v26
    v_dot2_f32_bf16 v27, v101, s73, v27
    v_dot2_f32_bf16 v28, v102, s72, v28
    v_dot2_f32_bf16 v29, v102, s73, v29
    v_dot2_f32_bf16 v30, v103, s72, v30
    v_dot2_f32_bf16 v31, v103, s73, v31
    v_accvgpr_read_b32 v96, a204
    v_accvgpr_read_b32 v97, a205
    v_accvgpr_read_b32 v98, a206
    v_accvgpr_read_b32 v99, a207
    v_dot2_f32_bf16 v24, v96, s72, v24
    v_dot2_f32_bf16 v25, v96, s73, v25
    v_dot2_f32_bf16 v26, v97, s72, v26
    v_dot2_f32_bf16 v27, v97, s73, v27
    v_dot2_f32_bf16 v28, v98, s72, v28
    v_dot2_f32_bf16 v29, v98, s73, v29
    v_dot2_f32_bf16 v30, v99, s72, v30
    v_dot2_f32_bf16 v31, v99, s73, v31
    v_accvgpr_read_b32 v100, a220
    v_accvgpr_read_b32 v101, a221
    v_accvgpr_read_b32 v102, a222
    v_accvgpr_read_b32 v103, a223
    v_dot2_f32_bf16 v24, v100, s72, v24
    v_dot2_f32_bf16 v25, v100, s73, v25
    v_dot2_f32_bf16 v26, v101, s72, v26
    v_dot2_f32_bf16 v27, v101, s73, v27
    v_dot2_f32_bf16 v28, v102, s72, v28
    v_dot2_f32_bf16 v29, v102, s73, v29
    v_dot2_f32_bf16 v30, v103, s72, v30
    v_dot2_f32_bf16 v31, v103, s73, v31
    v_accvgpr_read_b32 v96, a236
    v_accvgpr_read_b32 v97, a237
    v_accvgpr_read_b32 v98, a238
    v_accvgpr_read_b32 v99, a239
    v_dot2_f32_bf16 v24, v96, s72, v24
    v_dot2_f32_bf16 v25, v96, s73, v25
    v_dot2_f32_bf16 v26, v97, s72, v26
    v_dot2_f32_bf16 v27, v97, s73, v27
    v_dot2_f32_bf16 v28, v98, s72, v28
    v_dot2_f32_bf16 v29, v98, s73, v29
    v_dot2_f32_bf16 v30, v99, s72, v30
    v_dot2_f32_bf16 v31, v99, s73, v31
    v_accvgpr_read_b32 v100, a252
    v_accvgpr_read_b32 v101, a253
    v_accvgpr_read_b32 v102, a254
    v_accvgpr_read_b32 v103, a255
    v_dot2_f32_bf16 v24, v100, s72, v24
    v_dot2_f32_bf16 v25, v100, s73, v25
    v_dot2_f32_bf16 v26, v101, s72, v26
    v_dot2_f32_bf16 v27, v101, s73, v27
    v_dot2_f32_bf16 v28, v102, s72, v28
    v_dot2_f32_bf16 v29, v102, s73, v29
    v_dot2_f32_bf16 v30, v103, s72, v30
    v_dot2_f32_bf16 v31, v103, s73, v31
    v_cvt_pk_bf16_f32 v24, v24, v24
    v_and_b32 v24, 0xffff0000, v24
    v_cvt_pk_bf16_f32 v25, v25, v25
    v_and_b32 v25, 0xffff0000, v25
    v_cvt_pk_bf16_f32 v26, v26, v26
    v_and_b32 v26, 0xffff0000, v26
    v_cvt_pk_bf16_f32 v27, v27, v27
    v_and_b32 v27, 0xffff0000, v27
    v_cvt_pk_bf16_f32 v28, v28, v28
    v_and_b32 v28, 0xffff0000, v28
    v_cvt_pk_bf16_f32 v29, v29, v29
    v_and_b32 v29, 0xffff0000, v29
    v_cvt_pk_bf16_f32 v30, v30, v30
    v_and_b32 v30, 0xffff0000, v30
    v_cvt_pk_bf16_f32 v31, v31, v31
    v_and_b32 v31, 0xffff0000, v31
    v_mul_f32 v54, 0xbfb8aa3b, v24
    v_mul_f32 v55, 0xbfb8aa3b, v25
    v_mul_f32 v56, 0xbfb8aa3b, v26
    v_mul_f32 v57, 0xbfb8aa3b, v27
    v_mul_f32 v58, 0xbfb8aa3b, v28
    v_mul_f32 v59, 0xbfb8aa3b, v29
    v_mul_f32 v60, 0xbfb8aa3b, v30
    v_mul_f32 v61, 0xbfb8aa3b, v31
    v_exp_f32 v54, v54
    v_exp_f32 v55, v55
    v_exp_f32 v56, v56
    v_exp_f32 v57, v57
    v_exp_f32 v58, v58
    v_exp_f32 v59, v59
    v_exp_f32 v60, v60
    v_exp_f32 v61, v61
    v_add_f32 v54, 1.0, v54
    v_add_f32 v55, 1.0, v55
    v_add_f32 v56, 1.0, v56
    v_add_f32 v57, 1.0, v57
    v_add_f32 v58, 1.0, v58
    v_add_f32 v59, 1.0, v59
    v_add_f32 v60, 1.0, v60
    v_add_f32 v61, 1.0, v61
    v_rcp_f32 v54, v54
    v_rcp_f32 v55, v55
    v_rcp_f32 v56, v56
    v_rcp_f32 v57, v57
    v_rcp_f32 v58, v58
    v_rcp_f32 v59, v59
    v_rcp_f32 v60, v60
    v_rcp_f32 v61, v61
    v_mul_f32 v24, v24, v54
    v_mul_f32 v25, v25, v55
    v_mul_f32 v26, v26, v56
    v_mul_f32 v27, v27, v57
    v_mul_f32 v28, v28, v58
    v_mul_f32 v29, v29, v59
    v_mul_f32 v30, v30, v60
    v_mul_f32 v31, v31, v61
    v_cvt_pk_bf16_f32 v24, v24, v24
    v_and_b32 v24, 0xffff0000, v24
    v_cvt_pk_bf16_f32 v25, v25, v25
    v_and_b32 v25, 0xffff0000, v25
    v_cvt_pk_bf16_f32 v26, v26, v26
    v_and_b32 v26, 0xffff0000, v26
    v_cvt_pk_bf16_f32 v27, v27, v27
    v_and_b32 v27, 0xffff0000, v27
    v_cvt_pk_bf16_f32 v28, v28, v28
    v_and_b32 v28, 0xffff0000, v28
    v_cvt_pk_bf16_f32 v29, v29, v29
    v_and_b32 v29, 0xffff0000, v29
    v_cvt_pk_bf16_f32 v30, v30, v30
    v_and_b32 v30, 0xffff0000, v30
    v_cvt_pk_bf16_f32 v31, v31, v31
    v_and_b32 v31, 0xffff0000, v31
    s_cmp_eq_u32 s74, 0x63
    s_cbranch_scc1 L_haveB
    s_cmp_ge_u32 s75, 15
    s_cbranch_scc1 L_pdone_B
    v_mov_b32 v75, 0
    s_mov_b32 s58, 0
L_poll_B:
    buffer_load_dwordx2 v[76:77], v75, s[36:39], s97 offen sc1
    s_waitcnt vmcnt(0)
    v_readfirstlane_b32 s59, v76
    v_readfirstlane_b32 s60, v77
    s_add_u32 s58, s58, 1
    s_nop 3
    s_cmp_ge_u32 s60, 15
    s_cbranch_scc1 L_pdone_B
    s_sleep 2
    s_cmp_lt_u32 s58, 0x40000
    s_cbranch_scc1 L_poll_B
L_pdone_B:
    s_mul_i32 s61, s44, 0x1c0000
    s_add_u32 s61, s61, 0x1c00000
    buffer_load_dwordx4 v[192:195], v14, s[36:39], s61 offen sc1
    s_add_u32 s62, s61, 0x1c000
    buffer_load_dwordx4 v[196:199], v14, s[36:39], s62 offen sc1
    s_add_u32 s61, s62, 0x1c000
    buffer_load_dwordx4 v[200:203], v14, s[36:39], s61 offen sc1
    s_add_u32 s62, s61, 0x1c000
    buffer_load_dwordx4 v[204:207], v14, s[36:39], s62 offen sc1
    s_add_u32 s61, s62, 0x1c000
    buffer_load_dwordx4 v[208:211], v14, s[36:39], s61 offen sc1
    s_add_u32 s62, s61, 0x1c000
    buffer_load_dwordx4 v[212:215], v14, s[36:39], s62 offen sc1
    s_add_u32 s61, s62, 0x1c000
    buffer_load_dwordx4 v[216:219], v14, s[36:39], s61 offen sc1
    s_add_u32 s62, s61, 0x1c000
    buffer_load_dwordx4 v[220:223], v14, s[36:39], s62 offen sc1
    s_add_u32 s61, s62, 0x1c000
    buffer_load_dwordx4 v[224:227], v14, s[36:39], s61 offen sc1
    s_add_u32 s62, s61, 0x1c000
    buffer_load_dwordx4 v[228:231], v14, s[36:39], s62 offen sc1
    s_add_u32 s61, s62, 0x1c000
    buffer_load_dwordx4 v[232:235], v14, s[36:39], s61 offen sc1
    s_add_u32 s62, s61, 0x1c000
    buffer_load_dwordx4 v[236:239], v14, s[36:39], s62 offen sc1
    s_add_u32 s61, s62, 0x1c000
    buffer_load_dwordx4 v[240:243], v14, s[36:39], s61 offen sc1
    s_add_u32 s62, s61, 0x1c000
    buffer_load_dwordx4 v[244:247], v14, s[36:39], s62 offen sc1
    s_add_u32 s61, s62, 0x1c000
    buffer_load_dwordx4 v[248:251], v14, s[36:39], s61 offen sc1
    s_add_u32 s62, s61, 0x1c000
    buffer_load_dwordx4 v[252:255], v14, s[36:39], s62 offen sc1
L_haveB:
    s_waitcnt vmcnt(16)
    v_dot2_f32_bf16 v32, v128, s72, 0
    v_dot2_f32_bf16 v33, v128, s73, 0
    v_dot2_f32_bf16 v34, v129, s72, 0
    v_dot2_f32_bf16 v35, v129, s73, 0
    v_dot2_f32_bf16 v36, v130, s72, 0
    v_dot2_f32_bf16 v37, v130, s73, 0
    v_dot2_f32_bf16 v38, v131, s72, 0
    v_dot2_f32_bf16 v39, v131, s73, 0
    v_dot2_f32_bf16 v32, v132, s72, v32
    v_dot2_f32_bf16 v33, v132, s73, v33
    v_dot2_f32_bf16 v34, v133, s72, v34
    v_dot2_f32_bf16 v35, v133, s73, v35
    v_dot2_f32_bf16 v36, v134, s72, v36
    v_dot2_f32_bf16 v37, v134, s73, v37
    v_dot2_f32_bf16 v38, v135, s72, v38
    v_dot2_f32_bf16 v39, v135, s73, v39
    v_dot2_f32_bf16 v32, v136, s72, v32
    v_dot2_f32_bf16 v33, v136, s73, v33
    v_dot2_f32_bf16 v34, v137, s72, v34
    v_dot2_f32_bf16 v35, v137, s73, v35
    v_dot2_f32_bf16 v36, v138, s72, v36
    v_dot2_f32_bf16 v37, v138, s73, v37
    v_dot2_f32_bf16 v38, v139, s72, v38
    v_dot2_f32_bf16 v39, v139, s73, v39
    v_dot2_f32_bf16 v32, v140, s72, v32
    v_dot2_f32_bf16 v33, v140, s73, v33
    v_dot2_f32_bf16 v34, v141, s72, v34
    v_dot2_f32_bf16 v35, v141, s73, v35
    v_dot2_f32_bf16 v36, v142, s72, v36
    v_dot2_f32_bf16 v37, v142, s73, v37
    v_dot2_f32_bf16 v38, v143, s72, v38
    v_dot2_f32_bf16 v39, v143, s73, v39
    v_dot2_f32_bf16 v32, v144, s72, v32
    v_dot2_f32_bf16 v33, v144, s73, v33
    v_dot2_f32_bf16 v34, v145, s72, v34
    v_dot2_f32_bf16 v35, v145, s73, v35
    v_dot2_f32_bf16 v36, v146, s72, v36
    v_dot2_f32_bf16 v37, v146, s73, v37
    v_dot2_f32_bf16 v38, v147, s72, v38
    v_dot2_f32_bf16 v39, v147, s73, v39
    v_dot2_f32_bf16 v32, v148, s72, v32
    v_dot2_f32_bf16 v33, v148, s73, v33
    v_dot2_f32_bf16 v34, v149, s72, v34
    v_dot2_f32_bf16 v35, v149, s73, v35
    v_dot2_f32_bf16 v36, v150, s72, v36
    v_dot2_f32_bf16 v37, v150, s73, v37
    v_dot2_f32_bf16 v38, v151, s72, v38
    v_dot2_f32_bf16 v39, v151, s73, v39
    v_dot2_f32_bf16 v32, v152, s72, v32
    v_dot2_f32_bf16 v33, v152, s73, v33
    v_dot2_f32_bf16 v34, v153, s72, v34
    v_dot2_f32_bf16 v35, v153, s73, v35
    v_dot2_f32_bf16 v36, v154, s72, v36
    v_dot2_f32_bf16 v37, v154, s73, v37
    v_dot2_f32_bf16 v38, v155, s72, v38
    v_dot2_f32_bf16 v39, v155, s73, v39
    v_dot2_f32_bf16 v32, v156, s72, v32
    v_dot2_f32_bf16 v33, v156, s73, v33
    v_dot2_f32_bf16 v34, v157, s72, v34
    v_dot2_f32_bf16 v35, v157, s73, v35
    v_dot2_f32_bf16 v36, v158, s72, v36
    v_dot2_f32_bf16 v37, v158, s73, v37
    v_dot2_f32_bf16 v38, v159, s72, v38
    v_dot2_f32_bf16 v39, v159, s73, v39
    v_dot2_f32_bf16 v32, v160, s72, v32
    v_dot2_f32_bf16 v33, v160, s73, v33
    v_dot2_f32_bf16 v34, v161, s72, v34
    v_dot2_f32_bf16 v35, v161, s73, v35
    v_dot2_f32_bf16 v36, v162, s72, v36
    v_dot2_f32_bf16 v37, v162, s73, v37
    v_dot2_f32_bf16 v38, v163, s72, v38
    v_dot2_f32_bf16 v39, v163, s73, v39
    v_dot2_f32_bf16 v32, v164, s72, v32
    v_dot2_f32_bf16 v33, v164, s73, v33
    v_dot2_f32_bf16 v34, v165, s72, v34
    v_dot2_f32_bf16 v35, v165, s73, v35
    v_dot2_f32_bf16 v36, v166, s72, v36
    v_dot2_f32_bf16 v37, v166, s73, v37
    v_dot2_f32_bf16 v38, v167, s72, v38
    v_dot2_f32_bf16 v39, v167, s73, v39
    v_dot2_f32_bf16 v32, v168, s72, v32
    v_dot2_f32_bf16 v33, v168, s73, v33
    v_dot2_f32_bf16 v34, v169, s72, v34
    v_dot2_f32_bf16 v35, v169, s73, v35
    v_dot2_f32_bf16 v36, v170, s72, v36
    v_dot2_f32_bf16 v37, v170, s73, v37
    v_dot2_f32_bf16 v38, v171, s72, v38
    v_dot2_f32_bf16 v39, v171, s73, v39
    v_dot2_f32_bf16 v32, v172, s72, v32
    v_dot2_f32_bf16 v33, v172, s73, v33
    v_dot2_f32_bf16 v34, v173, s72, v34
    v_dot2_f32_bf16 v35, v173, s73, v35
    v_dot2_f32_bf16 v36, v174, s72, v36
    v_dot2_f32_bf16 v37, v174, s73, v37
    v_dot2_f32_bf16 v38, v175, s72, v38
    v_dot2_f32_bf16 v39, v175, s73, v39
    v_dot2_f32_bf16 v32, v176, s72, v32
    v_dot2_f32_bf16 v33, v176, s73, v33
    v_dot2_f32_bf16 v34, v177, s72, v34
    v_dot2_f32_bf16 v35, v177, s73, v35
    v_dot2_f32_bf16 v36, v178, s72, v36
    v_dot2_f32_bf16 v37, v178, s73, v37
    v_dot2_f32_bf16 v38, v179, s72, v38
    v_dot2_f32_bf16 v39, v179, s73, v39
    v_dot2_f32_bf16 v32, v180, s72, v32
    v_dot2_f32_bf16 v33, v180, s73, v33
    v_dot2_f32_bf16 v34, v181, s72, v34
    v_dot2_f32_bf16 v35, v181, s73, v35
    v_dot2_f32_bf16 v36, v182, s72, v36
    v_dot2_f32_bf16 v37, v182, s73, v37
    v_dot2_f32_bf16 v38, v183, s72, v38
    v_dot2_f32_bf16 v39, v183, s73, v39
    v_dot2_f32_bf16 v32, v184, s72, v32
    v_dot2_f32_bf16 v33, v184, s73, v33
    v_dot2_f32_bf16 v34, v185, s72, v34
    v_dot2_f32_bf16 v35, v185, s73, v35
    v_dot2_f32_bf16 v36, v186, s72, v36
    v_dot2_f32_bf16 v37, v186, s73, v37
    v_dot2_f32_bf16 v38, v187, s72, v38
    v_dot2_f32_bf16 v39, v187, s73, v39
    v_dot2_f32_bf16 v32, v188, s72, v32
    v_dot2_f32_bf16 v33, v188, s73, v33
    v_dot2_f32_bf16 v34, v189, s72, v34
    v_dot2_f32_bf16 v35, v189, s73, v35
    v_dot2_f32_bf16 v36, v190, s72, v36
    v_dot2_f32_bf16 v37, v190, s73, v37
    v_dot2_f32_bf16 v38, v191, s72, v38
    v_dot2_f32_bf16 v39, v191, s73, v39
    s_waitcnt vmcnt(0)
    v_dot2_f32_bf16 v40, v192, s72, 0
    v_dot2_f32_bf16 v41, v192, s73, 0
    v_dot2_f32_bf16 v42, v193, s72, 0
    v_dot2_f32_bf16 v43, v193, s73, 0
    v_dot2_f32_bf16 v44, v194, s72, 0
    v_dot2_f32_bf16 v45, v194, s73, 0
    v_dot2_f32_bf16 v46, v195, s72, 0
    v_dot2_f32_bf16 v47, v195, s73, 0
    v_dot2_f32_bf16 v40, v196, s72, v40
    v_dot2_f32_bf16 v41, v196, s73, v41
    v_dot2_f32_bf16 v42, v197, s72, v42
    v_dot2_f32_bf16 v43, v197, s73, v43
    v_dot2_f32_bf16 v44, v198, s72, v44
    v_dot2_f32_bf16 v45, v198, s73, v45
    v_dot2_f32_bf16 v46, v199, s72, v46
    v_dot2_f32_bf16 v47, v199, s73, v47
    v_dot2_f32_bf16 v40, v200, s72, v40
    v_dot2_f32_bf16 v41, v200, s73, v41
    v_dot2_f32_bf16 v42, v201, s72, v42
    v_dot2_f32_bf16 v43, v201, s73, v43
    v_dot2_f32_bf16 v44, v202, s72, v44
    v_dot2_f32_bf16 v45, v202, s73, v45
    v_dot2_f32_bf16 v46, v203, s72, v46
    v_dot2_f32_bf16 v47, v203, s73, v47
    v_dot2_f32_bf16 v40, v204, s72, v40
    v_dot2_f32_bf16 v41, v204, s73, v41
    v_dot2_f32_bf16 v42, v205, s72, v42
    v_dot2_f32_bf16 v43, v205, s73, v43
    v_dot2_f32_bf16 v44, v206, s72, v44
    v_dot2_f32_bf16 v45, v206, s73, v45
    v_dot2_f32_bf16 v46, v207, s72, v46
    v_dot2_f32_bf16 v47, v207, s73, v47
    v_dot2_f32_bf16 v40, v208, s72, v40
    v_dot2_f32_bf16 v41, v208, s73, v41
    v_dot2_f32_bf16 v42, v209, s72, v42
    v_dot2_f32_bf16 v43, v209, s73, v43
    v_dot2_f32_bf16 v44, v210, s72, v44
    v_dot2_f32_bf16 v45, v210, s73, v45
    v_dot2_f32_bf16 v46, v211, s72, v46
    v_dot2_f32_bf16 v47, v211, s73, v47
    v_dot2_f32_bf16 v40, v212, s72, v40
    v_dot2_f32_bf16 v41, v212, s73, v41
    v_dot2_f32_bf16 v42, v213, s72, v42
    v_dot2_f32_bf16 v43, v213, s73, v43
    v_dot2_f32_bf16 v44, v214, s72, v44
    v_dot2_f32_bf16 v45, v214, s73, v45
    v_dot2_f32_bf16 v46, v215, s72, v46
    v_dot2_f32_bf16 v47, v215, s73, v47
    v_dot2_f32_bf16 v40, v216, s72, v40
    v_dot2_f32_bf16 v41, v216, s73, v41
    v_dot2_f32_bf16 v42, v217, s72, v42
    v_dot2_f32_bf16 v43, v217, s73, v43
    v_dot2_f32_bf16 v44, v218, s72, v44
    v_dot2_f32_bf16 v45, v218, s73, v45
    v_dot2_f32_bf16 v46, v219, s72, v46
    v_dot2_f32_bf16 v47, v219, s73, v47
    v_dot2_f32_bf16 v40, v220, s72, v40
    v_dot2_f32_bf16 v41, v220, s73, v41
    v_dot2_f32_bf16 v42, v221, s72, v42
    v_dot2_f32_bf16 v43, v221, s73, v43
    v_dot2_f32_bf16 v44, v222, s72, v44
    v_dot2_f32_bf16 v45, v222, s73, v45
    v_dot2_f32_bf16 v46, v223, s72, v46
    v_dot2_f32_bf16 v47, v223, s73, v47
    v_dot2_f32_bf16 v40, v224, s72, v40
    v_dot2_f32_bf16 v41, v224, s73, v41
    v_dot2_f32_bf16 v42, v225, s72, v42
    v_dot2_f32_bf16 v43, v225, s73, v43
    v_dot2_f32_bf16 v44, v226, s72, v44
    v_dot2_f32_bf16 v45, v226, s73, v45
    v_dot2_f32_bf16 v46, v227, s72, v46
    v_dot2_f32_bf16 v47, v227, s73, v47
    v_dot2_f32_bf16 v40, v228, s72, v40
    v_dot2_f32_bf16 v41, v228, s73, v41
    v_dot2_f32_bf16 v42, v229, s72, v42
    v_dot2_f32_bf16 v43, v229, s73, v43
    v_dot2_f32_bf16 v44, v230, s72, v44
    v_dot2_f32_bf16 v45, v230, s73, v45
    v_dot2_f32_bf16 v46, v231, s72, v46
    v_dot2_f32_bf16 v47, v231, s73, v47
    v_dot2_f32_bf16 v40, v232, s72, v40
    v_dot2_f32_bf16 v41, v232, s73, v41
    v_dot2_f32_bf16 v42, v233, s72, v42
    v_dot2_f32_bf16 v43, v233, s73, v43
    v_dot2_f32_bf16 v44, v234, s72, v44
    v_dot2_f32_bf16 v45, v234, s73, v45
    v_dot2_f32_bf16 v46, v235, s72, v46
    v_dot2_f32_bf16 v47, v235, s73, v47
    v_dot2_f32_bf16 v40, v236, s72, v40
    v_dot2_f32_bf16 v41, v236, s73, v41
    v_dot2_f32_bf16 v42, v237, s72, v42
    v_dot2_f32_bf16 v43, v237, s73, v43
    v_dot2_f32_bf16 v44, v238, s72, v44
    v_dot2_f32_bf16 v45, v238, s73, v45
    v_dot2_f32_bf16 v46, v239, s72, v46
    v_dot2_f32_bf16 v47, v239, s73, v47
    v_dot2_f32_bf16 v40, v240, s72, v40
    v_dot2_f32_bf16 v41, v240, s73, v41
    v_dot2_f32_bf16 v42, v241, s72, v42
    v_dot2_f32_bf16 v43, v241, s73, v43
    v_dot2_f32_bf16 v44, v242, s72, v44
    v_dot2_f32_bf16 v45, v242, s73, v45
    v_dot2_f32_bf16 v46, v243, s72, v46
    v_dot2_f32_bf16 v47, v243, s73, v47
    v_dot2_f32_bf16 v40, v244, s72, v40
    v_dot2_f32_bf16 v41, v244, s73, v41
    v_dot2_f32_bf16 v42, v245, s72, v42
    v_dot2_f32_bf16 v43, v245, s73, v43
    v_dot2_f32_bf16 v44, v246, s72, v44
    v_dot2_f32_bf16 v45, v246, s73, v45
    v_dot2_f32_bf16 v46, v247, s72, v46
    v_dot2_f32_bf16 v47, v247, s73, v47
    v_dot2_f32_bf16 v40, v248, s72, v40
    v_dot2_f32_bf16 v41, v248, s73, v41
    v_dot2_f32_bf16 v42, v249, s72, v42
    v_dot2_f32_bf16 v43, v249, s73, v43
    v_dot2_f32_bf16 v44, v250, s72, v44
    v_dot2_f32_bf16 v45, v250, s73, v45
    v_dot2_f32_bf16 v46, v251, s72, v46
    v_dot2_f32_bf16 v47, v251, s73, v47
    v_dot2_f32_bf16 v40, v252, s72, v40
    v_dot2_f32_bf16 v41, v252, s73, v41
    v_dot2_f32_bf16 v42, v253, s72, v42
    v_dot2_f32_bf16 v43, v253, s73, v43
    v_dot2_f32_bf16 v44, v254, s72, v44
    v_dot2_f32_bf16 v45, v254, s73, v45
    v_dot2_f32_bf16 v46, v255, s72, v46
    v_dot2_f32_bf16 v47, v255, s73, v47
    v_cvt_pk_bf16_f32 v32, v32, v32
    v_and_b32 v32, 0xffff0000, v32
    v_cvt_pk_bf16_f32 v33, v33, v33
    v_and_b32 v33, 0xffff0000, v33
    v_cvt_pk_bf16_f32 v34, v34, v34
    v_and_b32 v34, 0xffff0000, v34
    v_cvt_pk_bf16_f32 v35, v35, v35
    v_and_b32 v35, 0xffff0000, v35
    v_cvt_pk_bf16_f32 v36, v36, v36
    v_and_b32 v36, 0xffff0000, v36
    v_cvt_pk_bf16_f32 v37, v37, v37
    v_and_b32 v37, 0xffff0000, v37
    v_cvt_pk_bf16_f32 v38, v38, v38
    v_and_b32 v38, 0xffff0000, v38
    v_cvt_pk_bf16_f32 v39, v39, v39
    v_and_b32 v39, 0xffff0000, v39
    v_mul_f32 v32, v32, v16
    v_mul_f32 v33, v33, v17
    v_mul_f32 v34, v34, v18
    v_mul_f32 v35, v35, v19
    v_mul_f32 v36, v36, v20
    v_mul_f32 v37, v37, v21
    v_mul_f32 v38, v38, v22
    v_mul_f32 v39, v39, v23
    v_cvt_pk_bf16_f32 v32, v32, v32
    v_and_b32 v32, 0xffff0000, v32
    v_cvt_pk_bf16_f32 v33, v33, v33
    v_and_b32 v33, 0xffff0000, v33
    v_cvt_pk_bf16_f32 v34, v34, v34
    v_and_b32 v34, 0xffff0000, v34
    v_cvt_pk_bf16_f32 v35, v35, v35
    v_and_b32 v35, 0xffff0000, v35
    v_cvt_pk_bf16_f32 v36, v36, v36
    v_and_b32 v36, 0xffff0000, v36
    v_cvt_pk_bf16_f32 v37, v37, v37
    v_and_b32 v37, 0xffff0000, v37
    v_cvt_pk_bf16_f32 v38, v38, v38
    v_and_b32 v38, 0xffff0000, v38
    v_cvt_pk_bf16_f32 v39, v39, v39
    v_and_b32 v39, 0xffff0000, v39
    v_lshlrev_b32 v96, 16, v62
    v_and_b32 v97, 0xffff0000, v62
    v_add_f32 v96, v96, v32
    v_add_f32 v97, v97, v33
    v_cvt_pk_bf16_f32 v62, v96, v97
    v_lshlrev_b32 v96, 16, v63
    v_and_b32 v97, 0xffff0000, v63
    v_add_f32 v96, v96, v34
    v_add_f32 v97, v97, v35
    v_cvt_pk_bf16_f32 v63, v96, v97
    buffer_store_dwordx2 v[62:63], v70, s[68:71], 0 offen
    v_lshlrev_b32 v96, 16, v64
    v_and_b32 v97, 0xffff0000, v64
    v_add_f32 v96, v96, v36
    v_add_f32 v97, v97, v37
    v_cvt_pk_bf16_f32 v64, v96, v97
    v_lshlrev_b32 v96, 16, v65
    v_and_b32 v97, 0xffff0000, v65
    v_add_f32 v96, v96, v38
    v_add_f32 v97, v97, v39
    v_cvt_pk_bf16_f32 v65, v96, v97
    buffer_store_dwordx2 v[64:65], v70, s[68:71], 0 offen offset:32
    v_cvt_pk_bf16_f32 v40, v40, v40
    v_and_b32 v40, 0xffff0000, v40
    v_cvt_pk_bf16_f32 v41, v41, v41
    v_and_b32 v41, 0xffff0000, v41
    v_cvt_pk_bf16_f32 v42, v42, v42
    v_and_b32 v42, 0xffff0000, v42
    v_cvt_pk_bf16_f32 v43, v43, v43
    v_and_b32 v43, 0xffff0000, v43
    v_cvt_pk_bf16_f32 v44, v44, v44
    v_and_b32 v44, 0xffff0000, v44
    v_cvt_pk_bf16_f32 v45, v45, v45
    v_and_b32 v45, 0xffff0000, v45
    v_cvt_pk_bf16_f32 v46, v46, v46
    v_and_b32 v46, 0xffff0000, v46
    v_cvt_pk_bf16_f32 v47, v47, v47
    v_and_b32 v47, 0xffff0000, v47
    v_mul_f32 v40, v40, v24
    v_mul_f32 v41, v41, v25
    v_mul_f32 v42, v42, v26
    v_mul_f32 v43, v43, v27
    v_mul_f32 v44, v44, v28
    v_mul_f32 v45, v45, v29
    v_mul_f32 v46, v46, v30
    v_mul_f32 v47, v47, v31
    v_cvt_pk_bf16_f32 v40, v40, v40
    v_and_b32 v40, 0xffff0000, v40
    v_cvt_pk_bf16_f32 v41, v41, v41
    v_and_b32 v41, 0xffff0000, v41
    v_cvt_pk_bf16_f32 v42, v42, v42
    v_and_b32 v42, 0xffff0000, v42
    v_cvt_pk_bf16_f32 v43, v43, v43
    v_and_b32 v43, 0xffff0000, v43
    v_cvt_pk_bf16_f32 v44, v44, v44
    v_and_b32 v44, 0xffff0000, v44
    v_cvt_pk_bf16_f32 v45, v45, v45
    v_and_b32 v45, 0xffff0000, v45
    v_cvt_pk_bf16_f32 v46, v46, v46
    v_and_b32 v46, 0xffff0000, v46
    v_cvt_pk_bf16_f32 v47, v47, v47
    v_and_b32 v47, 0xffff0000, v47
    v_lshlrev_b32 v96, 16, v66
    v_and_b32 v97, 0xffff0000, v66
    v_add_f32 v96, v96, v40
    v_add_f32 v97, v97, v41
    v_cvt_pk_bf16_f32 v66, v96, v97
    v_lshlrev_b32 v96, 16, v67
    v_and_b32 v97, 0xffff0000, v67
    v_add_f32 v96, v96, v42
    v_add_f32 v97, v97, v43
    v_cvt_pk_bf16_f32 v67, v96, v97
    buffer_store_dwordx2 v[66:67], v71, s[68:71], 0 offen
    v_lshlrev_b32 v96, 16, v68
    v_and_b32 v97, 0xffff0000, v68
    v_add_f32 v96, v96, v44
    v_add_f32 v97, v97, v45
    v_cvt_pk_bf16_f32 v68, v96, v97
    v_lshlrev_b32 v96, 16, v69
    v_and_b32 v97, 0xffff0000, v69
    v_add_f32 v96, v96, v46
    v_add_f32 v97, v97, v47
    v_cvt_pk_bf16_f32 v69, v96, v97
    buffer_store_dwordx2 v[68:69], v71, s[68:71], 0 offen offset:32
L_done:
    s_endpgm
L_stub_r1_p0:
    s_call_b64 s[40:41], L_r1_1
    s_branch L_ret_r1_p0
L_stub_r2_p1:
    s_call_b64 s[40:41], L_r2
    s_branch L_ret_r2_p1
L_stub_r1_p1:
    s_call_b64 s[40:41], L_r1_0
    s_branch L_ret_r1_p1
L_stub_r2_0:
    s_call_b64 s[40:41], L_r2
    s_branch L_ret_r2_0
L_stub_r1_0:
    s_call_b64 s[40:41], L_r1_1
    s_branch L_ret_r1_0
L_stub_r2_1:
    s_call_b64 s[40:41], L_r2
    s_branch L_ret_r2_1
L_stub_r1_1:
    s_call_b64 s[40:41], L_r1_0
    s_branch L_ret_r1_1
L_stub_r2_p28:
    s_call_b64 s[40:41], L_r2
    s_branch L_ret_r2_p28
L_stub_r1_p28:
    s_call_b64 s[40:41], L_r1_1
    s_branch L_ret_r1_p28
L_stub_r2_p29:
    s_call_b64 s[40:41], L_r2
    s_branch L_ret_r2_p29
L_stub_r1_p29:
    s_call_b64 s[40:41], L_r1_0
    s_branch L_ret_r1_p29
L_stub_r2_p30:
    s_call_b64 s[40:41], L_r2
    s_branch L_ret_r2_p30
L_stub_r1_p30:
    s_call_b64 s[40:41], L_r1_1
    s_branch L_ret_r1_p30
L_stub_r2_p31:
    s_call_b64 s[40:41], L_r2
    s_branch L_ret_r2_p31
L_r1_0:
    s_nop 7
    v_max3_f32 v44, v64, v65, v66
    v_max3_f32 v44, v44, v67, v68
    v_max3_f32 v44, v44, v69, v70
    v_max_f32 v44, v44, v71
    v_mov_b32 v45, v44
    s_nop 1
    v_permlane16_swap_b32 v44, v45
    v_max_f32 v44, v44, v45
    v_mov_b32 v45, v44
    s_nop 1
    v_permlane32_swap_b32 v44, v45
    v_max_f32 v44, v44, v45
    v_max_f32 v44, 0, v44
    v_sub_f32 v64, v64, v44
    v_sub_f32 v65, v65, v44
    v_sub_f32 v66, v66, v44
    v_sub_f32 v67, v67, v44
    v_sub_f32 v68, v68, v44
    v_sub_f32 v69, v69, v44
    v_sub_f32 v70, v70, v44
    v_sub_f32 v71, v71, v44
    v_sub_f32 v48, v48, v44
    v_sub_f32 v49, v49, v44
    v_sub_f32 v50, v50, v44
    v_sub_f32 v51, v51, v44
    v_exp_f32 v40, -v44
    s_nop 0
    v_mul_f32 v4, v4, v40
    v_max3_f32 v44, v72, v73, v74
    v_max3_f32 v44, v44, v75, v76
    v_max3_f32 v44, v44, v77, v78
    v_max_f32 v44, v44, v79
    v_mov_b32 v45, v44
    s_nop 1
    v_permlane16_swap_b32 v44, v45
    v_max_f32 v44, v44, v45
    v_mov_b32 v45, v44
    s_nop 1
    v_permlane32_swap_b32 v44, v45
    v_max_f32 v44, v44, v45
    v_max_f32 v44, 0, v44
    v_sub_f32 v72, v72, v44
    v_sub_f32 v73, v73, v44
    v_sub_f32 v74, v74, v44
    v_sub_f32 v75, v75, v44
    v_sub_f32 v76, v76, v44
    v_sub_f32 v77, v77, v44
    v_sub_f32 v78, v78, v44
    v_sub_f32 v79, v79, v44
    v_sub_f32 v52, v52, v44
    v_sub_f32 v53, v53, v44
    v_sub_f32 v54, v54, v44
    v_sub_f32 v55, v55, v44
    v_exp_f32 v41, -v44
    s_nop 0
    v_mul_f32 v5, v5, v41
    v_max3_f32 v44, v80, v81, v82
    v_max3_f32 v44, v44, v83, v84
    v_max3_f32 v44, v44, v85, v86
    v_max_f32 v44, v44, v87
    v_mov_b32 v45, v44
    s_nop 1
    v_permlane16_swap_b32 v44, v45
    v_max_f32 v44, v44, v45
    v_mov_b32 v45, v44
    s_nop 1
    v_permlane32_swap_b32 v44, v45
    v_max_f32 v44, v44, v45
    v_max_f32 v44, 0, v44
    v_sub_f32 v80, v80, v44
    v_sub_f32 v81, v81, v44
    v_sub_f32 v82, v82, v44
    v_sub_f32 v83, v83, v44
    v_sub_f32 v84, v84, v44
    v_sub_f32 v85, v85, v44
    v_sub_f32 v86, v86, v44
    v_sub_f32 v87, v87, v44
    v_sub_f32 v56, v56, v44
    v_sub_f32 v57, v57, v44
    v_sub_f32 v58, v58, v44
    v_sub_f32 v59, v59, v44
    v_exp_f32 v42, -v44
    s_nop 0
    v_mul_f32 v6, v6, v42
    v_max3_f32 v44, v88, v89, v90
    v_max3_f32 v44, v44, v91, v92
    v_max3_f32 v44, v44, v93, v94
    v_max_f32 v44, v44, v95
    v_mov_b32 v45, v44
    s_nop 1
    v_permlane16_swap_b32 v44, v45
    v_max_f32 v44, v44, v45
    v_mov_b32 v45, v44
    s_nop 1
    v_permlane32_swap_b32 v44, v45
    v_max_f32 v44, v44, v45
    v_max_f32 v44, 0, v44
    v_sub_f32 v88, v88, v44
    v_sub_f32 v89, v89, v44
    v_sub_f32 v90, v90, v44
    v_sub_f32 v91, v91, v44
    v_sub_f32 v92, v92, v44
    v_sub_f32 v93, v93, v44
    v_sub_f32 v94, v94, v44
    v_sub_f32 v95, v95, v44
    v_sub_f32 v60, v60, v44
    v_sub_f32 v61, v61, v44
    v_sub_f32 v62, v62, v44
    v_sub_f32 v63, v63, v44
    v_exp_f32 v43, -v44
    s_nop 0
    v_mul_f32 v7, v7, v43
    s_nop 3
    s_setpc_b64 s[40:41]
L_r1_1:
    s_nop 7
    v_max3_f32 v44, v96, v97, v98
    v_max3_f32 v44, v44, v99, v100
    v_max3_f32 v44, v44, v101, v102
    v_max_f32 v44, v44, v103
    v_mov_b32 v45, v44
    s_nop 1
    v_permlane16_swap_b32 v44, v45
    v_max_f32 v44, v44, v45
    v_mov_b32 v45, v44
    s_nop 1
    v_permlane32_swap_b32 v44, v45
    v_max_f32 v44, v44, v45
    v_max_f32 v44, 0, v44
    v_sub_f32 v96, v96, v44
    v_sub_f32 v97, v97, v44
    v_sub_f32 v98, v98, v44
    v_sub_f32 v99, v99, v44
    v_sub_f32 v100, v100, v44
    v_sub_f32 v101, v101, v44
    v_sub_f32 v102, v102, v44
    v_sub_f32 v103, v103, v44
    v_sub_f32 v48, v48, v44
    v_sub_f32 v49, v49, v44
    v_sub_f32 v50, v50, v44
    v_sub_f32 v51, v51, v44
    v_exp_f32 v40, -v44
    s_nop 0
    v_mul_f32 v4, v4, v40
    v_max3_f32 v44, v104, v105, v106
    v_max3_f32 v44, v44, v107, v108
    v_max3_f32 v44, v44, v109, v110
    v_max_f32 v44, v44, v111
    v_mov_b32 v45, v44
    s_nop 1
    v_permlane16_swap_b32 v44, v45
    v_max_f32 v44, v44, v45
    v_mov_b32 v45, v44
    s_nop 1
    v_permlane32_swap_b32 v44, v45
    v_max_f32 v44, v44, v45
    v_max_f32 v44, 0, v44
    v_sub_f32 v104, v104, v44
    v_sub_f32 v105, v105, v44
    v_sub_f32 v106, v106, v44
    v_sub_f32 v107, v107, v44
    v_sub_f32 v108, v108, v44
    v_sub_f32 v109, v109, v44
    v_sub_f32 v110, v110, v44
    v_sub_f32 v111, v111, v44
    v_sub_f32 v52, v52, v44
    v_sub_f32 v53, v53, v44
    v_sub_f32 v54, v54, v44
    v_sub_f32 v55, v55, v44
    v_exp_f32 v41, -v44
    s_nop 0
    v_mul_f32 v5, v5, v41
    v_max3_f32 v44, v112, v113, v114
    v_max3_f32 v44, v44, v115, v116
    v_max3_f32 v44, v44, v117, v118
    v_max_f32 v44, v44, v119
    v_mov_b32 v45, v44
    s_nop 1
    v_permlane16_swap_b32 v44, v45
    v_max_f32 v44, v44, v45
    v_mov_b32 v45, v44
    s_nop 1
    v_permlane32_swap_b32 v44, v45
    v_max_f32 v44, v44, v45
    v_max_f32 v44, 0, v44
    v_sub_f32 v112, v112, v44
    v_sub_f32 v113, v113, v44
    v_sub_f32 v114, v114, v44
    v_sub_f32 v115, v115, v44
    v_sub_f32 v116, v116, v44
    v_sub_f32 v117, v117, v44
    v_sub_f32 v118, v118, v44
    v_sub_f32 v119, v119, v44
    v_sub_f32 v56, v56, v44
    v_sub_f32 v57, v57, v44
    v_sub_f32 v58, v58, v44
    v_sub_f32 v59, v59, v44
    v_exp_f32 v42, -v44
    s_nop 0
    v_mul_f32 v6, v6, v42
    v_max3_f32 v44, v120, v121, v122
    v_max3_f32 v44, v44, v123, v124
    v_max3_f32 v44, v44, v125, v126
    v_max_f32 v44, v44, v127
    v_mov_b32 v45, v44
    s_nop 1
    v_permlane16_swap_b32 v44, v45
    v_max_f32 v44, v44, v45
    v_mov_b32 v45, v44
    s_nop 1
    v_permlane32_swap_b32 v44, v45
    v_max_f32 v44, v44, v45
    v_max_f32 v44, 0, v44
    v_sub_f32 v120, v120, v44
    v_sub_f32 v121, v121, v44
    v_sub_f32 v122, v122, v44
    v_sub_f32 v123, v123, v44
    v_sub_f32 v124, v124, v44
    v_sub_f32 v125, v125, v44
    v_sub_f32 v126, v126, v44
    v_sub_f32 v127, v127, v44
    v_sub_f32 v60, v60, v44
    v_sub_f32 v61, v61, v44
    v_sub_f32 v62, v62, v44
    v_sub_f32 v63, v63, v44
    v_exp_f32 v43, -v44
    s_nop 0
    v_mul_f32 v7, v7, v43
    s_nop 3
    s_setpc_b64 s[40:41]
L_r2:
    s_nop 15
    v_accvgpr_read_b32 v44, a0
    v_accvgpr_read_b32 v45, a1
    v_accvgpr_read_b32 v46, a2
    v_accvgpr_read_b32 v47, a3
    v_mul_f32 v44, v44, v40
    v_mul_f32 v45, v45, v40
    v_mul_f32 v46, v46, v40
    v_mul_f32 v47, v47, v40
    v_accvgpr_write_b32 a0, v44
    v_accvgpr_write_b32 a1, v45
    v_accvgpr_write_b32 a2, v46
    v_accvgpr_write_b32 a3, v47
    v_accvgpr_read_b32 v44, a4
    v_accvgpr_read_b32 v45, a5
    v_accvgpr_read_b32 v46, a6
    v_accvgpr_read_b32 v47, a7
    v_mul_f32 v44, v44, v41
    v_mul_f32 v45, v45, v41
    v_mul_f32 v46, v46, v41
    v_mul_f32 v47, v47, v41
    v_accvgpr_write_b32 a4, v44
    v_accvgpr_write_b32 a5, v45
    v_accvgpr_write_b32 a6, v46
    v_accvgpr_write_b32 a7, v47
    v_accvgpr_read_b32 v44, a8
    v_accvgpr_read_b32 v45, a9
    v_accvgpr_read_b32 v46, a10
    v_accvgpr_read_b32 v47, a11
    v_mul_f32 v44, v44, v42
    v_mul_f32 v45, v45, v42
    v_mul_f32 v46, v46, v42
    v_mul_f32 v47, v47, v42
    v_accvgpr_write_b32 a8, v44
    v_accvgpr_write_b32 a9, v45
    v_accvgpr_write_b32 a10, v46
    v_accvgpr_write_b32 a11, v47
    v_accvgpr_read_b32 v44, a12
    v_accvgpr_read_b32 v45, a13
    v_accvgpr_read_b32 v46, a14
    v_accvgpr_read_b32 v47, a15
    v_mul_f32 v44, v44, v43
    v_mul_f32 v45, v45, v43
    v_mul_f32 v46, v46, v43
    v_mul_f32 v47, v47, v43
    v_accvgpr_write_b32 a12, v44
    v_accvgpr_write_b32 a13, v45
    v_accvgpr_write_b32 a14, v46
    v_accvgpr_write_b32 a15, v47
    v_accvgpr_read_b32 v44, a16
    v_accvgpr_read_b32 v45, a17
    v_accvgpr_read_b32 v46, a18
    v_accvgpr_read_b32 v47, a19
    v_mul_f32 v44, v44, v40
    v_mul_f32 v45, v45, v40
    v_mul_f32 v46, v46, v40
    v_mul_f32 v47, v47, v40
    v_accvgpr_write_b32 a16, v44
    v_accvgpr_write_b32 a17, v45
    v_accvgpr_write_b32 a18, v46
    v_accvgpr_write_b32 a19, v47
    v_accvgpr_read_b32 v44, a20
    v_accvgpr_read_b32 v45, a21
    v_accvgpr_read_b32 v46, a22
    v_accvgpr_read_b32 v47, a23
    v_mul_f32 v44, v44, v41
    v_mul_f32 v45, v45, v41
    v_mul_f32 v46, v46, v41
    v_mul_f32 v47, v47, v41
    v_accvgpr_write_b32 a20, v44
    v_accvgpr_write_b32 a21, v45
    v_accvgpr_write_b32 a22, v46
    v_accvgpr_write_b32 a23, v47
    v_accvgpr_read_b32 v44, a24
    v_accvgpr_read_b32 v45, a25
    v_accvgpr_read_b32 v46, a26
    v_accvgpr_read_b32 v47, a27
    v_mul_f32 v44, v44, v42
    v_mul_f32 v45, v45, v42
    v_mul_f32 v46, v46, v42
    v_mul_f32 v47, v47, v42
    v_accvgpr_write_b32 a24, v44
    v_accvgpr_write_b32 a25, v45
    v_accvgpr_write_b32 a26, v46
    v_accvgpr_write_b32 a27, v47
    v_accvgpr_read_b32 v44, a28
    v_accvgpr_read_b32 v45, a29
    v_accvgpr_read_b32 v46, a30
    v_accvgpr_read_b32 v47, a31
    v_mul_f32 v44, v44, v43
    v_mul_f32 v45, v45, v43
    v_mul_f32 v46, v46, v43
    v_mul_f32 v47, v47, v43
    v_accvgpr_write_b32 a28, v44
    v_accvgpr_write_b32 a29, v45
    v_accvgpr_write_b32 a30, v46
    v_accvgpr_write_b32 a31, v47
    v_accvgpr_read_b32 v44, a32
    v_accvgpr_read_b32 v45, a33
    v_accvgpr_read_b32 v46, a34
    v_accvgpr_read_b32 v47, a35
    v_mul_f32 v44, v44, v40
    v_mul_f32 v45, v45, v40
    v_mul_f32 v46, v46, v40
    v_mul_f32 v47, v47, v40
    v_accvgpr_write_b32 a32, v44
    v_accvgpr_write_b32 a33, v45
    v_accvgpr_write_b32 a34, v46
    v_accvgpr_write_b32 a35, v47
    v_accvgpr_read_b32 v44, a36
    v_accvgpr_read_b32 v45, a37
    v_accvgpr_read_b32 v46, a38
    v_accvgpr_read_b32 v47, a39
    v_mul_f32 v44, v44, v41
    v_mul_f32 v45, v45, v41
    v_mul_f32 v46, v46, v41
    v_mul_f32 v47, v47, v41
    v_accvgpr_write_b32 a36, v44
    v_accvgpr_write_b32 a37, v45
    v_accvgpr_write_b32 a38, v46
    v_accvgpr_write_b32 a39, v47
    v_accvgpr_read_b32 v44, a40
    v_accvgpr_read_b32 v45, a41
    v_accvgpr_read_b32 v46, a42
    v_accvgpr_read_b32 v47, a43
    v_mul_f32 v44, v44, v42
    v_mul_f32 v45, v45, v42
    v_mul_f32 v46, v46, v42
    v_mul_f32 v47, v47, v42
    v_accvgpr_write_b32 a40, v44
    v_accvgpr_write_b32 a41, v45
    v_accvgpr_write_b32 a42, v46
    v_accvgpr_write_b32 a43, v47
    v_accvgpr_read_b32 v44, a44
    v_accvgpr_read_b32 v45, a45
    v_accvgpr_read_b32 v46, a46
    v_accvgpr_read_b32 v47, a47
    v_mul_f32 v44, v44, v43
    v_mul_f32 v45, v45, v43
    v_mul_f32 v46, v46, v43
    v_mul_f32 v47, v47, v43
    v_accvgpr_write_b32 a44, v44
    v_accvgpr_write_b32 a45, v45
    v_accvgpr_write_b32 a46, v46
    v_accvgpr_write_b32 a47, v47
    v_accvgpr_read_b32 v44, a48
    v_accvgpr_read_b32 v45, a49
    v_accvgpr_read_b32 v46, a50
    v_accvgpr_read_b32 v47, a51
    v_mul_f32 v44, v44, v40
    v_mul_f32 v45, v45, v40
    v_mul_f32 v46, v46, v40
    v_mul_f32 v47, v47, v40
    v_accvgpr_write_b32 a48, v44
    v_accvgpr_write_b32 a49, v45
    v_accvgpr_write_b32 a50, v46
    v_accvgpr_write_b32 a51, v47
    v_accvgpr_read_b32 v44, a52
    v_accvgpr_read_b32 v45, a53
    v_accvgpr_read_b32 v46, a54
    v_accvgpr_read_b32 v47, a55
    v_mul_f32 v44, v44, v41
    v_mul_f32 v45, v45, v41
    v_mul_f32 v46, v46, v41
    v_mul_f32 v47, v47, v41
    v_accvgpr_write_b32 a52, v44
    v_accvgpr_write_b32 a53, v45
    v_accvgpr_write_b32 a54, v46
    v_accvgpr_write_b32 a55, v47
    v_accvgpr_read_b32 v44, a56
    v_accvgpr_read_b32 v45, a57
    v_accvgpr_read_b32 v46, a58
    v_accvgpr_read_b32 v47, a59
    v_mul_f32 v44, v44, v42
    v_mul_f32 v45, v45, v42
    v_mul_f32 v46, v46, v42
    v_mul_f32 v47, v47, v42
    v_accvgpr_write_b32 a56, v44
    v_accvgpr_write_b32 a57, v45
    v_accvgpr_write_b32 a58, v46
    v_accvgpr_write_b32 a59, v47
    v_accvgpr_read_b32 v44, a60
    v_accvgpr_read_b32 v45, a61
    v_accvgpr_read_b32 v46, a62
    v_accvgpr_read_b32 v47, a63
    v_mul_f32 v44, v44, v43
    v_mul_f32 v45, v45, v43
    v_mul_f32 v46, v46, v43
    v_mul_f32 v47, v47, v43
    v_accvgpr_write_b32 a60, v44
    v_accvgpr_write_b32 a61, v45
    v_accvgpr_write_b32 a62, v46
    v_accvgpr_write_b32 a63, v47
    v_accvgpr_read_b32 v44, a64
    v_accvgpr_read_b32 v45, a65
    v_accvgpr_read_b32 v46, a66
    v_accvgpr_read_b32 v47, a67
    v_mul_f32 v44, v44, v40
    v_mul_f32 v45, v45, v40
    v_mul_f32 v46, v46, v40
    v_mul_f32 v47, v47, v40
    v_accvgpr_write_b32 a64, v44
    v_accvgpr_write_b32 a65, v45
    v_accvgpr_write_b32 a66, v46
    v_accvgpr_write_b32 a67, v47
    v_accvgpr_read_b32 v44, a68
    v_accvgpr_read_b32 v45, a69
    v_accvgpr_read_b32 v46, a70
    v_accvgpr_read_b32 v47, a71
    v_mul_f32 v44, v44, v41
    v_mul_f32 v45, v45, v41
    v_mul_f32 v46, v46, v41
    v_mul_f32 v47, v47, v41
    v_accvgpr_write_b32 a68, v44
    v_accvgpr_write_b32 a69, v45
    v_accvgpr_write_b32 a70, v46
    v_accvgpr_write_b32 a71, v47
    v_accvgpr_read_b32 v44, a72
    v_accvgpr_read_b32 v45, a73
    v_accvgpr_read_b32 v46, a74
    v_accvgpr_read_b32 v47, a75
    v_mul_f32 v44, v44, v42
    v_mul_f32 v45, v45, v42
    v_mul_f32 v46, v46, v42
    v_mul_f32 v47, v47, v42
    v_accvgpr_write_b32 a72, v44
    v_accvgpr_write_b32 a73, v45
    v_accvgpr_write_b32 a74, v46
    v_accvgpr_write_b32 a75, v47
    v_accvgpr_read_b32 v44, a76
    v_accvgpr_read_b32 v45, a77
    v_accvgpr_read_b32 v46, a78
    v_accvgpr_read_b32 v47, a79
    v_mul_f32 v44, v44, v43
    v_mul_f32 v45, v45, v43
    v_mul_f32 v46, v46, v43
    v_mul_f32 v47, v47, v43
    v_accvgpr_write_b32 a76, v44
    v_accvgpr_write_b32 a77, v45
    v_accvgpr_write_b32 a78, v46
    v_accvgpr_write_b32 a79, v47
    v_accvgpr_read_b32 v44, a80
    v_accvgpr_read_b32 v45, a81
    v_accvgpr_read_b32 v46, a82
    v_accvgpr_read_b32 v47, a83
    v_mul_f32 v44, v44, v40
    v_mul_f32 v45, v45, v40
    v_mul_f32 v46, v46, v40
    v_mul_f32 v47, v47, v40
    v_accvgpr_write_b32 a80, v44
    v_accvgpr_write_b32 a81, v45
    v_accvgpr_write_b32 a82, v46
    v_accvgpr_write_b32 a83, v47
    v_accvgpr_read_b32 v44, a84
    v_accvgpr_read_b32 v45, a85
    v_accvgpr_read_b32 v46, a86
    v_accvgpr_read_b32 v47, a87
    v_mul_f32 v44, v44, v41
    v_mul_f32 v45, v45, v41
    v_mul_f32 v46, v46, v41
    v_mul_f32 v47, v47, v41
    v_accvgpr_write_b32 a84, v44
    v_accvgpr_write_b32 a85, v45
    v_accvgpr_write_b32 a86, v46
    v_accvgpr_write_b32 a87, v47
    v_accvgpr_read_b32 v44, a88
    v_accvgpr_read_b32 v45, a89
    v_accvgpr_read_b32 v46, a90
    v_accvgpr_read_b32 v47, a91
    v_mul_f32 v44, v44, v42
    v_mul_f32 v45, v45, v42
    v_mul_f32 v46, v46, v42
    v_mul_f32 v47, v47, v42
    v_accvgpr_write_b32 a88, v44
    v_accvgpr_write_b32 a89, v45
    v_accvgpr_write_b32 a90, v46
    v_accvgpr_write_b32 a91, v47
    v_accvgpr_read_b32 v44, a92
    v_accvgpr_read_b32 v45, a93
    v_accvgpr_read_b32 v46, a94
    v_accvgpr_read_b32 v47, a95
    v_mul_f32 v44, v44, v43
    v_mul_f32 v45, v45, v43
    v_mul_f32 v46, v46, v43
    v_mul_f32 v47, v47, v43
    v_accvgpr_write_b32 a92, v44
    v_accvgpr_write_b32 a93, v45
    v_accvgpr_write_b32 a94, v46
    v_accvgpr_write_b32 a95, v47
    v_accvgpr_read_b32 v44, a96
    v_accvgpr_read_b32 v45, a97
    v_accvgpr_read_b32 v46, a98
    v_accvgpr_read_b32 v47, a99
    v_mul_f32 v44, v44, v40
    v_mul_f32 v45, v45, v40
    v_mul_f32 v46, v46, v40
    v_mul_f32 v47, v47, v40
    v_accvgpr_write_b32 a96, v44
    v_accvgpr_write_b32 a97, v45
    v_accvgpr_write_b32 a98, v46
    v_accvgpr_write_b32 a99, v47
    v_accvgpr_read_b32 v44, a100
    v_accvgpr_read_b32 v45, a101
    v_accvgpr_read_b32 v46, a102
    v_accvgpr_read_b32 v47, a103
    v_mul_f32 v44, v44, v41
    v_mul_f32 v45, v45, v41
    v_mul_f32 v46, v46, v41
    v_mul_f32 v47, v47, v41
    v_accvgpr_write_b32 a100, v44
    v_accvgpr_write_b32 a101, v45
    v_accvgpr_write_b32 a102, v46
    v_accvgpr_write_b32 a103, v47
    v_accvgpr_read_b32 v44, a104
    v_accvgpr_read_b32 v45, a105
    v_accvgpr_read_b32 v46, a106
    v_accvgpr_read_b32 v47, a107
    v_mul_f32 v44, v44, v42
    v_mul_f32 v45, v45, v42
    v_mul_f32 v46, v46, v42
    v_mul_f32 v47, v47, v42
    v_accvgpr_write_b32 a104, v44
    v_accvgpr_write_b32 a105, v45
    v_accvgpr_write_b32 a106, v46
    v_accvgpr_write_b32 a107, v47
    v_accvgpr_read_b32 v44, a108
    v_accvgpr_read_b32 v45, a109
    v_accvgpr_read_b32 v46, a110
    v_accvgpr_read_b32 v47, a111
    v_mul_f32 v44, v44, v43
    v_mul_f32 v45, v45, v43
    v_mul_f32 v46, v46, v43
    v_mul_f32 v47, v47, v43
    v_accvgpr_write_b32 a108, v44
    v_accvgpr_write_b32 a109, v45
    v_accvgpr_write_b32 a110, v46
    v_accvgpr_write_b32 a111, v47
    v_accvgpr_read_b32 v44, a112
    v_accvgpr_read_b32 v45, a113
    v_accvgpr_read_b32 v46, a114
    v_accvgpr_read_b32 v47, a115
    v_mul_f32 v44, v44, v40
    v_mul_f32 v45, v45, v40
    v_mul_f32 v46, v46, v40
    v_mul_f32 v47, v47, v40
    v_accvgpr_write_b32 a112, v44
    v_accvgpr_write_b32 a113, v45
    v_accvgpr_write_b32 a114, v46
    v_accvgpr_write_b32 a115, v47
    v_accvgpr_read_b32 v44, a116
    v_accvgpr_read_b32 v45, a117
    v_accvgpr_read_b32 v46, a118
    v_accvgpr_read_b32 v47, a119
    v_mul_f32 v44, v44, v41
    v_mul_f32 v45, v45, v41
    v_mul_f32 v46, v46, v41
    v_mul_f32 v47, v47, v41
    v_accvgpr_write_b32 a116, v44
    v_accvgpr_write_b32 a117, v45
    v_accvgpr_write_b32 a118, v46
    v_accvgpr_write_b32 a119, v47
    v_accvgpr_read_b32 v44, a120
    v_accvgpr_read_b32 v45, a121
    v_accvgpr_read_b32 v46, a122
    v_accvgpr_read_b32 v47, a123
    v_mul_f32 v44, v44, v42
    v_mul_f32 v45, v45, v42
    v_mul_f32 v46, v46, v42
    v_mul_f32 v47, v47, v42
    v_accvgpr_write_b32 a120, v44
    v_accvgpr_write_b32 a121, v45
    v_accvgpr_write_b32 a122, v46
    v_accvgpr_write_b32 a123, v47
    v_accvgpr_read_b32 v44, a124
    v_accvgpr_read_b32 v45, a125
    v_accvgpr_read_b32 v46, a126
    v_accvgpr_read_b32 v47, a127
    v_mul_f32 v44, v44, v43
    v_mul_f32 v45, v45, v43
    v_mul_f32 v46, v46, v43
    v_mul_f32 v47, v47, v43
    v_accvgpr_write_b32 a124, v44
    v_accvgpr_write_b32 a125, v45
    v_accvgpr_write_b32 a126, v46
    v_accvgpr_write_b32 a127, v47
    v_accvgpr_read_b32 v44, a128
    v_accvgpr_read_b32 v45, a129
    v_accvgpr_read_b32 v46, a130
    v_accvgpr_read_b32 v47, a131
    v_mul_f32 v44, v44, v40
    v_mul_f32 v45, v45, v40
    v_mul_f32 v46, v46, v40
    v_mul_f32 v47, v47, v40
    v_accvgpr_write_b32 a128, v44
    v_accvgpr_write_b32 a129, v45
    v_accvgpr_write_b32 a130, v46
    v_accvgpr_write_b32 a131, v47
    v_accvgpr_read_b32 v44, a132
    v_accvgpr_read_b32 v45, a133
    v_accvgpr_read_b32 v46, a134
    v_accvgpr_read_b32 v47, a135
    v_mul_f32 v44, v44, v41
    v_mul_f32 v45, v45, v41
    v_mul_f32 v46, v46, v41
    v_mul_f32 v47, v47, v41
    v_accvgpr_write_b32 a132, v44
    v_accvgpr_write_b32 a133, v45
    v_accvgpr_write_b32 a134, v46
    v_accvgpr_write_b32 a135, v47
    v_accvgpr_read_b32 v44, a136
    v_accvgpr_read_b32 v45, a137
    v_accvgpr_read_b32 v46, a138
    v_accvgpr_read_b32 v47, a139
    v_mul_f32 v44, v44, v42
    v_mul_f32 v45, v45, v42
    v_mul_f32 v46, v46, v42
    v_mul_f32 v47, v47, v42
    v_accvgpr_write_b32 a136, v44
    v_accvgpr_write_b32 a137, v45
    v_accvgpr_write_b32 a138, v46
    v_accvgpr_write_b32 a139, v47
    v_accvgpr_read_b32 v44, a140
    v_accvgpr_read_b32 v45, a141
    v_accvgpr_read_b32 v46, a142
    v_accvgpr_read_b32 v47, a143
    v_mul_f32 v44, v44, v43
    v_mul_f32 v45, v45, v43
    v_mul_f32 v46, v46, v43
    v_mul_f32 v47, v47, v43
    v_accvgpr_write_b32 a140, v44
    v_accvgpr_write_b32 a141, v45
    v_accvgpr_write_b32 a142, v46
    v_accvgpr_write_b32 a143, v47
    v_accvgpr_read_b32 v44, a144
    v_accvgpr_read_b32 v45, a145
    v_accvgpr_read_b32 v46, a146
    v_accvgpr_read_b32 v47, a147
    v_mul_f32 v44, v44, v40
    v_mul_f32 v45, v45, v40
    v_mul_f32 v46, v46, v40
    v_mul_f32 v47, v47, v40
    v_accvgpr_write_b32 a144, v44
    v_accvgpr_write_b32 a145, v45
    v_accvgpr_write_b32 a146, v46
    v_accvgpr_write_b32 a147, v47
    v_accvgpr_read_b32 v44, a148
    v_accvgpr_read_b32 v45, a149
    v_accvgpr_read_b32 v46, a150
    v_accvgpr_read_b32 v47, a151
    v_mul_f32 v44, v44, v41
    v_mul_f32 v45, v45, v41
    v_mul_f32 v46, v46, v41
    v_mul_f32 v47, v47, v41
    v_accvgpr_write_b32 a148, v44
    v_accvgpr_write_b32 a149, v45
    v_accvgpr_write_b32 a150, v46
    v_accvgpr_write_b32 a151, v47
    v_accvgpr_read_b32 v44, a152
    v_accvgpr_read_b32 v45, a153
    v_accvgpr_read_b32 v46, a154
    v_accvgpr_read_b32 v47, a155
    v_mul_f32 v44, v44, v42
    v_mul_f32 v45, v45, v42
    v_mul_f32 v46, v46, v42
    v_mul_f32 v47, v47, v42
    v_accvgpr_write_b32 a152, v44
    v_accvgpr_write_b32 a153, v45
    v_accvgpr_write_b32 a154, v46
    v_accvgpr_write_b32 a155, v47
    v_accvgpr_read_b32 v44, a156
    v_accvgpr_read_b32 v45, a157
    v_accvgpr_read_b32 v46, a158
    v_accvgpr_read_b32 v47, a159
    v_mul_f32 v44, v44, v43
    v_mul_f32 v45, v45, v43
    v_mul_f32 v46, v46, v43
    v_mul_f32 v47, v47, v43
    v_accvgpr_write_b32 a156, v44
    v_accvgpr_write_b32 a157, v45
    v_accvgpr_write_b32 a158, v46
    v_accvgpr_write_b32 a159, v47
    v_accvgpr_read_b32 v44, a160
    v_accvgpr_read_b32 v45, a161
    v_accvgpr_read_b32 v46, a162
    v_accvgpr_read_b32 v47, a163
    v_mul_f32 v44, v44, v40
    v_mul_f32 v45, v45, v40
    v_mul_f32 v46, v46, v40
    v_mul_f32 v47, v47, v40
    v_accvgpr_write_b32 a160, v44
    v_accvgpr_write_b32 a161, v45
    v_accvgpr_write_b32 a162, v46
    v_accvgpr_write_b32 a163, v47
    v_accvgpr_read_b32 v44, a164
    v_accvgpr_read_b32 v45, a165
    v_accvgpr_read_b32 v46, a166
    v_accvgpr_read_b32 v47, a167
    v_mul_f32 v44, v44, v41
    v_mul_f32 v45, v45, v41
    v_mul_f32 v46, v46, v41
    v_mul_f32 v47, v47, v41
    v_accvgpr_write_b32 a164, v44
    v_accvgpr_write_b32 a165, v45
    v_accvgpr_write_b32 a166, v46
    v_accvgpr_write_b32 a167, v47
    v_accvgpr_read_b32 v44, a168
    v_accvgpr_read_b32 v45, a169
    v_accvgpr_read_b32 v46, a170
    v_accvgpr_read_b32 v47, a171
    v_mul_f32 v44, v44, v42
    v_mul_f32 v45, v45, v42
    v_mul_f32 v46, v46, v42
    v_mul_f32 v47, v47, v42
    v_accvgpr_write_b32 a168, v44
    v_accvgpr_write_b32 a169, v45
    v_accvgpr_write_b32 a170, v46
    v_accvgpr_write_b32 a171, v47
    v_accvgpr_read_b32 v44, a172
    v_accvgpr_read_b32 v45, a173
    v_accvgpr_read_b32 v46, a174
    v_accvgpr_read_b32 v47, a175
    v_mul_f32 v44, v44, v43
    v_mul_f32 v45, v45, v43
    v_mul_f32 v46, v46, v43
    v_mul_f32 v47, v47, v43
    v_accvgpr_write_b32 a172, v44
    v_accvgpr_write_b32 a173, v45
    v_accvgpr_write_b32 a174, v46
    v_accvgpr_write_b32 a175, v47
    v_accvgpr_read_b32 v44, a176
    v_accvgpr_read_b32 v45, a177
    v_accvgpr_read_b32 v46, a178
    v_accvgpr_read_b32 v47, a179
    v_mul_f32 v44, v44, v40
    v_mul_f32 v45, v45, v40
    v_mul_f32 v46, v46, v40
    v_mul_f32 v47, v47, v40
    v_accvgpr_write_b32 a176, v44
    v_accvgpr_write_b32 a177, v45
    v_accvgpr_write_b32 a178, v46
    v_accvgpr_write_b32 a179, v47
    v_accvgpr_read_b32 v44, a180
    v_accvgpr_read_b32 v45, a181
    v_accvgpr_read_b32 v46, a182
    v_accvgpr_read_b32 v47, a183
    v_mul_f32 v44, v44, v41
    v_mul_f32 v45, v45, v41
    v_mul_f32 v46, v46, v41
    v_mul_f32 v47, v47, v41
    v_accvgpr_write_b32 a180, v44
    v_accvgpr_write_b32 a181, v45
    v_accvgpr_write_b32 a182, v46
    v_accvgpr_write_b32 a183, v47
    v_accvgpr_read_b32 v44, a184
    v_accvgpr_read_b32 v45, a185
    v_accvgpr_read_b32 v46, a186
    v_accvgpr_read_b32 v47, a187
    v_mul_f32 v44, v44, v42
    v_mul_f32 v45, v45, v42
    v_mul_f32 v46, v46, v42
    v_mul_f32 v47, v47, v42
    v_accvgpr_write_b32 a184, v44
    v_accvgpr_write_b32 a185, v45
    v_accvgpr_write_b32 a186, v46
    v_accvgpr_write_b32 a187, v47
    v_accvgpr_read_b32 v44, a188
    v_accvgpr_read_b32 v45, a189
    v_accvgpr_read_b32 v46, a190
    v_accvgpr_read_b32 v47, a191
    v_mul_f32 v44, v44, v43
    v_mul_f32 v45, v45, v43
    v_mul_f32 v46, v46, v43
    v_mul_f32 v47, v47, v43
    v_accvgpr_write_b32 a188, v44
    v_accvgpr_write_b32 a189, v45
    v_accvgpr_write_b32 a190, v46
    v_accvgpr_write_b32 a191, v47
    v_accvgpr_read_b32 v44, a192
    v_accvgpr_read_b32 v45, a193
    v_accvgpr_read_b32 v46, a194
    v_accvgpr_read_b32 v47, a195
    v_mul_f32 v44, v44, v40
    v_mul_f32 v45, v45, v40
    v_mul_f32 v46, v46, v40
    v_mul_f32 v47, v47, v40
    v_accvgpr_write_b32 a192, v44
    v_accvgpr_write_b32 a193, v45
    v_accvgpr_write_b32 a194, v46
    v_accvgpr_write_b32 a195, v47
    v_accvgpr_read_b32 v44, a196
    v_accvgpr_read_b32 v45, a197
    v_accvgpr_read_b32 v46, a198
    v_accvgpr_read_b32 v47, a199
    v_mul_f32 v44, v44, v41
    v_mul_f32 v45, v45, v41
    v_mul_f32 v46, v46, v41
    v_mul_f32 v47, v47, v41
    v_accvgpr_write_b32 a196, v44
    v_accvgpr_write_b32 a197, v45
    v_accvgpr_write_b32 a198, v46
    v_accvgpr_write_b32 a199, v47
    v_accvgpr_read_b32 v44, a200
    v_accvgpr_read_b32 v45, a201
    v_accvgpr_read_b32 v46, a202
    v_accvgpr_read_b32 v47, a203
    v_mul_f32 v44, v44, v42
    v_mul_f32 v45, v45, v42
    v_mul_f32 v46, v46, v42
    v_mul_f32 v47, v47, v42
    v_accvgpr_write_b32 a200, v44
    v_accvgpr_write_b32 a201, v45
    v_accvgpr_write_b32 a202, v46
    v_accvgpr_write_b32 a203, v47
    v_accvgpr_read_b32 v44, a204
    v_accvgpr_read_b32 v45, a205
    v_accvgpr_read_b32 v46, a206
    v_accvgpr_read_b32 v47, a207
    v_mul_f32 v44, v44, v43
    v_mul_f32 v45, v45, v43
    v_mul_f32 v46, v46, v43
    v_mul_f32 v47, v47, v43
    v_accvgpr_write_b32 a204, v44
    v_accvgpr_write_b32 a205, v45
    v_accvgpr_write_b32 a206, v46
    v_accvgpr_write_b32 a207, v47
    v_accvgpr_read_b32 v44, a208
    v_accvgpr_read_b32 v45, a209
    v_accvgpr_read_b32 v46, a210
    v_accvgpr_read_b32 v47, a211
    v_mul_f32 v44, v44, v40
    v_mul_f32 v45, v45, v40
    v_mul_f32 v46, v46, v40
    v_mul_f32 v47, v47, v40
    v_accvgpr_write_b32 a208, v44
    v_accvgpr_write_b32 a209, v45
    v_accvgpr_write_b32 a210, v46
    v_accvgpr_write_b32 a211, v47
    v_accvgpr_read_b32 v44, a212
    v_accvgpr_read_b32 v45, a213
    v_accvgpr_read_b32 v46, a214
    v_accvgpr_read_b32 v47, a215
    v_mul_f32 v44, v44, v41
    v_mul_f32 v45, v45, v41
    v_mul_f32 v46, v46, v41
    v_mul_f32 v47, v47, v41
    v_accvgpr_write_b32 a212, v44
    v_accvgpr_write_b32 a213, v45
    v_accvgpr_write_b32 a214, v46
    v_accvgpr_write_b32 a215, v47
    v_accvgpr_read_b32 v44, a216
    v_accvgpr_read_b32 v45, a217
    v_accvgpr_read_b32 v46, a218
    v_accvgpr_read_b32 v47, a219
    v_mul_f32 v44, v44, v42
    v_mul_f32 v45, v45, v42
    v_mul_f32 v46, v46, v42
    v_mul_f32 v47, v47, v42
    v_accvgpr_write_b32 a216, v44
    v_accvgpr_write_b32 a217, v45
    v_accvgpr_write_b32 a218, v46
    v_accvgpr_write_b32 a219, v47
    v_accvgpr_read_b32 v44, a220
    v_accvgpr_read_b32 v45, a221
    v_accvgpr_read_b32 v46, a222
    v_accvgpr_read_b32 v47, a223
    v_mul_f32 v44, v44, v43
    v_mul_f32 v45, v45, v43
    v_mul_f32 v46, v46, v43
    v_mul_f32 v47, v47, v43
    v_accvgpr_write_b32 a220, v44
    v_accvgpr_write_b32 a221, v45
    v_accvgpr_write_b32 a222, v46
    v_accvgpr_write_b32 a223, v47
    v_accvgpr_read_b32 v44, a224
    v_accvgpr_read_b32 v45, a225
    v_accvgpr_read_b32 v46, a226
    v_accvgpr_read_b32 v47, a227
    v_mul_f32 v44, v44, v40
    v_mul_f32 v45, v45, v40
    v_mul_f32 v46, v46, v40
    v_mul_f32 v47, v47, v40
    v_accvgpr_write_b32 a224, v44
    v_accvgpr_write_b32 a225, v45
    v_accvgpr_write_b32 a226, v46
    v_accvgpr_write_b32 a227, v47
    v_accvgpr_read_b32 v44, a228
    v_accvgpr_read_b32 v45, a229
    v_accvgpr_read_b32 v46, a230
    v_accvgpr_read_b32 v47, a231
    v_mul_f32 v44, v44, v41
    v_mul_f32 v45, v45, v41
    v_mul_f32 v46, v46, v41
    v_mul_f32 v47, v47, v41
    v_accvgpr_write_b32 a228, v44
    v_accvgpr_write_b32 a229, v45
    v_accvgpr_write_b32 a230, v46
    v_accvgpr_write_b32 a231, v47
    v_accvgpr_read_b32 v44, a232
    v_accvgpr_read_b32 v45, a233
    v_accvgpr_read_b32 v46, a234
    v_accvgpr_read_b32 v47, a235
    v_mul_f32 v44, v44, v42
    v_mul_f32 v45, v45, v42
    v_mul_f32 v46, v46, v42
    v_mul_f32 v47, v47, v42
    v_accvgpr_write_b32 a232, v44
    v_accvgpr_write_b32 a233, v45
    v_accvgpr_write_b32 a234, v46
    v_accvgpr_write_b32 a235, v47
    v_accvgpr_read_b32 v44, a236
    v_accvgpr_read_b32 v45, a237
    v_accvgpr_read_b32 v46, a238
    v_accvgpr_read_b32 v47, a239
    v_mul_f32 v44, v44, v43
    v_mul_f32 v45, v45, v43
    v_mul_f32 v46, v46, v43
    v_mul_f32 v47, v47, v43
    v_accvgpr_write_b32 a236, v44
    v_accvgpr_write_b32 a237, v45
    v_accvgpr_write_b32 a238, v46
    v_accvgpr_write_b32 a239, v47
    v_accvgpr_read_b32 v44, a240
    v_accvgpr_read_b32 v45, a241
    v_accvgpr_read_b32 v46, a242
    v_accvgpr_read_b32 v47, a243
    v_mul_f32 v44, v44, v40
    v_mul_f32 v45, v45, v40
    v_mul_f32 v46, v46, v40
    v_mul_f32 v47, v47, v40
    v_accvgpr_write_b32 a240, v44
    v_accvgpr_write_b32 a241, v45
    v_accvgpr_write_b32 a242, v46
    v_accvgpr_write_b32 a243, v47
    v_accvgpr_read_b32 v44, a244
    v_accvgpr_read_b32 v45, a245
    v_accvgpr_read_b32 v46, a246
    v_accvgpr_read_b32 v47, a247
    v_mul_f32 v44, v44, v41
    v_mul_f32 v45, v45, v41
    v_mul_f32 v46, v46, v41
    v_mul_f32 v47, v47, v41
    v_accvgpr_write_b32 a244, v44
    v_accvgpr_write_b32 a245, v45
    v_accvgpr_write_b32 a246, v46
    v_accvgpr_write_b32 a247, v47
    v_accvgpr_read_b32 v44, a248
    v_accvgpr_read_b32 v45, a249
    v_accvgpr_read_b32 v46, a250
    v_accvgpr_read_b32 v47, a251
    v_mul_f32 v44, v44, v42
    v_mul_f32 v45, v45, v42
    v_mul_f32 v46, v46, v42
    v_mul_f32 v47, v47, v42
    v_accvgpr_write_b32 a248, v44
    v_accvgpr_write_b32 a249, v45
    v_accvgpr_write_b32 a250, v46
    v_accvgpr_write_b32 a251, v47
    v_accvgpr_read_b32 v44, a252
    v_accvgpr_read_b32 v45, a253
    v_accvgpr_read_b32 v46, a254
    v_accvgpr_read_b32 v47, a255
    v_mul_f32 v44, v44, v43
    v_mul_f32 v45, v45, v43
    v_mul_f32 v46, v46, v43
    v_mul_f32 v47, v47, v43
    v_accvgpr_write_b32 a252, v44
    v_accvgpr_write_b32 a253, v45
    v_accvgpr_write_b32 a254, v46
    v_accvgpr_write_b32 a255, v47
    s_nop 3
    s_setpc_b64 s[40:41]
L_end:
.section .rodata,"a"
.p2align 6
.amdhsa_kernel recurrent_scan__mha_block_cached__glu_gated_swiglu__prompt_kernel
  .amdhsa_next_free_vgpr 512
  .amdhsa_next_free_sgpr 102
  .amdhsa_accum_offset 256
  .amdhsa_group_segment_fixed_size 0
  .amdhsa_kernarg_size 96
  .amdhsa_user_sgpr_count 2
  .amdhsa_user_sgpr_kernarg_segment_ptr 1
  .amdhsa_system_sgpr_workgroup_id_x 1
.end_amdhsa_kernel
```
